```python
import torch

def _softmax(x, axis=-1):
    return torch.softmax(x, dim=axis)
def _gelu(x):
    return torch.nn.functional.gelu(x, approximate="tanh")
def _silu(x):
    return torch.nn.functional.silu(x)
def _sigmoid(x):
    return torch.sigmoid(x)
def _layernorm(x, axis=-1, eps=1e-5):
    m = x.mean(dim=axis, keepdim=True)
    v = x.var(dim=axis, keepdim=True, unbiased=False)
    return (x - m) / torch.sqrt(v + eps)
def _scatter_add(tgt, idx, src, axis=0):
    return tgt.clone().index_add_(axis, idx, src)
def _segment_sum(src, seg, n):
    out = torch.zeros((n,) + src.shape[1:], dtype=src.dtype)
    return out.index_add_(0, seg, src)
def _pad(x, pw):
    flat = tuple(v for pair in reversed(pw) for v in pair)
    return torch.nn.functional.pad(x, flat)

kernel_name = 'recurrent_scan__mha_block_cached__swiglu_ffn__prompt'

def setup_inputs():

    _w = (lambda a: (lambda t: t.to(torch.bfloat16) if t.is_floating_point() else t)(torch.as_tensor(a)))
    def _A_setup():
        B, Sq, D = 1, 2048, 576
        H, Sk, Dh = 32, 2048, 128
        return {
            "x": _w((lambda *s: torch.randn(*s, dtype=torch.bfloat16) * 0.05)(B, Sq, D)),
            "k_cache": _w((lambda *s: torch.randn(*s, dtype=torch.bfloat16) * 0.8)(B, H, Sk, Dh)),
            "v_cache": _w((lambda *s: torch.randn(*s, dtype=torch.bfloat16) * 0.2)(B, H, Sk, Dh)),
            "wq": _w((lambda *s: torch.randn(*s, dtype=torch.bfloat16) * 0.8)(D, H * Dh) * (D ** -0.5)),
            "wo": _w((lambda *s: torch.randn(*s, dtype=torch.bfloat16) * 0.2)(H * Dh, D) * ((H * Dh) ** -0.5)),
        }
    _A_in = _A_setup()

    def _B_setup():
        B, S, D, F = 1, 2048, 576, 4608
        return {
            "x": _w((lambda *s: torch.randn(*s, dtype=torch.bfloat16) * 0.05)(B, S, D)),
            "w_gate": _w((lambda *s: torch.randn(*s, dtype=torch.bfloat16) * 0.1)(D, F)),
            "w_up": _w((lambda *s: torch.randn(*s, dtype=torch.bfloat16) * 0.1)(D, F)),
            "w_down": _w((lambda *s: torch.randn(*s, dtype=torch.bfloat16) * 0.1)(F, D)),
        }
    _B_in = _B_setup()

    return {
        "A_x": _A_in["x"],
        "A_k_cache": _A_in["k_cache"],
        "A_v_cache": _A_in["v_cache"],
        "A_wq": _A_in["wq"],
        "A_wo": _A_in["wo"],
        "B_x": _B_in["x"],
        "B_w_gate": _B_in["w_gate"],
        "B_w_up": _B_in["w_up"],
        "B_w_down": _B_in["w_down"],
    }

def reference(A_x, A_k_cache, A_v_cache, A_wq, A_wo, B_x, B_w_gate, B_w_up, B_w_down):
    def _A_ref(x, k_cache, v_cache, wq, wo):
        B, Sq, D = x.shape
        H, Dh = 32, 128
        q = (lambda x, *d: x.permute(*d))((x @ wq).reshape(B, Sq, H, Dh), 0, 2, 1, 3)
        scores = torch.einsum("bhqd,bhkd->bhqk", q, k_cache) * (Dh ** -0.5)
        p = _softmax(scores, axis=-1)
        o = torch.einsum("bhqk,bhkd->bhqd", p, v_cache)
        return (lambda x, *d: x.permute(*d))(o, 0, 2, 1, 3).reshape(B, Sq, H * Dh) @ wo

    def _B_ref(x, w_gate, w_up, w_down):
        g = _silu(x @ w_gate)
        u = x @ w_up
        return (g * u) @ w_down

    x = A_x
    xn = _layernorm(x, axis=-1)
    s = _A_ref(xn, A_k_cache, A_v_cache, A_wq, A_wo)
    g = _silu(_B_ref(xn, B_w_gate, B_w_up, B_w_down))
    return x + s * g
```

```asm
; @launch grid=(256,1,1) block=(256,1,1) lds=163840
.amdgcn_target "amdgcn-amd-amdhsa--gfx950"
.text
.globl recurrent_scan__mha_block_cached__swiglu_ffn__prompt_kernel
.p2align 8
.type recurrent_scan__mha_block_cached__swiglu_ffn__prompt_kernel,@function
recurrent_scan__mha_block_cached__swiglu_ffn__prompt_kernel:
 s_cmp_ge_u32 s2, 256
 s_cbranch_scc1 L_main_end
 s_load_dwordx2 s[8:9], s[0:1], 0
 s_load_dwordx2 s[10:11], s[0:1], 80
 s_load_dwordx4 s[48:51], s[0:1], 48
 s_load_dwordx2 s[46:47], s[0:1], 88
 s_load_dwordx4 s[4:7], s[0:1], 8
 s_load_dwordx2 s[44:45], s[0:1], 24
 s_load_dwordx2 s[98:99], s[0:1], 32
 s_load_dwordx2 s[92:93], s[0:1], 64
 v_lshrrev_b32 v2, 6, v0
 v_and_b32 v1, 63, v0
 v_readfirstlane_b32 s52, v2
 v_lshlrev_b32 v2, 4, v1
 s_and_b32 s55, s2, 7
 s_lshr_b32 s56, s2, 3
 s_and_b32 s54, s56, 7
 s_lshr_b32 s56, s56, 3
 s_lshl2_add_u32 s53, s55, s56
 v_and_b32 v10, 7, v1
 v_lshrrev_b32 v11, 3, v1
 v_mul_u32_u24 v8, 1152, v10
 v_lshl_add_u32 v6, v11, 4, v8
 s_lshl_b32 s55, s54, 5
 s_add_u32 s55, s55, s53
 s_mul_i32 s56, s55, 9216
 s_lshl_b32 s57, s52, 8
 s_add_u32 s57, s57, s56
 s_waitcnt lgkmcnt(0)
 s_mov_b32 s24, s8
 s_mov_b32 s25, s9
 s_mov_b32 s26, 2359296
 s_mov_b32 s27, 0x20000
 buffer_load_dword v112, v8, s[24:27], s56 offen
 buffer_load_dwordx4 v[116:119], v6, s[24:27], s57 offen offset:0
 buffer_load_dwordx4 v[120:123], v6, s[24:27], s57 offen offset:128
 buffer_load_dwordx4 v[124:127], v6, s[24:27], s57 offen offset:256
 v_lshlrev_b32 v7, 8, v11
 v_lshl_add_u32 v7, v10, 4, v7
 v_lshlrev_b32 v8, 5, v10
 s_lshl_b32 s56, s52, 3
 v_add_u32 v9, s56, v8
 s_lshr_b32 s77, s55, 1
 s_mul_i32 s77, s77, 18432
 s_and_b32 s55, s55, 1
 s_lshl_b32 s55, s55, 7
 s_add_u32 s77, s77, s55
 s_lshl_b32 s55, s52, 12
 s_add_u32 s77, s77, s55
 s_getpc_b64 s[20:21]
L_cpf:
 s_mov_b32 s22, L_slow-L_cpf
 s_mov_b32 s23, 0x20000
 s_lshr_b32 s55, s2, 3
 s_lshl2_add_u32 s55, s55, s52
 s_mul_i32 s55, s55, 896
 v_lshlrev_b32 v10, 7, v1
 s_mov_b64 exec, 0x7f
 buffer_load_dword v22, v10, s[20:23], s55 offen
 s_mov_b64 exec, -1
 s_mov_b32 s32, s10
 s_mov_b32 s33, s11
 s_mov_b32 s34, 256
 s_mov_b32 s35, 0x20000
 s_mov_b32 s28, s46
 s_mov_b32 s29, s47
 s_mov_b32 s30, 2359296
 s_mov_b32 s31, 0x20000
 s_mov_b32 s55, s54
 s_sub_u32 s56, s55, 6
 s_cmp_ge_u32 s55, 6
 s_cselect_b32 s55, s56, s55
 s_mul_i32 s86, s55, 3072
 s_mul_i32 s80, s55, 884736
 s_add_u32 s55, s55, 1
 s_sub_u32 s56, s55, 6
 s_cmp_ge_u32 s55, 6
 s_cselect_b32 s55, s56, s55
 s_mul_i32 s87, s55, 3072
 s_mul_i32 s81, s55, 884736
 s_add_u32 s55, s55, 1
 s_sub_u32 s56, s55, 6
 s_cmp_ge_u32 s55, 6
 s_cselect_b32 s55, s56, s55
 s_mul_i32 s88, s55, 3072
 s_mul_i32 s82, s55, 884736
 s_add_u32 s55, s55, 1
 s_sub_u32 s56, s55, 6
 s_cmp_ge_u32 s55, 6
 s_cselect_b32 s55, s56, s55
 s_mul_i32 s89, s55, 3072
 s_mul_i32 s83, s55, 884736
 s_add_u32 s55, s55, 1
 s_sub_u32 s56, s55, 6
 s_cmp_ge_u32 s55, 6
 s_cselect_b32 s55, s56, s55
 s_mul_i32 s90, s55, 3072
 s_mul_i32 s84, s55, 884736
 s_add_u32 s55, s55, 1
 s_sub_u32 s56, s55, 6
 s_cmp_ge_u32 s55, 6
 s_cselect_b32 s55, s56, s55
 s_mul_i32 s91, s55, 3072
 s_mul_i32 s85, s55, 884736
 s_lshl_b32 s70, s52, 10
 v_lshrrev_b32 v10, 3, v1
 v_bfe_u32 v11, v1, 4, 1
 s_and_b32 s55, s52, 1
 s_lshl_b32 s56, s55, 1
 v_or_b32 v11, s56, v11
 v_lshlrev_b32 v11, 1, v11
 v_and_b32 v12, 7, v1
 v_xor_b32 v11, v11, v12
 v_lshlrev_b32 v11, 4, v11
 s_lshl_b32 s56, s52, 3
 v_add_u32 v10, s56, v10
 v_mul_u32_u24 v3, 9216, v10
 v_add_u32 v3, v3, v11
 v_lshl_add_u32 v5, v10, 13, v11
 s_lshl_b32 s55, s53, 8
 s_lshl_b32 s56, s54, 4
 s_lshl2_add_u32 s59, s52, s56
 s_mul_i32 s57, s59, 18432
 s_waitcnt lgkmcnt(0)
 s_add_u32 s12, s48, s55
 s_addc_u32 s13, s49, 0
 s_sub_u32 s14, 5308416, s55
 s_mov_b32 s15, 0x20000
 s_add_u32 s16, s50, s55
 s_addc_u32 s17, s51, 0
 s_sub_u32 s18, 5308416, s55
 s_mov_b32 s19, 0x20000
 s_add_u32 s8, s46, s57
 s_addc_u32 s9, s47, 0
 s_mov_b32 s10, 73728
 s_mov_b32 s11, 0x20000
 s_add_u32 m0, s70, 90112
 s_add_u32 s58, s80, 0
 buffer_load_dwordx4 v3, s[12:15], s58 offen nt lds
 s_add_u32 m0, s70, 94208
 s_add_u32 s58, s80, 294912
 buffer_load_dwordx4 v3, s[12:15], s58 offen nt lds
 s_add_u32 m0, s70, 98304
 s_add_u32 s58, s80, 589824
 buffer_load_dwordx4 v3, s[12:15], s58 offen nt lds
 s_mov_b32 s73, 0xffff0000
 s_cmp_eq_u32 s52, 3
 s_cselect_b32 s56, 1.0, 0
 s_cselect_b32 s55, 0, 0x7f000000
 s_add_u32 s55, s55, s77
 s_add_u32 s55, s55, 4096
 s_waitcnt vmcnt(7)
 v_lshlrev_b32 v112, 16, v112
 v_mov_b32 v113, v112
 s_waitcnt vmcnt(6)
 v_lshlrev_b32 v128, 16, v116
 v_and_b32 v129, s73, v116
 v_lshlrev_b32 v130, 16, v117
 v_and_b32 v131, s73, v117
 v_lshlrev_b32 v132, 16, v118
 v_and_b32 v133, s73, v118
 v_lshlrev_b32 v134, 16, v119
 v_and_b32 v135, s73, v119
 s_waitcnt vmcnt(5)
 v_lshlrev_b32 v136, 16, v120
 v_and_b32 v137, s73, v120
 v_lshlrev_b32 v138, 16, v121
 v_and_b32 v139, s73, v121
 v_lshlrev_b32 v140, 16, v122
 v_and_b32 v141, s73, v122
 v_lshlrev_b32 v142, 16, v123
 v_and_b32 v143, s73, v123
 s_waitcnt vmcnt(4)
 v_lshlrev_b32 v144, 16, v124
 v_and_b32 v145, s73, v124
 v_lshlrev_b32 v146, 16, v125
 v_and_b32 v147, s73, v125
 v_lshlrev_b32 v148, 16, v126
 v_and_b32 v149, s73, v126
 v_lshlrev_b32 v150, 16, v127
 v_and_b32 v151, s73, v127
 v_pk_add_f32 v[168:169], v[128:129], v[112:113] neg_lo:[0,1] neg_hi:[0,1]
 v_pk_mul_f32 v[172:173], v[168:169], v[168:169]
 v_pk_add_f32 v[162:163], v[130:131], v[112:113] neg_lo:[0,1] neg_hi:[0,1]
 v_pk_fma_f32 v[172:173], v[162:163], v[162:163], v[172:173]
 v_pk_add_f32 v[168:169], v[168:169], v[162:163]
 v_pk_add_f32 v[164:165], v[132:133], v[112:113] neg_lo:[0,1] neg_hi:[0,1]
 v_pk_fma_f32 v[172:173], v[164:165], v[164:165], v[172:173]
 v_pk_add_f32 v[168:169], v[168:169], v[164:165]
 v_pk_add_f32 v[166:167], v[134:135], v[112:113] neg_lo:[0,1] neg_hi:[0,1]
 v_pk_fma_f32 v[172:173], v[166:167], v[166:167], v[172:173]
 v_pk_add_f32 v[168:169], v[168:169], v[166:167]
 v_pk_add_f32 v[160:161], v[136:137], v[112:113] neg_lo:[0,1] neg_hi:[0,1]
 v_pk_fma_f32 v[172:173], v[160:161], v[160:161], v[172:173]
 v_pk_add_f32 v[168:169], v[168:169], v[160:161]
 v_pk_add_f32 v[162:163], v[138:139], v[112:113] neg_lo:[0,1] neg_hi:[0,1]
 v_pk_fma_f32 v[172:173], v[162:163], v[162:163], v[172:173]
 v_pk_add_f32 v[168:169], v[168:169], v[162:163]
 v_pk_add_f32 v[164:165], v[140:141], v[112:113] neg_lo:[0,1] neg_hi:[0,1]
 v_pk_fma_f32 v[172:173], v[164:165], v[164:165], v[172:173]
 v_pk_add_f32 v[168:169], v[168:169], v[164:165]
 v_pk_add_f32 v[166:167], v[142:143], v[112:113] neg_lo:[0,1] neg_hi:[0,1]
 v_pk_fma_f32 v[172:173], v[166:167], v[166:167], v[172:173]
 v_pk_add_f32 v[168:169], v[168:169], v[166:167]
 v_pk_add_f32 v[170:171], v[144:145], v[112:113] neg_lo:[0,1] neg_hi:[0,1]
 v_pk_mul_f32 v[174:175], v[170:171], v[170:171]
 v_pk_add_f32 v[162:163], v[146:147], v[112:113] neg_lo:[0,1] neg_hi:[0,1]
 v_pk_fma_f32 v[174:175], v[162:163], v[162:163], v[174:175]
 v_pk_add_f32 v[170:171], v[170:171], v[162:163]
 v_pk_add_f32 v[164:165], v[148:149], v[112:113] neg_lo:[0,1] neg_hi:[0,1]
 v_pk_fma_f32 v[174:175], v[164:165], v[164:165], v[174:175]
 v_pk_add_f32 v[170:171], v[170:171], v[164:165]
 v_pk_add_f32 v[166:167], v[150:151], v[112:113] neg_lo:[0,1] neg_hi:[0,1]
 v_pk_fma_f32 v[174:175], v[166:167], v[166:167], v[174:175]
 v_pk_add_f32 v[170:171], v[170:171], v[166:167]
 v_add_f32 v10, v168, v169
 v_add_f32 v11, v172, v173
 v_add_f32 v12, v170, v171
 v_add_f32 v13, v174, v175
 v_fmac_f32 v10, s56, v12
 v_fmac_f32 v11, s56, v13
 s_nop 0
 v_add_f32_dpp v10, v10, v10 row_ror:8 row_mask:0xf bank_mask:0xf
 v_add_f32_dpp v11, v11, v11 row_ror:8 row_mask:0xf bank_mask:0xf
 v_mov_b32 v12, v10
 v_mov_b32 v13, v11
 s_nop 0
 v_permlane16_swap_b32 v12, v10
 v_permlane16_swap_b32 v13, v11
 v_add_f32 v10, v10, v12
 v_add_f32 v11, v11, v13
 v_mov_b32 v12, v10
 v_mov_b32 v13, v11
 s_nop 0
 v_permlane32_swap_b32 v12, v10
 v_permlane32_swap_b32 v13, v11
 v_add_f32 v10, v10, v12
 v_add_f32 v11, v11, v13
 ds_write_b64 v9, v[10:11]
 s_waitcnt lgkmcnt(0)
 s_barrier
 ds_read_b128 v[160:163], v8
 ds_read_b128 v[164:167], v8 offset:16
 s_waitcnt lgkmcnt(1)
 v_add_f32 v10, v160, v162
 v_add_f32 v11, v161, v163
 s_waitcnt lgkmcnt(0)
 v_add_f32 v12, v164, v166
 v_add_f32 v13, v165, v167
 v_add_f32 v10, v10, v12
 v_add_f32 v11, v11, v13
 v_mul_f32 v10, 0x3ae38e39, v10
 v_mul_f32 v11, 0x3ae38e39, v11
 v_add_f32 v14, v112, v10
 v_fma_f32 v16, -v10, v10, v11
 v_max_f32 v16, 0, v16
 v_cvt_pk_bf16_f32 v18, v14, v16
 v_lshlrev_b32 v14, 16, v18
 v_and_b32 v16, s73, v18
 v_add_f32 v16, 0x3727c5ac, v16
 v_cvt_pk_bf16_f32 v16, v16, v16
 v_and_b32 v16, s73, v16
 v_sqrt_f32 v16, v16
 v_mov_b32 v15, v14
 v_cvt_pk_bf16_f32 v16, v16, v16
 v_and_b32 v16, s73, v16
 v_rcp_f32 v16, v16
 v_pk_add_f32 v[128:129], v[128:129], v[14:15] neg_lo:[0,1] neg_hi:[0,1]
 v_pk_add_f32 v[130:131], v[130:131], v[14:15] neg_lo:[0,1] neg_hi:[0,1]
 v_pk_add_f32 v[132:133], v[132:133], v[14:15] neg_lo:[0,1] neg_hi:[0,1]
 v_pk_add_f32 v[134:135], v[134:135], v[14:15] neg_lo:[0,1] neg_hi:[0,1]
 v_mov_b32 v17, v16
 v_pk_mul_f32 v[128:129], v[128:129], v[16:17]
 v_pk_mul_f32 v[130:131], v[130:131], v[16:17]
 v_pk_mul_f32 v[132:133], v[132:133], v[16:17]
 v_pk_mul_f32 v[134:135], v[134:135], v[16:17]
 v_cvt_pk_bf16_f32 v116, v128, v129
 v_cvt_pk_bf16_f32 v117, v130, v131
 v_cvt_pk_bf16_f32 v118, v132, v133
 v_cvt_pk_bf16_f32 v119, v134, v135
 buffer_store_dwordx4 v[116:119], v7, s[28:31], s77 offen offset:0 sc1
 v_pk_add_f32 v[136:137], v[136:137], v[14:15] neg_lo:[0,1] neg_hi:[0,1]
 v_pk_add_f32 v[138:139], v[138:139], v[14:15] neg_lo:[0,1] neg_hi:[0,1]
 v_pk_add_f32 v[140:141], v[140:141], v[14:15] neg_lo:[0,1] neg_hi:[0,1]
 v_pk_add_f32 v[142:143], v[142:143], v[14:15] neg_lo:[0,1] neg_hi:[0,1]
 v_pk_mul_f32 v[136:137], v[136:137], v[16:17]
 v_pk_mul_f32 v[138:139], v[138:139], v[16:17]
 v_pk_mul_f32 v[140:141], v[140:141], v[16:17]
 v_pk_mul_f32 v[142:143], v[142:143], v[16:17]
 v_cvt_pk_bf16_f32 v120, v136, v137
 v_cvt_pk_bf16_f32 v121, v138, v139
 v_cvt_pk_bf16_f32 v122, v140, v141
 v_cvt_pk_bf16_f32 v123, v142, v143
 buffer_store_dwordx4 v[120:123], v7, s[28:31], s77 offen offset:2048 sc1
 v_pk_add_f32 v[144:145], v[144:145], v[14:15] neg_lo:[0,1] neg_hi:[0,1]
 v_pk_add_f32 v[146:147], v[146:147], v[14:15] neg_lo:[0,1] neg_hi:[0,1]
 v_pk_add_f32 v[148:149], v[148:149], v[14:15] neg_lo:[0,1] neg_hi:[0,1]
 v_pk_add_f32 v[150:151], v[150:151], v[14:15] neg_lo:[0,1] neg_hi:[0,1]
 v_pk_mul_f32 v[144:145], v[144:145], v[16:17]
 v_pk_mul_f32 v[146:147], v[146:147], v[16:17]
 v_pk_mul_f32 v[148:149], v[148:149], v[16:17]
 v_pk_mul_f32 v[150:151], v[150:151], v[16:17]
 v_cvt_pk_bf16_f32 v124, v144, v145
 v_cvt_pk_bf16_f32 v125, v146, v147
 v_cvt_pk_bf16_f32 v126, v148, v149
 v_cvt_pk_bf16_f32 v127, v150, v151
 buffer_store_dwordx4 v[124:127], v7, s[28:31], s55 offen offset:0 sc1
 s_waitcnt vmcnt(0)
 s_barrier
 s_lshl_b32 s77, s54, 5
 s_cmp_lg_u32 s52, 0
 s_cbranch_scc1 L_ln_sent
 v_mov_b32 v10, 1
 s_mov_b64 exec, 1
 buffer_atomic_add v10, off, s[32:35], s77 offset:16 sc1
 s_mov_b64 exec, -1
L_ln_sent:
 s_add_u32 m0, s70, 102400
 s_add_u32 s58, s80, 0
 buffer_load_dwordx4 v3, s[16:19], s58 offen nt lds
 s_add_u32 m0, s70, 106496
 s_add_u32 s58, s80, 294912
 buffer_load_dwordx4 v3, s[16:19], s58 offen nt lds
 s_add_u32 m0, s70, 110592
 s_add_u32 s58, s80, 589824
 buffer_load_dwordx4 v3, s[16:19], s58 offen nt lds
 s_add_u32 m0, s70, 114688
 s_add_u32 s58, s81, 0
 buffer_load_dwordx4 v3, s[12:15], s58 offen nt lds
 s_add_u32 m0, s70, 118784
 s_add_u32 s58, s81, 294912
 buffer_load_dwordx4 v3, s[12:15], s58 offen nt lds
 s_add_u32 m0, s70, 122880
 s_add_u32 s58, s81, 589824
 buffer_load_dwordx4 v3, s[12:15], s58 offen nt lds
 s_add_u32 m0, s70, 126976
 s_add_u32 s58, s81, 0
 buffer_load_dwordx4 v3, s[16:19], s58 offen nt lds
 s_add_u32 m0, s70, 131072
 s_add_u32 s58, s81, 294912
 buffer_load_dwordx4 v3, s[16:19], s58 offen nt lds
 s_add_u32 m0, s70, 135168
 s_add_u32 s58, s81, 589824
 buffer_load_dwordx4 v3, s[16:19], s58 offen nt lds
 s_add_u32 m0, s70, 139264
 s_add_u32 s58, s82, 0
 buffer_load_dwordx4 v3, s[12:15], s58 offen nt lds
 s_add_u32 m0, s70, 143360
 s_add_u32 s58, s82, 294912
 buffer_load_dwordx4 v3, s[12:15], s58 offen nt lds
 s_add_u32 m0, s70, 147456
 s_add_u32 s58, s82, 589824
 buffer_load_dwordx4 v3, s[12:15], s58 offen nt lds
 s_add_u32 m0, s70, 151552
 s_add_u32 s58, s82, 0
 buffer_load_dwordx4 v3, s[16:19], s58 offen nt lds
 s_add_u32 m0, s70, 155648
 s_add_u32 s58, s82, 294912
 buffer_load_dwordx4 v3, s[16:19], s58 offen nt lds
 s_add_u32 m0, s70, 159744
 s_add_u32 s58, s82, 589824
 buffer_load_dwordx4 v3, s[16:19], s58 offen nt lds
 s_lshl_b32 s55, s53, 8
 s_add_u32 s20, s44, s55
 s_addc_u32 s21, s45, 0
 s_sub_u32 s22, 4718592, s55
 s_mov_b32 s23, 0x20000
 s_lshl_b32 s57, s59, 10
 s_add_u32 s76, s46, s57
 s_addc_u32 s78, s47, 0
 s_add_u32 s36, s46, 25165824
 s_addc_u32 s37, s47, 0
 s_add_u32 s36, s36, s57
 s_addc_u32 s37, s37, 0
 s_sub_u32 s38, 16777216, s57
 s_mov_b32 s39, 0x20000
 s_lshl_b32 s57, s53, 19
 s_add_u32 s24, s4, s57
 s_addc_u32 s25, s5, 0
 s_mov_b32 s26, 524288
 s_mov_b32 s27, 0x20000
 s_sub_u32 s6, s6, 16384
 s_subb_u32 s7, s7, 0
 s_add_u32 s28, s6, s57
 s_addc_u32 s29, s7, 0
 s_mov_b32 s30, 540672
 s_mov_b32 s31, 0x20000
 s_lshr_b32 s55, s53, 3
 s_and_b32 s56, s53, 3
 s_lshl2_add_u32 s55, s55, s56
 s_lshl_b32 s57, s55, 17
 s_add_u32 s68, s57, 16777216
 s_lshl_b32 s64, s53, 19
 s_add_u32 s65, s64, 1024
 s_add_u32 s66, s64, 2048
 s_add_u32 s67, s64, 3072
 s_lshl_b32 s55, s55, 6
 s_add_u32 s55, s55, 8192
 s_cmp_ge_u32 s52, 2
 s_cselect_b64 s[44:45], s[50:51], s[48:49]
 s_add_u32 s40, s44, s55
 s_addc_u32 s41, s45, 0
 s_sub_u32 s42, 5308416, s55
 s_mov_b32 s43, 0x20000
 s_add_u32 s48, s46, 44040192
 s_addc_u32 s49, s47, 0
 s_mov_b32 s50, 10027008
 s_mov_b32 s51, 0x20000
 s_mov_b32 s44, s92
 s_mov_b32 s45, s93
 s_mov_b32 s46, 5308416
 s_mov_b32 s47, 0x20000
 s_mov_b32 s4, s98
 s_mov_b32 s5, s99
 s_mov_b32 s6, 4718592
 s_mov_b32 s7, 0x20000
 s_lshl2_add_u32 s55, s2, s52
 s_mul_i32 s56, s55, 7282
 s_lshr_b32 s56, s56, 16
 s_mul_i32 s58, s56, 9
 s_sub_u32 s58, s55, s58
 s_mul_i32 s56, s56, 36864
 s_lshl_b32 s96, s58, 7
 s_add_u32 s96, s96, s56
 s_lshl_b32 s97, s58, 12
 s_add_u32 s97, s97, s56
 s_lshr_b32 s55, s2, 1
 s_lshl2_add_u32 s55, s55, s52
 s_bitcmp1_b32 s2, 0
 s_cselect_b32 s55, s55, 1000
 s_cmp_ge_u32 s55, 272
 s_cselect_b64 s[92:93], s[98:99], s[92:93]
 s_mov_b32 s94, 5308416
 s_cselect_b32 s94, 4718592, s94
 s_mov_b32 s95, 0x20000
 s_cselect_b32 s57, 5308416, 0
 s_cselect_b32 s56, 272, 0
 s_sub_u32 s55, s55, s56
 s_add_u32 s55, s55, 1024
 s_mul_i32 s56, s55, 7282
 s_lshr_b32 s56, s56, 16
 s_mul_i32 s58, s56, 9
 s_sub_u32 s58, s55, s58
 s_mul_i32 s56, s56, 36864
 s_lshl_b32 s98, s58, 7
 s_add_u32 s98, s98, s56
 s_lshl_b32 s99, s58, 12
 s_add_u32 s99, s99, s56
 s_add_u32 s99, s99, s57
 s_lshl_b32 s79, s52, 13
 s_add_u32 s79, s79, 131072
 s_lshl_b32 s72, s52, 12
 s_mul_i32 s71, s52, 3072
 s_mov_b32 s73, 0xffff0000
 s_mov_b32 s74, 0xbfb8aa3b
 s_mov_b32 s75, 0x3e0293ee
 v_lshrrev_b32 v10, 2, v1
 v_bfe_u32 v11, v1, 5, 1
 v_lshlrev_b32 v11, 1, v11
 v_and_b32 v12, 3, v1
 v_xor_b32 v11, v11, v12
 s_and_b32 s55, s52, 1
 s_mul_i32 s56, s55, 48
 v_add_u32 v10, s56, v10
 v_mul_u32_u24 v4, 9216, v10
 v_lshl_add_u32 v4, v11, 4, v4
 v_lshrrev_b32 v10, 3, v1
 v_lshrrev_b32 v11, 4, v1
 v_lshlrev_b32 v11, 1, v11
 v_and_b32 v12, 7, v1
 v_xor_b32 v11, v11, v12
 v_mul_u32_u24 v10, 1152, v10
 v_lshl_add_u32 v254, v11, 4, v10
 v_lshrrev_b32 v10, 2, v1
 v_and_b32 v11, 3, v1
 v_lshlrev_b32 v11, 3, v11
 v_lshl_add_u32 v12, v10, 7, v11
 v_bfe_u32 v10, v1, 3, 2
 v_lshl_add_u32 v12, v10, 5, v12
 v_add_u32 v255, s79, v12
 v_lshrrev_b32 v10, 4, v1
 v_bfe_u32 v11, v1, 2, 2
 v_lshl_add_u32 v12, v10, 3, v11
 v_lshlrev_b32 v12, 7, v12
 v_and_b32 v10, 1, v10
 v_lshrrev_b32 v11, 1, v11
 v_lshl_or_b32 v10, v10, 1, v11
 v_and_b32 v11, 3, v1
 v_lshl_add_u32 v12, v11, 3, v12
 v_add_u32 v12, 90112, v12
 v_xor_b32 v11, 0, v10
 v_lshl_add_u32 v6, v11, 5, v12
 v_xor_b32 v11, 1, v10
 v_lshl_add_u32 v7, v11, 5, v12
 v_xor_b32 v11, 2, v10
 v_lshl_add_u32 v8, v11, 5, v12
 v_xor_b32 v11, 3, v10
 v_lshl_add_u32 v9, v11, 5, v12
 s_cmp_lg_u32 s52, 0
 s_cbranch_scc1 L_ln_ready
 s_mov_b32 s55, 0
L_ln_poll:
 buffer_load_dword v18, off, s[32:35], s77 offset:16 sc1
 s_add_u32 s55, s55, 1
 s_waitcnt vmcnt(0)
 v_cmp_gt_u32 vcc, 32, v18
 s_cmp_ge_u32 s55, 0x40000
 s_cbranch_scc1 L_ln_ready
 s_cbranch_vccnz L_ln_poll
L_ln_ready:
 s_waitcnt vmcnt(12)
 s_barrier
 s_add_u32 s55, s86, 0
 buffer_load_dwordx4 v[48:51], v2, s[8:11], s55 offen offset:0 sc1
 buffer_load_dwordx4 v[64:67], v2, s[8:11], s55 offen offset:1024 sc1
 buffer_load_dwordx4 a[0:3], v2, s[8:11], s55 offen offset:2048 sc1
 s_add_u32 s55, s86, 18432
 buffer_load_dwordx4 v[52:55], v2, s[8:11], s55 offen offset:0 sc1
 buffer_load_dwordx4 v[68:71], v2, s[8:11], s55 offen offset:1024 sc1
 buffer_load_dwordx4 a[4:7], v2, s[8:11], s55 offen offset:2048 sc1
 s_add_u32 s55, s86, 36864
 buffer_load_dwordx4 v[56:59], v2, s[8:11], s55 offen offset:0 sc1
 buffer_load_dwordx4 v[72:75], v2, s[8:11], s55 offen offset:1024 sc1
 buffer_load_dwordx4 a[8:11], v2, s[8:11], s55 offen offset:2048 sc1
 s_add_u32 s55, s86, 55296
 buffer_load_dwordx4 v[60:63], v2, s[8:11], s55 offen offset:0 sc1
 buffer_load_dwordx4 v[76:79], v2, s[8:11], s55 offen offset:1024 sc1
 buffer_load_dwordx4 a[12:15], v2, s[8:11], s55 offen offset:2048 sc1
 s_add_u32 s32, s76, 4194304
 s_addc_u32 s33, s78, 0
 s_lshl_b32 s57, s59, 10
 s_sub_u32 s34, 18874368, s57
 s_mov_b32 s35, 0x20000
 s_mov_b32 s78, 0x53800000
 ds_read_b64_tr_b16 v[24:25], v6 offset:0
 ds_read_b64_tr_b16 v[26:27], v6 offset:512
 ds_read_b64_tr_b16 v[28:29], v6 offset:4096
 ds_read_b64_tr_b16 v[30:31], v6 offset:4608
 ds_read_b64_tr_b16 v[32:33], v6 offset:8192
 ds_read_b64_tr_b16 v[34:35], v6 offset:8704
 s_waitcnt vmcnt(11) lgkmcnt(4)
 v_mfma_f32_16x16x32_bf16 v[112:115], v[24:27], v[48:51], 0
 ds_read_b64_tr_b16 v[36:37], v7 offset:0
 s_waitcnt vmcnt(10) lgkmcnt(3)
 v_mfma_f32_16x16x32_bf16 v[112:115], v[28:31], v[64:67], v[112:115]
 ds_read_b64_tr_b16 v[38:39], v7 offset:512
 s_waitcnt vmcnt(9) lgkmcnt(2)
 v_mfma_f32_16x16x32_bf16 v[112:115], v[32:35], a[0:3], v[112:115]
 ds_read_b64_tr_b16 v[40:41], v7 offset:4096
 s_waitcnt vmcnt(8)
 v_mfma_f32_16x16x32_bf16 v[116:119], v[24:27], v[52:55], 0
 ds_read_b64_tr_b16 v[42:43], v7 offset:4608
 s_waitcnt vmcnt(7)
 v_mfma_f32_16x16x32_bf16 v[116:119], v[28:31], v[68:71], v[116:119]
 ds_read_b64_tr_b16 v[44:45], v7 offset:8192
 s_waitcnt vmcnt(6)
 v_mfma_f32_16x16x32_bf16 v[116:119], v[32:35], a[4:7], v[116:119]
 ds_read_b64_tr_b16 v[46:47], v7 offset:8704
 s_waitcnt vmcnt(5)
 v_mfma_f32_16x16x32_bf16 v[120:123], v[24:27], v[56:59], 0
 s_add_u32 s55, s87, 0
 buffer_load_dwordx4 a[16:19], v2, s[8:11], s55 offen offset:0 sc1
 s_waitcnt vmcnt(5)
 v_mfma_f32_16x16x32_bf16 v[120:123], v[28:31], v[72:75], v[120:123]
 s_waitcnt vmcnt(4)
 v_mfma_f32_16x16x32_bf16 v[120:123], v[32:35], a[8:11], v[120:123]
 buffer_load_dwordx4 a[32:35], v2, s[8:11], s55 offen offset:1024 sc1
 s_waitcnt vmcnt(4)
 v_mfma_f32_16x16x32_bf16 v[124:127], v[24:27], v[60:63], 0
 buffer_load_dwordx4 a[48:51], v2, s[8:11], s55 offen offset:2048 sc1
 s_waitcnt vmcnt(4)
 v_mfma_f32_16x16x32_bf16 v[124:127], v[28:31], v[76:79], v[124:127]
 s_add_u32 s55, s87, 18432
 buffer_load_dwordx4 a[20:23], v2, s[8:11], s55 offen offset:0 sc1
 s_waitcnt vmcnt(4)
 v_mfma_f32_16x16x32_bf16 v[124:127], v[32:35], a[12:15], v[124:127]
 s_waitcnt lgkmcnt(4)
 v_mfma_f32_16x16x32_bf16 v[128:131], v[36:39], v[48:51], 0
 s_waitcnt lgkmcnt(2)
 ds_read_b64_tr_b16 v[24:25], v8 offset:0
 v_mfma_f32_16x16x32_bf16 v[128:131], v[40:43], v[64:67], v[128:131]
 s_waitcnt lgkmcnt(1)
 ds_read_b64_tr_b16 v[26:27], v8 offset:512
 v_mfma_f32_16x16x32_bf16 v[128:131], v[44:47], a[0:3], v[128:131]
 ds_read_b64_tr_b16 v[28:29], v8 offset:4096
 v_mfma_f32_16x16x32_bf16 v[132:135], v[36:39], v[52:55], 0
 ds_read_b64_tr_b16 v[30:31], v8 offset:4608
 v_mfma_f32_16x16x32_bf16 v[132:135], v[40:43], v[68:71], v[132:135]
 ds_read_b64_tr_b16 v[32:33], v8 offset:8192
 v_mfma_f32_16x16x32_bf16 v[132:135], v[44:47], a[4:7], v[132:135]
 ds_read_b64_tr_b16 v[34:35], v8 offset:8704
 v_mfma_f32_16x16x32_bf16 v[136:139], v[36:39], v[56:59], 0
 buffer_load_dwordx4 a[36:39], v2, s[8:11], s55 offen offset:1024 sc1
 v_mfma_f32_16x16x32_bf16 v[136:139], v[40:43], v[72:75], v[136:139]
 buffer_load_dwordx4 a[52:55], v2, s[8:11], s55 offen offset:2048 sc1
 v_mfma_f32_16x16x32_bf16 v[136:139], v[44:47], a[8:11], v[136:139]
 v_mfma_f32_16x16x32_bf16 v[140:143], v[36:39], v[60:63], 0
 s_add_u32 s55, s87, 36864
 buffer_load_dwordx4 a[24:27], v2, s[8:11], s55 offen offset:0 sc1
 v_mfma_f32_16x16x32_bf16 v[140:143], v[40:43], v[76:79], v[140:143]
 buffer_load_dwordx4 a[40:43], v2, s[8:11], s55 offen offset:1024 sc1
 v_mfma_f32_16x16x32_bf16 v[140:143], v[44:47], a[12:15], v[140:143]
 s_waitcnt lgkmcnt(4)
 v_mfma_f32_16x16x32_bf16 v[144:147], v[24:27], v[48:51], 0
 s_waitcnt lgkmcnt(2)
 ds_read_b64_tr_b16 v[36:37], v9 offset:0
 v_mfma_f32_16x16x32_bf16 v[144:147], v[28:31], v[64:67], v[144:147]
 s_waitcnt lgkmcnt(1)
 ds_read_b64_tr_b16 v[38:39], v9 offset:512
 v_mfma_f32_16x16x32_bf16 v[144:147], v[32:35], a[0:3], v[144:147]
 ds_read_b64_tr_b16 v[40:41], v9 offset:4096
 v_mfma_f32_16x16x32_bf16 v[148:151], v[24:27], v[52:55], 0
 ds_read_b64_tr_b16 v[42:43], v9 offset:4608
 v_mfma_f32_16x16x32_bf16 v[148:151], v[28:31], v[68:71], v[148:151]
 ds_read_b64_tr_b16 v[44:45], v9 offset:8192
 v_mfma_f32_16x16x32_bf16 v[148:151], v[32:35], a[4:7], v[148:151]
 ds_read_b64_tr_b16 v[46:47], v9 offset:8704
 v_mfma_f32_16x16x32_bf16 v[152:155], v[24:27], v[56:59], 0
 buffer_load_dwordx4 a[56:59], v2, s[8:11], s55 offen offset:2048 sc1
 v_mfma_f32_16x16x32_bf16 v[152:155], v[28:31], v[72:75], v[152:155]
 s_add_u32 s55, s87, 55296
 buffer_load_dwordx4 a[28:31], v2, s[8:11], s55 offen offset:0 sc1
 v_mfma_f32_16x16x32_bf16 v[152:155], v[32:35], a[8:11], v[152:155]
 buffer_load_dwordx4 a[44:47], v2, s[8:11], s55 offen offset:1024 sc1
 v_mfma_f32_16x16x32_bf16 v[156:159], v[24:27], v[60:63], 0
 v_mfma_f32_16x16x32_bf16 v[156:159], v[28:31], v[76:79], v[156:159]
 buffer_load_dwordx4 a[60:63], v2, s[8:11], s55 offen offset:2048 sc1
 v_mfma_f32_16x16x32_bf16 v[156:159], v[32:35], a[12:15], v[156:159]
 s_waitcnt lgkmcnt(4)
 v_mfma_f32_16x16x32_bf16 v[160:163], v[36:39], v[48:51], 0
 s_waitcnt lgkmcnt(2)
 ds_read_b64_tr_b16 v[24:25], v6 offset:12288
 v_mfma_f32_16x16x32_bf16 v[160:163], v[40:43], v[64:67], v[160:163]
 s_waitcnt lgkmcnt(1)
 ds_read_b64_tr_b16 v[26:27], v6 offset:12800
 v_mfma_f32_16x16x32_bf16 v[160:163], v[44:47], a[0:3], v[160:163]
 ds_read_b64_tr_b16 v[28:29], v6 offset:16384
 v_mfma_f32_16x16x32_bf16 v[164:167], v[36:39], v[52:55], 0
 ds_read_b64_tr_b16 v[30:31], v6 offset:16896
 v_mfma_f32_16x16x32_bf16 v[164:167], v[40:43], v[68:71], v[164:167]
 ds_read_b64_tr_b16 v[32:33], v6 offset:20480
 v_mfma_f32_16x16x32_bf16 v[164:167], v[44:47], a[4:7], v[164:167]
 ds_read_b64_tr_b16 v[34:35], v6 offset:20992
 v_mfma_f32_16x16x32_bf16 v[168:171], v[36:39], v[56:59], 0
 v_mfma_f32_16x16x32_bf16 v[168:171], v[40:43], v[72:75], v[168:171]
 v_mfma_f32_16x16x32_bf16 v[168:171], v[44:47], a[8:11], v[168:171]
 v_mfma_f32_16x16x32_bf16 v[172:175], v[36:39], v[60:63], 0
 v_mfma_f32_16x16x32_bf16 v[172:175], v[40:43], v[76:79], v[172:175]
 v_mfma_f32_16x16x32_bf16 v[172:175], v[44:47], a[12:15], v[172:175]
 s_waitcnt lgkmcnt(4)
 v_mfma_f32_16x16x32_bf16 v[176:179], v[24:27], v[48:51], 0
 s_waitcnt lgkmcnt(2)
 ds_read_b64_tr_b16 v[36:37], v7 offset:12288
 v_mfma_f32_16x16x32_bf16 v[176:179], v[28:31], v[64:67], v[176:179]
 s_waitcnt lgkmcnt(1)
 ds_read_b64_tr_b16 v[38:39], v7 offset:12800
 v_mfma_f32_16x16x32_bf16 v[176:179], v[32:35], a[0:3], v[176:179]
 ds_read_b64_tr_b16 v[40:41], v7 offset:16384
 v_mfma_f32_16x16x32_bf16 v[180:183], v[24:27], v[52:55], 0
 ds_read_b64_tr_b16 v[42:43], v7 offset:16896
 v_mfma_f32_16x16x32_bf16 v[180:183], v[28:31], v[68:71], v[180:183]
 ds_read_b64_tr_b16 v[44:45], v7 offset:20480
 v_mfma_f32_16x16x32_bf16 v[180:183], v[32:35], a[4:7], v[180:183]
 ds_read_b64_tr_b16 v[46:47], v7 offset:20992
 v_mfma_f32_16x16x32_bf16 v[184:187], v[24:27], v[56:59], 0
 s_add_u32 s55, s88, 0
 buffer_load_dwordx4 a[64:67], v2, s[8:11], s55 offen offset:0 sc1
 v_mfma_f32_16x16x32_bf16 v[184:187], v[28:31], v[72:75], v[184:187]
 v_mfma_f32_16x16x32_bf16 v[184:187], v[32:35], a[8:11], v[184:187]
 buffer_load_dwordx4 a[80:83], v2, s[8:11], s55 offen offset:1024 sc1
 v_mfma_f32_16x16x32_bf16 v[188:191], v[24:27], v[60:63], 0
 buffer_load_dwordx4 a[96:99], v2, s[8:11], s55 offen offset:2048 sc1
 v_mfma_f32_16x16x32_bf16 v[188:191], v[28:31], v[76:79], v[188:191]
 s_add_u32 s55, s88, 18432
 buffer_load_dwordx4 a[68:71], v2, s[8:11], s55 offen offset:0 sc1
 v_mfma_f32_16x16x32_bf16 v[188:191], v[32:35], a[12:15], v[188:191]
 s_waitcnt lgkmcnt(4)
 v_mfma_f32_16x16x32_bf16 v[192:195], v[36:39], v[48:51], 0
 s_waitcnt lgkmcnt(2)
 ds_read_b64_tr_b16 v[24:25], v8 offset:12288
 v_mfma_f32_16x16x32_bf16 v[192:195], v[40:43], v[64:67], v[192:195]
 s_waitcnt lgkmcnt(1)
 ds_read_b64_tr_b16 v[26:27], v8 offset:12800
 v_mfma_f32_16x16x32_bf16 v[192:195], v[44:47], a[0:3], v[192:195]
 ds_read_b64_tr_b16 v[28:29], v8 offset:16384
 v_mfma_f32_16x16x32_bf16 v[196:199], v[36:39], v[52:55], 0
 ds_read_b64_tr_b16 v[30:31], v8 offset:16896
 v_mfma_f32_16x16x32_bf16 v[196:199], v[40:43], v[68:71], v[196:199]
 ds_read_b64_tr_b16 v[32:33], v8 offset:20480
 v_mfma_f32_16x16x32_bf16 v[196:199], v[44:47], a[4:7], v[196:199]
 ds_read_b64_tr_b16 v[34:35], v8 offset:20992
 v_mfma_f32_16x16x32_bf16 v[200:203], v[36:39], v[56:59], 0
 buffer_load_dwordx4 a[84:87], v2, s[8:11], s55 offen offset:1024 sc1
 v_mfma_f32_16x16x32_bf16 v[200:203], v[40:43], v[72:75], v[200:203]
 buffer_load_dwordx4 a[100:103], v2, s[8:11], s55 offen offset:2048 sc1
 v_mfma_f32_16x16x32_bf16 v[200:203], v[44:47], a[8:11], v[200:203]
 v_mfma_f32_16x16x32_bf16 v[204:207], v[36:39], v[60:63], 0
 s_add_u32 s55, s88, 36864
 buffer_load_dwordx4 a[72:75], v2, s[8:11], s55 offen offset:0 sc1
 v_mfma_f32_16x16x32_bf16 v[204:207], v[40:43], v[76:79], v[204:207]
 buffer_load_dwordx4 a[88:91], v2, s[8:11], s55 offen offset:1024 sc1
 v_mfma_f32_16x16x32_bf16 v[204:207], v[44:47], a[12:15], v[204:207]
 s_waitcnt lgkmcnt(4)
 v_mfma_f32_16x16x32_bf16 v[208:211], v[24:27], v[48:51], 0
 s_waitcnt lgkmcnt(2)
 ds_read_b64_tr_b16 v[36:37], v9 offset:12288
 v_mfma_f32_16x16x32_bf16 v[208:211], v[28:31], v[64:67], v[208:211]
 s_waitcnt lgkmcnt(1)
 ds_read_b64_tr_b16 v[38:39], v9 offset:12800
 v_mfma_f32_16x16x32_bf16 v[208:211], v[32:35], a[0:3], v[208:211]
 ds_read_b64_tr_b16 v[40:41], v9 offset:16384
 v_mfma_f32_16x16x32_bf16 v[212:215], v[24:27], v[52:55], 0
 ds_read_b64_tr_b16 v[42:43], v9 offset:16896
 v_mfma_f32_16x16x32_bf16 v[212:215], v[28:31], v[68:71], v[212:215]
 ds_read_b64_tr_b16 v[44:45], v9 offset:20480
 v_mfma_f32_16x16x32_bf16 v[212:215], v[32:35], a[4:7], v[212:215]
 ds_read_b64_tr_b16 v[46:47], v9 offset:20992
 v_mfma_f32_16x16x32_bf16 v[216:219], v[24:27], v[56:59], 0
 buffer_load_dwordx4 a[104:107], v2, s[8:11], s55 offen offset:2048 sc1
 v_mfma_f32_16x16x32_bf16 v[216:219], v[28:31], v[72:75], v[216:219]
 s_add_u32 s55, s88, 55296
 buffer_load_dwordx4 a[76:79], v2, s[8:11], s55 offen offset:0 sc1
 v_mfma_f32_16x16x32_bf16 v[216:219], v[32:35], a[8:11], v[216:219]
 buffer_load_dwordx4 a[92:95], v2, s[8:11], s55 offen offset:1024 sc1
 v_mfma_f32_16x16x32_bf16 v[220:223], v[24:27], v[60:63], 0
 v_mfma_f32_16x16x32_bf16 v[220:223], v[28:31], v[76:79], v[220:223]
 buffer_load_dwordx4 a[108:111], v2, s[8:11], s55 offen offset:2048 sc1
 v_mfma_f32_16x16x32_bf16 v[220:223], v[32:35], a[12:15], v[220:223]
 s_barrier
 s_waitcnt lgkmcnt(4)
 v_mfma_f32_16x16x32_bf16 v[224:227], v[36:39], v[48:51], 0
 s_waitcnt lgkmcnt(2)
 ds_read_b64_tr_b16 v[24:25], v6 offset:24576
 v_mfma_f32_16x16x32_bf16 v[224:227], v[40:43], v[64:67], v[224:227]
 s_waitcnt lgkmcnt(1)
 ds_read_b64_tr_b16 v[26:27], v6 offset:25088
 v_mfma_f32_16x16x32_bf16 v[224:227], v[44:47], a[0:3], v[224:227]
 ds_read_b64_tr_b16 v[28:29], v6 offset:28672
 v_mfma_f32_16x16x32_bf16 v[228:231], v[36:39], v[52:55], 0
 ds_read_b64_tr_b16 v[30:31], v6 offset:29184
 v_mfma_f32_16x16x32_bf16 v[228:231], v[40:43], v[68:71], v[228:231]
 ds_read_b64_tr_b16 v[32:33], v6 offset:32768
 v_mfma_f32_16x16x32_bf16 v[228:231], v[44:47], a[4:7], v[228:231]
 ds_read_b64_tr_b16 v[34:35], v6 offset:33280
 v_mfma_f32_16x16x32_bf16 v[232:235], v[36:39], v[56:59], 0
 v_mfma_f32_16x16x32_bf16 v[232:235], v[40:43], v[72:75], v[232:235]
 v_mfma_f32_16x16x32_bf16 v[232:235], v[44:47], a[8:11], v[232:235]
 v_mfma_f32_16x16x32_bf16 v[236:239], v[36:39], v[60:63], 0
 v_mfma_f32_16x16x32_bf16 v[236:239], v[40:43], v[76:79], v[236:239]
 v_mfma_f32_16x16x32_bf16 v[236:239], v[44:47], a[12:15], v[236:239]
 s_waitcnt lgkmcnt(4)
 s_waitcnt vmcnt(23)
 v_mfma_f32_16x16x32_bf16 v[112:115], v[24:27], a[16:19], v[112:115]
 s_waitcnt lgkmcnt(2)
 ds_read_b64_tr_b16 v[36:37], v7 offset:24576
 s_waitcnt vmcnt(22)
 v_mfma_f32_16x16x32_bf16 v[112:115], v[28:31], a[32:35], v[112:115]
 s_waitcnt lgkmcnt(1)
 ds_read_b64_tr_b16 v[38:39], v7 offset:25088
 s_waitcnt vmcnt(21)
 v_mfma_f32_16x16x32_bf16 v[112:115], v[32:35], a[48:51], v[112:115]
 ds_read_b64_tr_b16 v[40:41], v7 offset:28672
 s_waitcnt vmcnt(20)
 v_mfma_f32_16x16x32_bf16 v[116:119], v[24:27], a[20:23], v[116:119]
 ds_read_b64_tr_b16 v[42:43], v7 offset:29184
 s_waitcnt vmcnt(19)
 v_mfma_f32_16x16x32_bf16 v[116:119], v[28:31], a[36:39], v[116:119]
 ds_read_b64_tr_b16 v[44:45], v7 offset:32768
 s_waitcnt vmcnt(18)
 v_mfma_f32_16x16x32_bf16 v[116:119], v[32:35], a[52:55], v[116:119]
 ds_read_b64_tr_b16 v[46:47], v7 offset:33280
 s_waitcnt vmcnt(17)
 v_mfma_f32_16x16x32_bf16 v[120:123], v[24:27], a[24:27], v[120:123]
 s_add_u32 m0, s70, 40960
 s_waitcnt vmcnt(16)
 v_mfma_f32_16x16x32_bf16 v[120:123], v[28:31], a[40:43], v[120:123]
 s_add_u32 s58, s83, 0
 buffer_load_dwordx4 v3, s[12:15], s58 offen nt lds
 s_waitcnt vmcnt(16)
 v_mfma_f32_16x16x32_bf16 v[120:123], v[32:35], a[56:59], v[120:123]
 s_waitcnt vmcnt(15)
 v_mfma_f32_16x16x32_bf16 v[124:127], v[24:27], a[28:31], v[124:127]
 s_add_u32 m0, s70, 45056
 s_waitcnt vmcnt(14)
 v_mfma_f32_16x16x32_bf16 v[124:127], v[28:31], a[44:47], v[124:127]
 s_add_u32 s58, s83, 294912
 buffer_load_dwordx4 v3, s[12:15], s58 offen nt lds
 s_waitcnt vmcnt(14)
 v_mfma_f32_16x16x32_bf16 v[124:127], v[32:35], a[60:63], v[124:127]
 s_waitcnt lgkmcnt(4)
 v_mfma_f32_16x16x32_bf16 v[128:131], v[36:39], a[16:19], v[128:131]
 s_waitcnt lgkmcnt(2)
 ds_read_b64_tr_b16 v[24:25], v8 offset:24576
 v_mfma_f32_16x16x32_bf16 v[128:131], v[40:43], a[32:35], v[128:131]
 s_waitcnt lgkmcnt(1)
 ds_read_b64_tr_b16 v[26:27], v8 offset:25088
 v_mfma_f32_16x16x32_bf16 v[128:131], v[44:47], a[48:51], v[128:131]
 ds_read_b64_tr_b16 v[28:29], v8 offset:28672
 v_mfma_f32_16x16x32_bf16 v[132:135], v[36:39], a[20:23], v[132:135]
 ds_read_b64_tr_b16 v[30:31], v8 offset:29184
 v_mfma_f32_16x16x32_bf16 v[132:135], v[40:43], a[36:39], v[132:135]
 ds_read_b64_tr_b16 v[32:33], v8 offset:32768
 v_mfma_f32_16x16x32_bf16 v[132:135], v[44:47], a[52:55], v[132:135]
 ds_read_b64_tr_b16 v[34:35], v8 offset:33280
 v_mfma_f32_16x16x32_bf16 v[136:139], v[36:39], a[24:27], v[136:139]
 s_add_u32 m0, s70, 49152
 v_mfma_f32_16x16x32_bf16 v[136:139], v[40:43], a[40:43], v[136:139]
 s_add_u32 s58, s83, 589824
 buffer_load_dwordx4 v3, s[12:15], s58 offen nt lds
 v_mfma_f32_16x16x32_bf16 v[136:139], v[44:47], a[56:59], v[136:139]
 s_add_u32 m0, s70, 53248
 v_mfma_f32_16x16x32_bf16 v[140:143], v[36:39], a[28:31], v[140:143]
 s_add_u32 s58, s83, 0
 buffer_load_dwordx4 v3, s[16:19], s58 offen nt lds
 v_mfma_f32_16x16x32_bf16 v[140:143], v[40:43], a[44:47], v[140:143]
 v_mfma_f32_16x16x32_bf16 v[140:143], v[44:47], a[60:63], v[140:143]
 s_waitcnt lgkmcnt(4)
 v_mfma_f32_16x16x32_bf16 v[144:147], v[24:27], a[16:19], v[144:147]
 s_waitcnt lgkmcnt(2)
 ds_read_b64_tr_b16 v[36:37], v9 offset:24576
 v_mfma_f32_16x16x32_bf16 v[144:147], v[28:31], a[32:35], v[144:147]
 s_waitcnt lgkmcnt(1)
 ds_read_b64_tr_b16 v[38:39], v9 offset:25088
 v_mfma_f32_16x16x32_bf16 v[144:147], v[32:35], a[48:51], v[144:147]
 ds_read_b64_tr_b16 v[40:41], v9 offset:28672
 v_mfma_f32_16x16x32_bf16 v[148:151], v[24:27], a[20:23], v[148:151]
 ds_read_b64_tr_b16 v[42:43], v9 offset:29184
 v_mfma_f32_16x16x32_bf16 v[148:151], v[28:31], a[36:39], v[148:151]
 ds_read_b64_tr_b16 v[44:45], v9 offset:32768
 v_mfma_f32_16x16x32_bf16 v[148:151], v[32:35], a[52:55], v[148:151]
 s_add_u32 m0, s70, 57344
 ds_read_b64_tr_b16 v[46:47], v9 offset:33280
 v_mfma_f32_16x16x32_bf16 v[152:155], v[24:27], a[24:27], v[152:155]
 s_add_u32 s58, s83, 294912
 buffer_load_dwordx4 v3, s[16:19], s58 offen nt lds
 v_mfma_f32_16x16x32_bf16 v[152:155], v[28:31], a[40:43], v[152:155]
 v_mfma_f32_16x16x32_bf16 v[152:155], v[32:35], a[56:59], v[152:155]
 s_add_u32 m0, s70, 61440
 v_mfma_f32_16x16x32_bf16 v[156:159], v[24:27], a[28:31], v[156:159]
 s_add_u32 s58, s83, 589824
 buffer_load_dwordx4 v3, s[16:19], s58 offen nt lds
 v_mfma_f32_16x16x32_bf16 v[156:159], v[28:31], a[44:47], v[156:159]
 v_mfma_f32_16x16x32_bf16 v[156:159], v[32:35], a[60:63], v[156:159]
 s_waitcnt lgkmcnt(4)
 v_mfma_f32_16x16x32_bf16 v[160:163], v[36:39], a[16:19], v[160:163]
 s_waitcnt lgkmcnt(2)
 ds_read_b64_tr_b16 v[24:25], v6 offset:36864
 v_mfma_f32_16x16x32_bf16 v[160:163], v[40:43], a[32:35], v[160:163]
 s_waitcnt lgkmcnt(1)
 ds_read_b64_tr_b16 v[26:27], v6 offset:37376
 v_mfma_f32_16x16x32_bf16 v[160:163], v[44:47], a[48:51], v[160:163]
 ds_read_b64_tr_b16 v[28:29], v6 offset:40960
 v_mfma_f32_16x16x32_bf16 v[164:167], v[36:39], a[20:23], v[164:167]
 ds_read_b64_tr_b16 v[30:31], v6 offset:41472
 v_mfma_f32_16x16x32_bf16 v[164:167], v[40:43], a[36:39], v[164:167]
 ds_read_b64_tr_b16 v[32:33], v6 offset:45056
 v_mfma_f32_16x16x32_bf16 v[164:167], v[44:47], a[52:55], v[164:167]
 ds_read_b64_tr_b16 v[34:35], v6 offset:45568
 v_mfma_f32_16x16x32_bf16 v[168:171], v[36:39], a[24:27], v[168:171]
 v_mfma_f32_16x16x32_bf16 v[168:171], v[40:43], a[40:43], v[168:171]
 v_mfma_f32_16x16x32_bf16 v[168:171], v[44:47], a[56:59], v[168:171]
 v_mfma_f32_16x16x32_bf16 v[172:175], v[36:39], a[28:31], v[172:175]
 v_mfma_f32_16x16x32_bf16 v[172:175], v[40:43], a[44:47], v[172:175]
 v_mfma_f32_16x16x32_bf16 v[172:175], v[44:47], a[60:63], v[172:175]
 s_waitcnt lgkmcnt(4)
 v_mfma_f32_16x16x32_bf16 v[176:179], v[24:27], a[16:19], v[176:179]
 s_waitcnt lgkmcnt(2)
 ds_read_b64_tr_b16 v[36:37], v7 offset:36864
 v_mfma_f32_16x16x32_bf16 v[176:179], v[28:31], a[32:35], v[176:179]
 s_waitcnt lgkmcnt(1)
 ds_read_b64_tr_b16 v[38:39], v7 offset:37376
 v_mfma_f32_16x16x32_bf16 v[176:179], v[32:35], a[48:51], v[176:179]
 ds_read_b64_tr_b16 v[40:41], v7 offset:40960
 v_mfma_f32_16x16x32_bf16 v[180:183], v[24:27], a[20:23], v[180:183]
 ds_read_b64_tr_b16 v[42:43], v7 offset:41472
 v_mfma_f32_16x16x32_bf16 v[180:183], v[28:31], a[36:39], v[180:183]
 ds_read_b64_tr_b16 v[44:45], v7 offset:45056
 v_mfma_f32_16x16x32_bf16 v[180:183], v[32:35], a[52:55], v[180:183]
 ds_read_b64_tr_b16 v[46:47], v7 offset:45568
 v_mfma_f32_16x16x32_bf16 v[184:187], v[24:27], a[24:27], v[184:187]
 s_add_u32 s55, s89, 0
 buffer_load_dwordx4 a[112:115], v2, s[8:11], s55 offen offset:0 sc1
 v_mfma_f32_16x16x32_bf16 v[184:187], v[28:31], a[40:43], v[184:187]
 v_mfma_f32_16x16x32_bf16 v[184:187], v[32:35], a[56:59], v[184:187]
 buffer_load_dwordx4 a[128:131], v2, s[8:11], s55 offen offset:1024 sc1
 v_mfma_f32_16x16x32_bf16 v[188:191], v[24:27], a[28:31], v[188:191]
 buffer_load_dwordx4 a[144:147], v2, s[8:11], s55 offen offset:2048 sc1
 v_mfma_f32_16x16x32_bf16 v[188:191], v[28:31], a[44:47], v[188:191]
 s_add_u32 s55, s89, 18432
 buffer_load_dwordx4 a[116:119], v2, s[8:11], s55 offen offset:0 sc1
 v_mfma_f32_16x16x32_bf16 v[188:191], v[32:35], a[60:63], v[188:191]
 s_waitcnt lgkmcnt(4)
 v_mfma_f32_16x16x32_bf16 v[192:195], v[36:39], a[16:19], v[192:195]
 s_waitcnt lgkmcnt(2)
 ds_read_b64_tr_b16 v[24:25], v8 offset:36864
 v_mfma_f32_16x16x32_bf16 v[192:195], v[40:43], a[32:35], v[192:195]
 s_waitcnt lgkmcnt(1)
 ds_read_b64_tr_b16 v[26:27], v8 offset:37376
 v_mfma_f32_16x16x32_bf16 v[192:195], v[44:47], a[48:51], v[192:195]
 ds_read_b64_tr_b16 v[28:29], v8 offset:40960
 v_mfma_f32_16x16x32_bf16 v[196:199], v[36:39], a[20:23], v[196:199]
 ds_read_b64_tr_b16 v[30:31], v8 offset:41472
 v_mfma_f32_16x16x32_bf16 v[196:199], v[40:43], a[36:39], v[196:199]
 ds_read_b64_tr_b16 v[32:33], v8 offset:45056
 v_mfma_f32_16x16x32_bf16 v[196:199], v[44:47], a[52:55], v[196:199]
 ds_read_b64_tr_b16 v[34:35], v8 offset:45568
 v_mfma_f32_16x16x32_bf16 v[200:203], v[36:39], a[24:27], v[200:203]
 buffer_load_dwordx4 a[132:135], v2, s[8:11], s55 offen offset:1024 sc1
 v_mfma_f32_16x16x32_bf16 v[200:203], v[40:43], a[40:43], v[200:203]
 buffer_load_dwordx4 a[148:151], v2, s[8:11], s55 offen offset:2048 sc1
 v_mfma_f32_16x16x32_bf16 v[200:203], v[44:47], a[56:59], v[200:203]
 v_mfma_f32_16x16x32_bf16 v[204:207], v[36:39], a[28:31], v[204:207]
 s_add_u32 s55, s89, 36864
 buffer_load_dwordx4 a[120:123], v2, s[8:11], s55 offen offset:0 sc1
 v_mfma_f32_16x16x32_bf16 v[204:207], v[40:43], a[44:47], v[204:207]
 buffer_load_dwordx4 a[136:139], v2, s[8:11], s55 offen offset:1024 sc1
 v_mfma_f32_16x16x32_bf16 v[204:207], v[44:47], a[60:63], v[204:207]
 s_waitcnt lgkmcnt(4)
 v_mfma_f32_16x16x32_bf16 v[208:211], v[24:27], a[16:19], v[208:211]
 s_waitcnt lgkmcnt(2)
 ds_read_b64_tr_b16 v[36:37], v9 offset:36864
 v_mfma_f32_16x16x32_bf16 v[208:211], v[28:31], a[32:35], v[208:211]
 s_waitcnt lgkmcnt(1)
 ds_read_b64_tr_b16 v[38:39], v9 offset:37376
 v_mfma_f32_16x16x32_bf16 v[208:211], v[32:35], a[48:51], v[208:211]
 ds_read_b64_tr_b16 v[40:41], v9 offset:40960
 v_mfma_f32_16x16x32_bf16 v[212:215], v[24:27], a[20:23], v[212:215]
 ds_read_b64_tr_b16 v[42:43], v9 offset:41472
 v_mfma_f32_16x16x32_bf16 v[212:215], v[28:31], a[36:39], v[212:215]
 ds_read_b64_tr_b16 v[44:45], v9 offset:45056
 v_mfma_f32_16x16x32_bf16 v[212:215], v[32:35], a[52:55], v[212:215]
 ds_read_b64_tr_b16 v[46:47], v9 offset:45568
 v_mfma_f32_16x16x32_bf16 v[216:219], v[24:27], a[24:27], v[216:219]
 buffer_load_dwordx4 a[152:155], v2, s[8:11], s55 offen offset:2048 sc1
 v_mfma_f32_16x16x32_bf16 v[216:219], v[28:31], a[40:43], v[216:219]
 s_add_u32 s55, s89, 55296
 buffer_load_dwordx4 a[124:127], v2, s[8:11], s55 offen offset:0 sc1
 v_mfma_f32_16x16x32_bf16 v[216:219], v[32:35], a[56:59], v[216:219]
 buffer_load_dwordx4 a[140:143], v2, s[8:11], s55 offen offset:1024 sc1
 v_mfma_f32_16x16x32_bf16 v[220:223], v[24:27], a[28:31], v[220:223]
 v_mfma_f32_16x16x32_bf16 v[220:223], v[28:31], a[44:47], v[220:223]
 buffer_load_dwordx4 a[156:159], v2, s[8:11], s55 offen offset:2048 sc1
 v_mfma_f32_16x16x32_bf16 v[220:223], v[32:35], a[60:63], v[220:223]
 s_barrier
 s_waitcnt lgkmcnt(4)
 v_mfma_f32_16x16x32_bf16 v[224:227], v[36:39], a[16:19], v[224:227]
 s_waitcnt lgkmcnt(2)
 ds_read_b64_tr_b16 v[24:25], v6 offset:49152
 v_mfma_f32_16x16x32_bf16 v[224:227], v[40:43], a[32:35], v[224:227]
 s_waitcnt lgkmcnt(1)
 ds_read_b64_tr_b16 v[26:27], v6 offset:49664
 v_mfma_f32_16x16x32_bf16 v[224:227], v[44:47], a[48:51], v[224:227]
 ds_read_b64_tr_b16 v[28:29], v6 offset:53248
 v_mfma_f32_16x16x32_bf16 v[228:231], v[36:39], a[20:23], v[228:231]
 ds_read_b64_tr_b16 v[30:31], v6 offset:53760
 v_mfma_f32_16x16x32_bf16 v[228:231], v[40:43], a[36:39], v[228:231]
 ds_read_b64_tr_b16 v[32:33], v6 offset:57344
 v_mfma_f32_16x16x32_bf16 v[228:231], v[44:47], a[52:55], v[228:231]
 ds_read_b64_tr_b16 v[34:35], v6 offset:57856
 v_mfma_f32_16x16x32_bf16 v[232:235], v[36:39], a[24:27], v[232:235]
 v_mfma_f32_16x16x32_bf16 v[232:235], v[40:43], a[40:43], v[232:235]
 v_mfma_f32_16x16x32_bf16 v[232:235], v[44:47], a[56:59], v[232:235]
 v_mfma_f32_16x16x32_bf16 v[236:239], v[36:39], a[28:31], v[236:239]
 v_mfma_f32_16x16x32_bf16 v[236:239], v[40:43], a[44:47], v[236:239]
 v_mfma_f32_16x16x32_bf16 v[236:239], v[44:47], a[60:63], v[236:239]
 s_waitcnt lgkmcnt(4)
 s_waitcnt vmcnt(29)
 v_mfma_f32_16x16x32_bf16 v[112:115], v[24:27], a[64:67], v[112:115]
 s_waitcnt lgkmcnt(2)
 ds_read_b64_tr_b16 v[36:37], v7 offset:49152
 s_waitcnt vmcnt(28)
 v_mfma_f32_16x16x32_bf16 v[112:115], v[28:31], a[80:83], v[112:115]
 s_waitcnt lgkmcnt(1)
 ds_read_b64_tr_b16 v[38:39], v7 offset:49664
 s_waitcnt vmcnt(27)
 v_mfma_f32_16x16x32_bf16 v[112:115], v[32:35], a[96:99], v[112:115]
 ds_read_b64_tr_b16 v[40:41], v7 offset:53248
 s_waitcnt vmcnt(26)
 v_mfma_f32_16x16x32_bf16 v[116:119], v[24:27], a[68:71], v[116:119]
 ds_read_b64_tr_b16 v[42:43], v7 offset:53760
 s_waitcnt vmcnt(25)
 v_mfma_f32_16x16x32_bf16 v[116:119], v[28:31], a[84:87], v[116:119]
 ds_read_b64_tr_b16 v[44:45], v7 offset:57344
 s_waitcnt vmcnt(24)
 v_mfma_f32_16x16x32_bf16 v[116:119], v[32:35], a[100:103], v[116:119]
 ds_read_b64_tr_b16 v[46:47], v7 offset:57856
 s_waitcnt vmcnt(23)
 v_mfma_f32_16x16x32_bf16 v[120:123], v[24:27], a[72:75], v[120:123]
 s_add_u32 m0, s70, 65536
 s_waitcnt vmcnt(22)
 v_mfma_f32_16x16x32_bf16 v[120:123], v[28:31], a[88:91], v[120:123]
 s_add_u32 s58, s84, 0
 buffer_load_dwordx4 v3, s[12:15], s58 offen nt lds
 s_waitcnt vmcnt(22)
 v_mfma_f32_16x16x32_bf16 v[120:123], v[32:35], a[104:107], v[120:123]
 s_add_u32 m0, s70, 69632
 s_waitcnt vmcnt(21)
 v_mfma_f32_16x16x32_bf16 v[124:127], v[24:27], a[76:79], v[124:127]
 s_add_u32 s58, s84, 294912
 buffer_load_dwordx4 v3, s[12:15], s58 offen nt lds
 s_waitcnt vmcnt(21)
 v_mfma_f32_16x16x32_bf16 v[124:127], v[28:31], a[92:95], v[124:127]
 s_waitcnt vmcnt(20)
 v_mfma_f32_16x16x32_bf16 v[124:127], v[32:35], a[108:111], v[124:127]
 s_waitcnt lgkmcnt(4)
 v_mfma_f32_16x16x32_bf16 v[128:131], v[36:39], a[64:67], v[128:131]
 s_waitcnt lgkmcnt(2)
 ds_read_b64_tr_b16 v[24:25], v8 offset:49152
 v_mfma_f32_16x16x32_bf16 v[128:131], v[40:43], a[80:83], v[128:131]
 s_waitcnt lgkmcnt(1)
 ds_read_b64_tr_b16 v[26:27], v8 offset:49664
 v_mfma_f32_16x16x32_bf16 v[128:131], v[44:47], a[96:99], v[128:131]
 ds_read_b64_tr_b16 v[28:29], v8 offset:53248
 v_mfma_f32_16x16x32_bf16 v[132:135], v[36:39], a[68:71], v[132:135]
 ds_read_b64_tr_b16 v[30:31], v8 offset:53760
 v_mfma_f32_16x16x32_bf16 v[132:135], v[40:43], a[84:87], v[132:135]
 ds_read_b64_tr_b16 v[32:33], v8 offset:57344
 v_mfma_f32_16x16x32_bf16 v[132:135], v[44:47], a[100:103], v[132:135]
 s_add_u32 m0, s70, 73728
 ds_read_b64_tr_b16 v[34:35], v8 offset:57856
 v_mfma_f32_16x16x32_bf16 v[136:139], v[36:39], a[72:75], v[136:139]
 s_add_u32 s58, s84, 589824
 buffer_load_dwordx4 v3, s[12:15], s58 offen nt lds
 v_mfma_f32_16x16x32_bf16 v[136:139], v[40:43], a[88:91], v[136:139]
 s_add_u32 m0, s70, 77824
 v_mfma_f32_16x16x32_bf16 v[136:139], v[44:47], a[104:107], v[136:139]
 s_add_u32 s58, s85, 0
 buffer_load_dwordx4 v3, s[12:15], s58 offen nt lds
 v_mfma_f32_16x16x32_bf16 v[140:143], v[36:39], a[76:79], v[140:143]
 s_add_u32 m0, s70, 81920
 v_mfma_f32_16x16x32_bf16 v[140:143], v[40:43], a[92:95], v[140:143]
 s_add_u32 s58, s85, 294912
 v_mfma_f32_16x16x32_bf16 v[140:143], v[44:47], a[108:111], v[140:143]
 s_waitcnt lgkmcnt(4)
 buffer_load_dwordx4 v3, s[12:15], s58 offen nt lds
 v_mfma_f32_16x16x32_bf16 v[144:147], v[24:27], a[64:67], v[144:147]
 s_waitcnt lgkmcnt(2)
 ds_read_b64_tr_b16 v[36:37], v9 offset:49152
 v_mfma_f32_16x16x32_bf16 v[144:147], v[28:31], a[80:83], v[144:147]
 s_waitcnt lgkmcnt(1)
 ds_read_b64_tr_b16 v[38:39], v9 offset:49664
 v_mfma_f32_16x16x32_bf16 v[144:147], v[32:35], a[96:99], v[144:147]
 ds_read_b64_tr_b16 v[40:41], v9 offset:53248
 v_mfma_f32_16x16x32_bf16 v[148:151], v[24:27], a[68:71], v[148:151]
 ds_read_b64_tr_b16 v[42:43], v9 offset:53760
 v_mfma_f32_16x16x32_bf16 v[148:151], v[28:31], a[84:87], v[148:151]
 ds_read_b64_tr_b16 v[44:45], v9 offset:57344
 v_mfma_f32_16x16x32_bf16 v[148:151], v[32:35], a[100:103], v[148:151]
 ds_read_b64_tr_b16 v[46:47], v9 offset:57856
 v_mfma_f32_16x16x32_bf16 v[152:155], v[24:27], a[72:75], v[152:155]
 v_add_u32 v6, 0xc000, v6
 v_add_u32 v7, 0xc000, v7
 v_mfma_f32_16x16x32_bf16 v[152:155], v[28:31], a[88:91], v[152:155]
 v_add_u32 v8, 0xc000, v8
 v_add_u32 v9, 0xc000, v9
 v_mfma_f32_16x16x32_bf16 v[152:155], v[32:35], a[104:107], v[152:155]
 s_add_u32 m0, s70, 86016
 v_mfma_f32_16x16x32_bf16 v[156:159], v[24:27], a[76:79], v[156:159]
 s_add_u32 s58, s85, 589824
 buffer_load_dwordx4 v3, s[12:15], s58 offen nt lds
 v_mfma_f32_16x16x32_bf16 v[156:159], v[28:31], a[92:95], v[156:159]
 v_mfma_f32_16x16x32_bf16 v[156:159], v[32:35], a[108:111], v[156:159]
 s_waitcnt lgkmcnt(4)
 v_mfma_f32_16x16x32_bf16 v[160:163], v[36:39], a[64:67], v[160:163]
 s_waitcnt lgkmcnt(2)
 ds_read_b64_tr_b16 v[24:25], v6 offset:12288
 v_mfma_f32_16x16x32_bf16 v[160:163], v[40:43], a[80:83], v[160:163]
 s_waitcnt lgkmcnt(1)
 ds_read_b64_tr_b16 v[26:27], v6 offset:12800
 v_mfma_f32_16x16x32_bf16 v[160:163], v[44:47], a[96:99], v[160:163]
 ds_read_b64_tr_b16 v[28:29], v6 offset:16384
 v_mfma_f32_16x16x32_bf16 v[164:167], v[36:39], a[68:71], v[164:167]
 ds_read_b64_tr_b16 v[30:31], v6 offset:16896
 v_mfma_f32_16x16x32_bf16 v[164:167], v[40:43], a[84:87], v[164:167]
 ds_read_b64_tr_b16 v[32:33], v6 offset:20480
 v_mfma_f32_16x16x32_bf16 v[164:167], v[44:47], a[100:103], v[164:167]
 ds_read_b64_tr_b16 v[34:35], v6 offset:20992
 v_mfma_f32_16x16x32_bf16 v[168:171], v[36:39], a[72:75], v[168:171]
 v_mfma_f32_16x16x32_bf16 v[168:171], v[40:43], a[88:91], v[168:171]
 v_mfma_f32_16x16x32_bf16 v[168:171], v[44:47], a[104:107], v[168:171]
 v_mfma_f32_16x16x32_bf16 v[172:175], v[36:39], a[76:79], v[172:175]
 v_mfma_f32_16x16x32_bf16 v[172:175], v[40:43], a[92:95], v[172:175]
 v_mfma_f32_16x16x32_bf16 v[172:175], v[44:47], a[108:111], v[172:175]
 s_waitcnt lgkmcnt(4)
 v_mfma_f32_16x16x32_bf16 v[176:179], v[24:27], a[64:67], v[176:179]
 s_waitcnt lgkmcnt(2)
 ds_read_b64_tr_b16 v[36:37], v7 offset:12288
 v_mfma_f32_16x16x32_bf16 v[176:179], v[28:31], a[80:83], v[176:179]
 s_waitcnt lgkmcnt(1)
 ds_read_b64_tr_b16 v[38:39], v7 offset:12800
 v_mfma_f32_16x16x32_bf16 v[176:179], v[32:35], a[96:99], v[176:179]
 ds_read_b64_tr_b16 v[40:41], v7 offset:16384
 v_mfma_f32_16x16x32_bf16 v[180:183], v[24:27], a[68:71], v[180:183]
 ds_read_b64_tr_b16 v[42:43], v7 offset:16896
 v_mfma_f32_16x16x32_bf16 v[180:183], v[28:31], a[84:87], v[180:183]
 ds_read_b64_tr_b16 v[44:45], v7 offset:20480
 v_mfma_f32_16x16x32_bf16 v[180:183], v[32:35], a[100:103], v[180:183]
 ds_read_b64_tr_b16 v[46:47], v7 offset:20992
 v_mfma_f32_16x16x32_bf16 v[184:187], v[24:27], a[72:75], v[184:187]
 s_add_u32 s55, s90, 0
 buffer_load_dwordx4 a[160:163], v2, s[8:11], s55 offen offset:0 sc1
 v_mfma_f32_16x16x32_bf16 v[184:187], v[28:31], a[88:91], v[184:187]
 buffer_load_dwordx4 a[176:179], v2, s[8:11], s55 offen offset:1024 sc1
 v_mfma_f32_16x16x32_bf16 v[184:187], v[32:35], a[104:107], v[184:187]
 v_mfma_f32_16x16x32_bf16 v[188:191], v[24:27], a[76:79], v[188:191]
 buffer_load_dwordx4 a[192:195], v2, s[8:11], s55 offen offset:2048 sc1
 v_mfma_f32_16x16x32_bf16 v[188:191], v[28:31], a[92:95], v[188:191]
 s_add_u32 s55, s90, 18432
 buffer_load_dwordx4 a[164:167], v2, s[8:11], s55 offen offset:0 sc1
 v_mfma_f32_16x16x32_bf16 v[188:191], v[32:35], a[108:111], v[188:191]
 s_waitcnt lgkmcnt(4)
 buffer_load_dwordx4 a[180:183], v2, s[8:11], s55 offen offset:1024 sc1
 v_mfma_f32_16x16x32_bf16 v[192:195], v[36:39], a[64:67], v[192:195]
 s_waitcnt lgkmcnt(2)
 ds_read_b64_tr_b16 v[24:25], v8 offset:12288
 v_mfma_f32_16x16x32_bf16 v[192:195], v[40:43], a[80:83], v[192:195]
 s_waitcnt lgkmcnt(1)
 ds_read_b64_tr_b16 v[26:27], v8 offset:12800
 v_mfma_f32_16x16x32_bf16 v[192:195], v[44:47], a[96:99], v[192:195]
 ds_read_b64_tr_b16 v[28:29], v8 offset:16384
 v_mfma_f32_16x16x32_bf16 v[196:199], v[36:39], a[68:71], v[196:199]
 ds_read_b64_tr_b16 v[30:31], v8 offset:16896
 v_mfma_f32_16x16x32_bf16 v[196:199], v[40:43], a[84:87], v[196:199]
 ds_read_b64_tr_b16 v[32:33], v8 offset:20480
 v_mfma_f32_16x16x32_bf16 v[196:199], v[44:47], a[100:103], v[196:199]
 ds_read_b64_tr_b16 v[34:35], v8 offset:20992
 v_mfma_f32_16x16x32_bf16 v[200:203], v[36:39], a[72:75], v[200:203]
 buffer_load_dwordx4 a[196:199], v2, s[8:11], s55 offen offset:2048 sc1
 v_mfma_f32_16x16x32_bf16 v[200:203], v[40:43], a[88:91], v[200:203]
 v_mfma_f32_16x16x32_bf16 v[200:203], v[44:47], a[104:107], v[200:203]
 s_add_u32 s55, s90, 36864
 buffer_load_dwordx4 a[168:171], v2, s[8:11], s55 offen offset:0 sc1
 v_mfma_f32_16x16x32_bf16 v[204:207], v[36:39], a[76:79], v[204:207]
 buffer_load_dwordx4 a[184:187], v2, s[8:11], s55 offen offset:1024 sc1
 v_mfma_f32_16x16x32_bf16 v[204:207], v[40:43], a[92:95], v[204:207]
 buffer_load_dwordx4 a[200:203], v2, s[8:11], s55 offen offset:2048 sc1
 v_mfma_f32_16x16x32_bf16 v[204:207], v[44:47], a[108:111], v[204:207]
 s_waitcnt lgkmcnt(4)
 s_add_u32 s55, s90, 55296
 buffer_load_dwordx4 a[172:175], v2, s[8:11], s55 offen offset:0 sc1
 v_mfma_f32_16x16x32_bf16 v[208:211], v[24:27], a[64:67], v[208:211]
 s_waitcnt lgkmcnt(2)
 ds_read_b64_tr_b16 v[36:37], v9 offset:12288
 v_mfma_f32_16x16x32_bf16 v[208:211], v[28:31], a[80:83], v[208:211]
 s_waitcnt lgkmcnt(1)
 ds_read_b64_tr_b16 v[38:39], v9 offset:12800
 v_mfma_f32_16x16x32_bf16 v[208:211], v[32:35], a[96:99], v[208:211]
 ds_read_b64_tr_b16 v[40:41], v9 offset:16384
 v_mfma_f32_16x16x32_bf16 v[212:215], v[24:27], a[68:71], v[212:215]
 ds_read_b64_tr_b16 v[42:43], v9 offset:16896
 v_mfma_f32_16x16x32_bf16 v[212:215], v[28:31], a[84:87], v[212:215]
 ds_read_b64_tr_b16 v[44:45], v9 offset:20480
 v_mfma_f32_16x16x32_bf16 v[212:215], v[32:35], a[100:103], v[212:215]
 ds_read_b64_tr_b16 v[46:47], v9 offset:20992
 v_mfma_f32_16x16x32_bf16 v[216:219], v[24:27], a[72:75], v[216:219]
 v_add_u32 v6, 0xfffe8000, v6
 v_add_u32 v7, 0xfffe8000, v7
 v_mfma_f32_16x16x32_bf16 v[216:219], v[28:31], a[88:91], v[216:219]
 v_add_u32 v8, 0xfffe8000, v8
 v_add_u32 v9, 0xfffe8000, v9
 v_mfma_f32_16x16x32_bf16 v[216:219], v[32:35], a[104:107], v[216:219]
 v_mfma_f32_16x16x32_bf16 v[220:223], v[24:27], a[76:79], v[220:223]
 buffer_load_dwordx4 a[188:191], v2, s[8:11], s55 offen offset:1024 sc1
 v_mfma_f32_16x16x32_bf16 v[220:223], v[28:31], a[92:95], v[220:223]
 buffer_load_dwordx4 a[204:207], v2, s[8:11], s55 offen offset:2048 sc1
 v_mfma_f32_16x16x32_bf16 v[220:223], v[32:35], a[108:111], v[220:223]
 s_waitcnt vmcnt(30)
 s_barrier
 s_waitcnt lgkmcnt(4)
 v_mfma_f32_16x16x32_bf16 v[224:227], v[36:39], a[64:67], v[224:227]
 s_waitcnt lgkmcnt(2)
 ds_read_b64_tr_b16 v[24:25], v6 offset:0
 v_mfma_f32_16x16x32_bf16 v[224:227], v[40:43], a[80:83], v[224:227]
 s_waitcnt lgkmcnt(1)
 ds_read_b64_tr_b16 v[26:27], v6 offset:512
 v_mfma_f32_16x16x32_bf16 v[224:227], v[44:47], a[96:99], v[224:227]
 ds_read_b64_tr_b16 v[28:29], v6 offset:4096
 v_mfma_f32_16x16x32_bf16 v[228:231], v[36:39], a[68:71], v[228:231]
 ds_read_b64_tr_b16 v[30:31], v6 offset:4608
 v_mfma_f32_16x16x32_bf16 v[228:231], v[40:43], a[84:87], v[228:231]
 ds_read_b64_tr_b16 v[32:33], v6 offset:8192
 v_mfma_f32_16x16x32_bf16 v[228:231], v[44:47], a[100:103], v[228:231]
 ds_read_b64_tr_b16 v[34:35], v6 offset:8704
 v_mfma_f32_16x16x32_bf16 v[232:235], v[36:39], a[72:75], v[232:235]
 v_mfma_f32_16x16x32_bf16 v[232:235], v[40:43], a[88:91], v[232:235]
 v_mfma_f32_16x16x32_bf16 v[232:235], v[44:47], a[104:107], v[232:235]
 v_mfma_f32_16x16x32_bf16 v[236:239], v[36:39], a[76:79], v[236:239]
 v_mfma_f32_16x16x32_bf16 v[236:239], v[40:43], a[92:95], v[236:239]
 v_mfma_f32_16x16x32_bf16 v[236:239], v[44:47], a[108:111], v[236:239]
 s_waitcnt lgkmcnt(4)
 s_waitcnt vmcnt(29)
 v_mfma_f32_16x16x32_bf16 v[112:115], v[24:27], a[112:115], v[112:115]
 s_waitcnt lgkmcnt(2)
 ds_read_b64_tr_b16 v[36:37], v7 offset:0
 s_waitcnt vmcnt(28)
 v_mfma_f32_16x16x32_bf16 v[112:115], v[28:31], a[128:131], v[112:115]
 s_waitcnt lgkmcnt(1)
 ds_read_b64_tr_b16 v[38:39], v7 offset:512
 s_waitcnt vmcnt(27)
 v_mfma_f32_16x16x32_bf16 v[112:115], v[32:35], a[144:147], v[112:115]
 ds_read_b64_tr_b16 v[40:41], v7 offset:4096
 s_waitcnt vmcnt(26)
 v_mfma_f32_16x16x32_bf16 v[116:119], v[24:27], a[116:119], v[116:119]
 ds_read_b64_tr_b16 v[42:43], v7 offset:4608
 s_waitcnt vmcnt(25)
 v_mfma_f32_16x16x32_bf16 v[116:119], v[28:31], a[132:135], v[116:119]
 ds_read_b64_tr_b16 v[44:45], v7 offset:8192
 s_waitcnt vmcnt(24)
 v_mfma_f32_16x16x32_bf16 v[116:119], v[32:35], a[148:151], v[116:119]
 ds_read_b64_tr_b16 v[46:47], v7 offset:8704
 s_waitcnt vmcnt(23)
 v_mfma_f32_16x16x32_bf16 v[120:123], v[24:27], a[120:123], v[120:123]
 s_add_u32 s55, s91, 0
 buffer_load_dwordx4 a[208:211], v2, s[8:11], s55 offen offset:0 sc1
 s_waitcnt vmcnt(23)
 v_mfma_f32_16x16x32_bf16 v[120:123], v[28:31], a[136:139], v[120:123]
 s_waitcnt vmcnt(22)
 v_mfma_f32_16x16x32_bf16 v[120:123], v[32:35], a[152:155], v[120:123]
 buffer_load_dwordx4 a[224:227], v2, s[8:11], s55 offen offset:1024 sc1
 s_waitcnt vmcnt(22)
 v_mfma_f32_16x16x32_bf16 v[124:127], v[24:27], a[124:127], v[124:127]
 buffer_load_dwordx4 a[240:243], v2, s[8:11], s55 offen offset:2048 sc1
 s_waitcnt vmcnt(22)
 v_mfma_f32_16x16x32_bf16 v[124:127], v[28:31], a[140:143], v[124:127]
 s_add_u32 s55, s91, 18432
 buffer_load_dwordx4 a[212:215], v2, s[8:11], s55 offen offset:0 sc1
 s_waitcnt vmcnt(22)
 v_mfma_f32_16x16x32_bf16 v[124:127], v[32:35], a[156:159], v[124:127]
 s_waitcnt lgkmcnt(4)
 v_mfma_f32_16x16x32_bf16 v[128:131], v[36:39], a[112:115], v[128:131]
 s_waitcnt lgkmcnt(2)
 ds_read_b64_tr_b16 v[24:25], v8 offset:0
 v_mfma_f32_16x16x32_bf16 v[128:131], v[40:43], a[128:131], v[128:131]
 s_waitcnt lgkmcnt(1)
 ds_read_b64_tr_b16 v[26:27], v8 offset:512
 v_mfma_f32_16x16x32_bf16 v[128:131], v[44:47], a[144:147], v[128:131]
 ds_read_b64_tr_b16 v[28:29], v8 offset:4096
 v_mfma_f32_16x16x32_bf16 v[132:135], v[36:39], a[116:119], v[132:135]
 ds_read_b64_tr_b16 v[30:31], v8 offset:4608
 v_mfma_f32_16x16x32_bf16 v[132:135], v[40:43], a[132:135], v[132:135]
 ds_read_b64_tr_b16 v[32:33], v8 offset:8192
 v_mfma_f32_16x16x32_bf16 v[132:135], v[44:47], a[148:151], v[132:135]
 ds_read_b64_tr_b16 v[34:35], v8 offset:8704
 v_mfma_f32_16x16x32_bf16 v[136:139], v[36:39], a[120:123], v[136:139]
 buffer_load_dwordx4 a[228:231], v2, s[8:11], s55 offen offset:1024 sc1
 v_mfma_f32_16x16x32_bf16 v[136:139], v[40:43], a[136:139], v[136:139]
 buffer_load_dwordx4 a[244:247], v2, s[8:11], s55 offen offset:2048 sc1
 v_mfma_f32_16x16x32_bf16 v[136:139], v[44:47], a[152:155], v[136:139]
 v_mfma_f32_16x16x32_bf16 v[140:143], v[36:39], a[124:127], v[140:143]
 s_add_u32 s55, s91, 36864
 buffer_load_dwordx4 a[216:219], v2, s[8:11], s55 offen offset:0 sc1
 v_mfma_f32_16x16x32_bf16 v[140:143], v[40:43], a[140:143], v[140:143]
 buffer_load_dwordx4 a[232:235], v2, s[8:11], s55 offen offset:1024 sc1
 v_mfma_f32_16x16x32_bf16 v[140:143], v[44:47], a[156:159], v[140:143]
 s_waitcnt lgkmcnt(4)
 v_mfma_f32_16x16x32_bf16 v[144:147], v[24:27], a[112:115], v[144:147]
 s_waitcnt lgkmcnt(2)
 ds_read_b64_tr_b16 v[36:37], v9 offset:0
 v_mfma_f32_16x16x32_bf16 v[144:147], v[28:31], a[128:131], v[144:147]
 s_waitcnt lgkmcnt(1)
 ds_read_b64_tr_b16 v[38:39], v9 offset:512
 v_mfma_f32_16x16x32_bf16 v[144:147], v[32:35], a[144:147], v[144:147]
 ds_read_b64_tr_b16 v[40:41], v9 offset:4096
 v_mfma_f32_16x16x32_bf16 v[148:151], v[24:27], a[116:119], v[148:151]
 ds_read_b64_tr_b16 v[42:43], v9 offset:4608
 v_mfma_f32_16x16x32_bf16 v[148:151], v[28:31], a[132:135], v[148:151]
 ds_read_b64_tr_b16 v[44:45], v9 offset:8192
 v_mfma_f32_16x16x32_bf16 v[148:151], v[32:35], a[148:151], v[148:151]
 ds_read_b64_tr_b16 v[46:47], v9 offset:8704
 v_mfma_f32_16x16x32_bf16 v[152:155], v[24:27], a[120:123], v[152:155]
 buffer_load_dwordx4 a[248:251], v2, s[8:11], s55 offen offset:2048 sc1
 v_mfma_f32_16x16x32_bf16 v[152:155], v[28:31], a[136:139], v[152:155]
 s_add_u32 s55, s91, 55296
 buffer_load_dwordx4 a[220:223], v2, s[8:11], s55 offen offset:0 sc1
 v_mfma_f32_16x16x32_bf16 v[152:155], v[32:35], a[152:155], v[152:155]
 buffer_load_dwordx4 a[236:239], v2, s[8:11], s55 offen offset:1024 sc1
 v_mfma_f32_16x16x32_bf16 v[156:159], v[24:27], a[124:127], v[156:159]
 v_mfma_f32_16x16x32_bf16 v[156:159], v[28:31], a[140:143], v[156:159]
 buffer_load_dwordx4 a[252:255], v2, s[8:11], s55 offen offset:2048 sc1
 v_mfma_f32_16x16x32_bf16 v[156:159], v[32:35], a[156:159], v[156:159]
 s_waitcnt lgkmcnt(4)
 v_mfma_f32_16x16x32_bf16 v[160:163], v[36:39], a[112:115], v[160:163]
 s_waitcnt lgkmcnt(2)
 ds_read_b64_tr_b16 v[24:25], v6 offset:12288
 v_mfma_f32_16x16x32_bf16 v[160:163], v[40:43], a[128:131], v[160:163]
 s_waitcnt lgkmcnt(1)
 ds_read_b64_tr_b16 v[26:27], v6 offset:12800
 v_mfma_f32_16x16x32_bf16 v[160:163], v[44:47], a[144:147], v[160:163]
 ds_read_b64_tr_b16 v[28:29], v6 offset:16384
 v_mfma_f32_16x16x32_bf16 v[164:167], v[36:39], a[116:119], v[164:167]
 ds_read_b64_tr_b16 v[30:31], v6 offset:16896
 v_mfma_f32_16x16x32_bf16 v[164:167], v[40:43], a[132:135], v[164:167]
 ds_read_b64_tr_b16 v[32:33], v6 offset:20480
 v_mfma_f32_16x16x32_bf16 v[164:167], v[44:47], a[148:151], v[164:167]
 ds_read_b64_tr_b16 v[34:35], v6 offset:20992
 v_mfma_f32_16x16x32_bf16 v[168:171], v[36:39], a[120:123], v[168:171]
 v_mfma_f32_16x16x32_bf16 v[168:171], v[40:43], a[136:139], v[168:171]
 v_mfma_f32_16x16x32_bf16 v[168:171], v[44:47], a[152:155], v[168:171]
 v_mfma_f32_16x16x32_bf16 v[172:175], v[36:39], a[124:127], v[172:175]
 v_mfma_f32_16x16x32_bf16 v[172:175], v[40:43], a[140:143], v[172:175]
 v_mfma_f32_16x16x32_bf16 v[172:175], v[44:47], a[156:159], v[172:175]
 s_waitcnt lgkmcnt(4)
 v_mfma_f32_16x16x32_bf16 v[176:179], v[24:27], a[112:115], v[176:179]
 s_waitcnt lgkmcnt(2)
 ds_read_b64_tr_b16 v[36:37], v7 offset:12288
 v_mfma_f32_16x16x32_bf16 v[176:179], v[28:31], a[128:131], v[176:179]
 s_waitcnt lgkmcnt(1)
 ds_read_b64_tr_b16 v[38:39], v7 offset:12800
 v_mfma_f32_16x16x32_bf16 v[176:179], v[32:35], a[144:147], v[176:179]
 ds_read_b64_tr_b16 v[40:41], v7 offset:16384
 v_mfma_f32_16x16x32_bf16 v[180:183], v[24:27], a[116:119], v[180:183]
 ds_read_b64_tr_b16 v[42:43], v7 offset:16896
 v_mfma_f32_16x16x32_bf16 v[180:183], v[28:31], a[132:135], v[180:183]
 ds_read_b64_tr_b16 v[44:45], v7 offset:20480
 v_mfma_f32_16x16x32_bf16 v[180:183], v[32:35], a[148:151], v[180:183]
 ds_read_b64_tr_b16 v[46:47], v7 offset:20992
 v_mfma_f32_16x16x32_bf16 v[184:187], v[24:27], a[120:123], v[184:187]
 s_add_u32 m0, s70, 90112
 v_mfma_f32_16x16x32_bf16 v[184:187], v[28:31], a[136:139], v[184:187]
 s_add_u32 s58, s84, 0
 buffer_load_dwordx4 v3, s[16:19], s58 offen nt lds
 v_mfma_f32_16x16x32_bf16 v[184:187], v[32:35], a[152:155], v[184:187]
 v_mfma_f32_16x16x32_bf16 v[188:191], v[24:27], a[124:127], v[188:191]
 s_add_u32 m0, s70, 94208
 v_mfma_f32_16x16x32_bf16 v[188:191], v[28:31], a[140:143], v[188:191]
 s_add_u32 s58, s84, 294912
 buffer_load_dwordx4 v3, s[16:19], s58 offen nt lds
 v_mfma_f32_16x16x32_bf16 v[188:191], v[32:35], a[156:159], v[188:191]
 s_waitcnt lgkmcnt(4)
 v_mfma_f32_16x16x32_bf16 v[192:195], v[36:39], a[112:115], v[192:195]
 s_waitcnt lgkmcnt(2)
 ds_read_b64_tr_b16 v[24:25], v8 offset:12288
 v_mfma_f32_16x16x32_bf16 v[192:195], v[40:43], a[128:131], v[192:195]
 s_waitcnt lgkmcnt(1)
 ds_read_b64_tr_b16 v[26:27], v8 offset:12800
 v_mfma_f32_16x16x32_bf16 v[192:195], v[44:47], a[144:147], v[192:195]
 ds_read_b64_tr_b16 v[28:29], v8 offset:16384
 v_mfma_f32_16x16x32_bf16 v[196:199], v[36:39], a[116:119], v[196:199]
 ds_read_b64_tr_b16 v[30:31], v8 offset:16896
 v_mfma_f32_16x16x32_bf16 v[196:199], v[40:43], a[132:135], v[196:199]
 ds_read_b64_tr_b16 v[32:33], v8 offset:20480
 v_mfma_f32_16x16x32_bf16 v[196:199], v[44:47], a[148:151], v[196:199]
 ds_read_b64_tr_b16 v[34:35], v8 offset:20992
 v_mfma_f32_16x16x32_bf16 v[200:203], v[36:39], a[120:123], v[200:203]
 s_add_u32 m0, s70, 98304
 v_mfma_f32_16x16x32_bf16 v[200:203], v[40:43], a[136:139], v[200:203]
 s_add_u32 s58, s84, 589824
 buffer_load_dwordx4 v3, s[16:19], s58 offen nt lds
 v_mfma_f32_16x16x32_bf16 v[200:203], v[44:47], a[152:155], v[200:203]
 s_add_u32 m0, s70, 102400
 v_mfma_f32_16x16x32_bf16 v[204:207], v[36:39], a[124:127], v[204:207]
 s_add_u32 s58, s85, 0
 buffer_load_dwordx4 v3, s[16:19], s58 offen nt lds
 v_mfma_f32_16x16x32_bf16 v[204:207], v[40:43], a[140:143], v[204:207]
 v_mfma_f32_16x16x32_bf16 v[204:207], v[44:47], a[156:159], v[204:207]
 s_waitcnt lgkmcnt(4)
 v_mfma_f32_16x16x32_bf16 v[208:211], v[24:27], a[112:115], v[208:211]
 s_waitcnt lgkmcnt(2)
 ds_read_b64_tr_b16 v[36:37], v9 offset:12288
 v_mfma_f32_16x16x32_bf16 v[208:211], v[28:31], a[128:131], v[208:211]
 s_waitcnt lgkmcnt(1)
 ds_read_b64_tr_b16 v[38:39], v9 offset:12800
 v_mfma_f32_16x16x32_bf16 v[208:211], v[32:35], a[144:147], v[208:211]
 ds_read_b64_tr_b16 v[40:41], v9 offset:16384
 v_mfma_f32_16x16x32_bf16 v[212:215], v[24:27], a[116:119], v[212:215]
 ds_read_b64_tr_b16 v[42:43], v9 offset:16896
 v_mfma_f32_16x16x32_bf16 v[212:215], v[28:31], a[132:135], v[212:215]
 ds_read_b64_tr_b16 v[44:45], v9 offset:20480
 v_mfma_f32_16x16x32_bf16 v[212:215], v[32:35], a[148:151], v[212:215]
 s_add_u32 m0, s70, 106496
 ds_read_b64_tr_b16 v[46:47], v9 offset:20992
 v_mfma_f32_16x16x32_bf16 v[216:219], v[24:27], a[120:123], v[216:219]
 s_add_u32 s58, s85, 294912
 buffer_load_dwordx4 v3, s[16:19], s58 offen nt lds
 v_mfma_f32_16x16x32_bf16 v[216:219], v[28:31], a[136:139], v[216:219]
 v_mfma_f32_16x16x32_bf16 v[216:219], v[32:35], a[152:155], v[216:219]
 s_add_u32 m0, s70, 110592
 v_mfma_f32_16x16x32_bf16 v[220:223], v[24:27], a[124:127], v[220:223]
 s_add_u32 s58, s85, 589824
 buffer_load_dwordx4 v3, s[16:19], s58 offen nt lds
 v_mfma_f32_16x16x32_bf16 v[220:223], v[28:31], a[140:143], v[220:223]
 v_mfma_f32_16x16x32_bf16 v[220:223], v[32:35], a[156:159], v[220:223]
 s_waitcnt vmcnt(30)
 s_barrier
 s_waitcnt lgkmcnt(4)
 v_mfma_f32_16x16x32_bf16 v[224:227], v[36:39], a[112:115], v[224:227]
 s_waitcnt lgkmcnt(2)
 ds_read_b64_tr_b16 v[24:25], v6 offset:24576
 v_mfma_f32_16x16x32_bf16 v[224:227], v[40:43], a[128:131], v[224:227]
 s_waitcnt lgkmcnt(1)
 ds_read_b64_tr_b16 v[26:27], v6 offset:25088
 v_mfma_f32_16x16x32_bf16 v[224:227], v[44:47], a[144:147], v[224:227]
 ds_read_b64_tr_b16 v[28:29], v6 offset:28672
 v_mfma_f32_16x16x32_bf16 v[228:231], v[36:39], a[116:119], v[228:231]
 ds_read_b64_tr_b16 v[30:31], v6 offset:29184
 v_mfma_f32_16x16x32_bf16 v[228:231], v[40:43], a[132:135], v[228:231]
 ds_read_b64_tr_b16 v[32:33], v6 offset:32768
 v_mfma_f32_16x16x32_bf16 v[228:231], v[44:47], a[148:151], v[228:231]
 ds_read_b64_tr_b16 v[34:35], v6 offset:33280
 v_mfma_f32_16x16x32_bf16 v[232:235], v[36:39], a[120:123], v[232:235]
 v_mfma_f32_16x16x32_bf16 v[232:235], v[40:43], a[136:139], v[232:235]
 v_mfma_f32_16x16x32_bf16 v[232:235], v[44:47], a[152:155], v[232:235]
 v_mfma_f32_16x16x32_bf16 v[236:239], v[36:39], a[124:127], v[236:239]
 v_mfma_f32_16x16x32_bf16 v[236:239], v[40:43], a[140:143], v[236:239]
 v_mfma_f32_16x16x32_bf16 v[236:239], v[44:47], a[156:159], v[236:239]
 s_waitcnt lgkmcnt(4)
 s_waitcnt vmcnt(29)
 v_mfma_f32_16x16x32_bf16 v[112:115], v[24:27], a[160:163], v[112:115]
 s_waitcnt lgkmcnt(2)
 ds_read_b64_tr_b16 v[36:37], v7 offset:24576
 s_waitcnt vmcnt(28)
 v_mfma_f32_16x16x32_bf16 v[112:115], v[28:31], a[176:179], v[112:115]
 s_waitcnt lgkmcnt(1)
 ds_read_b64_tr_b16 v[38:39], v7 offset:25088
 s_waitcnt vmcnt(27)
 v_mfma_f32_16x16x32_bf16 v[112:115], v[32:35], a[192:195], v[112:115]
 ds_read_b64_tr_b16 v[40:41], v7 offset:28672
 s_waitcnt vmcnt(26)
 v_mfma_f32_16x16x32_bf16 v[116:119], v[24:27], a[164:167], v[116:119]
 ds_read_b64_tr_b16 v[42:43], v7 offset:29184
 s_waitcnt vmcnt(25)
 v_mfma_f32_16x16x32_bf16 v[116:119], v[28:31], a[180:183], v[116:119]
 ds_read_b64_tr_b16 v[44:45], v7 offset:32768
 s_waitcnt vmcnt(24)
 v_mfma_f32_16x16x32_bf16 v[116:119], v[32:35], a[196:199], v[116:119]
 ds_read_b64_tr_b16 v[46:47], v7 offset:33280
 s_waitcnt vmcnt(23)
 v_mfma_f32_16x16x32_bf16 v[120:123], v[24:27], a[168:171], v[120:123]
 s_add_u32 m0, s70, 114688
 s_waitcnt vmcnt(22)
 v_mfma_f32_16x16x32_bf16 v[120:123], v[28:31], a[184:187], v[120:123]
 s_add_u32 s58, s80, 128
 buffer_load_dwordx4 v3, s[12:15], s58 offen nt lds
 s_waitcnt vmcnt(22)
 v_mfma_f32_16x16x32_bf16 v[120:123], v[32:35], a[200:203], v[120:123]
 s_waitcnt vmcnt(21)
 v_mfma_f32_16x16x32_bf16 v[124:127], v[24:27], a[172:175], v[124:127]
 s_add_u32 m0, s70, 118784
 s_waitcnt vmcnt(20)
 v_mfma_f32_16x16x32_bf16 v[124:127], v[28:31], a[188:191], v[124:127]
 s_add_u32 s58, s80, 295040
 buffer_load_dwordx4 v3, s[12:15], s58 offen nt lds
 s_waitcnt vmcnt(20)
 v_mfma_f32_16x16x32_bf16 v[124:127], v[32:35], a[204:207], v[124:127]
 s_waitcnt lgkmcnt(4)
 v_mfma_f32_16x16x32_bf16 v[128:131], v[36:39], a[160:163], v[128:131]
 s_waitcnt lgkmcnt(2)
 ds_read_b64_tr_b16 v[24:25], v8 offset:24576
 v_mfma_f32_16x16x32_bf16 v[128:131], v[40:43], a[176:179], v[128:131]
 s_waitcnt lgkmcnt(1)
 ds_read_b64_tr_b16 v[26:27], v8 offset:25088
 v_mfma_f32_16x16x32_bf16 v[128:131], v[44:47], a[192:195], v[128:131]
 ds_read_b64_tr_b16 v[28:29], v8 offset:28672
 v_mfma_f32_16x16x32_bf16 v[132:135], v[36:39], a[164:167], v[132:135]
 ds_read_b64_tr_b16 v[30:31], v8 offset:29184
 v_mfma_f32_16x16x32_bf16 v[132:135], v[40:43], a[180:183], v[132:135]
 ds_read_b64_tr_b16 v[32:33], v8 offset:32768
 v_mfma_f32_16x16x32_bf16 v[132:135], v[44:47], a[196:199], v[132:135]
 ds_read_b64_tr_b16 v[34:35], v8 offset:33280
 v_mfma_f32_16x16x32_bf16 v[136:139], v[36:39], a[168:171], v[136:139]
 s_add_u32 m0, s70, 122880
 v_mfma_f32_16x16x32_bf16 v[136:139], v[40:43], a[184:187], v[136:139]
 s_add_u32 s58, s80, 589952
 buffer_load_dwordx4 v3, s[12:15], s58 offen nt lds
 v_mfma_f32_16x16x32_bf16 v[136:139], v[44:47], a[200:203], v[136:139]
 s_add_u32 m0, s70, 126976
 v_mfma_f32_16x16x32_bf16 v[140:143], v[36:39], a[172:175], v[140:143]
 s_add_u32 s58, s81, 128
 buffer_load_dwordx4 v3, s[12:15], s58 offen nt lds
 v_mfma_f32_16x16x32_bf16 v[140:143], v[40:43], a[188:191], v[140:143]
 v_mfma_f32_16x16x32_bf16 v[140:143], v[44:47], a[204:207], v[140:143]
 s_waitcnt lgkmcnt(4)
 v_mfma_f32_16x16x32_bf16 v[144:147], v[24:27], a[160:163], v[144:147]
 s_waitcnt lgkmcnt(2)
 ds_read_b64_tr_b16 v[36:37], v9 offset:24576
 v_mfma_f32_16x16x32_bf16 v[144:147], v[28:31], a[176:179], v[144:147]
 s_waitcnt lgkmcnt(1)
 ds_read_b64_tr_b16 v[38:39], v9 offset:25088
 v_mfma_f32_16x16x32_bf16 v[144:147], v[32:35], a[192:195], v[144:147]
 ds_read_b64_tr_b16 v[40:41], v9 offset:28672
 v_mfma_f32_16x16x32_bf16 v[148:151], v[24:27], a[164:167], v[148:151]
 ds_read_b64_tr_b16 v[42:43], v9 offset:29184
 v_mfma_f32_16x16x32_bf16 v[148:151], v[28:31], a[180:183], v[148:151]
 ds_read_b64_tr_b16 v[44:45], v9 offset:32768
 v_mfma_f32_16x16x32_bf16 v[148:151], v[32:35], a[196:199], v[148:151]
 s_add_u32 m0, s70, 131072
 ds_read_b64_tr_b16 v[46:47], v9 offset:33280
 v_mfma_f32_16x16x32_bf16 v[152:155], v[24:27], a[168:171], v[152:155]
 s_add_u32 s58, s81, 295040
 buffer_load_dwordx4 v3, s[12:15], s58 offen nt lds
 v_mfma_f32_16x16x32_bf16 v[152:155], v[28:31], a[184:187], v[152:155]
 v_mfma_f32_16x16x32_bf16 v[152:155], v[32:35], a[200:203], v[152:155]
 s_add_u32 m0, s70, 135168
 v_mfma_f32_16x16x32_bf16 v[156:159], v[24:27], a[172:175], v[156:159]
 s_add_u32 s58, s81, 589952
 buffer_load_dwordx4 v3, s[12:15], s58 offen nt lds
 v_mfma_f32_16x16x32_bf16 v[156:159], v[28:31], a[188:191], v[156:159]
 v_mfma_f32_16x16x32_bf16 v[156:159], v[32:35], a[204:207], v[156:159]
 s_waitcnt lgkmcnt(4)
 v_mfma_f32_16x16x32_bf16 v[160:163], v[36:39], a[160:163], v[160:163]
 s_waitcnt lgkmcnt(2)
 ds_read_b64_tr_b16 v[24:25], v6 offset:36864
 v_mfma_f32_16x16x32_bf16 v[160:163], v[40:43], a[176:179], v[160:163]
 s_waitcnt lgkmcnt(1)
 ds_read_b64_tr_b16 v[26:27], v6 offset:37376
 v_mfma_f32_16x16x32_bf16 v[160:163], v[44:47], a[192:195], v[160:163]
 ds_read_b64_tr_b16 v[28:29], v6 offset:40960
 v_mfma_f32_16x16x32_bf16 v[164:167], v[36:39], a[164:167], v[164:167]
 ds_read_b64_tr_b16 v[30:31], v6 offset:41472
 v_mfma_f32_16x16x32_bf16 v[164:167], v[40:43], a[180:183], v[164:167]
 ds_read_b64_tr_b16 v[32:33], v6 offset:45056
 v_mfma_f32_16x16x32_bf16 v[164:167], v[44:47], a[196:199], v[164:167]
 ds_read_b64_tr_b16 v[34:35], v6 offset:45568
 v_mfma_f32_16x16x32_bf16 v[168:171], v[36:39], a[168:171], v[168:171]
 v_mfma_f32_16x16x32_bf16 v[168:171], v[40:43], a[184:187], v[168:171]
 v_mfma_f32_16x16x32_bf16 v[168:171], v[44:47], a[200:203], v[168:171]
 v_mfma_f32_16x16x32_bf16 v[172:175], v[36:39], a[172:175], v[172:175]
 v_mfma_f32_16x16x32_bf16 v[172:175], v[40:43], a[188:191], v[172:175]
 v_mfma_f32_16x16x32_bf16 v[172:175], v[44:47], a[204:207], v[172:175]
 s_waitcnt lgkmcnt(4)
 s_waitcnt vmcnt(23)
 v_mfma_f32_16x16x32_bf16 v[112:115], v[24:27], a[208:211], v[112:115]
 s_waitcnt lgkmcnt(2)
 ds_read_b64_tr_b16 v[36:37], v7 offset:36864
 s_waitcnt vmcnt(22)
 v_mfma_f32_16x16x32_bf16 v[112:115], v[28:31], a[224:227], v[112:115]
 s_waitcnt lgkmcnt(1)
 ds_read_b64_tr_b16 v[38:39], v7 offset:37376
 s_waitcnt vmcnt(21)
 v_mfma_f32_16x16x32_bf16 v[112:115], v[32:35], a[240:243], v[112:115]
 ds_read_b64_tr_b16 v[40:41], v7 offset:40960
 s_waitcnt vmcnt(20)
 v_mfma_f32_16x16x32_bf16 v[116:119], v[24:27], a[212:215], v[116:119]
 ds_read_b64_tr_b16 v[42:43], v7 offset:41472
 s_waitcnt vmcnt(19)
 v_mfma_f32_16x16x32_bf16 v[116:119], v[28:31], a[228:231], v[116:119]
 ds_read_b64_tr_b16 v[44:45], v7 offset:45056
 s_waitcnt vmcnt(18)
 v_mfma_f32_16x16x32_bf16 v[116:119], v[32:35], a[244:247], v[116:119]
 ds_read_b64_tr_b16 v[46:47], v7 offset:45568
 s_waitcnt vmcnt(17)
 v_mfma_f32_16x16x32_bf16 v[120:123], v[24:27], a[216:219], v[120:123]
 s_add_u32 m0, s70, 139264
 s_waitcnt vmcnt(16)
 v_mfma_f32_16x16x32_bf16 v[120:123], v[28:31], a[232:235], v[120:123]
 s_add_u32 s58, s82, 128
 buffer_load_dwordx4 v3, s[12:15], s58 offen nt lds
 s_waitcnt vmcnt(16)
 v_mfma_f32_16x16x32_bf16 v[120:123], v[32:35], a[248:251], v[120:123]
 s_waitcnt vmcnt(15)
 v_mfma_f32_16x16x32_bf16 v[124:127], v[24:27], a[220:223], v[124:127]
 s_add_u32 m0, s70, 143360
 s_waitcnt vmcnt(14)
 v_mfma_f32_16x16x32_bf16 v[124:127], v[28:31], a[236:239], v[124:127]
 s_add_u32 s58, s82, 295040
 buffer_load_dwordx4 v3, s[12:15], s58 offen nt lds
 s_waitcnt vmcnt(14)
 v_mfma_f32_16x16x32_bf16 v[124:127], v[32:35], a[252:255], v[124:127]
 s_waitcnt lgkmcnt(4)
 v_mfma_f32_16x16x32_bf16 v[128:131], v[36:39], a[208:211], v[128:131]
 s_waitcnt lgkmcnt(2)
 ds_read_b64_tr_b16 v[24:25], v8 offset:36864
 v_mfma_f32_16x16x32_bf16 v[128:131], v[40:43], a[224:227], v[128:131]
 s_waitcnt lgkmcnt(1)
 ds_read_b64_tr_b16 v[26:27], v8 offset:37376
 v_mfma_f32_16x16x32_bf16 v[128:131], v[44:47], a[240:243], v[128:131]
 ds_read_b64_tr_b16 v[28:29], v8 offset:40960
 v_mfma_f32_16x16x32_bf16 v[132:135], v[36:39], a[212:215], v[132:135]
 ds_read_b64_tr_b16 v[30:31], v8 offset:41472
 v_mfma_f32_16x16x32_bf16 v[132:135], v[40:43], a[228:231], v[132:135]
 ds_read_b64_tr_b16 v[32:33], v8 offset:45056
 v_mfma_f32_16x16x32_bf16 v[132:135], v[44:47], a[244:247], v[132:135]
 ds_read_b64_tr_b16 v[34:35], v8 offset:45568
 v_mfma_f32_16x16x32_bf16 v[136:139], v[36:39], a[216:219], v[136:139]
 s_add_u32 m0, s70, 147456
 v_mfma_f32_16x16x32_bf16 v[136:139], v[40:43], a[232:235], v[136:139]
 s_add_u32 s58, s82, 589952
 buffer_load_dwordx4 v3, s[12:15], s58 offen nt lds
 v_mfma_f32_16x16x32_bf16 v[136:139], v[44:47], a[248:251], v[136:139]
 s_add_u32 m0, s70, 151552
 v_mfma_f32_16x16x32_bf16 v[140:143], v[36:39], a[220:223], v[140:143]
 s_add_u32 s58, s83, 128
 buffer_load_dwordx4 v3, s[12:15], s58 offen nt lds
 v_mfma_f32_16x16x32_bf16 v[140:143], v[40:43], a[236:239], v[140:143]
 v_mfma_f32_16x16x32_bf16 v[140:143], v[44:47], a[252:255], v[140:143]
 s_waitcnt lgkmcnt(4)
 v_mfma_f32_16x16x32_bf16 v[144:147], v[24:27], a[208:211], v[144:147]
 s_waitcnt lgkmcnt(2)
 ds_read_b64_tr_b16 v[36:37], v9 offset:36864
 v_mfma_f32_16x16x32_bf16 v[144:147], v[28:31], a[224:227], v[144:147]
 s_waitcnt lgkmcnt(1)
 ds_read_b64_tr_b16 v[38:39], v9 offset:37376
 v_mfma_f32_16x16x32_bf16 v[144:147], v[32:35], a[240:243], v[144:147]
 ds_read_b64_tr_b16 v[40:41], v9 offset:40960
 v_mfma_f32_16x16x32_bf16 v[148:151], v[24:27], a[212:215], v[148:151]
 ds_read_b64_tr_b16 v[42:43], v9 offset:41472
 v_mfma_f32_16x16x32_bf16 v[148:151], v[28:31], a[228:231], v[148:151]
 ds_read_b64_tr_b16 v[44:45], v9 offset:45056
 v_mfma_f32_16x16x32_bf16 v[148:151], v[32:35], a[244:247], v[148:151]
 s_add_u32 m0, s70, 155648
 ds_read_b64_tr_b16 v[46:47], v9 offset:45568
 v_mfma_f32_16x16x32_bf16 v[152:155], v[24:27], a[216:219], v[152:155]
 s_add_u32 s58, s83, 295040
 buffer_load_dwordx4 v3, s[12:15], s58 offen nt lds
 v_mfma_f32_16x16x32_bf16 v[152:155], v[28:31], a[232:235], v[152:155]
 v_mfma_f32_16x16x32_bf16 v[152:155], v[32:35], a[248:251], v[152:155]
 s_add_u32 m0, s70, 159744
 v_mfma_f32_16x16x32_bf16 v[156:159], v[24:27], a[220:223], v[156:159]
 s_add_u32 s58, s83, 589952
 buffer_load_dwordx4 v3, s[12:15], s58 offen nt lds
 v_mfma_f32_16x16x32_bf16 v[156:159], v[28:31], a[236:239], v[156:159]
 v_mfma_f32_16x16x32_bf16 v[156:159], v[32:35], a[252:255], v[156:159]
 s_waitcnt vmcnt(12)
 s_barrier
 s_waitcnt lgkmcnt(4)
 v_mfma_f32_16x16x32_bf16 v[160:163], v[36:39], a[208:211], v[160:163]
 s_waitcnt lgkmcnt(2)
 ds_read_b64_tr_b16 v[24:25], v6 offset:49152
 v_mfma_f32_16x16x32_bf16 v[160:163], v[40:43], a[224:227], v[160:163]
 s_waitcnt lgkmcnt(1)
 ds_read_b64_tr_b16 v[26:27], v6 offset:49664
 v_mfma_f32_16x16x32_bf16 v[160:163], v[44:47], a[240:243], v[160:163]
 ds_read_b64_tr_b16 v[28:29], v6 offset:53248
 v_mfma_f32_16x16x32_bf16 v[164:167], v[36:39], a[212:215], v[164:167]
 ds_read_b64_tr_b16 v[30:31], v6 offset:53760
 v_mfma_f32_16x16x32_bf16 v[164:167], v[40:43], a[228:231], v[164:167]
 ds_read_b64_tr_b16 v[32:33], v6 offset:57344
 v_mfma_f32_16x16x32_bf16 v[164:167], v[44:47], a[244:247], v[164:167]
 ds_read_b64_tr_b16 v[34:35], v6 offset:57856
 v_mfma_f32_16x16x32_bf16 v[168:171], v[36:39], a[216:219], v[168:171]
 v_mfma_f32_16x16x32_bf16 v[168:171], v[40:43], a[232:235], v[168:171]
 v_mfma_f32_16x16x32_bf16 v[168:171], v[44:47], a[248:251], v[168:171]
 v_mfma_f32_16x16x32_bf16 v[172:175], v[36:39], a[220:223], v[172:175]
 v_mfma_f32_16x16x32_bf16 v[172:175], v[40:43], a[236:239], v[172:175]
 v_mfma_f32_16x16x32_bf16 v[172:175], v[44:47], a[252:255], v[172:175]
 s_waitcnt lgkmcnt(4)
 v_mfma_f32_16x16x32_bf16 v[176:179], v[24:27], a[160:163], v[176:179]
 s_waitcnt lgkmcnt(2)
 ds_read_b64_tr_b16 v[36:37], v7 offset:49152
 v_mfma_f32_16x16x32_bf16 v[176:179], v[28:31], a[176:179], v[176:179]
 s_waitcnt lgkmcnt(1)
 ds_read_b64_tr_b16 v[38:39], v7 offset:49664
 v_mfma_f32_16x16x32_bf16 v[176:179], v[32:35], a[192:195], v[176:179]
 ds_read_b64_tr_b16 v[40:41], v7 offset:53248
 v_mul_f32 v16, s74, v112
 v_mfma_f32_16x16x32_bf16 v[180:183], v[24:27], a[164:167], v[180:183]
 ds_read_b64_tr_b16 v[42:43], v7 offset:53760
 v_mul_f32 v17, s74, v113
 v_mul_f32 v18, s74, v114
 v_mfma_f32_16x16x32_bf16 v[180:183], v[28:31], a[180:183], v[180:183]
 ds_read_b64_tr_b16 v[44:45], v7 offset:57344
 v_mul_f32 v19, s74, v115
 v_mfma_f32_16x16x32_bf16 v[180:183], v[32:35], a[196:199], v[180:183]
 ds_read_b64_tr_b16 v[46:47], v7 offset:57856
 v_exp_f32 v16, v16
 v_mfma_f32_16x16x32_bf16 v[184:187], v[24:27], a[168:171], v[184:187]
 v_exp_f32 v17, v17
 v_mfma_f32_16x16x32_bf16 v[184:187], v[28:31], a[184:187], v[184:187]
 s_add_u32 m0, s70, 40960
 v_exp_f32 v18, v18
 v_add_f32 v16, 1.0, v16
 v_mfma_f32_16x16x32_bf16 v[184:187], v[32:35], a[200:203], v[184:187]
 s_add_u32 s58, s84, 128
 buffer_load_dwordx4 v3, s[12:15], s58 offen nt lds
 v_add_f32 v17, 1.0, v17
 v_mfma_f32_16x16x32_bf16 v[188:191], v[24:27], a[172:175], v[188:191]
 v_exp_f32 v19, v19
 v_add_f32 v18, 1.0, v18
 v_mfma_f32_16x16x32_bf16 v[188:191], v[28:31], a[188:191], v[188:191]
 v_rcp_f32 v16, v16
 v_mfma_f32_16x16x32_bf16 v[188:191], v[32:35], a[204:207], v[188:191]
 s_waitcnt lgkmcnt(4)
 v_rcp_f32 v17, v17
 v_add_f32 v19, 1.0, v19
 v_mfma_f32_16x16x32_bf16 v[192:195], v[36:39], a[160:163], v[192:195]
 s_waitcnt lgkmcnt(2)
 ds_read_b64_tr_b16 v[24:25], v8 offset:49152
 v_rcp_f32 v18, v18
 v_mfma_f32_16x16x32_bf16 v[192:195], v[40:43], a[176:179], v[192:195]
 s_waitcnt lgkmcnt(1)
 ds_read_b64_tr_b16 v[26:27], v8 offset:49664
 v_rcp_f32 v19, v19
 v_mfma_f32_16x16x32_bf16 v[192:195], v[44:47], a[192:195], v[192:195]
 ds_read_b64_tr_b16 v[28:29], v8 offset:53248
 v_mul_f32 v112, v112, v16
 v_mfma_f32_16x16x32_bf16 v[196:199], v[36:39], a[164:167], v[196:199]
 ds_read_b64_tr_b16 v[30:31], v8 offset:53760
 v_mul_f32 v113, v113, v17
 v_mul_f32 v114, v114, v18
 v_mfma_f32_16x16x32_bf16 v[196:199], v[40:43], a[180:183], v[196:199]
 ds_read_b64_tr_b16 v[32:33], v8 offset:57344
 v_mul_f32 v115, v115, v19
 v_mul_f32 v20, s74, v128
 v_mfma_f32_16x16x32_bf16 v[196:199], v[44:47], a[196:199], v[196:199]
 ds_read_b64_tr_b16 v[34:35], v8 offset:57856
 v_mul_f32 v21, s74, v129
 v_mul_f32 v22, s74, v130
 v_mfma_f32_16x16x32_bf16 v[200:203], v[36:39], a[168:171], v[200:203]
 s_add_u32 m0, s70, 45056
 v_exp_f32 v20, v20
 v_mfma_f32_16x16x32_bf16 v[200:203], v[40:43], a[184:187], v[200:203]
 s_add_u32 s58, s84, 295040
 buffer_load_dwordx4 v3, s[12:15], s58 offen nt lds
 v_mul_f32 v23, s74, v131
 v_mfma_f32_16x16x32_bf16 v[200:203], v[44:47], a[200:203], v[200:203]
 v_exp_f32 v21, v21
 v_add_f32 v20, 1.0, v20
 v_mfma_f32_16x16x32_bf16 v[204:207], v[36:39], a[172:175], v[204:207]
 v_exp_f32 v22, v22
 v_mul_f32 v16, s74, v116
 v_mfma_f32_16x16x32_bf16 v[204:207], v[40:43], a[188:191], v[204:207]
 v_exp_f32 v23, v23
 v_mfma_f32_16x16x32_bf16 v[204:207], v[44:47], a[204:207], v[204:207]
 s_waitcnt lgkmcnt(4)
 v_rcp_f32 v20, v20
 v_add_f32 v21, 1.0, v21
 v_mfma_f32_16x16x32_bf16 v[208:211], v[24:27], a[160:163], v[208:211]
 s_waitcnt lgkmcnt(2)
 ds_read_b64_tr_b16 v[36:37], v9 offset:49152
 v_add_f32 v22, 1.0, v22
 v_add_f32 v23, 1.0, v23
 v_mfma_f32_16x16x32_bf16 v[208:211], v[28:31], a[176:179], v[208:211]
 s_waitcnt lgkmcnt(1)
 ds_read_b64_tr_b16 v[38:39], v9 offset:49664
 v_rcp_f32 v21, v21
 v_mfma_f32_16x16x32_bf16 v[208:211], v[32:35], a[192:195], v[208:211]
 ds_read_b64_tr_b16 v[40:41], v9 offset:53248
 v_mul_f32 v128, v128, v20
 v_mfma_f32_16x16x32_bf16 v[212:215], v[24:27], a[164:167], v[212:215]
 ds_read_b64_tr_b16 v[42:43], v9 offset:53760
 v_rcp_f32 v22, v22
 v_mfma_f32_16x16x32_bf16 v[212:215], v[28:31], a[180:183], v[212:215]
 ds_read_b64_tr_b16 v[44:45], v9 offset:57344
 v_rcp_f32 v23, v23
 v_mfma_f32_16x16x32_bf16 v[212:215], v[32:35], a[196:199], v[212:215]
 ds_read_b64_tr_b16 v[46:47], v9 offset:57856
 v_mul_f32 v129, v129, v21
 v_mul_f32 v130, v130, v22
 v_mfma_f32_16x16x32_bf16 v[216:219], v[24:27], a[168:171], v[216:219]
 v_add_u32 v6, 0xc000, v6
 v_add_u32 v7, 0xc000, v7
 v_mul_f32 v131, v131, v23
 v_mfma_f32_16x16x32_bf16 v[216:219], v[28:31], a[184:187], v[216:219]
 s_add_u32 m0, s70, 49152
 v_add_u32 v8, 0xc000, v8
 v_add_u32 v9, 0xc000, v9
 v_mfma_f32_16x16x32_bf16 v[216:219], v[32:35], a[200:203], v[216:219]
 s_add_u32 s58, s84, 589952
 buffer_load_dwordx4 v3, s[12:15], s58 offen nt lds
 v_mul_f32 v17, s74, v117
 v_mfma_f32_16x16x32_bf16 v[220:223], v[24:27], a[172:175], v[220:223]
 v_exp_f32 v16, v16
 v_mul_f32 v18, s74, v118
 v_mfma_f32_16x16x32_bf16 v[220:223], v[28:31], a[188:191], v[220:223]
 v_exp_f32 v17, v17
 v_mul_f32 v19, s74, v119
 v_mfma_f32_16x16x32_bf16 v[220:223], v[32:35], a[204:207], v[220:223]
 s_waitcnt lgkmcnt(4)
 v_exp_f32 v18, v18
 v_mfma_f32_16x16x32_bf16 v[224:227], v[36:39], a[160:163], v[224:227]
 s_waitcnt lgkmcnt(2)
 ds_read_b64_tr_b16 v[24:25], v6 offset:12288
 v_exp_f32 v19, v19
 v_mfma_f32_16x16x32_bf16 v[224:227], v[40:43], a[176:179], v[224:227]
 s_waitcnt lgkmcnt(1)
 ds_read_b64_tr_b16 v[26:27], v6 offset:12800
 v_add_f32 v16, 1.0, v16
 v_add_f32 v17, 1.0, v17
 v_mfma_f32_16x16x32_bf16 v[224:227], v[44:47], a[192:195], v[224:227]
 ds_read_b64_tr_b16 v[28:29], v6 offset:16384
 v_add_f32 v18, 1.0, v18
 v_add_f32 v19, 1.0, v19
 v_mfma_f32_16x16x32_bf16 v[228:231], v[36:39], a[164:167], v[228:231]
 ds_read_b64_tr_b16 v[30:31], v6 offset:16896
 v_mul_f32 v20, s74, v132
 v_mfma_f32_16x16x32_bf16 v[228:231], v[40:43], a[180:183], v[228:231]
 ds_read_b64_tr_b16 v[32:33], v6 offset:20480
 v_rcp_f32 v16, v16
 v_mfma_f32_16x16x32_bf16 v[228:231], v[44:47], a[196:199], v[228:231]
 ds_read_b64_tr_b16 v[34:35], v6 offset:20992
 v_rcp_f32 v17, v17
 v_mfma_f32_16x16x32_bf16 v[232:235], v[36:39], a[168:171], v[232:235]
 v_rcp_f32 v18, v18
 v_mul_f32 v116, v116, v16
 v_mfma_f32_16x16x32_bf16 v[232:235], v[40:43], a[184:187], v[232:235]
 v_rcp_f32 v19, v19
 v_mfma_f32_16x16x32_bf16 v[232:235], v[44:47], a[200:203], v[232:235]
 v_exp_f32 v20, v20
 v_mul_f32 v117, v117, v17
 v_mfma_f32_16x16x32_bf16 v[236:239], v[36:39], a[172:175], v[236:239]
 v_mul_f32 v118, v118, v18
 v_mul_f32 v119, v119, v19
 v_mul_f32 v21, s74, v133
 v_mfma_f32_16x16x32_bf16 v[236:239], v[40:43], a[188:191], v[236:239]
 v_mul_f32 v22, s74, v134
 v_mul_f32 v23, s74, v135
 v_add_f32 v20, 1.0, v20
 v_mfma_f32_16x16x32_bf16 v[236:239], v[44:47], a[204:207], v[236:239]
 s_waitcnt lgkmcnt(4)
 v_exp_f32 v21, v21
 v_mfma_f32_16x16x32_bf16 v[176:179], v[24:27], a[208:211], v[176:179]
 s_waitcnt lgkmcnt(2)
 ds_read_b64_tr_b16 v[36:37], v7 offset:12288
 v_exp_f32 v22, v22
 v_mfma_f32_16x16x32_bf16 v[176:179], v[28:31], a[224:227], v[176:179]
 s_waitcnt lgkmcnt(1)
 ds_read_b64_tr_b16 v[38:39], v7 offset:12800
 v_exp_f32 v23, v23
 v_mfma_f32_16x16x32_bf16 v[176:179], v[32:35], a[240:243], v[176:179]
 ds_read_b64_tr_b16 v[40:41], v7 offset:16384
 v_add_f32 v21, 1.0, v21
 v_add_f32 v22, 1.0, v22
 v_mfma_f32_16x16x32_bf16 v[180:183], v[24:27], a[212:215], v[180:183]
 ds_read_b64_tr_b16 v[42:43], v7 offset:16896
 v_add_f32 v23, 1.0, v23
 v_mul_f32 v16, s74, v120
 v_mfma_f32_16x16x32_bf16 v[180:183], v[28:31], a[228:231], v[180:183]
 ds_read_b64_tr_b16 v[44:45], v7 offset:20480
 v_mul_f32 v17, s74, v121
 v_mfma_f32_16x16x32_bf16 v[180:183], v[32:35], a[244:247], v[180:183]
 ds_read_b64_tr_b16 v[46:47], v7 offset:20992
 v_rcp_f32 v20, v20
 v_mfma_f32_16x16x32_bf16 v[184:187], v[24:27], a[216:219], v[184:187]
 v_rcp_f32 v21, v21
 v_mul_f32 v18, s74, v122
 v_mfma_f32_16x16x32_bf16 v[184:187], v[28:31], a[232:235], v[184:187]
 s_add_u32 m0, s70, 53248
 v_rcp_f32 v22, v22
 v_mul_f32 v132, v132, v20
 v_mfma_f32_16x16x32_bf16 v[184:187], v[32:35], a[248:251], v[184:187]
 s_add_u32 s58, s85, 128
 buffer_load_dwordx4 v3, s[12:15], s58 offen nt lds
 v_mfma_f32_16x16x32_bf16 v[188:191], v[24:27], a[220:223], v[188:191]
 v_cvt_pk_bf16_f32 v80, v176, v177
 v_cvt_pk_bf16_f32 v81, v178, v179
 v_mul_f32 v133, v133, v21
 v_mfma_f32_16x16x32_bf16 v[188:191], v[28:31], a[236:239], v[188:191]
 v_rcp_f32 v23, v23
 v_mul_f32 v134, v134, v22
 v_mfma_f32_16x16x32_bf16 v[188:191], v[32:35], a[252:255], v[188:191]
 s_waitcnt lgkmcnt(4)
 v_exp_f32 v16, v16
 v_mul_f32 v19, s74, v123
 v_mfma_f32_16x16x32_bf16 v[192:195], v[36:39], a[208:211], v[192:195]
 s_waitcnt lgkmcnt(2)
 ds_read_b64_tr_b16 v[24:25], v8 offset:12288
 v_cvt_pk_bf16_f32 v84, v180, v181
 v_mfma_f32_16x16x32_bf16 v[192:195], v[40:43], a[224:227], v[192:195]
 s_waitcnt lgkmcnt(1)
 ds_read_b64_tr_b16 v[26:27], v8 offset:12800
 v_cvt_pk_bf16_f32 v85, v182, v183
 v_mul_f32 v135, v135, v23
 v_mfma_f32_16x16x32_bf16 v[192:195], v[44:47], a[240:243], v[192:195]
 ds_read_b64_tr_b16 v[28:29], v8 offset:16384
 v_exp_f32 v17, v17
 v_mfma_f32_16x16x32_bf16 v[196:199], v[36:39], a[212:215], v[196:199]
 ds_read_b64_tr_b16 v[30:31], v8 offset:16896
 v_cvt_pk_bf16_f32 v88, v184, v185
 v_add_f32 v16, 1.0, v16
 v_mfma_f32_16x16x32_bf16 v[196:199], v[40:43], a[228:231], v[196:199]
 ds_read_b64_tr_b16 v[32:33], v8 offset:20480
 v_cvt_pk_bf16_f32 v89, v186, v187
 v_mfma_f32_16x16x32_bf16 v[196:199], v[44:47], a[244:247], v[196:199]
 ds_read_b64_tr_b16 v[34:35], v8 offset:20992
 v_exp_f32 v18, v18
 v_mfma_f32_16x16x32_bf16 v[200:203], v[36:39], a[216:219], v[200:203]
 v_cvt_pk_bf16_f32 v92, v188, v189
 v_cvt_pk_bf16_f32 v93, v190, v191
 v_add_f32 v17, 1.0, v17
 v_mfma_f32_16x16x32_bf16 v[200:203], v[40:43], a[232:235], v[200:203]
 s_add_u32 m0, s70, 57344
 v_exp_f32 v19, v19
 v_add_f32 v18, 1.0, v18
 v_mfma_f32_16x16x32_bf16 v[200:203], v[44:47], a[248:251], v[200:203]
 s_add_u32 s58, s85, 295040
 buffer_load_dwordx4 v3, s[12:15], s58 offen nt lds
 v_mfma_f32_16x16x32_bf16 v[204:207], v[36:39], a[220:223], v[204:207]
 v_cvt_pk_bf16_f32 v82, v192, v193
 v_cvt_pk_bf16_f32 v83, v194, v195
 v_add_f32 v19, 1.0, v19
 v_mfma_f32_16x16x32_bf16 v[204:207], v[40:43], a[236:239], v[204:207]
 v_rcp_f32 v16, v16
 v_mul_f32 v20, s74, v136
 v_mfma_f32_16x16x32_bf16 v[204:207], v[44:47], a[252:255], v[204:207]
 s_waitcnt lgkmcnt(4)
 v_rcp_f32 v17, v17
 v_mul_f32 v21, s74, v137
 v_mfma_f32_16x16x32_bf16 v[208:211], v[24:27], a[208:211], v[208:211]
 s_waitcnt lgkmcnt(2)
 ds_read_b64_tr_b16 v[36:37], v9 offset:12288
 v_cvt_pk_bf16_f32 v86, v196, v197
 v_mfma_f32_16x16x32_bf16 v[208:211], v[28:31], a[224:227], v[208:211]
 s_waitcnt lgkmcnt(1)
 ds_read_b64_tr_b16 v[38:39], v9 offset:12800
 v_cvt_pk_bf16_f32 v87, v198, v199
 v_mul_f32 v120, v120, v16
 v_mfma_f32_16x16x32_bf16 v[208:211], v[32:35], a[240:243], v[208:211]
 ds_read_b64_tr_b16 v[40:41], v9 offset:16384
 v_rcp_f32 v18, v18
 v_mfma_f32_16x16x32_bf16 v[212:215], v[24:27], a[212:215], v[212:215]
 ds_read_b64_tr_b16 v[42:43], v9 offset:16896
 v_cvt_pk_bf16_f32 v90, v200, v201
 v_mul_f32 v121, v121, v17
 v_mfma_f32_16x16x32_bf16 v[212:215], v[28:31], a[228:231], v[212:215]
 ds_read_b64_tr_b16 v[44:45], v9 offset:20480
 v_cvt_pk_bf16_f32 v91, v202, v203
 v_mul_f32 v122, v122, v18
 v_mfma_f32_16x16x32_bf16 v[212:215], v[32:35], a[244:247], v[212:215]
 ds_read_b64_tr_b16 v[46:47], v9 offset:20992
 v_mul_f32 v22, s74, v138
 v_mfma_f32_16x16x32_bf16 v[216:219], v[24:27], a[216:219], v[216:219]
 v_cvt_pk_bf16_f32 v94, v204, v205
 v_cvt_pk_bf16_f32 v95, v206, v207
 v_mul_f32 v23, s74, v139
 v_mfma_f32_16x16x32_bf16 v[216:219], v[28:31], a[232:235], v[216:219]
 s_add_u32 m0, s70, 61440
 v_rcp_f32 v19, v19
 v_mfma_f32_16x16x32_bf16 v[216:219], v[32:35], a[248:251], v[216:219]
 s_add_u32 s58, s85, 589952
 buffer_load_dwordx4 v3, s[12:15], s58 offen nt lds
 v_mfma_f32_16x16x32_bf16 v[220:223], v[24:27], a[220:223], v[220:223]
 v_cvt_pk_bf16_f32 v96, v208, v209
 v_cvt_pk_bf16_f32 v97, v210, v211
 v_mul_f32 v123, v123, v19
 v_mfma_f32_16x16x32_bf16 v[220:223], v[28:31], a[236:239], v[220:223]
 v_exp_f32 v20, v20
 v_mfma_f32_16x16x32_bf16 v[220:223], v[32:35], a[252:255], v[220:223]
 s_waitcnt vmcnt(12)
 s_barrier
 s_waitcnt lgkmcnt(4)
 v_mfma_f32_16x16x32_bf16 v[224:227], v[36:39], a[208:211], v[224:227]
 s_waitcnt lgkmcnt(2)
 ds_read_b64_tr_b16 v[24:25], v6 offset:24576
 v_cvt_pk_bf16_f32 v100, v212, v213
 v_add_f32 v20, 1.0, v20
 v_mfma_f32_16x16x32_bf16 v[224:227], v[40:43], a[224:227], v[224:227]
 s_waitcnt lgkmcnt(1)
 ds_read_b64_tr_b16 v[26:27], v6 offset:25088
 v_cvt_pk_bf16_f32 v101, v214, v215
 v_mfma_f32_16x16x32_bf16 v[224:227], v[44:47], a[240:243], v[224:227]
 ds_read_b64_tr_b16 v[28:29], v6 offset:28672
 v_exp_f32 v21, v21
 v_mfma_f32_16x16x32_bf16 v[228:231], v[36:39], a[212:215], v[228:231]
 ds_read_b64_tr_b16 v[30:31], v6 offset:29184
 v_cvt_pk_bf16_f32 v104, v216, v217
 v_exp_f32 v22, v22
 v_mfma_f32_16x16x32_bf16 v[228:231], v[40:43], a[228:231], v[228:231]
 ds_read_b64_tr_b16 v[32:33], v6 offset:32768
 v_cvt_pk_bf16_f32 v105, v218, v219
 v_add_f32 v21, 1.0, v21
 v_mfma_f32_16x16x32_bf16 v[228:231], v[44:47], a[244:247], v[228:231]
 ds_read_b64_tr_b16 v[34:35], v6 offset:33280
 v_exp_f32 v23, v23
 v_mfma_f32_16x16x32_bf16 v[232:235], v[36:39], a[216:219], v[232:235]
 v_cvt_pk_bf16_f32 v108, v220, v221
 v_cvt_pk_bf16_f32 v109, v222, v223
 v_add_f32 v22, 1.0, v22
 v_mfma_f32_16x16x32_bf16 v[232:235], v[40:43], a[232:235], v[232:235]
 v_rcp_f32 v20, v20
 v_add_f32 v23, 1.0, v23
 v_mfma_f32_16x16x32_bf16 v[232:235], v[44:47], a[248:251], v[232:235]
 v_rcp_f32 v21, v21
 v_mfma_f32_16x16x32_bf16 v[236:239], v[36:39], a[220:223], v[236:239]
 v_cvt_pk_bf16_f32 v98, v224, v225
 v_cvt_pk_bf16_f32 v99, v226, v227
 v_mul_f32 v136, v136, v20
 v_mfma_f32_16x16x32_bf16 v[236:239], v[40:43], a[236:239], v[236:239]
 v_rcp_f32 v22, v22
 v_mul_f32 v137, v137, v21
 v_mfma_f32_16x16x32_bf16 v[236:239], v[44:47], a[252:255], v[236:239]
 s_waitcnt lgkmcnt(4)
 v_rcp_f32 v23, v23
 v_mul_f32 v138, v138, v22
 v_mul_f32 v139, v139, v23
 v_mfma_f32_16x16x32_bf16 v[176:179], v[24:27], v[48:51], 0
 s_waitcnt lgkmcnt(2)
 ds_read_b64_tr_b16 v[36:37], v7 offset:24576
 v_cvt_pk_bf16_f32 v102, v228, v229
 v_mfma_f32_16x16x32_bf16 v[176:179], v[28:31], v[64:67], v[176:179]
 s_waitcnt lgkmcnt(1)
 ds_read_b64_tr_b16 v[38:39], v7 offset:25088
 v_cvt_pk_bf16_f32 v103, v230, v231
 v_mfma_f32_16x16x32_bf16 v[176:179], v[32:35], a[0:3], v[176:179]
 ds_read_b64_tr_b16 v[40:41], v7 offset:28672
 v_mfma_f32_16x16x32_bf16 v[180:183], v[24:27], v[52:55], 0
 ds_read_b64_tr_b16 v[42:43], v7 offset:29184
 v_cvt_pk_bf16_f32 v106, v232, v233
 v_mfma_f32_16x16x32_bf16 v[180:183], v[28:31], v[68:71], v[180:183]
 ds_read_b64_tr_b16 v[44:45], v7 offset:32768
 v_cvt_pk_bf16_f32 v107, v234, v235
 v_mfma_f32_16x16x32_bf16 v[180:183], v[32:35], a[4:7], v[180:183]
 ds_read_b64_tr_b16 v[46:47], v7 offset:33280
 v_mfma_f32_16x16x32_bf16 v[184:187], v[24:27], v[56:59], 0
 v_cvt_pk_bf16_f32 v110, v236, v237
 v_cvt_pk_bf16_f32 v111, v238, v239
 v_mfma_f32_16x16x32_bf16 v[184:187], v[28:31], v[72:75], v[184:187]
 s_add_u32 m0, s70, 65536
 v_mfma_f32_16x16x32_bf16 v[184:187], v[32:35], a[8:11], v[184:187]
 s_add_u32 s58, s80, 128
 buffer_load_dwordx4 v3, s[16:19], s58 offen nt lds
 v_mfma_f32_16x16x32_bf16 v[188:191], v[24:27], v[60:63], 0
 v_mfma_f32_16x16x32_bf16 v[188:191], v[28:31], v[76:79], v[188:191]
 v_mfma_f32_16x16x32_bf16 v[188:191], v[32:35], a[12:15], v[188:191]
 s_waitcnt lgkmcnt(4)
 v_mfma_f32_16x16x32_bf16 v[192:195], v[36:39], v[48:51], 0
 s_waitcnt lgkmcnt(2)
 ds_read_b64_tr_b16 v[24:25], v8 offset:24576
 v_lshlrev_b32 v16, 16, v80
 v_mfma_f32_16x16x32_bf16 v[192:195], v[40:43], v[64:67], v[192:195]
 s_waitcnt lgkmcnt(1)
 ds_read_b64_tr_b16 v[26:27], v8 offset:25088
 v_and_b32 v17, s73, v80
 v_mfma_f32_16x16x32_bf16 v[192:195], v[44:47], a[0:3], v[192:195]
 ds_read_b64_tr_b16 v[28:29], v8 offset:28672
 v_lshlrev_b32 v18, 16, v81
 v_mfma_f32_16x16x32_bf16 v[196:199], v[36:39], v[52:55], 0
 ds_read_b64_tr_b16 v[30:31], v8 offset:29184
 v_and_b32 v19, s73, v81
 v_mul_f32 v112, v112, v16
 v_mfma_f32_16x16x32_bf16 v[196:199], v[40:43], v[68:71], v[196:199]
 ds_read_b64_tr_b16 v[32:33], v8 offset:32768
 v_mul_f32 v113, v113, v17
 v_mfma_f32_16x16x32_bf16 v[196:199], v[44:47], a[4:7], v[196:199]
 s_add_u32 s59, s64, 0
 ds_read_b64_tr_b16 v[34:35], v8 offset:33280
 v_mul_f32 v114, v114, v18
 v_mfma_f32_16x16x32_bf16 v[200:203], v[36:39], v[56:59], 0
 v_mul_f32 v115, v115, v19
 v_cvt_pk_bf16_f32 v80, v112, v113
 v_lshlrev_b32 v20, 16, v82
 v_mfma_f32_16x16x32_bf16 v[200:203], v[40:43], v[72:75], v[200:203]
 s_add_u32 m0, s70, 69632
 v_and_b32 v21, s73, v82
 v_lshlrev_b32 v22, 16, v83
 v_mfma_f32_16x16x32_bf16 v[200:203], v[44:47], a[8:11], v[200:203]
 s_add_u32 s58, s80, 295040
 buffer_load_dwordx4 v3, s[16:19], s58 offen nt lds
 v_mfma_f32_16x16x32_bf16 v[204:207], v[36:39], v[60:63], 0
 v_cvt_pk_bf16_f32 v81, v114, v115
 v_and_b32 v23, s73, v83
 v_mul_f32 v128, v128, v20
 v_mfma_f32_16x16x32_bf16 v[204:207], v[40:43], v[76:79], v[204:207]
 v_mul_f32 v129, v129, v21
 v_mul_f32 v130, v130, v22
 v_mfma_f32_16x16x32_bf16 v[204:207], v[44:47], a[12:15], v[204:207]
 s_waitcnt lgkmcnt(4)
 v_mul_f32 v131, v131, v23
 v_lshlrev_b32 v16, 16, v84
 v_mfma_f32_16x16x32_bf16 v[208:211], v[24:27], v[48:51], 0
 s_waitcnt lgkmcnt(2)
 ds_read_b64_tr_b16 v[36:37], v9 offset:24576
 v_cvt_pk_bf16_f32 v82, v128, v129
 v_and_b32 v17, s73, v84
 v_mfma_f32_16x16x32_bf16 v[208:211], v[28:31], v[64:67], v[208:211]
 s_waitcnt lgkmcnt(1)
 ds_read_b64_tr_b16 v[38:39], v9 offset:25088
 v_cvt_pk_bf16_f32 v83, v130, v131
 v_mfma_f32_16x16x32_bf16 v[208:211], v[32:35], a[0:3], v[208:211]
 ds_read_b64_tr_b16 v[40:41], v9 offset:28672
 v_lshlrev_b32 v18, 16, v85
 v_mfma_f32_16x16x32_bf16 v[212:215], v[24:27], v[52:55], 0
 ds_read_b64_tr_b16 v[42:43], v9 offset:29184
 v_and_b32 v19, s73, v85
 v_mul_f32 v116, v116, v16
 v_mfma_f32_16x16x32_bf16 v[212:215], v[28:31], v[68:71], v[212:215]
 ds_read_b64_tr_b16 v[44:45], v9 offset:32768
 v_mul_f32 v117, v117, v17
 v_mfma_f32_16x16x32_bf16 v[212:215], v[32:35], a[4:7], v[212:215]
 ds_read_b64_tr_b16 v[46:47], v9 offset:33280
 v_mul_f32 v118, v118, v18
 v_mfma_f32_16x16x32_bf16 v[216:219], v[24:27], v[56:59], 0
 buffer_store_dwordx4 v[80:83], v2, s[32:35], s59 offen sc1
 v_mfma_f32_16x16x32_bf16 v[216:219], v[28:31], v[72:75], v[216:219]
 s_add_u32 m0, s70, 73728
 v_mul_f32 v119, v119, v19
 v_cvt_pk_bf16_f32 v84, v116, v117
 v_mfma_f32_16x16x32_bf16 v[216:219], v[32:35], a[8:11], v[216:219]
 s_add_u32 s58, s80, 589952
 buffer_load_dwordx4 v3, s[16:19], s58 offen nt lds
 v_mfma_f32_16x16x32_bf16 v[220:223], v[24:27], v[60:63], 0
 s_add_u32 s59, s65, 0
 v_cvt_pk_bf16_f32 v85, v118, v119
 v_lshlrev_b32 v20, 16, v86
 v_and_b32 v21, s73, v86
 v_mfma_f32_16x16x32_bf16 v[220:223], v[28:31], v[76:79], v[220:223]
 v_lshlrev_b32 v22, 16, v87
 v_and_b32 v23, s73, v87
 v_mfma_f32_16x16x32_bf16 v[220:223], v[32:35], a[12:15], v[220:223]
 s_waitcnt lgkmcnt(4)
 v_mul_f32 v132, v132, v20
 v_mul_f32 v133, v133, v21
 v_mfma_f32_16x16x32_bf16 v[224:227], v[36:39], v[48:51], 0
 s_waitcnt lgkmcnt(2)
 ds_read_b64_tr_b16 v[24:25], v6 offset:36864
 v_mul_f32 v134, v134, v22
 v_mul_f32 v135, v135, v23
 v_mfma_f32_16x16x32_bf16 v[224:227], v[40:43], v[64:67], v[224:227]
 s_waitcnt lgkmcnt(1)
 ds_read_b64_tr_b16 v[26:27], v6 offset:37376
 v_cvt_pk_bf16_f32 v86, v132, v133
 v_mfma_f32_16x16x32_bf16 v[224:227], v[44:47], a[0:3], v[224:227]
 ds_read_b64_tr_b16 v[28:29], v6 offset:40960
 v_cvt_pk_bf16_f32 v87, v134, v135
 v_mfma_f32_16x16x32_bf16 v[228:231], v[36:39], v[52:55], 0
 ds_read_b64_tr_b16 v[30:31], v6 offset:41472
 v_lshlrev_b32 v16, 16, v88
 v_and_b32 v17, s73, v88
 v_mfma_f32_16x16x32_bf16 v[228:231], v[40:43], v[68:71], v[228:231]
 ds_read_b64_tr_b16 v[32:33], v6 offset:45056
 v_lshlrev_b32 v18, 16, v89
 v_mfma_f32_16x16x32_bf16 v[228:231], v[44:47], a[4:7], v[228:231]
 ds_read_b64_tr_b16 v[34:35], v6 offset:45568
 v_and_b32 v19, s73, v89
 v_mfma_f32_16x16x32_bf16 v[232:235], v[36:39], v[56:59], 0
 buffer_store_dwordx4 v[84:87], v2, s[32:35], s59 offen sc1
 v_mfma_f32_16x16x32_bf16 v[232:235], v[40:43], v[72:75], v[232:235]
 v_mul_f32 v120, v120, v16
 v_mul_f32 v121, v121, v17
 v_mfma_f32_16x16x32_bf16 v[232:235], v[44:47], a[8:11], v[232:235]
 s_add_u32 s59, s66, 0
 v_mul_f32 v122, v122, v18
 v_mul_f32 v123, v123, v19
 v_mfma_f32_16x16x32_bf16 v[236:239], v[36:39], v[60:63], 0
 v_cvt_pk_bf16_f32 v88, v120, v121
 v_lshlrev_b32 v20, 16, v90
 v_and_b32 v21, s73, v90
 v_mfma_f32_16x16x32_bf16 v[236:239], v[40:43], v[76:79], v[236:239]
 v_cvt_pk_bf16_f32 v89, v122, v123
 v_lshlrev_b32 v22, 16, v91
 v_mfma_f32_16x16x32_bf16 v[236:239], v[44:47], a[12:15], v[236:239]
 s_waitcnt lgkmcnt(4)
 v_and_b32 v23, s73, v91
 v_mul_f32 v136, v136, v20
 v_mfma_f32_16x16x32_bf16 v[176:179], v[24:27], a[16:19], v[176:179]
 s_waitcnt lgkmcnt(2)
 ds_read_b64_tr_b16 v[36:37], v7 offset:36864
 v_mul_f32 v137, v137, v21
 v_mul_f32 v138, v138, v22
 v_mfma_f32_16x16x32_bf16 v[176:179], v[28:31], a[32:35], v[176:179]
 s_waitcnt lgkmcnt(1)
 ds_read_b64_tr_b16 v[38:39], v7 offset:37376
 v_mul_f32 v139, v139, v23
 v_mfma_f32_16x16x32_bf16 v[176:179], v[32:35], a[48:51], v[176:179]
 ds_read_b64_tr_b16 v[40:41], v7 offset:40960
 v_cvt_pk_bf16_f32 v90, v136, v137
 v_mfma_f32_16x16x32_bf16 v[180:183], v[24:27], a[20:23], v[180:183]
 ds_read_b64_tr_b16 v[42:43], v7 offset:41472
 v_cvt_pk_bf16_f32 v91, v138, v139
 v_mul_f32 v16, s74, v124
 v_mfma_f32_16x16x32_bf16 v[180:183], v[28:31], a[36:39], v[180:183]
 ds_read_b64_tr_b16 v[44:45], v7 offset:45056
 v_mul_f32 v17, s74, v125
 v_mfma_f32_16x16x32_bf16 v[180:183], v[32:35], a[52:55], v[180:183]
 ds_read_b64_tr_b16 v[46:47], v7 offset:45568
 v_mul_f32 v18, s74, v126
 v_mfma_f32_16x16x32_bf16 v[184:187], v[24:27], a[24:27], v[184:187]
 buffer_store_dwordx4 v[88:91], v2, s[32:35], s59 offen sc1
 v_mfma_f32_16x16x32_bf16 v[184:187], v[28:31], a[40:43], v[184:187]
 s_add_u32 m0, s70, 77824
 v_exp_f32 v16, v16
 v_mfma_f32_16x16x32_bf16 v[184:187], v[32:35], a[56:59], v[184:187]
 s_add_u32 s58, s81, 128
 buffer_load_dwordx4 v3, s[16:19], s58 offen nt lds
 v_mfma_f32_16x16x32_bf16 v[188:191], v[24:27], a[28:31], v[188:191]
 v_exp_f32 v17, v17
 v_mul_f32 v19, s74, v127
 v_mfma_f32_16x16x32_bf16 v[188:191], v[28:31], a[44:47], v[188:191]
 v_exp_f32 v18, v18
 v_mfma_f32_16x16x32_bf16 v[188:191], v[32:35], a[60:63], v[188:191]
 s_waitcnt lgkmcnt(4)
 v_exp_f32 v19, v19
 v_mfma_f32_16x16x32_bf16 v[192:195], v[36:39], a[16:19], v[192:195]
 s_waitcnt lgkmcnt(2)
 ds_read_b64_tr_b16 v[24:25], v8 offset:36864
 v_add_f32 v16, 1.0, v16
 v_add_f32 v17, 1.0, v17
 v_mfma_f32_16x16x32_bf16 v[192:195], v[40:43], a[32:35], v[192:195]
 s_waitcnt lgkmcnt(1)
 ds_read_b64_tr_b16 v[26:27], v8 offset:37376
 v_add_f32 v18, 1.0, v18
 v_mfma_f32_16x16x32_bf16 v[192:195], v[44:47], a[48:51], v[192:195]
 ds_read_b64_tr_b16 v[28:29], v8 offset:40960
 v_add_f32 v19, 1.0, v19
 v_mfma_f32_16x16x32_bf16 v[196:199], v[36:39], a[20:23], v[196:199]
 ds_read_b64_tr_b16 v[30:31], v8 offset:41472
 v_rcp_f32 v16, v16
 v_mfma_f32_16x16x32_bf16 v[196:199], v[40:43], a[36:39], v[196:199]
 ds_read_b64_tr_b16 v[32:33], v8 offset:45056
 v_mfma_f32_16x16x32_bf16 v[196:199], v[44:47], a[52:55], v[196:199]
 ds_read_b64_tr_b16 v[34:35], v8 offset:45568
 v_rcp_f32 v17, v17
 v_mfma_f32_16x16x32_bf16 v[200:203], v[36:39], a[24:27], v[200:203]
 v_rcp_f32 v18, v18
 v_mfma_f32_16x16x32_bf16 v[200:203], v[40:43], a[40:43], v[200:203]
 s_add_u32 m0, s70, 81920
 v_rcp_f32 v19, v19
 v_mfma_f32_16x16x32_bf16 v[200:203], v[44:47], a[56:59], v[200:203]
 s_add_u32 s58, s81, 295040
 buffer_load_dwordx4 v3, s[16:19], s58 offen nt lds
 v_mul_f32 v124, v124, v16
 v_mfma_f32_16x16x32_bf16 v[204:207], v[36:39], a[28:31], v[204:207]
 v_mul_f32 v125, v125, v17
 v_mul_f32 v126, v126, v18
 v_mfma_f32_16x16x32_bf16 v[204:207], v[40:43], a[44:47], v[204:207]
 v_mul_f32 v127, v127, v19
 v_lshlrev_b32 v16, 16, v92
 v_mfma_f32_16x16x32_bf16 v[204:207], v[44:47], a[60:63], v[204:207]
 s_waitcnt lgkmcnt(4)
 v_and_b32 v17, s73, v92
 v_lshlrev_b32 v18, 16, v93
 v_and_b32 v19, s73, v93
 v_mfma_f32_16x16x32_bf16 v[208:211], v[24:27], a[16:19], v[208:211]
 s_waitcnt lgkmcnt(2)
 ds_read_b64_tr_b16 v[36:37], v9 offset:36864
 v_mul_f32 v124, v124, v16
 v_mfma_f32_16x16x32_bf16 v[208:211], v[28:31], a[32:35], v[208:211]
 s_waitcnt lgkmcnt(1)
 ds_read_b64_tr_b16 v[38:39], v9 offset:37376
 v_mul_f32 v125, v125, v17
 v_mfma_f32_16x16x32_bf16 v[208:211], v[32:35], a[48:51], v[208:211]
 ds_read_b64_tr_b16 v[40:41], v9 offset:40960
 v_mul_f32 v126, v126, v18
 v_mul_f32 v127, v127, v19
 v_mfma_f32_16x16x32_bf16 v[212:215], v[24:27], a[20:23], v[212:215]
 ds_read_b64_tr_b16 v[42:43], v9 offset:41472
 v_cvt_pk_bf16_f32 v92, v124, v125
 v_mfma_f32_16x16x32_bf16 v[212:215], v[28:31], a[36:39], v[212:215]
 ds_read_b64_tr_b16 v[44:45], v9 offset:45056
 v_cvt_pk_bf16_f32 v93, v126, v127
 v_mfma_f32_16x16x32_bf16 v[212:215], v[32:35], a[52:55], v[212:215]
 ds_read_b64_tr_b16 v[46:47], v9 offset:45568
 v_mul_f32 v20, s74, v140
 v_mul_f32 v21, s74, v141
 v_mfma_f32_16x16x32_bf16 v[216:219], v[24:27], a[24:27], v[216:219]
 v_mul_f32 v22, s74, v142
 v_mul_f32 v23, s74, v143
 v_mfma_f32_16x16x32_bf16 v[216:219], v[28:31], a[40:43], v[216:219]
 s_add_u32 m0, s70, 86016
 v_exp_f32 v20, v20
 v_mfma_f32_16x16x32_bf16 v[216:219], v[32:35], a[56:59], v[216:219]
 s_add_u32 s58, s81, 589952
 buffer_load_dwordx4 v3, s[16:19], s58 offen nt lds
 v_mfma_f32_16x16x32_bf16 v[220:223], v[24:27], a[28:31], v[220:223]
 v_exp_f32 v21, v21
 v_mfma_f32_16x16x32_bf16 v[220:223], v[28:31], a[44:47], v[220:223]
 v_exp_f32 v22, v22
 v_mfma_f32_16x16x32_bf16 v[220:223], v[32:35], a[60:63], v[220:223]
 s_waitcnt vmcnt(15)
 s_barrier
 s_waitcnt lgkmcnt(4)
 v_add_f32 v20, 1.0, v20
 v_mfma_f32_16x16x32_bf16 v[224:227], v[36:39], a[16:19], v[224:227]
 s_waitcnt lgkmcnt(2)
 ds_read_b64_tr_b16 v[24:25], v6 offset:49152
 v_add_f32 v21, 1.0, v21
 v_mfma_f32_16x16x32_bf16 v[224:227], v[40:43], a[32:35], v[224:227]
 s_waitcnt lgkmcnt(1)
 ds_read_b64_tr_b16 v[26:27], v6 offset:49664
 v_add_f32 v22, 1.0, v22
 v_mfma_f32_16x16x32_bf16 v[224:227], v[44:47], a[48:51], v[224:227]
 ds_read_b64_tr_b16 v[28:29], v6 offset:53248
 v_exp_f32 v23, v23
 v_mfma_f32_16x16x32_bf16 v[228:231], v[36:39], a[20:23], v[228:231]
 ds_read_b64_tr_b16 v[30:31], v6 offset:53760
 v_mfma_f32_16x16x32_bf16 v[228:231], v[40:43], a[36:39], v[228:231]
 ds_read_b64_tr_b16 v[32:33], v6 offset:57344
 v_add_f32 v23, 1.0, v23
 v_mfma_f32_16x16x32_bf16 v[228:231], v[44:47], a[52:55], v[228:231]
 ds_read_b64_tr_b16 v[34:35], v6 offset:57856
 v_rcp_f32 v20, v20
 v_mfma_f32_16x16x32_bf16 v[232:235], v[36:39], a[24:27], v[232:235]
 v_rcp_f32 v21, v21
 v_mfma_f32_16x16x32_bf16 v[232:235], v[40:43], a[40:43], v[232:235]
 v_rcp_f32 v22, v22
 v_mul_f32 v140, v140, v20
 v_mfma_f32_16x16x32_bf16 v[232:235], v[44:47], a[56:59], v[232:235]
 s_add_u32 s59, s67, 0
 v_rcp_f32 v23, v23
 v_mfma_f32_16x16x32_bf16 v[236:239], v[36:39], a[28:31], v[236:239]
 v_mul_f32 v141, v141, v21
 v_mul_f32 v142, v142, v22
 v_mfma_f32_16x16x32_bf16 v[236:239], v[40:43], a[44:47], v[236:239]
 v_mul_f32 v143, v143, v23
 v_lshlrev_b32 v20, 16, v94
 v_and_b32 v21, s73, v94
 v_mfma_f32_16x16x32_bf16 v[236:239], v[44:47], a[60:63], v[236:239]
 s_waitcnt lgkmcnt(4)
 v_lshlrev_b32 v22, 16, v95
 v_and_b32 v23, s73, v95
 v_mfma_f32_16x16x32_bf16 v[176:179], v[24:27], a[64:67], v[176:179]
 s_waitcnt lgkmcnt(2)
 ds_read_b64_tr_b16 v[36:37], v7 offset:49152
 v_mul_f32 v140, v140, v20
 v_mfma_f32_16x16x32_bf16 v[176:179], v[28:31], a[80:83], v[176:179]
 s_waitcnt lgkmcnt(1)
 ds_read_b64_tr_b16 v[38:39], v7 offset:49664
 v_mul_f32 v141, v141, v21
 v_mul_f32 v142, v142, v22
 v_mfma_f32_16x16x32_bf16 v[176:179], v[32:35], a[96:99], v[176:179]
 ds_read_b64_tr_b16 v[40:41], v7 offset:53248
 v_mul_f32 v143, v143, v23
 v_mfma_f32_16x16x32_bf16 v[180:183], v[24:27], a[68:71], v[180:183]
 ds_read_b64_tr_b16 v[42:43], v7 offset:53760
 v_cvt_pk_bf16_f32 v94, v140, v141
 v_mfma_f32_16x16x32_bf16 v[180:183], v[28:31], a[84:87], v[180:183]
 ds_read_b64_tr_b16 v[44:45], v7 offset:57344
 v_cvt_pk_bf16_f32 v95, v142, v143
 v_mul_f32 v16, s74, v144
 v_mfma_f32_16x16x32_bf16 v[180:183], v[32:35], a[100:103], v[180:183]
 ds_read_b64_tr_b16 v[46:47], v7 offset:57856
 v_mul_f32 v17, s74, v145
 v_mfma_f32_16x16x32_bf16 v[184:187], v[24:27], a[72:75], v[184:187]
 buffer_store_dwordx4 v[92:95], v2, s[32:35], s59 offen sc1
 v_mfma_f32_16x16x32_bf16 v[184:187], v[28:31], a[88:91], v[184:187]
 s_add_u32 m0, s70, 90112
 v_exp_f32 v16, v16
 v_mul_f32 v18, s74, v146
 v_mfma_f32_16x16x32_bf16 v[184:187], v[32:35], a[104:107], v[184:187]
 s_add_u32 s58, s82, 128
 buffer_load_dwordx4 v3, s[16:19], s58 offen nt lds
 v_mfma_f32_16x16x32_bf16 v[188:191], v[24:27], a[76:79], v[188:191]
 v_exp_f32 v17, v17
 v_mfma_f32_16x16x32_bf16 v[188:191], v[28:31], a[92:95], v[188:191]
 v_exp_f32 v18, v18
 v_mul_f32 v19, s74, v147
 v_mfma_f32_16x16x32_bf16 v[188:191], v[32:35], a[108:111], v[188:191]
 s_waitcnt lgkmcnt(4)
 v_add_f32 v16, 1.0, v16
 v_add_f32 v17, 1.0, v17
 v_mfma_f32_16x16x32_bf16 v[192:195], v[36:39], a[64:67], v[192:195]
 s_waitcnt lgkmcnt(2)
 ds_read_b64_tr_b16 v[24:25], v8 offset:49152
 v_exp_f32 v19, v19
 v_mfma_f32_16x16x32_bf16 v[192:195], v[40:43], a[80:83], v[192:195]
 s_waitcnt lgkmcnt(1)
 ds_read_b64_tr_b16 v[26:27], v8 offset:49664
 v_add_f32 v18, 1.0, v18
 v_mfma_f32_16x16x32_bf16 v[192:195], v[44:47], a[96:99], v[192:195]
 ds_read_b64_tr_b16 v[28:29], v8 offset:53248
 v_add_f32 v19, 1.0, v19
 v_mfma_f32_16x16x32_bf16 v[196:199], v[36:39], a[68:71], v[196:199]
 ds_read_b64_tr_b16 v[30:31], v8 offset:53760
 v_rcp_f32 v16, v16
 v_mfma_f32_16x16x32_bf16 v[196:199], v[40:43], a[84:87], v[196:199]
 ds_read_b64_tr_b16 v[32:33], v8 offset:57344
 v_mfma_f32_16x16x32_bf16 v[196:199], v[44:47], a[100:103], v[196:199]
 ds_read_b64_tr_b16 v[34:35], v8 offset:57856
 v_mul_f32 v144, v144, v16
 v_mfma_f32_16x16x32_bf16 v[200:203], v[36:39], a[72:75], v[200:203]
 s_add_u32 m0, s70, 94208
 v_rcp_f32 v17, v17
 v_lshlrev_b32 v16, 16, v96
 v_mfma_f32_16x16x32_bf16 v[200:203], v[40:43], a[88:91], v[200:203]
 s_add_u32 s58, s82, 295040
 buffer_load_dwordx4 v3, s[16:19], s58 offen nt lds
 v_mfma_f32_16x16x32_bf16 v[200:203], v[44:47], a[104:107], v[200:203]
 v_rcp_f32 v18, v18
 v_mfma_f32_16x16x32_bf16 v[204:207], v[36:39], a[76:79], v[204:207]
 v_rcp_f32 v19, v19
 v_mul_f32 v145, v145, v17
 v_mfma_f32_16x16x32_bf16 v[204:207], v[40:43], a[92:95], v[204:207]
 v_mul_f32 v146, v146, v18
 v_and_b32 v17, s73, v96
 v_mfma_f32_16x16x32_bf16 v[204:207], v[44:47], a[108:111], v[204:207]
 s_waitcnt lgkmcnt(4)
 v_mul_f32 v147, v147, v19
 v_lshlrev_b32 v18, 16, v97
 v_mfma_f32_16x16x32_bf16 v[208:211], v[24:27], a[64:67], v[208:211]
 s_waitcnt lgkmcnt(2)
 ds_read_b64_tr_b16 v[36:37], v9 offset:49152
 v_and_b32 v19, s73, v97
 v_mul_f32 v144, v144, v16
 v_mfma_f32_16x16x32_bf16 v[208:211], v[28:31], a[80:83], v[208:211]
 s_waitcnt lgkmcnt(1)
 ds_read_b64_tr_b16 v[38:39], v9 offset:49664
 v_mul_f32 v145, v145, v17
 v_mfma_f32_16x16x32_bf16 v[208:211], v[32:35], a[96:99], v[208:211]
 ds_read_b64_tr_b16 v[40:41], v9 offset:53248
 v_mul_f32 v146, v146, v18
 v_mul_f32 v147, v147, v19
 v_mfma_f32_16x16x32_bf16 v[212:215], v[24:27], a[68:71], v[212:215]
 ds_read_b64_tr_b16 v[42:43], v9 offset:53760
 v_cvt_pk_bf16_f32 v96, v144, v145
 v_mfma_f32_16x16x32_bf16 v[212:215], v[28:31], a[84:87], v[212:215]
 ds_read_b64_tr_b16 v[44:45], v9 offset:57344
 v_cvt_pk_bf16_f32 v97, v146, v147
 v_mfma_f32_16x16x32_bf16 v[212:215], v[32:35], a[100:103], v[212:215]
 ds_read_b64_tr_b16 v[46:47], v9 offset:57856
 v_mul_f32 v20, s74, v160
 v_mul_f32 v21, s74, v161
 v_mfma_f32_16x16x32_bf16 v[216:219], v[24:27], a[72:75], v[216:219]
 v_add_u32 v6, 0xc000, v6
 v_add_u32 v7, 0xc000, v7
 v_mfma_f32_16x16x32_bf16 v[216:219], v[28:31], a[88:91], v[216:219]
 s_add_u32 m0, s70, 98304
 v_add_u32 v8, 0xc000, v8
 v_add_u32 v9, 0xc000, v9
 v_mfma_f32_16x16x32_bf16 v[216:219], v[32:35], a[104:107], v[216:219]
 s_add_u32 s58, s82, 589952
 buffer_load_dwordx4 v3, s[16:19], s58 offen nt lds
 v_mul_f32 v22, s74, v162
 v_mfma_f32_16x16x32_bf16 v[220:223], v[24:27], a[76:79], v[220:223]
 v_exp_f32 v20, v20
 v_mfma_f32_16x16x32_bf16 v[220:223], v[28:31], a[92:95], v[220:223]
 v_exp_f32 v21, v21
 v_mfma_f32_16x16x32_bf16 v[220:223], v[32:35], a[108:111], v[220:223]
 s_waitcnt lgkmcnt(4)
 v_exp_f32 v22, v22
 v_mul_f32 v23, s74, v163
 v_mfma_f32_16x16x32_bf16 v[224:227], v[36:39], a[64:67], v[224:227]
 s_waitcnt lgkmcnt(2)
 ds_read_b64_tr_b16 v[24:25], v6 offset:12288
 v_add_f32 v20, 1.0, v20
 v_mfma_f32_16x16x32_bf16 v[224:227], v[40:43], a[80:83], v[224:227]
 s_waitcnt lgkmcnt(1)
 ds_read_b64_tr_b16 v[26:27], v6 offset:12800
 v_exp_f32 v23, v23
 v_mfma_f32_16x16x32_bf16 v[224:227], v[44:47], a[96:99], v[224:227]
 ds_read_b64_tr_b16 v[28:29], v6 offset:16384
 v_add_f32 v21, 1.0, v21
 v_mfma_f32_16x16x32_bf16 v[228:231], v[36:39], a[68:71], v[228:231]
 ds_read_b64_tr_b16 v[30:31], v6 offset:16896
 v_add_f32 v22, 1.0, v22
 v_mfma_f32_16x16x32_bf16 v[228:231], v[40:43], a[84:87], v[228:231]
 ds_read_b64_tr_b16 v[32:33], v6 offset:20480
 v_add_f32 v23, 1.0, v23
 v_mfma_f32_16x16x32_bf16 v[228:231], v[44:47], a[100:103], v[228:231]
 ds_read_b64_tr_b16 v[34:35], v6 offset:20992
 v_mfma_f32_16x16x32_bf16 v[232:235], v[36:39], a[72:75], v[232:235]
 v_rcp_f32 v20, v20
 v_mfma_f32_16x16x32_bf16 v[232:235], v[40:43], a[88:91], v[232:235]
 v_rcp_f32 v21, v21
 v_mfma_f32_16x16x32_bf16 v[232:235], v[44:47], a[104:107], v[232:235]
 v_rcp_f32 v22, v22
 v_mfma_f32_16x16x32_bf16 v[236:239], v[36:39], a[76:79], v[236:239]
 v_rcp_f32 v23, v23
 v_mfma_f32_16x16x32_bf16 v[236:239], v[40:43], a[92:95], v[236:239]
 s_add_u32 s59, s64, 131072
 v_mul_f32 v160, v160, v20
 v_mul_f32 v161, v161, v21
 v_mul_f32 v162, v162, v22
 v_mfma_f32_16x16x32_bf16 v[236:239], v[44:47], a[108:111], v[236:239]
 s_waitcnt lgkmcnt(4)
 v_mul_f32 v163, v163, v23
 v_lshlrev_b32 v20, 16, v98
 v_mfma_f32_16x16x32_bf16 v[176:179], v[24:27], a[112:115], v[176:179]
 s_waitcnt lgkmcnt(2)
 ds_read_b64_tr_b16 v[36:37], v7 offset:12288
 v_and_b32 v21, s73, v98
 v_lshlrev_b32 v22, 16, v99
 v_mfma_f32_16x16x32_bf16 v[176:179], v[28:31], a[128:131], v[176:179]
 s_waitcnt lgkmcnt(1)
 ds_read_b64_tr_b16 v[38:39], v7 offset:12800
 v_and_b32 v23, s73, v99
 v_mfma_f32_16x16x32_bf16 v[176:179], v[32:35], a[144:147], v[176:179]
 ds_read_b64_tr_b16 v[40:41], v7 offset:16384
 v_mul_f32 v160, v160, v20
 v_mfma_f32_16x16x32_bf16 v[180:183], v[24:27], a[116:119], v[180:183]
 ds_read_b64_tr_b16 v[42:43], v7 offset:16896
 v_mul_f32 v161, v161, v21
 v_mul_f32 v162, v162, v22
 v_mfma_f32_16x16x32_bf16 v[180:183], v[28:31], a[132:135], v[180:183]
 ds_read_b64_tr_b16 v[44:45], v7 offset:20480
 v_mul_f32 v163, v163, v23
 v_mfma_f32_16x16x32_bf16 v[180:183], v[32:35], a[148:151], v[180:183]
 ds_read_b64_tr_b16 v[46:47], v7 offset:20992
 v_cvt_pk_bf16_f32 v98, v160, v161
 v_mul_f32 v16, s74, v148
 v_mfma_f32_16x16x32_bf16 v[184:187], v[24:27], a[120:123], v[184:187]
 v_cvt_pk_bf16_f32 v99, v162, v163
 v_mul_f32 v17, s74, v149
 s_getpc_b64 s[8:9]
L_cpa:
 s_add_u32 s8, s8, L_ab_split-L_cpa
 s_addc_u32 s9, s9, 0
 s_mov_b32 s10, L_att_last-L_ab_split
 s_mov_b32 s11, 0x20000
 s_lshr_b32 s56, s2, 3
 s_lshl2_add_u32 s56, s56, s52
 s_mul_i32 s56, s56, 512
 v_min_u32 v13, 3, v1
 v_lshlrev_b32 v13, 7, v13
 buffer_load_dword v13, v13, s[8:11], s56 offen
 v_mfma_f32_16x16x32_bf16 v[184:187], v[28:31], a[136:139], v[184:187]
 s_add_u32 m0, s70, 102400
 v_exp_f32 v16, v16
 v_mfma_f32_16x16x32_bf16 v[184:187], v[32:35], a[152:155], v[184:187]
 s_add_u32 s58, s83, 128
 buffer_load_dwordx4 v3, s[16:19], s58 offen nt lds
 v_mul_f32 v18, s74, v150
 v_mfma_f32_16x16x32_bf16 v[188:191], v[24:27], a[124:127], v[188:191]
 buffer_store_dwordx4 v[96:99], v2, s[32:35], s59 offen sc1
 v_mfma_f32_16x16x32_bf16 v[188:191], v[28:31], a[140:143], v[188:191]
 v_exp_f32 v17, v17
 v_mfma_f32_16x16x32_bf16 v[188:191], v[32:35], a[156:159], v[188:191]
 s_waitcnt lgkmcnt(4)
 v_exp_f32 v18, v18
 v_mul_f32 v19, s74, v151
 v_mfma_f32_16x16x32_bf16 v[192:195], v[36:39], a[112:115], v[192:195]
 s_waitcnt lgkmcnt(2)
 ds_read_b64_tr_b16 v[24:25], v8 offset:12288
 v_add_f32 v16, 1.0, v16
 v_mfma_f32_16x16x32_bf16 v[192:195], v[40:43], a[128:131], v[192:195]
 s_waitcnt lgkmcnt(1)
 ds_read_b64_tr_b16 v[26:27], v8 offset:12800
 v_exp_f32 v19, v19
 v_mfma_f32_16x16x32_bf16 v[192:195], v[44:47], a[144:147], v[192:195]
 ds_read_b64_tr_b16 v[28:29], v8 offset:16384
 v_add_f32 v17, 1.0, v17
 v_mfma_f32_16x16x32_bf16 v[196:199], v[36:39], a[116:119], v[196:199]
 ds_read_b64_tr_b16 v[30:31], v8 offset:16896
 v_add_f32 v18, 1.0, v18
 v_mfma_f32_16x16x32_bf16 v[196:199], v[40:43], a[132:135], v[196:199]
 ds_read_b64_tr_b16 v[32:33], v8 offset:20480
 v_add_f32 v19, 1.0, v19
 v_mfma_f32_16x16x32_bf16 v[196:199], v[44:47], a[148:151], v[196:199]
 ds_read_b64_tr_b16 v[34:35], v8 offset:20992
 v_mfma_f32_16x16x32_bf16 v[200:203], v[36:39], a[120:123], v[200:203]
 s_add_u32 m0, s70, 106496
 v_rcp_f32 v16, v16
 v_mfma_f32_16x16x32_bf16 v[200:203], v[40:43], a[136:139], v[200:203]
 s_add_u32 s58, s83, 295040
 buffer_load_dwordx4 v3, s[16:19], s58 offen nt lds
 v_mfma_f32_16x16x32_bf16 v[200:203], v[44:47], a[152:155], v[200:203]
 v_rcp_f32 v17, v17
 v_mfma_f32_16x16x32_bf16 v[204:207], v[36:39], a[124:127], v[204:207]
 v_rcp_f32 v18, v18
 v_mul_f32 v148, v148, v16
 v_mfma_f32_16x16x32_bf16 v[204:207], v[40:43], a[140:143], v[204:207]
 v_rcp_f32 v19, v19
 v_mfma_f32_16x16x32_bf16 v[204:207], v[44:47], a[156:159], v[204:207]
 s_waitcnt lgkmcnt(4)
 v_mul_f32 v149, v149, v17
 v_mul_f32 v150, v150, v18
 v_lshlrev_b32 v16, 16, v100
 v_mfma_f32_16x16x32_bf16 v[208:211], v[24:27], a[112:115], v[208:211]
 s_waitcnt lgkmcnt(2)
 ds_read_b64_tr_b16 v[36:37], v9 offset:12288
 v_mul_f32 v151, v151, v19
 v_mfma_f32_16x16x32_bf16 v[208:211], v[28:31], a[128:131], v[208:211]
 s_waitcnt lgkmcnt(1)
 ds_read_b64_tr_b16 v[38:39], v9 offset:12800
 v_and_b32 v17, s73, v100
 v_mfma_f32_16x16x32_bf16 v[208:211], v[32:35], a[144:147], v[208:211]
 ds_read_b64_tr_b16 v[40:41], v9 offset:16384
 v_lshlrev_b32 v18, 16, v101
 v_and_b32 v19, s73, v101
 v_mfma_f32_16x16x32_bf16 v[212:215], v[24:27], a[116:119], v[212:215]
 ds_read_b64_tr_b16 v[42:43], v9 offset:16896
 v_mul_f32 v148, v148, v16
 v_mfma_f32_16x16x32_bf16 v[212:215], v[28:31], a[132:135], v[212:215]
 ds_read_b64_tr_b16 v[44:45], v9 offset:20480
 v_mul_f32 v149, v149, v17
 v_mul_f32 v150, v150, v18
 v_mfma_f32_16x16x32_bf16 v[212:215], v[32:35], a[148:151], v[212:215]
 ds_read_b64_tr_b16 v[46:47], v9 offset:20992
 v_mul_f32 v151, v151, v19
 v_mfma_f32_16x16x32_bf16 v[216:219], v[24:27], a[120:123], v[216:219]
 v_add_u32 v6, 0xfffe8000, v6
 v_add_u32 v7, 0xfffe8000, v7
 v_mfma_f32_16x16x32_bf16 v[216:219], v[28:31], a[136:139], v[216:219]
 s_add_u32 m0, s70, 110592
 v_add_u32 v8, 0xfffe8000, v8
 v_add_u32 v9, 0xfffe8000, v9
 v_cvt_pk_bf16_f32 v100, v148, v149
 v_mfma_f32_16x16x32_bf16 v[216:219], v[32:35], a[152:155], v[216:219]
 s_add_u32 s58, s83, 589952
 buffer_load_dwordx4 v3, s[16:19], s58 offen nt lds
 v_mfma_f32_16x16x32_bf16 v[220:223], v[24:27], a[124:127], v[220:223]
 v_cvt_pk_bf16_f32 v101, v150, v151
 v_mul_f32 v20, s74, v164
 v_mul_f32 v21, s74, v165
 v_mfma_f32_16x16x32_bf16 v[220:223], v[28:31], a[140:143], v[220:223]
 v_mul_f32 v22, s74, v166
 v_mul_f32 v23, s74, v167
 v_mfma_f32_16x16x32_bf16 v[220:223], v[32:35], a[156:159], v[220:223]
 s_waitcnt vmcnt(18)
 s_barrier
 s_waitcnt lgkmcnt(4)
 v_mfma_f32_16x16x32_bf16 v[224:227], v[36:39], a[112:115], v[224:227]
 s_waitcnt lgkmcnt(2)
 ds_read_b64_tr_b16 v[24:25], v6 offset:0
 v_exp_f32 v20, v20
 v_mfma_f32_16x16x32_bf16 v[224:227], v[40:43], a[128:131], v[224:227]
 s_waitcnt lgkmcnt(1)
 ds_read_b64_tr_b16 v[26:27], v6 offset:512
 v_mfma_f32_16x16x32_bf16 v[224:227], v[44:47], a[144:147], v[224:227]
 ds_read_b64_tr_b16 v[28:29], v6 offset:4096
 v_exp_f32 v21, v21
 v_mfma_f32_16x16x32_bf16 v[228:231], v[36:39], a[116:119], v[228:231]
 ds_read_b64_tr_b16 v[30:31], v6 offset:4608
 v_add_f32 v20, 1.0, v20
 v_mfma_f32_16x16x32_bf16 v[228:231], v[40:43], a[132:135], v[228:231]
 ds_read_b64_tr_b16 v[32:33], v6 offset:8192
 v_add_f32 v21, 1.0, v21
 v_mfma_f32_16x16x32_bf16 v[228:231], v[44:47], a[148:151], v[228:231]
 ds_read_b64_tr_b16 v[34:35], v6 offset:8704
 v_exp_f32 v22, v22
 v_mfma_f32_16x16x32_bf16 v[232:235], v[36:39], a[120:123], v[232:235]
 v_exp_f32 v23, v23
 v_mfma_f32_16x16x32_bf16 v[232:235], v[40:43], a[136:139], v[232:235]
 v_rcp_f32 v20, v20
 v_add_f32 v22, 1.0, v22
 v_mfma_f32_16x16x32_bf16 v[232:235], v[44:47], a[152:155], v[232:235]
 v_rcp_f32 v21, v21
 v_mfma_f32_16x16x32_bf16 v[236:239], v[36:39], a[124:127], v[236:239]
 v_rcp_f32 v22, v22
 v_mfma_f32_16x16x32_bf16 v[236:239], v[40:43], a[140:143], v[236:239]
 s_add_u32 s59, s65, 131072
 v_add_f32 v23, 1.0, v23
 v_mul_f32 v164, v164, v20
 v_mul_f32 v165, v165, v21
 v_mfma_f32_16x16x32_bf16 v[236:239], v[44:47], a[156:159], v[236:239]
 s_waitcnt lgkmcnt(4)
 v_mul_f32 v166, v166, v22
 v_lshlrev_b32 v20, 16, v102
 v_mfma_f32_16x16x32_bf16 v[176:179], v[24:27], a[160:163], v[176:179]
 s_waitcnt lgkmcnt(2)
 ds_read_b64_tr_b16 v[36:37], v7 offset:0
 v_rcp_f32 v23, v23
 v_mfma_f32_16x16x32_bf16 v[176:179], v[28:31], a[176:179], v[176:179]
 s_waitcnt lgkmcnt(1)
 ds_read_b64_tr_b16 v[38:39], v7 offset:512
 v_and_b32 v21, s73, v102
 v_mfma_f32_16x16x32_bf16 v[176:179], v[32:35], a[192:195], v[176:179]
 ds_read_b64_tr_b16 v[40:41], v7 offset:4096
 v_mul_f32 v167, v167, v23
 v_lshlrev_b32 v22, 16, v103
 v_mfma_f32_16x16x32_bf16 v[180:183], v[24:27], a[164:167], v[180:183]
 ds_read_b64_tr_b16 v[42:43], v7 offset:4608
 v_and_b32 v23, s73, v103
 v_mfma_f32_16x16x32_bf16 v[180:183], v[28:31], a[180:183], v[180:183]
 ds_read_b64_tr_b16 v[44:45], v7 offset:8192
 v_mul_f32 v164, v164, v20
 v_mfma_f32_16x16x32_bf16 v[180:183], v[32:35], a[196:199], v[180:183]
 ds_read_b64_tr_b16 v[46:47], v7 offset:8704
 v_mul_f32 v165, v165, v21
 v_mul_f32 v166, v166, v22
 v_mfma_f32_16x16x32_bf16 v[184:187], v[24:27], a[168:171], v[184:187]
 v_mul_f32 v167, v167, v23
 v_mul_f32 v16, s74, v152
 v_mfma_f32_16x16x32_bf16 v[184:187], v[28:31], a[184:187], v[184:187]
 s_add_u32 m0, s70, 114688
 v_cvt_pk_bf16_f32 v102, v164, v165
 v_mul_f32 v17, s74, v153
 v_mul_f32 v18, s74, v154
 v_mfma_f32_16x16x32_bf16 v[184:187], v[32:35], a[200:203], v[184:187]
 s_add_u32 s58, s84, 128
 buffer_load_dwordx4 v3, s[16:19], s58 offen nt lds
 v_mfma_f32_16x16x32_bf16 v[188:191], v[24:27], a[172:175], v[188:191]
 v_exp_f32 v16, v16
 v_mfma_f32_16x16x32_bf16 v[188:191], v[28:31], a[188:191], v[188:191]
 v_exp_f32 v17, v17
 v_cvt_pk_bf16_f32 v103, v166, v167
 v_mfma_f32_16x16x32_bf16 v[188:191], v[32:35], a[204:207], v[188:191]
 s_waitcnt lgkmcnt(4)
 v_exp_f32 v18, v18
 v_mfma_f32_16x16x32_bf16 v[192:195], v[36:39], a[160:163], v[192:195]
 s_waitcnt lgkmcnt(2)
 ds_read_b64_tr_b16 v[24:25], v8 offset:0
 v_mul_f32 v19, s74, v155
 v_add_f32 v16, 1.0, v16
 v_mfma_f32_16x16x32_bf16 v[192:195], v[40:43], a[176:179], v[192:195]
 s_waitcnt lgkmcnt(1)
 ds_read_b64_tr_b16 v[26:27], v8 offset:512
 v_add_f32 v17, 1.0, v17
 v_mfma_f32_16x16x32_bf16 v[192:195], v[44:47], a[192:195], v[192:195]
 ds_read_b64_tr_b16 v[28:29], v8 offset:4096
 v_exp_f32 v19, v19
 v_mfma_f32_16x16x32_bf16 v[196:199], v[36:39], a[164:167], v[196:199]
 ds_read_b64_tr_b16 v[30:31], v8 offset:4608
 v_add_f32 v18, 1.0, v18
 v_mfma_f32_16x16x32_bf16 v[196:199], v[40:43], a[180:183], v[196:199]
 ds_read_b64_tr_b16 v[32:33], v8 offset:8192
 v_add_f32 v19, 1.0, v19
 v_mfma_f32_16x16x32_bf16 v[196:199], v[44:47], a[196:199], v[196:199]
 ds_read_b64_tr_b16 v[34:35], v8 offset:8704
 v_rcp_f32 v16, v16
 v_mfma_f32_16x16x32_bf16 v[200:203], v[36:39], a[168:171], v[200:203]
 buffer_store_dwordx4 v[100:103], v2, s[32:35], s59 offen sc1
 v_mfma_f32_16x16x32_bf16 v[200:203], v[40:43], a[184:187], v[200:203]
 s_add_u32 m0, s70, 118784
 v_rcp_f32 v17, v17
 v_mul_f32 v152, v152, v16
 v_mfma_f32_16x16x32_bf16 v[200:203], v[44:47], a[200:203], v[200:203]
 s_add_u32 s58, s84, 295040
 buffer_load_dwordx4 v3, s[16:19], s58 offen nt lds
 v_mfma_f32_16x16x32_bf16 v[204:207], v[36:39], a[172:175], v[204:207]
 v_rcp_f32 v18, v18
 v_mfma_f32_16x16x32_bf16 v[204:207], v[40:43], a[188:191], v[204:207]
 v_rcp_f32 v19, v19
 v_mul_f32 v153, v153, v17
 v_mfma_f32_16x16x32_bf16 v[204:207], v[44:47], a[204:207], v[204:207]
 s_waitcnt lgkmcnt(4)
 v_mul_f32 v154, v154, v18
 v_lshlrev_b32 v16, 16, v104
 v_mfma_f32_16x16x32_bf16 v[208:211], v[24:27], a[160:163], v[208:211]
 s_waitcnt lgkmcnt(2)
 ds_read_b64_tr_b16 v[36:37], v9 offset:0
 v_mul_f32 v155, v155, v19
 v_and_b32 v17, s73, v104
 v_mfma_f32_16x16x32_bf16 v[208:211], v[28:31], a[176:179], v[208:211]
 s_waitcnt lgkmcnt(1)
 ds_read_b64_tr_b16 v[38:39], v9 offset:512
 v_lshlrev_b32 v18, 16, v105
 v_mfma_f32_16x16x32_bf16 v[208:211], v[32:35], a[192:195], v[208:211]
 ds_read_b64_tr_b16 v[40:41], v9 offset:4096
 v_and_b32 v19, s73, v105
 v_mfma_f32_16x16x32_bf16 v[212:215], v[24:27], a[164:167], v[212:215]
 ds_read_b64_tr_b16 v[42:43], v9 offset:4608
 v_mul_f32 v152, v152, v16
 v_mul_f32 v153, v153, v17
 v_mfma_f32_16x16x32_bf16 v[212:215], v[28:31], a[180:183], v[212:215]
 ds_read_b64_tr_b16 v[44:45], v9 offset:8192
 v_mul_f32 v154, v154, v18
 v_mfma_f32_16x16x32_bf16 v[212:215], v[32:35], a[196:199], v[212:215]
 ds_read_b64_tr_b16 v[46:47], v9 offset:8704
 v_mul_f32 v155, v155, v19
 v_cvt_pk_bf16_f32 v104, v152, v153
 v_mfma_f32_16x16x32_bf16 v[216:219], v[24:27], a[168:171], v[216:219]
 v_mul_f32 v20, s74, v168
 v_mul_f32 v21, s74, v169
 v_mfma_f32_16x16x32_bf16 v[216:219], v[28:31], a[184:187], v[216:219]
 s_add_u32 m0, s70, 122880
 v_cvt_pk_bf16_f32 v105, v154, v155
 v_mul_f32 v22, s74, v170
 v_mul_f32 v23, s74, v171
 v_mfma_f32_16x16x32_bf16 v[216:219], v[32:35], a[200:203], v[216:219]
 s_add_u32 s58, s84, 589952
 buffer_load_dwordx4 v3, s[16:19], s58 offen nt lds
 v_mfma_f32_16x16x32_bf16 v[220:223], v[24:27], a[172:175], v[220:223]
 v_exp_f32 v20, v20
 v_mfma_f32_16x16x32_bf16 v[220:223], v[28:31], a[188:191], v[220:223]
 v_exp_f32 v21, v21
 v_mfma_f32_16x16x32_bf16 v[220:223], v[32:35], a[204:207], v[220:223]
 s_waitcnt lgkmcnt(4)
 v_exp_f32 v22, v22
 v_mfma_f32_16x16x32_bf16 v[224:227], v[36:39], a[160:163], v[224:227]
 s_waitcnt lgkmcnt(2)
 ds_read_b64_tr_b16 v[24:25], v6 offset:12288
 v_exp_f32 v23, v23
 v_mfma_f32_16x16x32_bf16 v[224:227], v[40:43], a[176:179], v[224:227]
 s_waitcnt lgkmcnt(1)
 ds_read_b64_tr_b16 v[26:27], v6 offset:12800
 v_add_f32 v20, 1.0, v20
 v_mfma_f32_16x16x32_bf16 v[224:227], v[44:47], a[192:195], v[224:227]
 ds_read_b64_tr_b16 v[28:29], v6 offset:16384
 v_add_f32 v21, 1.0, v21
 v_mfma_f32_16x16x32_bf16 v[228:231], v[36:39], a[164:167], v[228:231]
 ds_read_b64_tr_b16 v[30:31], v6 offset:16896
 v_add_f32 v22, 1.0, v22
 v_add_f32 v23, 1.0, v23
 v_mfma_f32_16x16x32_bf16 v[228:231], v[40:43], a[180:183], v[228:231]
 ds_read_b64_tr_b16 v[32:33], v6 offset:20480
 v_mfma_f32_16x16x32_bf16 v[228:231], v[44:47], a[196:199], v[228:231]
 ds_read_b64_tr_b16 v[34:35], v6 offset:20992
 v_rcp_f32 v20, v20
 v_mfma_f32_16x16x32_bf16 v[232:235], v[36:39], a[168:171], v[232:235]
 v_rcp_f32 v21, v21
 v_mfma_f32_16x16x32_bf16 v[232:235], v[40:43], a[184:187], v[232:235]
 v_rcp_f32 v22, v22
 v_mul_f32 v168, v168, v20
 v_mfma_f32_16x16x32_bf16 v[232:235], v[44:47], a[200:203], v[232:235]
 s_add_u32 s59, s66, 131072
 v_rcp_f32 v23, v23
 v_mfma_f32_16x16x32_bf16 v[236:239], v[36:39], a[172:175], v[236:239]
 v_mul_f32 v169, v169, v21
 v_mul_f32 v170, v170, v22
 v_lshlrev_b32 v20, 16, v106
 v_mfma_f32_16x16x32_bf16 v[236:239], v[40:43], a[188:191], v[236:239]
 v_mul_f32 v171, v171, v23
 v_and_b32 v21, s73, v106
 v_mfma_f32_16x16x32_bf16 v[236:239], v[44:47], a[204:207], v[236:239]
 s_waitcnt lgkmcnt(4)
 v_lshlrev_b32 v22, 16, v107
 v_and_b32 v23, s73, v107
 v_mfma_f32_16x16x32_bf16 v[176:179], v[24:27], a[208:211], v[176:179]
 s_waitcnt lgkmcnt(2)
 ds_read_b64_tr_b16 v[36:37], v7 offset:12288
 v_mul_f32 v168, v168, v20
 v_mul_f32 v169, v169, v21
 v_mfma_f32_16x16x32_bf16 v[176:179], v[28:31], a[224:227], v[176:179]
 s_waitcnt lgkmcnt(1)
 ds_read_b64_tr_b16 v[38:39], v7 offset:12800
 v_mul_f32 v170, v170, v22
 v_mfma_f32_16x16x32_bf16 v[176:179], v[32:35], a[240:243], v[176:179]
 ds_read_b64_tr_b16 v[40:41], v7 offset:16384
 v_mul_f32 v171, v171, v23
 v_cvt_pk_bf16_f32 v106, v168, v169
 v_mfma_f32_16x16x32_bf16 v[180:183], v[24:27], a[212:215], v[180:183]
 ds_read_b64_tr_b16 v[42:43], v7 offset:16896
 v_mul_f32 v16, s74, v156
 v_mfma_f32_16x16x32_bf16 v[180:183], v[28:31], a[228:231], v[180:183]
 ds_read_b64_tr_b16 v[44:45], v7 offset:20480
 v_cvt_pk_bf16_f32 v107, v170, v171
 v_mul_f32 v17, s74, v157
 v_mfma_f32_16x16x32_bf16 v[180:183], v[32:35], a[244:247], v[180:183]
 ds_read_b64_tr_b16 v[46:47], v7 offset:20992
 v_mul_f32 v18, s74, v158
 v_mfma_f32_16x16x32_bf16 v[184:187], v[24:27], a[216:219], v[184:187]
 buffer_store_dwordx4 v[104:107], v2, s[32:35], s59 offen sc1
 v_mfma_f32_16x16x32_bf16 v[184:187], v[28:31], a[232:235], v[184:187]
 s_add_u32 m0, s70, 126976
 v_exp_f32 v16, v16
 v_mfma_f32_16x16x32_bf16 v[184:187], v[32:35], a[248:251], v[184:187]
 s_add_u32 s58, s85, 128
 buffer_load_dwordx4 v3, s[16:19], s58 offen nt lds
 v_mul_f32 v19, s74, v159
 v_mfma_f32_16x16x32_bf16 v[188:191], v[24:27], a[220:223], v[188:191]
 v_exp_f32 v17, v17
 v_mfma_f32_16x16x32_bf16 v[188:191], v[28:31], a[236:239], v[188:191]
 v_exp_f32 v18, v18
 v_add_f32 v16, 1.0, v16
 v_mfma_f32_16x16x32_bf16 v[188:191], v[32:35], a[252:255], v[188:191]
 s_waitcnt lgkmcnt(4)
 v_exp_f32 v19, v19
 v_mfma_f32_16x16x32_bf16 v[192:195], v[36:39], a[208:211], v[192:195]
 s_waitcnt lgkmcnt(2)
 ds_read_b64_tr_b16 v[24:25], v8 offset:12288
 v_add_f32 v17, 1.0, v17
 v_mfma_f32_16x16x32_bf16 v[192:195], v[40:43], a[224:227], v[192:195]
 s_waitcnt lgkmcnt(1)
 ds_read_b64_tr_b16 v[26:27], v8 offset:12800
 v_add_f32 v18, 1.0, v18
 v_add_f32 v19, 1.0, v19
 v_mfma_f32_16x16x32_bf16 v[192:195], v[44:47], a[240:243], v[192:195]
 ds_read_b64_tr_b16 v[28:29], v8 offset:16384
 v_mfma_f32_16x16x32_bf16 v[196:199], v[36:39], a[212:215], v[196:199]
 ds_read_b64_tr_b16 v[30:31], v8 offset:16896
 v_rcp_f32 v16, v16
 v_mfma_f32_16x16x32_bf16 v[196:199], v[40:43], a[228:231], v[196:199]
 ds_read_b64_tr_b16 v[32:33], v8 offset:20480
 v_mfma_f32_16x16x32_bf16 v[196:199], v[44:47], a[244:247], v[196:199]
 ds_read_b64_tr_b16 v[34:35], v8 offset:20992
 v_rcp_f32 v17, v17
 v_mfma_f32_16x16x32_bf16 v[200:203], v[36:39], a[216:219], v[200:203]
 v_rcp_f32 v18, v18
 v_mul_f32 v156, v156, v16
 v_mfma_f32_16x16x32_bf16 v[200:203], v[40:43], a[232:235], v[200:203]
 s_add_u32 m0, s70, 131072
 v_rcp_f32 v19, v19
 v_mfma_f32_16x16x32_bf16 v[200:203], v[44:47], a[248:251], v[200:203]
 s_add_u32 s58, s85, 295040
 buffer_load_dwordx4 v3, s[16:19], s58 offen nt lds
 v_mul_f32 v157, v157, v17
 v_mfma_f32_16x16x32_bf16 v[204:207], v[36:39], a[220:223], v[204:207]
 v_mul_f32 v158, v158, v18
 v_mul_f32 v159, v159, v19
 v_mfma_f32_16x16x32_bf16 v[204:207], v[40:43], a[236:239], v[204:207]
 v_lshlrev_b32 v16, 16, v108
 v_and_b32 v17, s73, v108
 v_lshlrev_b32 v18, 16, v109
 v_mfma_f32_16x16x32_bf16 v[204:207], v[44:47], a[252:255], v[204:207]
 s_waitcnt lgkmcnt(4)
 v_and_b32 v19, s73, v109
 v_mul_f32 v20, s74, v172
 v_mfma_f32_16x16x32_bf16 v[208:211], v[24:27], a[208:211], v[208:211]
 s_waitcnt lgkmcnt(2)
 ds_read_b64_tr_b16 v[36:37], v9 offset:12288
 v_mul_f32 v156, v156, v16
 v_mul_f32 v157, v157, v17
 v_mfma_f32_16x16x32_bf16 v[208:211], v[28:31], a[224:227], v[208:211]
 s_waitcnt lgkmcnt(1)
 ds_read_b64_tr_b16 v[38:39], v9 offset:12800
 v_mul_f32 v158, v158, v18
 v_mfma_f32_16x16x32_bf16 v[208:211], v[32:35], a[240:243], v[208:211]
 ds_read_b64_tr_b16 v[40:41], v9 offset:16384
 v_mul_f32 v159, v159, v19
 v_cvt_pk_bf16_f32 v108, v156, v157
 v_mfma_f32_16x16x32_bf16 v[212:215], v[24:27], a[212:215], v[212:215]
 ds_read_b64_tr_b16 v[42:43], v9 offset:16896
 v_mul_f32 v21, s74, v173
 v_mfma_f32_16x16x32_bf16 v[212:215], v[28:31], a[228:231], v[212:215]
 ds_read_b64_tr_b16 v[44:45], v9 offset:20480
 v_cvt_pk_bf16_f32 v109, v158, v159
 v_mul_f32 v22, s74, v174
 v_mfma_f32_16x16x32_bf16 v[212:215], v[32:35], a[244:247], v[212:215]
 ds_read_b64_tr_b16 v[46:47], v9 offset:20992
 v_mul_f32 v23, s74, v175
 v_mfma_f32_16x16x32_bf16 v[216:219], v[24:27], a[216:219], v[216:219]
 v_exp_f32 v20, v20
 v_mfma_f32_16x16x32_bf16 v[216:219], v[28:31], a[232:235], v[216:219]
 s_add_u32 m0, s70, 135168
 v_exp_f32 v21, v21
 v_mfma_f32_16x16x32_bf16 v[216:219], v[32:35], a[248:251], v[216:219]
 s_add_u32 s58, s85, 589952
 buffer_load_dwordx4 v3, s[16:19], s58 offen nt lds
 v_add_f32 v20, 1.0, v20
 v_mfma_f32_16x16x32_bf16 v[220:223], v[24:27], a[220:223], v[220:223]
 v_exp_f32 v22, v22
 v_add_f32 v21, 1.0, v21
 v_mfma_f32_16x16x32_bf16 v[220:223], v[28:31], a[236:239], v[220:223]
 v_exp_f32 v23, v23
 v_mfma_f32_16x16x32_bf16 v[220:223], v[32:35], a[252:255], v[220:223]
 s_waitcnt vmcnt(17)
 s_barrier
 s_waitcnt lgkmcnt(4)
 v_add_f32 v22, 1.0, v22
 v_mfma_f32_16x16x32_bf16 v[224:227], v[36:39], a[208:211], v[224:227]
 s_waitcnt lgkmcnt(2)
 ds_read_b64_tr_b16 v[24:25], v6 offset:24576
 v_add_f32 v23, 1.0, v23
 v_mfma_f32_16x16x32_bf16 v[224:227], v[40:43], a[224:227], v[224:227]
 s_waitcnt lgkmcnt(1)
 ds_read_b64_tr_b16 v[26:27], v6 offset:25088
 v_rcp_f32 v20, v20
 v_mfma_f32_16x16x32_bf16 v[224:227], v[44:47], a[240:243], v[224:227]
 ds_read_b64_tr_b16 v[28:29], v6 offset:28672
 v_rcp_f32 v21, v21
 v_mfma_f32_16x16x32_bf16 v[228:231], v[36:39], a[212:215], v[228:231]
 ds_read_b64_tr_b16 v[30:31], v6 offset:29184
 v_mul_f32 v172, v172, v20
 v_mfma_f32_16x16x32_bf16 v[228:231], v[40:43], a[228:231], v[228:231]
 ds_read_b64_tr_b16 v[32:33], v6 offset:32768
 v_rcp_f32 v22, v22
 v_mfma_f32_16x16x32_bf16 v[228:231], v[44:47], a[244:247], v[228:231]
 s_add_u32 s59, s67, 131072
 ds_read_b64_tr_b16 v[34:35], v6 offset:33280
 v_mul_f32 v173, v173, v21
 v_mfma_f32_16x16x32_bf16 v[232:235], v[36:39], a[216:219], v[232:235]
 v_rcp_f32 v23, v23
 v_mul_f32 v174, v174, v22
 v_mfma_f32_16x16x32_bf16 v[232:235], v[40:43], a[232:235], v[232:235]
 v_lshlrev_b32 v20, 16, v110
 v_and_b32 v21, s73, v110
 v_lshlrev_b32 v22, 16, v111
 v_mfma_f32_16x16x32_bf16 v[232:235], v[44:47], a[248:251], v[232:235]
 v_mul_f32 v175, v175, v23
 v_and_b32 v23, s73, v111
 v_mfma_f32_16x16x32_bf16 v[236:239], v[36:39], a[220:223], v[236:239]
 v_mul_f32 v172, v172, v20
 v_mul_f32 v173, v173, v21
 v_mul_f32 v174, v174, v22
 v_mfma_f32_16x16x32_bf16 v[236:239], v[40:43], a[236:239], v[236:239]
 v_mul_f32 v175, v175, v23
 v_mfma_f32_16x16x32_bf16 v[236:239], v[44:47], a[252:255], v[236:239]
 s_waitcnt lgkmcnt(4)
 v_cvt_pk_bf16_f32 v110, v172, v173
 v_cvt_pk_bf16_f32 v111, v174, v175
 buffer_store_dwordx4 v[108:111], v2, s[32:35], s59 offen sc1
L_ab_split:
 s_bitcmp1_b32 s2, 0
 s_cbranch_scc1 L_light
 v_mfma_f32_16x16x32_bf16 v[112:115], v[24:27], v[48:51], 0
 s_waitcnt lgkmcnt(2)
 ds_read_b64_tr_b16 v[36:37], v7 offset:24576
 v_mfma_f32_16x16x32_bf16 v[112:115], v[28:31], v[64:67], v[112:115]
 s_waitcnt lgkmcnt(1)
 ds_read_b64_tr_b16 v[38:39], v7 offset:25088
 v_mfma_f32_16x16x32_bf16 v[112:115], v[32:35], a[0:3], v[112:115]
 ds_read_b64_tr_b16 v[40:41], v7 offset:28672
 v_mul_f32 v16, s74, v176
 v_mfma_f32_16x16x32_bf16 v[116:119], v[24:27], v[52:55], 0
 ds_read_b64_tr_b16 v[42:43], v7 offset:29184
 v_mul_f32 v17, s74, v177
 v_mfma_f32_16x16x32_bf16 v[116:119], v[28:31], v[68:71], v[116:119]
 ds_read_b64_tr_b16 v[44:45], v7 offset:32768
 v_mul_f32 v18, s74, v178
 v_mfma_f32_16x16x32_bf16 v[116:119], v[32:35], a[4:7], v[116:119]
 ds_read_b64_tr_b16 v[46:47], v7 offset:33280
 v_mul_f32 v19, s74, v179
 v_mfma_f32_16x16x32_bf16 v[120:123], v[24:27], v[56:59], 0
 v_exp_f32 v16, v16
 v_mfma_f32_16x16x32_bf16 v[120:123], v[28:31], v[72:75], v[120:123]
 s_add_u32 m0, s71, 139264
 v_exp_f32 v17, v17
 v_mfma_f32_16x16x32_bf16 v[120:123], v[32:35], a[8:11], v[120:123]
 s_add_u32 s58, s80, 0
 buffer_load_dwordx4 v4, s[40:43], s58 offen nt lds
 v_add_f32 v16, 1.0, v16
 v_mfma_f32_16x16x32_bf16 v[124:127], v[24:27], v[60:63], 0
 v_exp_f32 v18, v18
 v_mfma_f32_16x16x32_bf16 v[124:127], v[28:31], v[76:79], v[124:127]
 v_exp_f32 v19, v19
 v_mfma_f32_16x16x32_bf16 v[124:127], v[32:35], a[12:15], v[124:127]
 s_waitcnt lgkmcnt(4)
 v_rcp_f32 v16, v16
 v_add_f32 v17, 1.0, v17
 v_mfma_f32_16x16x32_bf16 v[128:131], v[36:39], v[48:51], 0
 s_waitcnt lgkmcnt(2)
 ds_read_b64_tr_b16 v[24:25], v8 offset:24576
 v_add_f32 v18, 1.0, v18
 v_mfma_f32_16x16x32_bf16 v[128:131], v[40:43], v[64:67], v[128:131]
 s_waitcnt lgkmcnt(1)
 ds_read_b64_tr_b16 v[26:27], v8 offset:25088
 v_add_f32 v19, 1.0, v19
 v_mfma_f32_16x16x32_bf16 v[128:131], v[44:47], a[0:3], v[128:131]
 ds_read_b64_tr_b16 v[28:29], v8 offset:28672
 v_rcp_f32 v17, v17
 v_mfma_f32_16x16x32_bf16 v[132:135], v[36:39], v[52:55], 0
 ds_read_b64_tr_b16 v[30:31], v8 offset:29184
 v_mul_f32 v176, v176, v16
 v_mfma_f32_16x16x32_bf16 v[132:135], v[40:43], v[68:71], v[132:135]
 ds_read_b64_tr_b16 v[32:33], v8 offset:32768
 v_mul_f32 v177, v177, v17
 v_mfma_f32_16x16x32_bf16 v[132:135], v[44:47], a[4:7], v[132:135]
 ds_read_b64_tr_b16 v[34:35], v8 offset:33280
 v_rcp_f32 v18, v18
 v_mfma_f32_16x16x32_bf16 v[136:139], v[36:39], v[56:59], 0
 v_rcp_f32 v19, v19
 v_mfma_f32_16x16x32_bf16 v[136:139], v[40:43], v[72:75], v[136:139]
 s_add_u32 m0, s71, 140288
 v_mul_f32 v178, v178, v18
 v_cvt_pk_bf16_f32 v80, v176, v177
 v_mfma_f32_16x16x32_bf16 v[136:139], v[44:47], a[8:11], v[136:139]
 s_add_u32 s58, s80, 147456
 buffer_load_dwordx4 v4, s[40:43], s58 offen nt lds
 v_mul_f32 v179, v179, v19
 v_mfma_f32_16x16x32_bf16 v[140:143], v[36:39], v[60:63], 0
 v_mul_f32 v20, s74, v192
 v_mul_f32 v21, s74, v193
 v_mfma_f32_16x16x32_bf16 v[140:143], v[40:43], v[76:79], v[140:143]
 v_cvt_pk_bf16_f32 v81, v178, v179
 v_mul_f32 v22, s74, v194
 v_mfma_f32_16x16x32_bf16 v[140:143], v[44:47], a[12:15], v[140:143]
 s_waitcnt lgkmcnt(4)
 v_exp_f32 v20, v20
 v_mul_f32 v23, s74, v195
 v_mfma_f32_16x16x32_bf16 v[144:147], v[24:27], v[48:51], 0
 s_waitcnt lgkmcnt(2)
 ds_read_b64_tr_b16 v[36:37], v9 offset:24576
 v_mfma_f32_16x16x32_bf16 v[144:147], v[28:31], v[64:67], v[144:147]
 s_waitcnt lgkmcnt(1)
 ds_read_b64_tr_b16 v[38:39], v9 offset:25088
 v_add_f32 v20, 1.0, v20
 v_mfma_f32_16x16x32_bf16 v[144:147], v[32:35], a[0:3], v[144:147]
 ds_read_b64_tr_b16 v[40:41], v9 offset:28672
 v_exp_f32 v21, v21
 v_mfma_f32_16x16x32_bf16 v[148:151], v[24:27], v[52:55], 0
 ds_read_b64_tr_b16 v[42:43], v9 offset:29184
 v_mfma_f32_16x16x32_bf16 v[148:151], v[28:31], v[68:71], v[148:151]
 ds_read_b64_tr_b16 v[44:45], v9 offset:32768
 v_add_f32 v21, 1.0, v21
 v_mfma_f32_16x16x32_bf16 v[148:151], v[32:35], a[4:7], v[148:151]
 ds_read_b64_tr_b16 v[46:47], v9 offset:33280
 v_exp_f32 v22, v22
 v_mfma_f32_16x16x32_bf16 v[152:155], v[24:27], v[56:59], 0
 v_exp_f32 v23, v23
 v_mfma_f32_16x16x32_bf16 v[152:155], v[28:31], v[72:75], v[152:155]
 s_add_u32 m0, s71, 141312
 v_rcp_f32 v20, v20
 v_mfma_f32_16x16x32_bf16 v[152:155], v[32:35], a[8:11], v[152:155]
 s_add_u32 s58, s80, 294912
 buffer_load_dwordx4 v4, s[40:43], s58 offen nt lds
 v_add_f32 v22, 1.0, v22
 v_mfma_f32_16x16x32_bf16 v[156:159], v[24:27], v[60:63], 0
 v_rcp_f32 v21, v21
 v_mfma_f32_16x16x32_bf16 v[156:159], v[28:31], v[76:79], v[156:159]
 v_rcp_f32 v22, v22
 v_mfma_f32_16x16x32_bf16 v[156:159], v[32:35], a[12:15], v[156:159]
 s_waitcnt lgkmcnt(4)
 v_add_f32 v23, 1.0, v23
 v_mul_f32 v192, v192, v20
 v_mul_f32 v193, v193, v21
 v_mfma_f32_16x16x32_bf16 v[160:163], v[36:39], v[48:51], 0
 s_waitcnt lgkmcnt(2)
 ds_read_b64_tr_b16 v[24:25], v6 offset:36864
 v_mul_f32 v194, v194, v22
 v_mfma_f32_16x16x32_bf16 v[160:163], v[40:43], v[64:67], v[160:163]
 s_waitcnt lgkmcnt(1)
 ds_read_b64_tr_b16 v[26:27], v6 offset:37376
 v_cvt_pk_bf16_f32 v82, v192, v193
 v_mfma_f32_16x16x32_bf16 v[160:163], v[44:47], a[0:3], v[160:163]
 ds_read_b64_tr_b16 v[28:29], v6 offset:40960
 v_rcp_f32 v23, v23
 v_mfma_f32_16x16x32_bf16 v[164:167], v[36:39], v[52:55], 0
 ds_read_b64_tr_b16 v[30:31], v6 offset:41472
 v_mul_f32 v16, s74, v180
 v_mfma_f32_16x16x32_bf16 v[164:167], v[40:43], v[68:71], v[164:167]
 ds_read_b64_tr_b16 v[32:33], v6 offset:45056
 v_mul_f32 v195, v195, v23
 v_mfma_f32_16x16x32_bf16 v[164:167], v[44:47], a[4:7], v[164:167]
 ds_read_b64_tr_b16 v[34:35], v6 offset:45568
 v_mul_f32 v17, s74, v181
 v_mul_f32 v18, s74, v182
 v_mfma_f32_16x16x32_bf16 v[168:171], v[36:39], v[56:59], 0
 v_exp_f32 v16, v16
 v_mfma_f32_16x16x32_bf16 v[168:171], v[40:43], v[72:75], v[168:171]
 v_exp_f32 v17, v17
 v_cvt_pk_bf16_f32 v83, v194, v195
 v_mfma_f32_16x16x32_bf16 v[168:171], v[44:47], a[8:11], v[168:171]
 v_exp_f32 v18, v18
 v_mfma_f32_16x16x32_bf16 v[172:175], v[36:39], v[60:63], 0
 v_mul_f32 v19, s74, v183
 v_add_f32 v16, 1.0, v16
 v_mfma_f32_16x16x32_bf16 v[172:175], v[40:43], v[76:79], v[172:175]
 v_add_f32 v17, 1.0, v17
 v_add_f32 v18, 1.0, v18
 v_mul_f32 v20, s74, v196
 v_mfma_f32_16x16x32_bf16 v[172:175], v[44:47], a[12:15], v[172:175]
 s_waitcnt lgkmcnt(4)
 v_exp_f32 v19, v19
 v_mfma_f32_16x16x32_bf16 v[112:115], v[24:27], a[16:19], v[112:115]
 s_waitcnt lgkmcnt(2)
 ds_read_b64_tr_b16 v[36:37], v7 offset:36864
 v_mul_f32 v21, s74, v197
 v_mfma_f32_16x16x32_bf16 v[112:115], v[28:31], a[32:35], v[112:115]
 s_waitcnt lgkmcnt(1)
 ds_read_b64_tr_b16 v[38:39], v7 offset:37376
 v_add_f32 v19, 1.0, v19
 v_mul_f32 v22, s74, v198
 v_mfma_f32_16x16x32_bf16 v[112:115], v[32:35], a[48:51], v[112:115]
 ds_read_b64_tr_b16 v[40:41], v7 offset:40960
 v_mul_f32 v23, s74, v199
 v_mfma_f32_16x16x32_bf16 v[116:119], v[24:27], a[20:23], v[116:119]
 ds_read_b64_tr_b16 v[42:43], v7 offset:41472
 v_mfma_f32_16x16x32_bf16 v[116:119], v[28:31], a[36:39], v[116:119]
 ds_read_b64_tr_b16 v[44:45], v7 offset:45056
 v_rcp_f32 v16, v16
 v_mfma_f32_16x16x32_bf16 v[116:119], v[32:35], a[52:55], v[116:119]
 ds_read_b64_tr_b16 v[46:47], v7 offset:45568
 v_mfma_f32_16x16x32_bf16 v[120:123], v[24:27], a[24:27], v[120:123]
 v_rcp_f32 v17, v17
 v_mfma_f32_16x16x32_bf16 v[120:123], v[28:31], a[40:43], v[120:123]
 s_add_u32 m0, s71, 151552
 v_rcp_f32 v18, v18
 v_mul_f32 v180, v180, v16
 v_mfma_f32_16x16x32_bf16 v[120:123], v[32:35], a[56:59], v[120:123]
 s_add_u32 s58, s81, 0
 buffer_load_dwordx4 v4, s[40:43], s58 offen nt lds
 v_mfma_f32_16x16x32_bf16 v[124:127], v[24:27], a[28:31], v[124:127]
 v_rcp_f32 v19, v19
 v_mfma_f32_16x16x32_bf16 v[124:127], v[28:31], a[44:47], v[124:127]
 v_exp_f32 v20, v20
 v_mul_f32 v181, v181, v17
 v_mfma_f32_16x16x32_bf16 v[124:127], v[32:35], a[60:63], v[124:127]
 s_waitcnt lgkmcnt(4)
 v_exp_f32 v21, v21
 v_mfma_f32_16x16x32_bf16 v[128:131], v[36:39], a[16:19], v[128:131]
 s_waitcnt lgkmcnt(2)
 ds_read_b64_tr_b16 v[24:25], v8 offset:36864
 v_mul_f32 v182, v182, v18
 v_mfma_f32_16x16x32_bf16 v[128:131], v[40:43], a[32:35], v[128:131]
 s_waitcnt lgkmcnt(1)
 ds_read_b64_tr_b16 v[26:27], v8 offset:37376
 v_mul_f32 v183, v183, v19
 v_cvt_pk_bf16_f32 v84, v180, v181
 v_mfma_f32_16x16x32_bf16 v[128:131], v[44:47], a[48:51], v[128:131]
 ds_read_b64_tr_b16 v[28:29], v8 offset:40960
 v_add_f32 v20, 1.0, v20
 v_mfma_f32_16x16x32_bf16 v[132:135], v[36:39], a[20:23], v[132:135]
 ds_read_b64_tr_b16 v[30:31], v8 offset:41472
 v_cvt_pk_bf16_f32 v85, v182, v183
 v_mfma_f32_16x16x32_bf16 v[132:135], v[40:43], a[36:39], v[132:135]
 ds_read_b64_tr_b16 v[32:33], v8 offset:45056
 v_exp_f32 v22, v22
 v_mfma_f32_16x16x32_bf16 v[132:135], v[44:47], a[52:55], v[132:135]
 ds_read_b64_tr_b16 v[34:35], v8 offset:45568
 v_add_f32 v21, 1.0, v21
 v_mfma_f32_16x16x32_bf16 v[136:139], v[36:39], a[24:27], v[136:139]
 v_exp_f32 v23, v23
 v_mfma_f32_16x16x32_bf16 v[136:139], v[40:43], a[40:43], v[136:139]
 s_add_u32 m0, s71, 152576
 v_rcp_f32 v20, v20
 v_add_f32 v22, 1.0, v22
 v_mfma_f32_16x16x32_bf16 v[136:139], v[44:47], a[56:59], v[136:139]
 s_add_u32 s58, s81, 147456
 buffer_load_dwordx4 v4, s[40:43], s58 offen nt lds
 v_mfma_f32_16x16x32_bf16 v[140:143], v[36:39], a[28:31], v[140:143]
 v_rcp_f32 v21, v21
 v_mfma_f32_16x16x32_bf16 v[140:143], v[40:43], a[44:47], v[140:143]
 v_rcp_f32 v22, v22
 v_add_f32 v23, 1.0, v23
 v_mfma_f32_16x16x32_bf16 v[140:143], v[44:47], a[60:63], v[140:143]
 s_waitcnt lgkmcnt(4)
 v_mul_f32 v196, v196, v20
 v_mul_f32 v197, v197, v21
 v_mfma_f32_16x16x32_bf16 v[144:147], v[24:27], a[16:19], v[144:147]
 s_waitcnt lgkmcnt(2)
 ds_read_b64_tr_b16 v[36:37], v9 offset:36864
 v_mul_f32 v198, v198, v22
 v_mfma_f32_16x16x32_bf16 v[144:147], v[28:31], a[32:35], v[144:147]
 s_waitcnt lgkmcnt(1)
 ds_read_b64_tr_b16 v[38:39], v9 offset:37376
 v_rcp_f32 v23, v23
 v_mfma_f32_16x16x32_bf16 v[144:147], v[32:35], a[48:51], v[144:147]
 ds_read_b64_tr_b16 v[40:41], v9 offset:40960
 v_cvt_pk_bf16_f32 v86, v196, v197
 v_mfma_f32_16x16x32_bf16 v[148:151], v[24:27], a[20:23], v[148:151]
 ds_read_b64_tr_b16 v[42:43], v9 offset:41472
 v_mul_f32 v199, v199, v23
 v_mul_f32 v16, s74, v184
 v_mfma_f32_16x16x32_bf16 v[148:151], v[28:31], a[36:39], v[148:151]
 ds_read_b64_tr_b16 v[44:45], v9 offset:45056
 v_mul_f32 v17, s74, v185
 v_mfma_f32_16x16x32_bf16 v[148:151], v[32:35], a[52:55], v[148:151]
 ds_read_b64_tr_b16 v[46:47], v9 offset:45568
 v_cvt_pk_bf16_f32 v87, v198, v199
 v_mfma_f32_16x16x32_bf16 v[152:155], v[24:27], a[24:27], v[152:155]
 v_exp_f32 v16, v16
 v_mul_f32 v18, s74, v186
 v_mfma_f32_16x16x32_bf16 v[152:155], v[28:31], a[40:43], v[152:155]
 s_add_u32 m0, s71, 153600
 v_exp_f32 v17, v17
 v_mfma_f32_16x16x32_bf16 v[152:155], v[32:35], a[56:59], v[152:155]
 s_add_u32 s58, s81, 294912
 buffer_load_dwordx4 v4, s[40:43], s58 offen nt lds
 v_mfma_f32_16x16x32_bf16 v[156:159], v[24:27], a[28:31], v[156:159]
 v_exp_f32 v18, v18
 v_mul_f32 v19, s74, v187
 v_mfma_f32_16x16x32_bf16 v[156:159], v[28:31], a[44:47], v[156:159]
 v_add_f32 v16, 1.0, v16
 v_add_f32 v17, 1.0, v17
 v_mfma_f32_16x16x32_bf16 v[156:159], v[32:35], a[60:63], v[156:159]
 s_waitcnt vmcnt(15)
 s_barrier
 s_waitcnt lgkmcnt(4)
 v_mfma_f32_16x16x32_bf16 v[160:163], v[36:39], a[16:19], v[160:163]
 s_waitcnt lgkmcnt(2)
 ds_read_b64_tr_b16 v[24:25], v6 offset:49152
 v_exp_f32 v19, v19
 v_mfma_f32_16x16x32_bf16 v[160:163], v[40:43], a[32:35], v[160:163]
 s_waitcnt lgkmcnt(1)
 ds_read_b64_tr_b16 v[26:27], v6 offset:49664
 v_add_f32 v18, 1.0, v18
 v_mfma_f32_16x16x32_bf16 v[160:163], v[44:47], a[48:51], v[160:163]
 ds_read_b64_tr_b16 v[28:29], v6 offset:53248
 v_add_f32 v19, 1.0, v19
 v_mfma_f32_16x16x32_bf16 v[164:167], v[36:39], a[20:23], v[164:167]
 ds_read_b64_tr_b16 v[30:31], v6 offset:53760
 v_rcp_f32 v16, v16
 v_mfma_f32_16x16x32_bf16 v[164:167], v[40:43], a[36:39], v[164:167]
 ds_read_b64_tr_b16 v[32:33], v6 offset:57344
 v_mul_f32 v20, s74, v200
 v_mfma_f32_16x16x32_bf16 v[164:167], v[44:47], a[52:55], v[164:167]
 ds_read_b64_tr_b16 v[34:35], v6 offset:57856
 v_mul_f32 v184, v184, v16
 v_mfma_f32_16x16x32_bf16 v[168:171], v[36:39], a[24:27], v[168:171]
 v_rcp_f32 v17, v17
 v_mul_f32 v21, s74, v201
 v_mfma_f32_16x16x32_bf16 v[168:171], v[40:43], a[40:43], v[168:171]
 v_rcp_f32 v18, v18
 v_mfma_f32_16x16x32_bf16 v[168:171], v[44:47], a[56:59], v[168:171]
 v_rcp_f32 v19, v19
 v_mfma_f32_16x16x32_bf16 v[172:175], v[36:39], a[28:31], v[172:175]
 v_exp_f32 v20, v20
 v_mul_f32 v185, v185, v17
 v_mfma_f32_16x16x32_bf16 v[172:175], v[40:43], a[44:47], v[172:175]
 v_exp_f32 v21, v21
 v_mfma_f32_16x16x32_bf16 v[172:175], v[44:47], a[60:63], v[172:175]
 s_waitcnt lgkmcnt(4)
 v_mul_f32 v186, v186, v18
 v_mul_f32 v187, v187, v19
 v_mfma_f32_16x16x32_bf16 v[112:115], v[24:27], a[64:67], v[112:115]
 s_waitcnt lgkmcnt(2)
 ds_read_b64_tr_b16 v[36:37], v7 offset:49152
 v_cvt_pk_bf16_f32 v88, v184, v185
 v_mul_f32 v22, s74, v202
 v_mfma_f32_16x16x32_bf16 v[112:115], v[28:31], a[80:83], v[112:115]
 s_waitcnt lgkmcnt(1)
 ds_read_b64_tr_b16 v[38:39], v7 offset:49664
 v_cvt_pk_bf16_f32 v89, v186, v187
 v_mfma_f32_16x16x32_bf16 v[112:115], v[32:35], a[96:99], v[112:115]
 ds_read_b64_tr_b16 v[40:41], v7 offset:53248
 v_mul_f32 v23, s74, v203
 v_mfma_f32_16x16x32_bf16 v[116:119], v[24:27], a[68:71], v[116:119]
 ds_read_b64_tr_b16 v[42:43], v7 offset:53760
 v_exp_f32 v22, v22
 v_mfma_f32_16x16x32_bf16 v[116:119], v[28:31], a[84:87], v[116:119]
 ds_read_b64_tr_b16 v[44:45], v7 offset:57344
 v_add_f32 v20, 1.0, v20
 v_mfma_f32_16x16x32_bf16 v[116:119], v[32:35], a[100:103], v[116:119]
 ds_read_b64_tr_b16 v[46:47], v7 offset:57856
 v_exp_f32 v23, v23
 v_mfma_f32_16x16x32_bf16 v[120:123], v[24:27], a[72:75], v[120:123]
 v_rcp_f32 v20, v20
 v_mfma_f32_16x16x32_bf16 v[120:123], v[28:31], a[88:91], v[120:123]
 s_add_u32 m0, s71, 40960
 v_add_f32 v21, 1.0, v21
 v_add_f32 v22, 1.0, v22
 v_mfma_f32_16x16x32_bf16 v[120:123], v[32:35], a[104:107], v[120:123]
 s_add_u32 s58, s82, 0
 buffer_load_dwordx4 v4, s[40:43], s58 offen nt lds
 v_add_f32 v23, 1.0, v23
 v_mfma_f32_16x16x32_bf16 v[124:127], v[24:27], a[76:79], v[124:127]
 v_rcp_f32 v21, v21
 v_mfma_f32_16x16x32_bf16 v[124:127], v[28:31], a[92:95], v[124:127]
 v_rcp_f32 v22, v22
 v_mfma_f32_16x16x32_bf16 v[124:127], v[32:35], a[108:111], v[124:127]
 s_waitcnt lgkmcnt(4)
 v_rcp_f32 v23, v23
 v_mul_f32 v200, v200, v20
 v_mfma_f32_16x16x32_bf16 v[128:131], v[36:39], a[64:67], v[128:131]
 s_waitcnt lgkmcnt(2)
 ds_read_b64_tr_b16 v[24:25], v8 offset:49152
 v_mul_f32 v201, v201, v21
 v_mfma_f32_16x16x32_bf16 v[128:131], v[40:43], a[80:83], v[128:131]
 s_waitcnt lgkmcnt(1)
 ds_read_b64_tr_b16 v[26:27], v8 offset:49664
 v_mul_f32 v202, v202, v22
 v_mfma_f32_16x16x32_bf16 v[128:131], v[44:47], a[96:99], v[128:131]
 ds_read_b64_tr_b16 v[28:29], v8 offset:53248
 v_mul_f32 v203, v203, v23
 v_cvt_pk_bf16_f32 v90, v200, v201
 v_mfma_f32_16x16x32_bf16 v[132:135], v[36:39], a[68:71], v[132:135]
 ds_read_b64_tr_b16 v[30:31], v8 offset:53760
 v_mul_f32 v16, s74, v188
 v_mfma_f32_16x16x32_bf16 v[132:135], v[40:43], a[84:87], v[132:135]
 ds_read_b64_tr_b16 v[32:33], v8 offset:57344
 v_cvt_pk_bf16_f32 v91, v202, v203
 v_mfma_f32_16x16x32_bf16 v[132:135], v[44:47], a[100:103], v[132:135]
 ds_read_b64_tr_b16 v[34:35], v8 offset:57856
 v_mul_f32 v17, s74, v189
 v_mul_f32 v18, s74, v190
 v_mfma_f32_16x16x32_bf16 v[136:139], v[36:39], a[72:75], v[136:139]
 s_add_u32 m0, s71, 41984
 v_exp_f32 v16, v16
 v_mfma_f32_16x16x32_bf16 v[136:139], v[40:43], a[88:91], v[136:139]
 s_add_u32 s58, s82, 147456
 buffer_load_dwordx4 v4, s[40:43], s58 offen nt lds
 v_mfma_f32_16x16x32_bf16 v[136:139], v[44:47], a[104:107], v[136:139]
 v_exp_f32 v17, v17
 v_mul_f32 v19, s74, v191
 v_mfma_f32_16x16x32_bf16 v[140:143], v[36:39], a[76:79], v[140:143]
 v_exp_f32 v18, v18
 v_mfma_f32_16x16x32_bf16 v[140:143], v[40:43], a[92:95], v[140:143]
 v_exp_f32 v19, v19
 v_mfma_f32_16x16x32_bf16 v[140:143], v[44:47], a[108:111], v[140:143]
 s_waitcnt lgkmcnt(4)
 v_add_f32 v16, 1.0, v16
 v_add_f32 v17, 1.0, v17
 v_add_f32 v18, 1.0, v18
 v_mfma_f32_16x16x32_bf16 v[144:147], v[24:27], a[64:67], v[144:147]
 s_waitcnt lgkmcnt(2)
 ds_read_b64_tr_b16 v[36:37], v9 offset:49152
 v_add_f32 v19, 1.0, v19
 v_mfma_f32_16x16x32_bf16 v[144:147], v[28:31], a[80:83], v[144:147]
 s_waitcnt lgkmcnt(1)
 ds_read_b64_tr_b16 v[38:39], v9 offset:49664
 v_mul_f32 v20, s74, v204
 v_mfma_f32_16x16x32_bf16 v[144:147], v[32:35], a[96:99], v[144:147]
 ds_read_b64_tr_b16 v[40:41], v9 offset:53248
 v_rcp_f32 v16, v16
 v_mfma_f32_16x16x32_bf16 v[148:151], v[24:27], a[68:71], v[148:151]
 ds_read_b64_tr_b16 v[42:43], v9 offset:53760
 v_mul_f32 v21, s74, v205
 v_mfma_f32_16x16x32_bf16 v[148:151], v[28:31], a[84:87], v[148:151]
 ds_read_b64_tr_b16 v[44:45], v9 offset:57344
 v_rcp_f32 v17, v17
 v_mfma_f32_16x16x32_bf16 v[148:151], v[32:35], a[100:103], v[148:151]
 ds_read_b64_tr_b16 v[46:47], v9 offset:57856
 v_mul_f32 v188, v188, v16
 v_mfma_f32_16x16x32_bf16 v[152:155], v[24:27], a[72:75], v[152:155]
 v_add_u32 v6, 0xc000, v6
 v_add_u32 v7, 0xc000, v7
 v_mfma_f32_16x16x32_bf16 v[152:155], v[28:31], a[88:91], v[152:155]
 s_add_u32 m0, s71, 43008
 v_add_u32 v8, 0xc000, v8
 v_add_u32 v9, 0xc000, v9
 v_mul_f32 v189, v189, v17
 v_mfma_f32_16x16x32_bf16 v[152:155], v[32:35], a[104:107], v[152:155]
 s_add_u32 s58, s82, 294912
 buffer_load_dwordx4 v4, s[40:43], s58 offen nt lds
 v_mfma_f32_16x16x32_bf16 v[156:159], v[24:27], a[76:79], v[156:159]
 v_rcp_f32 v18, v18
 v_mfma_f32_16x16x32_bf16 v[156:159], v[28:31], a[92:95], v[156:159]
 v_rcp_f32 v19, v19
 v_cvt_pk_bf16_f32 v92, v188, v189
 v_mfma_f32_16x16x32_bf16 v[156:159], v[32:35], a[108:111], v[156:159]
 s_waitcnt lgkmcnt(4)
 v_exp_f32 v20, v20
 v_mfma_f32_16x16x32_bf16 v[160:163], v[36:39], a[64:67], v[160:163]
 s_waitcnt lgkmcnt(2)
 ds_read_b64_tr_b16 v[24:25], v6 offset:12288
 v_mul_f32 v190, v190, v18
 v_mfma_f32_16x16x32_bf16 v[160:163], v[40:43], a[80:83], v[160:163]
 s_waitcnt lgkmcnt(1)
 ds_read_b64_tr_b16 v[26:27], v6 offset:12800
 v_mul_f32 v191, v191, v19
 v_mul_f32 v22, s74, v206
 v_mfma_f32_16x16x32_bf16 v[160:163], v[44:47], a[96:99], v[160:163]
 ds_read_b64_tr_b16 v[28:29], v6 offset:16384
 v_mul_f32 v23, s74, v207
 v_mfma_f32_16x16x32_bf16 v[164:167], v[36:39], a[68:71], v[164:167]
 ds_read_b64_tr_b16 v[30:31], v6 offset:16896
 v_cvt_pk_bf16_f32 v93, v190, v191
 v_mfma_f32_16x16x32_bf16 v[164:167], v[40:43], a[84:87], v[164:167]
 ds_read_b64_tr_b16 v[32:33], v6 offset:20480
 v_exp_f32 v21, v21
 v_mfma_f32_16x16x32_bf16 v[164:167], v[44:47], a[100:103], v[164:167]
 ds_read_b64_tr_b16 v[34:35], v6 offset:20992
 v_add_f32 v20, 1.0, v20
 v_mfma_f32_16x16x32_bf16 v[168:171], v[36:39], a[72:75], v[168:171]
 v_exp_f32 v22, v22
 v_mfma_f32_16x16x32_bf16 v[168:171], v[40:43], a[88:91], v[168:171]
 v_exp_f32 v23, v23
 v_add_f32 v21, 1.0, v21
 v_mfma_f32_16x16x32_bf16 v[168:171], v[44:47], a[104:107], v[168:171]
 v_rcp_f32 v20, v20
 v_mfma_f32_16x16x32_bf16 v[172:175], v[36:39], a[76:79], v[172:175]
 v_rcp_f32 v21, v21
 v_mfma_f32_16x16x32_bf16 v[172:175], v[40:43], a[92:95], v[172:175]
 v_add_f32 v22, 1.0, v22
 v_add_f32 v23, 1.0, v23
 v_mul_f32 v204, v204, v20
 v_mfma_f32_16x16x32_bf16 v[172:175], v[44:47], a[108:111], v[172:175]
 s_waitcnt lgkmcnt(4)
 v_mul_f32 v205, v205, v21
 v_mul_f32 v16, s74, v208
 v_mfma_f32_16x16x32_bf16 v[112:115], v[24:27], a[112:115], v[112:115]
 s_waitcnt lgkmcnt(2)
 ds_read_b64_tr_b16 v[36:37], v7 offset:12288
 v_mul_f32 v17, s74, v209
 v_mfma_f32_16x16x32_bf16 v[112:115], v[28:31], a[128:131], v[112:115]
 s_waitcnt lgkmcnt(1)
 ds_read_b64_tr_b16 v[38:39], v7 offset:12800
 v_rcp_f32 v22, v22
 v_mfma_f32_16x16x32_bf16 v[112:115], v[32:35], a[144:147], v[112:115]
 ds_read_b64_tr_b16 v[40:41], v7 offset:16384
 v_cvt_pk_bf16_f32 v94, v204, v205
 v_mfma_f32_16x16x32_bf16 v[116:119], v[24:27], a[116:119], v[116:119]
 ds_read_b64_tr_b16 v[42:43], v7 offset:16896
 v_mul_f32 v206, v206, v22
 v_mfma_f32_16x16x32_bf16 v[116:119], v[28:31], a[132:135], v[116:119]
 ds_read_b64_tr_b16 v[44:45], v7 offset:20480
 v_rcp_f32 v23, v23
 v_mfma_f32_16x16x32_bf16 v[116:119], v[32:35], a[148:151], v[116:119]
 ds_read_b64_tr_b16 v[46:47], v7 offset:20992
 v_mul_f32 v18, s74, v210
 v_mfma_f32_16x16x32_bf16 v[120:123], v[24:27], a[120:123], v[120:123]
 v_exp_f32 v16, v16
 v_mul_f32 v207, v207, v23
 v_mfma_f32_16x16x32_bf16 v[120:123], v[28:31], a[136:139], v[120:123]
 v_exp_f32 v17, v17
 v_mfma_f32_16x16x32_bf16 v[120:123], v[32:35], a[152:155], v[120:123]
 v_exp_f32 v18, v18
 v_mfma_f32_16x16x32_bf16 v[124:127], v[24:27], a[124:127], v[124:127]
 v_cvt_pk_bf16_f32 v95, v206, v207
 v_mul_f32 v19, s74, v211
 v_add_f32 v16, 1.0, v16
 v_mfma_f32_16x16x32_bf16 v[124:127], v[28:31], a[140:143], v[124:127]
 v_add_f32 v17, 1.0, v17
 v_add_f32 v18, 1.0, v18
 v_mfma_f32_16x16x32_bf16 v[124:127], v[32:35], a[156:159], v[124:127]
 s_waitcnt lgkmcnt(4)
 v_exp_f32 v19, v19
 v_mfma_f32_16x16x32_bf16 v[128:131], v[36:39], a[112:115], v[128:131]
 s_waitcnt lgkmcnt(2)
 ds_read_b64_tr_b16 v[24:25], v8 offset:12288
 v_rcp_f32 v16, v16
 v_mfma_f32_16x16x32_bf16 v[128:131], v[40:43], a[128:131], v[128:131]
 s_waitcnt lgkmcnt(1)
 ds_read_b64_tr_b16 v[26:27], v8 offset:12800
 v_add_f32 v19, 1.0, v19
 v_mfma_f32_16x16x32_bf16 v[128:131], v[44:47], a[144:147], v[128:131]
 ds_read_b64_tr_b16 v[28:29], v8 offset:16384
 v_mul_f32 v208, v208, v16
 v_mfma_f32_16x16x32_bf16 v[132:135], v[36:39], a[116:119], v[132:135]
 ds_read_b64_tr_b16 v[30:31], v8 offset:16896
 v_rcp_f32 v17, v17
 v_mfma_f32_16x16x32_bf16 v[132:135], v[40:43], a[132:135], v[132:135]
 ds_read_b64_tr_b16 v[32:33], v8 offset:20480
 v_mul_f32 v20, s74, v224
 v_mfma_f32_16x16x32_bf16 v[132:135], v[44:47], a[148:151], v[132:135]
 ds_read_b64_tr_b16 v[34:35], v8 offset:20992
 v_mul_f32 v209, v209, v17
 v_mfma_f32_16x16x32_bf16 v[136:139], v[36:39], a[120:123], v[136:139]
 v_rcp_f32 v18, v18
 v_mul_f32 v21, s74, v225
 v_mfma_f32_16x16x32_bf16 v[136:139], v[40:43], a[136:139], v[136:139]
 v_rcp_f32 v19, v19
 v_mfma_f32_16x16x32_bf16 v[136:139], v[44:47], a[152:155], v[136:139]
 v_exp_f32 v20, v20
 v_mfma_f32_16x16x32_bf16 v[140:143], v[36:39], a[124:127], v[140:143]
 v_exp_f32 v21, v21
 v_mul_f32 v210, v210, v18
 v_mfma_f32_16x16x32_bf16 v[140:143], v[40:43], a[140:143], v[140:143]
 v_mul_f32 v211, v211, v19
 v_cvt_pk_bf16_f32 v96, v208, v209
 v_mfma_f32_16x16x32_bf16 v[140:143], v[44:47], a[156:159], v[140:143]
 s_waitcnt lgkmcnt(4)
 v_mul_f32 v22, s74, v226
 v_mul_f32 v23, s74, v227
 v_mfma_f32_16x16x32_bf16 v[144:147], v[24:27], a[112:115], v[144:147]
 s_waitcnt lgkmcnt(2)
 ds_read_b64_tr_b16 v[36:37], v9 offset:12288
 v_cvt_pk_bf16_f32 v97, v210, v211
 v_add_f32 v20, 1.0, v20
 v_mfma_f32_16x16x32_bf16 v[144:147], v[28:31], a[128:131], v[144:147]
 s_waitcnt lgkmcnt(1)
 ds_read_b64_tr_b16 v[38:39], v9 offset:12800
 v_add_f32 v21, 1.0, v21
 v_mfma_f32_16x16x32_bf16 v[144:147], v[32:35], a[144:147], v[144:147]
 ds_read_b64_tr_b16 v[40:41], v9 offset:16384
 v_mfma_f32_16x16x32_bf16 v[148:151], v[24:27], a[116:119], v[148:151]
 ds_read_b64_tr_b16 v[42:43], v9 offset:16896
 v_exp_f32 v22, v22
 v_mfma_f32_16x16x32_bf16 v[148:151], v[28:31], a[132:135], v[148:151]
 ds_read_b64_tr_b16 v[44:45], v9 offset:20480
 v_mul_f32 v16, s74, v212
 v_mfma_f32_16x16x32_bf16 v[148:151], v[32:35], a[148:151], v[148:151]
 ds_read_b64_tr_b16 v[46:47], v9 offset:20992
 v_exp_f32 v23, v23
 v_mfma_f32_16x16x32_bf16 v[152:155], v[24:27], a[120:123], v[152:155]
 v_rcp_f32 v20, v20
 v_mfma_f32_16x16x32_bf16 v[152:155], v[28:31], a[136:139], v[152:155]
 v_rcp_f32 v21, v21
 v_mfma_f32_16x16x32_bf16 v[152:155], v[32:35], a[152:155], v[152:155]
 v_exp_f32 v16, v16
 v_add_f32 v22, 1.0, v22
 v_mfma_f32_16x16x32_bf16 v[156:159], v[24:27], a[124:127], v[156:159]
 v_add_f32 v23, 1.0, v23
 v_mul_f32 v224, v224, v20
 v_mfma_f32_16x16x32_bf16 v[156:159], v[28:31], a[140:143], v[156:159]
 v_rcp_f32 v22, v22
 v_mfma_f32_16x16x32_bf16 v[156:159], v[32:35], a[156:159], v[156:159]
 s_waitcnt vmcnt(10)
 s_barrier
 s_waitcnt lgkmcnt(4)
 v_mul_f32 v225, v225, v21
 v_mfma_f32_16x16x32_bf16 v[160:163], v[36:39], a[112:115], v[160:163]
 s_waitcnt lgkmcnt(2)
 ds_read_b64_tr_b16 v[24:25], v6 offset:24576
 v_mul_f32 v226, v226, v22
 v_mfma_f32_16x16x32_bf16 v[160:163], v[40:43], a[128:131], v[160:163]
 s_waitcnt lgkmcnt(1)
 ds_read_b64_tr_b16 v[26:27], v6 offset:25088
 v_cvt_pk_bf16_f32 v98, v224, v225
 v_mfma_f32_16x16x32_bf16 v[160:163], v[44:47], a[144:147], v[160:163]
 ds_read_b64_tr_b16 v[28:29], v6 offset:28672
 v_rcp_f32 v23, v23
 v_mfma_f32_16x16x32_bf16 v[164:167], v[36:39], a[116:119], v[164:167]
 ds_read_b64_tr_b16 v[30:31], v6 offset:29184
 v_mul_f32 v17, s74, v213
 v_mfma_f32_16x16x32_bf16 v[164:167], v[40:43], a[132:135], v[164:167]
 ds_read_b64_tr_b16 v[32:33], v6 offset:32768
 v_mul_f32 v227, v227, v23
 v_mfma_f32_16x16x32_bf16 v[164:167], v[44:47], a[148:151], v[164:167]
 ds_read_b64_tr_b16 v[34:35], v6 offset:33280
 v_mul_f32 v18, s74, v214
 v_mul_f32 v19, s74, v215
 v_mfma_f32_16x16x32_bf16 v[168:171], v[36:39], a[120:123], v[168:171]
 v_exp_f32 v17, v17
 v_mfma_f32_16x16x32_bf16 v[168:171], v[40:43], a[136:139], v[168:171]
 v_exp_f32 v18, v18
 v_mfma_f32_16x16x32_bf16 v[168:171], v[44:47], a[152:155], v[168:171]
 v_exp_f32 v19, v19
 v_cvt_pk_bf16_f32 v99, v226, v227
 v_mfma_f32_16x16x32_bf16 v[172:175], v[36:39], a[124:127], v[172:175]
 v_add_f32 v16, 1.0, v16
 v_add_f32 v17, 1.0, v17
 v_mfma_f32_16x16x32_bf16 v[172:175], v[40:43], a[140:143], v[172:175]
 v_add_f32 v18, 1.0, v18
 v_add_f32 v19, 1.0, v19
 v_mul_f32 v20, s74, v228
 v_mfma_f32_16x16x32_bf16 v[172:175], v[44:47], a[156:159], v[172:175]
 s_waitcnt lgkmcnt(4)
 v_rcp_f32 v16, v16
 v_mfma_f32_16x16x32_bf16 v[112:115], v[24:27], a[160:163], v[112:115]
 s_waitcnt lgkmcnt(2)
 ds_read_b64_tr_b16 v[36:37], v7 offset:24576
 v_mul_f32 v21, s74, v229
 v_mfma_f32_16x16x32_bf16 v[112:115], v[28:31], a[176:179], v[112:115]
 s_waitcnt lgkmcnt(1)
 ds_read_b64_tr_b16 v[38:39], v7 offset:25088
 v_rcp_f32 v17, v17
 v_mfma_f32_16x16x32_bf16 v[112:115], v[32:35], a[192:195], v[112:115]
 ds_read_b64_tr_b16 v[40:41], v7 offset:28672
 v_mul_f32 v212, v212, v16
 v_mfma_f32_16x16x32_bf16 v[116:119], v[24:27], a[164:167], v[116:119]
 ds_read_b64_tr_b16 v[42:43], v7 offset:29184
 v_mul_f32 v213, v213, v17
 v_mfma_f32_16x16x32_bf16 v[116:119], v[28:31], a[180:183], v[116:119]
 ds_read_b64_tr_b16 v[44:45], v7 offset:32768
 v_rcp_f32 v18, v18
 v_mfma_f32_16x16x32_bf16 v[116:119], v[32:35], a[196:199], v[116:119]
 ds_read_b64_tr_b16 v[46:47], v7 offset:33280
 v_cvt_pk_bf16_f32 v100, v212, v213
 v_mfma_f32_16x16x32_bf16 v[120:123], v[24:27], a[168:171], v[120:123]
 v_rcp_f32 v19, v19
 v_mfma_f32_16x16x32_bf16 v[120:123], v[28:31], a[184:187], v[120:123]
 s_add_u32 m0, s71, 65536
 v_exp_f32 v20, v20
 v_mul_f32 v214, v214, v18
 v_mfma_f32_16x16x32_bf16 v[120:123], v[32:35], a[200:203], v[120:123]
 s_add_u32 s58, s83, 0
 buffer_load_dwordx4 v4, s[40:43], s58 offen nt lds
 v_mfma_f32_16x16x32_bf16 v[124:127], v[24:27], a[172:175], v[124:127]
 v_exp_f32 v21, v21
 v_mfma_f32_16x16x32_bf16 v[124:127], v[28:31], a[188:191], v[124:127]
 v_mul_f32 v215, v215, v19
 v_mul_f32 v22, s74, v230
 v_mul_f32 v23, s74, v231
 v_mfma_f32_16x16x32_bf16 v[124:127], v[32:35], a[204:207], v[124:127]
 s_waitcnt lgkmcnt(4)
 v_add_f32 v20, 1.0, v20
 v_add_f32 v21, 1.0, v21
 v_mfma_f32_16x16x32_bf16 v[128:131], v[36:39], a[160:163], v[128:131]
 s_waitcnt lgkmcnt(2)
 ds_read_b64_tr_b16 v[24:25], v8 offset:24576
 v_cvt_pk_bf16_f32 v101, v214, v215
 v_mfma_f32_16x16x32_bf16 v[128:131], v[40:43], a[176:179], v[128:131]
 s_waitcnt lgkmcnt(1)
 ds_read_b64_tr_b16 v[26:27], v8 offset:25088
 v_mfma_f32_16x16x32_bf16 v[128:131], v[44:47], a[192:195], v[128:131]
 ds_read_b64_tr_b16 v[28:29], v8 offset:28672
 v_mfma_f32_16x16x32_bf16 v[132:135], v[36:39], a[164:167], v[132:135]
 ds_read_b64_tr_b16 v[30:31], v8 offset:29184
 v_exp_f32 v22, v22
 v_mfma_f32_16x16x32_bf16 v[132:135], v[40:43], a[180:183], v[132:135]
 ds_read_b64_tr_b16 v[32:33], v8 offset:32768
 v_mul_f32 v16, s74, v216
 v_mfma_f32_16x16x32_bf16 v[132:135], v[44:47], a[196:199], v[132:135]
 ds_read_b64_tr_b16 v[34:35], v8 offset:33280
 v_add_f32 v22, 1.0, v22
 v_mfma_f32_16x16x32_bf16 v[136:139], v[36:39], a[168:171], v[136:139]
 v_exp_f32 v23, v23
 v_mul_f32 v17, s74, v217
 v_mfma_f32_16x16x32_bf16 v[136:139], v[40:43], a[184:187], v[136:139]
 s_add_u32 m0, s71, 66560
 v_rcp_f32 v20, v20
 v_mfma_f32_16x16x32_bf16 v[136:139], v[44:47], a[200:203], v[136:139]
 s_add_u32 s58, s83, 147456
 buffer_load_dwordx4 v4, s[40:43], s58 offen nt lds
 v_add_f32 v23, 1.0, v23
 v_mfma_f32_16x16x32_bf16 v[140:143], v[36:39], a[172:175], v[140:143]
 v_rcp_f32 v21, v21
 v_mfma_f32_16x16x32_bf16 v[140:143], v[40:43], a[188:191], v[140:143]
 v_rcp_f32 v22, v22
 v_mfma_f32_16x16x32_bf16 v[140:143], v[44:47], a[204:207], v[140:143]
 s_waitcnt lgkmcnt(4)
 v_rcp_f32 v23, v23
 v_mul_f32 v228, v228, v20
 v_mfma_f32_16x16x32_bf16 v[144:147], v[24:27], a[160:163], v[144:147]
 s_waitcnt lgkmcnt(2)
 ds_read_b64_tr_b16 v[36:37], v9 offset:24576
 v_mul_f32 v229, v229, v21
 v_mfma_f32_16x16x32_bf16 v[144:147], v[28:31], a[176:179], v[144:147]
 s_waitcnt lgkmcnt(1)
 ds_read_b64_tr_b16 v[38:39], v9 offset:25088
 v_mul_f32 v230, v230, v22
 v_mul_f32 v231, v231, v23
 v_mfma_f32_16x16x32_bf16 v[144:147], v[32:35], a[192:195], v[144:147]
 ds_read_b64_tr_b16 v[40:41], v9 offset:28672
 v_cvt_pk_bf16_f32 v102, v228, v229
 v_mfma_f32_16x16x32_bf16 v[148:151], v[24:27], a[164:167], v[148:151]
 ds_read_b64_tr_b16 v[42:43], v9 offset:29184
 v_cvt_pk_bf16_f32 v103, v230, v231
 v_mfma_f32_16x16x32_bf16 v[148:151], v[28:31], a[180:183], v[148:151]
 ds_read_b64_tr_b16 v[44:45], v9 offset:32768
 v_mul_f32 v18, s74, v218
 v_mul_f32 v19, s74, v219
 v_mfma_f32_16x16x32_bf16 v[148:151], v[32:35], a[196:199], v[148:151]
 ds_read_b64_tr_b16 v[46:47], v9 offset:33280
 v_mfma_f32_16x16x32_bf16 v[152:155], v[24:27], a[168:171], v[152:155]
 v_exp_f32 v16, v16
 v_mfma_f32_16x16x32_bf16 v[152:155], v[28:31], a[184:187], v[152:155]
 s_add_u32 m0, s71, 67584
 v_exp_f32 v17, v17
 v_mfma_f32_16x16x32_bf16 v[152:155], v[32:35], a[200:203], v[152:155]
 s_add_u32 s58, s83, 294912
 buffer_load_dwordx4 v4, s[40:43], s58 offen nt lds
 v_mfma_f32_16x16x32_bf16 v[156:159], v[24:27], a[172:175], v[156:159]
 v_exp_f32 v18, v18
 v_add_f32 v16, 1.0, v16
 v_mfma_f32_16x16x32_bf16 v[156:159], v[28:31], a[188:191], v[156:159]
 v_exp_f32 v19, v19
 v_mfma_f32_16x16x32_bf16 v[156:159], v[32:35], a[204:207], v[156:159]
 s_waitcnt lgkmcnt(4)
 v_rcp_f32 v16, v16
 v_add_f32 v17, 1.0, v17
 v_mfma_f32_16x16x32_bf16 v[160:163], v[36:39], a[160:163], v[160:163]
 s_waitcnt lgkmcnt(2)
 ds_read_b64_tr_b16 v[24:25], v6 offset:36864
 v_add_f32 v18, 1.0, v18
 v_mfma_f32_16x16x32_bf16 v[160:163], v[40:43], a[176:179], v[160:163]
 s_waitcnt lgkmcnt(1)
 ds_read_b64_tr_b16 v[26:27], v6 offset:37376
 v_add_f32 v19, 1.0, v19
 v_mul_f32 v216, v216, v16
 v_mfma_f32_16x16x32_bf16 v[160:163], v[44:47], a[192:195], v[160:163]
 ds_read_b64_tr_b16 v[28:29], v6 offset:40960
 v_mul_f32 v20, s74, v232
 v_mfma_f32_16x16x32_bf16 v[164:167], v[36:39], a[164:167], v[164:167]
 ds_read_b64_tr_b16 v[30:31], v6 offset:41472
 v_mul_f32 v21, s74, v233
 v_mfma_f32_16x16x32_bf16 v[164:167], v[40:43], a[180:183], v[164:167]
 ds_read_b64_tr_b16 v[32:33], v6 offset:45056
 v_rcp_f32 v17, v17
 v_mfma_f32_16x16x32_bf16 v[164:167], v[44:47], a[196:199], v[164:167]
 ds_read_b64_tr_b16 v[34:35], v6 offset:45568
 v_mul_f32 v22, s74, v234
 v_mfma_f32_16x16x32_bf16 v[168:171], v[36:39], a[168:171], v[168:171]
 v_rcp_f32 v18, v18
 v_mul_f32 v217, v217, v17
 v_mfma_f32_16x16x32_bf16 v[168:171], v[40:43], a[184:187], v[168:171]
 v_rcp_f32 v19, v19
 v_mfma_f32_16x16x32_bf16 v[168:171], v[44:47], a[200:203], v[168:171]
 v_exp_f32 v20, v20
 v_mfma_f32_16x16x32_bf16 v[172:175], v[36:39], a[172:175], v[172:175]
 v_exp_f32 v21, v21
 v_mul_f32 v218, v218, v18
 v_mfma_f32_16x16x32_bf16 v[172:175], v[40:43], a[188:191], v[172:175]
 v_exp_f32 v22, v22
 v_mfma_f32_16x16x32_bf16 v[172:175], v[44:47], a[204:207], v[172:175]
 s_waitcnt lgkmcnt(4)
 v_mul_f32 v219, v219, v19
 v_cvt_pk_bf16_f32 v104, v216, v217
 v_mul_f32 v23, s74, v235
 v_mfma_f32_16x16x32_bf16 v[112:115], v[24:27], a[208:211], v[112:115]
 s_waitcnt lgkmcnt(2)
 ds_read_b64_tr_b16 v[36:37], v7 offset:36864
 v_add_f32 v20, 1.0, v20
 v_mfma_f32_16x16x32_bf16 v[112:115], v[28:31], a[224:227], v[112:115]
 s_waitcnt lgkmcnt(1)
 ds_read_b64_tr_b16 v[38:39], v7 offset:37376
 v_cvt_pk_bf16_f32 v105, v218, v219
 v_add_f32 v21, 1.0, v21
 v_mfma_f32_16x16x32_bf16 v[112:115], v[32:35], a[240:243], v[112:115]
 ds_read_b64_tr_b16 v[40:41], v7 offset:40960
 v_add_f32 v22, 1.0, v22
 v_mfma_f32_16x16x32_bf16 v[116:119], v[24:27], a[212:215], v[116:119]
 ds_read_b64_tr_b16 v[42:43], v7 offset:41472
 v_mul_f32 v16, s74, v220
 v_mfma_f32_16x16x32_bf16 v[116:119], v[28:31], a[228:231], v[116:119]
 ds_read_b64_tr_b16 v[44:45], v7 offset:45056
 v_exp_f32 v23, v23
 v_mfma_f32_16x16x32_bf16 v[116:119], v[32:35], a[244:247], v[116:119]
 ds_read_b64_tr_b16 v[46:47], v7 offset:45568
 v_mul_f32 v17, s74, v221
 v_mfma_f32_16x16x32_bf16 v[120:123], v[24:27], a[216:219], v[120:123]
 v_rcp_f32 v20, v20
 v_add_f32 v23, 1.0, v23
 v_mfma_f32_16x16x32_bf16 v[120:123], v[28:31], a[232:235], v[120:123]
 v_rcp_f32 v21, v21
 v_mfma_f32_16x16x32_bf16 v[120:123], v[32:35], a[248:251], v[120:123]
 v_rcp_f32 v22, v22
 v_mul_f32 v232, v232, v20
 v_mfma_f32_16x16x32_bf16 v[124:127], v[24:27], a[220:223], v[124:127]
 v_rcp_f32 v23, v23
 v_mfma_f32_16x16x32_bf16 v[124:127], v[28:31], a[236:239], v[124:127]
 v_exp_f32 v16, v16
 v_mfma_f32_16x16x32_bf16 v[124:127], v[32:35], a[252:255], v[124:127]
 s_waitcnt lgkmcnt(4)
 v_exp_f32 v17, v17
 v_mul_f32 v233, v233, v21
 v_mfma_f32_16x16x32_bf16 v[128:131], v[36:39], a[208:211], v[128:131]
 s_waitcnt lgkmcnt(2)
 ds_read_b64_tr_b16 v[24:25], v8 offset:36864
 v_mul_f32 v234, v234, v22
 v_mfma_f32_16x16x32_bf16 v[128:131], v[40:43], a[224:227], v[128:131]
 s_waitcnt lgkmcnt(1)
 ds_read_b64_tr_b16 v[26:27], v8 offset:37376
 v_mul_f32 v235, v235, v23
 v_cvt_pk_bf16_f32 v106, v232, v233
 v_mfma_f32_16x16x32_bf16 v[128:131], v[44:47], a[240:243], v[128:131]
 ds_read_b64_tr_b16 v[28:29], v8 offset:40960
 v_mul_f32 v18, s74, v222
 v_mfma_f32_16x16x32_bf16 v[132:135], v[36:39], a[212:215], v[132:135]
 ds_read_b64_tr_b16 v[30:31], v8 offset:41472
 v_cvt_pk_bf16_f32 v107, v234, v235
 v_mfma_f32_16x16x32_bf16 v[132:135], v[40:43], a[228:231], v[132:135]
 ds_read_b64_tr_b16 v[32:33], v8 offset:45056
 v_mul_f32 v19, s74, v223
 v_add_f32 v16, 1.0, v16
 v_mfma_f32_16x16x32_bf16 v[132:135], v[44:47], a[244:247], v[132:135]
 ds_read_b64_tr_b16 v[34:35], v8 offset:45568
 v_add_f32 v17, 1.0, v17
 v_mfma_f32_16x16x32_bf16 v[136:139], v[36:39], a[216:219], v[136:139]
 v_exp_f32 v18, v18
 v_mul_f32 v20, s74, v236
 v_mfma_f32_16x16x32_bf16 v[136:139], v[40:43], a[232:235], v[136:139]
 v_exp_f32 v19, v19
 v_mfma_f32_16x16x32_bf16 v[136:139], v[44:47], a[248:251], v[136:139]
 v_rcp_f32 v16, v16
 v_add_f32 v18, 1.0, v18
 v_mfma_f32_16x16x32_bf16 v[140:143], v[36:39], a[220:223], v[140:143]
 v_rcp_f32 v17, v17
 v_mfma_f32_16x16x32_bf16 v[140:143], v[40:43], a[236:239], v[140:143]
 v_rcp_f32 v18, v18
 v_mfma_f32_16x16x32_bf16 v[140:143], v[44:47], a[252:255], v[140:143]
 s_waitcnt lgkmcnt(4)
 v_exp_f32 v20, v20
 v_add_f32 v19, 1.0, v19
 v_mfma_f32_16x16x32_bf16 v[144:147], v[24:27], a[208:211], v[144:147]
 s_waitcnt lgkmcnt(2)
 ds_read_b64_tr_b16 v[36:37], v9 offset:36864
 v_mul_f32 v220, v220, v16
 v_mfma_f32_16x16x32_bf16 v[144:147], v[28:31], a[224:227], v[144:147]
 s_waitcnt lgkmcnt(1)
 ds_read_b64_tr_b16 v[38:39], v9 offset:37376
 v_rcp_f32 v19, v19
 v_mfma_f32_16x16x32_bf16 v[144:147], v[32:35], a[240:243], v[144:147]
 ds_read_b64_tr_b16 v[40:41], v9 offset:40960
 v_mul_f32 v221, v221, v17
 v_mfma_f32_16x16x32_bf16 v[148:151], v[24:27], a[212:215], v[148:151]
 ds_read_b64_tr_b16 v[42:43], v9 offset:41472
 v_mul_f32 v222, v222, v18
 v_mul_f32 v223, v223, v19
 v_mfma_f32_16x16x32_bf16 v[148:151], v[28:31], a[228:231], v[148:151]
 ds_read_b64_tr_b16 v[44:45], v9 offset:45056
 v_cvt_pk_bf16_f32 v108, v220, v221
 v_mfma_f32_16x16x32_bf16 v[148:151], v[32:35], a[244:247], v[148:151]
 ds_read_b64_tr_b16 v[46:47], v9 offset:45568
 v_cvt_pk_bf16_f32 v109, v222, v223
 v_mfma_f32_16x16x32_bf16 v[152:155], v[24:27], a[216:219], v[152:155]
 v_lshrrev_b32 v10, 4, v1
 v_bfe_u32 v11, v1, 2, 2
 v_mul_f32 v21, s74, v237
 v_mfma_f32_16x16x32_bf16 v[152:155], v[28:31], a[232:235], v[152:155]
 v_lshl_add_u32 v12, v10, 3, v11
 v_and_b32 v10, 1, v10
 v_mfma_f32_16x16x32_bf16 v[152:155], v[32:35], a[248:251], v[152:155]
 v_lshlrev_b32 v12, 6, v12
 v_and_b32 v11, 3, v1
 v_mul_f32 v22, s74, v238
 v_mfma_f32_16x16x32_bf16 v[156:159], v[24:27], a[220:223], v[156:159]
 v_lshl_add_u32 v12, v11, 3, v12
 v_xor_b32 v11, 0, v10
 v_mfma_f32_16x16x32_bf16 v[156:159], v[28:31], a[236:239], v[156:159]
 v_add_u32 v12, 139264, v12
 v_mul_f32 v23, s74, v239
 v_add_f32 v20, 1.0, v20
 v_mfma_f32_16x16x32_bf16 v[156:159], v[32:35], a[252:255], v[156:159]
 s_waitcnt vmcnt(6)
 s_barrier
 s_waitcnt lgkmcnt(4)
 v_lshl_add_u32 v6, v11, 5, v12
 v_xor_b32 v11, 1, v10
 v_lshl_add_u32 v7, v11, 5, v12
 v_mfma_f32_16x16x32_bf16 v[160:163], v[36:39], a[208:211], v[160:163]
 s_waitcnt lgkmcnt(2)
 ds_read_b64_tr_b16 v[24:25], v6 offset:0
 v_mfma_f32_16x16x32_bf16 v[160:163], v[40:43], a[224:227], v[160:163]
 s_waitcnt lgkmcnt(1)
 ds_read_b64_tr_b16 v[26:27], v6 offset:256
 v_exp_f32 v21, v21
 v_mfma_f32_16x16x32_bf16 v[160:163], v[44:47], a[240:243], v[160:163]
 ds_read_b64_tr_b16 v[28:29], v6 offset:2048
 v_mfma_f32_16x16x32_bf16 v[164:167], v[36:39], a[212:215], v[164:167]
 ds_read_b64_tr_b16 v[30:31], v6 offset:2304
 v_exp_f32 v22, v22
 v_mfma_f32_16x16x32_bf16 v[164:167], v[40:43], a[228:231], v[164:167]
 ds_read_b64_tr_b16 v[32:33], v6 offset:4096
 v_exp_f32 v23, v23
 v_mfma_f32_16x16x32_bf16 v[164:167], v[44:47], a[244:247], v[164:167]
 ds_read_b64_tr_b16 v[34:35], v6 offset:4352
 v_add_f32 v21, 1.0, v21
 v_mfma_f32_16x16x32_bf16 v[168:171], v[36:39], a[216:219], v[168:171]
 v_rcp_f32 v20, v20
 v_add_f32 v22, 1.0, v22
 v_mfma_f32_16x16x32_bf16 v[168:171], v[40:43], a[232:235], v[168:171]
 v_rcp_f32 v21, v21
 v_mfma_f32_16x16x32_bf16 v[168:171], v[44:47], a[248:251], v[168:171]
 v_rcp_f32 v22, v22
 v_add_f32 v23, 1.0, v23
 v_mfma_f32_16x16x32_bf16 v[172:175], v[36:39], a[220:223], v[172:175]
 v_mul_f32 v236, v236, v20
 v_mul_f32 v237, v237, v21
 v_mfma_f32_16x16x32_bf16 v[172:175], v[40:43], a[236:239], v[172:175]
 v_rcp_f32 v23, v23
 v_mul_f32 v238, v238, v22
 v_mfma_f32_16x16x32_bf16 v[172:175], v[44:47], a[252:255], v[172:175]
 s_waitcnt lgkmcnt(4)
 v_mul_f32 v239, v239, v23
 v_cvt_pk_bf16_f32 v110, v236, v237
 v_cvt_pk_bf16_f32 v111, v238, v239
 v_mfma_f32_16x16x32_bf16 v[176:179], v[24:27], v[48:51], 0
 s_waitcnt lgkmcnt(2)
 ds_read_b64_tr_b16 v[36:37], v7 offset:0
 v_mfma_f32_16x16x32_bf16 v[176:179], v[28:31], v[64:67], v[176:179]
 s_waitcnt lgkmcnt(1)
 ds_read_b64_tr_b16 v[38:39], v7 offset:256
 v_mfma_f32_16x16x32_bf16 v[176:179], v[32:35], a[0:3], v[176:179]
 ds_read_b64_tr_b16 v[40:41], v7 offset:2048
 v_lshlrev_b32 v16, 16, v80
 v_mfma_f32_16x16x32_bf16 v[180:183], v[24:27], v[52:55], 0
 ds_read_b64_tr_b16 v[42:43], v7 offset:2304
 v_and_b32 v17, s73, v80
 v_mfma_f32_16x16x32_bf16 v[180:183], v[28:31], v[68:71], v[180:183]
 ds_read_b64_tr_b16 v[44:45], v7 offset:4096
 v_lshlrev_b32 v18, 16, v81
 v_mfma_f32_16x16x32_bf16 v[180:183], v[32:35], a[4:7], v[180:183]
 ds_read_b64_tr_b16 v[46:47], v7 offset:4352
 v_and_b32 v19, s73, v81
 v_mfma_f32_16x16x32_bf16 v[184:187], v[24:27], v[56:59], 0
 v_mul_f32 v112, v112, v16
 v_mul_f32 v113, v113, v17
 v_mfma_f32_16x16x32_bf16 v[184:187], v[28:31], v[72:75], v[184:187]
 s_add_u32 m0, s71, 90112
 v_mul_f32 v114, v114, v18
 v_mul_f32 v115, v115, v19
 v_mfma_f32_16x16x32_bf16 v[184:187], v[32:35], a[8:11], v[184:187]
 s_add_u32 s58, s84, 0
 buffer_load_dwordx4 v4, s[40:43], s58 offen nt lds
 v_mfma_f32_16x16x32_bf16 v[188:191], v[24:27], v[60:63], 0
 s_add_u32 s59, s64, 262144
 v_cvt_pk_bf16_f32 v80, v112, v113
 v_cvt_pk_bf16_f32 v81, v114, v115
 v_mfma_f32_16x16x32_bf16 v[188:191], v[28:31], v[76:79], v[188:191]
 v_lshlrev_b32 v20, 16, v82
 v_and_b32 v21, s73, v82
 v_mfma_f32_16x16x32_bf16 v[188:191], v[32:35], a[12:15], v[188:191]
 s_waitcnt lgkmcnt(4)
 v_lshlrev_b32 v22, 16, v83
 v_and_b32 v23, s73, v83
 v_mfma_f32_16x16x32_bf16 v[192:195], v[36:39], v[48:51], 0
 s_waitcnt lgkmcnt(2)
 ds_read_b64_tr_b16 v[24:25], v6 offset:6144
 v_mul_f32 v128, v128, v20
 v_mfma_f32_16x16x32_bf16 v[192:195], v[40:43], v[64:67], v[192:195]
 s_waitcnt lgkmcnt(1)
 ds_read_b64_tr_b16 v[26:27], v6 offset:6400
 v_mul_f32 v129, v129, v21
 v_mfma_f32_16x16x32_bf16 v[192:195], v[44:47], a[0:3], v[192:195]
 ds_read_b64_tr_b16 v[28:29], v6 offset:8192
 v_mul_f32 v130, v130, v22
 v_mfma_f32_16x16x32_bf16 v[196:199], v[36:39], v[52:55], 0
 ds_read_b64_tr_b16 v[30:31], v6 offset:8448
 v_mul_f32 v131, v131, v23
 v_mfma_f32_16x16x32_bf16 v[196:199], v[40:43], v[68:71], v[196:199]
 ds_read_b64_tr_b16 v[32:33], v6 offset:10240
 v_cvt_pk_bf16_f32 v82, v128, v129
 v_mfma_f32_16x16x32_bf16 v[196:199], v[44:47], a[4:7], v[196:199]
 ds_read_b64_tr_b16 v[34:35], v6 offset:10496
 v_cvt_pk_bf16_f32 v83, v130, v131
 v_mfma_f32_16x16x32_bf16 v[200:203], v[36:39], v[56:59], 0
 v_lshlrev_b32 v16, 16, v84
 v_and_b32 v17, s73, v84
 v_mfma_f32_16x16x32_bf16 v[200:203], v[40:43], v[72:75], v[200:203]
 s_add_u32 m0, s71, 91136
 buffer_store_dwordx4 v[80:83], v2, s[32:35], s59 offen sc1
 v_mfma_f32_16x16x32_bf16 v[200:203], v[44:47], a[8:11], v[200:203]
 s_add_u32 s58, s84, 147456
 buffer_load_dwordx4 v4, s[40:43], s58 offen nt lds
 v_mfma_f32_16x16x32_bf16 v[204:207], v[36:39], v[60:63], 0
 v_lshlrev_b32 v18, 16, v85
 v_and_b32 v19, s73, v85
 v_mfma_f32_16x16x32_bf16 v[204:207], v[40:43], v[76:79], v[204:207]
 v_mul_f32 v116, v116, v16
 v_mul_f32 v117, v117, v17
 v_mfma_f32_16x16x32_bf16 v[204:207], v[44:47], a[12:15], v[204:207]
 s_waitcnt lgkmcnt(4)
 v_mul_f32 v118, v118, v18
 v_mul_f32 v119, v119, v19
 v_mfma_f32_16x16x32_bf16 v[208:211], v[24:27], v[48:51], 0
 s_waitcnt lgkmcnt(2)
 ds_read_b64_tr_b16 v[36:37], v7 offset:6144
 v_cvt_pk_bf16_f32 v84, v116, v117
 v_mfma_f32_16x16x32_bf16 v[208:211], v[28:31], v[64:67], v[208:211]
 s_waitcnt lgkmcnt(1)
 ds_read_b64_tr_b16 v[38:39], v7 offset:6400
 v_cvt_pk_bf16_f32 v85, v118, v119
 v_mfma_f32_16x16x32_bf16 v[208:211], v[32:35], a[0:3], v[208:211]
 s_add_u32 s59, s65, 262144
 ds_read_b64_tr_b16 v[40:41], v7 offset:8192
 v_lshlrev_b32 v20, 16, v86
 v_mfma_f32_16x16x32_bf16 v[212:215], v[24:27], v[52:55], 0
 ds_read_b64_tr_b16 v[42:43], v7 offset:8448
 v_and_b32 v21, s73, v86
 v_mfma_f32_16x16x32_bf16 v[212:215], v[28:31], v[68:71], v[212:215]
 ds_read_b64_tr_b16 v[44:45], v7 offset:10240
 v_lshlrev_b32 v22, 16, v87
 v_mfma_f32_16x16x32_bf16 v[212:215], v[32:35], a[4:7], v[212:215]
 ds_read_b64_tr_b16 v[46:47], v7 offset:10496
 v_and_b32 v23, s73, v87
 v_mfma_f32_16x16x32_bf16 v[216:219], v[24:27], v[56:59], 0
 v_mul_f32 v132, v132, v20
 v_mul_f32 v133, v133, v21
 v_mfma_f32_16x16x32_bf16 v[216:219], v[28:31], v[72:75], v[216:219]
 s_add_u32 m0, s71, 92160
 v_mul_f32 v134, v134, v22
 v_mul_f32 v135, v135, v23
 v_mfma_f32_16x16x32_bf16 v[216:219], v[32:35], a[8:11], v[216:219]
 s_add_u32 s58, s84, 294912
 buffer_load_dwordx4 v4, s[40:43], s58 offen nt lds
 v_mfma_f32_16x16x32_bf16 v[220:223], v[24:27], v[60:63], 0
 v_cvt_pk_bf16_f32 v86, v132, v133
 v_cvt_pk_bf16_f32 v87, v134, v135
 v_mfma_f32_16x16x32_bf16 v[220:223], v[28:31], v[76:79], v[220:223]
 v_lshlrev_b32 v16, 16, v88
 v_and_b32 v17, s73, v88
 v_mfma_f32_16x16x32_bf16 v[220:223], v[32:35], a[12:15], v[220:223]
 s_waitcnt lgkmcnt(4)
 buffer_store_dwordx4 v[84:87], v2, s[32:35], s59 offen sc1
 v_mfma_f32_16x16x32_bf16 v[224:227], v[36:39], v[48:51], 0
 s_waitcnt lgkmcnt(2)
 ds_read_b64_tr_b16 v[24:25], v6 offset:12288
 v_lshlrev_b32 v18, 16, v89
 v_mfma_f32_16x16x32_bf16 v[224:227], v[40:43], v[64:67], v[224:227]
 s_waitcnt lgkmcnt(1)
 ds_read_b64_tr_b16 v[26:27], v6 offset:12544
 v_and_b32 v19, s73, v89
 v_mfma_f32_16x16x32_bf16 v[224:227], v[44:47], a[0:3], v[224:227]
 ds_read_b64_tr_b16 v[28:29], v6 offset:14336
 v_mul_f32 v120, v120, v16
 v_mfma_f32_16x16x32_bf16 v[228:231], v[36:39], v[52:55], 0
 ds_read_b64_tr_b16 v[30:31], v6 offset:14592
 v_mul_f32 v121, v121, v17
 v_mfma_f32_16x16x32_bf16 v[228:231], v[40:43], v[68:71], v[228:231]
 s_add_u32 s59, s66, 262144
 ds_read_b64_tr_b16 v[32:33], v6 offset:16384
 v_mul_f32 v122, v122, v18
 v_mfma_f32_16x16x32_bf16 v[228:231], v[44:47], a[4:7], v[228:231]
 ds_read_b64_tr_b16 v[34:35], v6 offset:16640
 v_mul_f32 v123, v123, v19
 v_mfma_f32_16x16x32_bf16 v[232:235], v[36:39], v[56:59], 0
 v_cvt_pk_bf16_f32 v88, v120, v121
 v_lshlrev_b32 v20, 16, v90
 v_mfma_f32_16x16x32_bf16 v[232:235], v[40:43], v[72:75], v[232:235]
 v_cvt_pk_bf16_f32 v89, v122, v123
 v_and_b32 v21, s73, v90
 v_mfma_f32_16x16x32_bf16 v[232:235], v[44:47], a[8:11], v[232:235]
 v_lshlrev_b32 v22, 16, v91
 v_and_b32 v23, s73, v91
 v_mfma_f32_16x16x32_bf16 v[236:239], v[36:39], v[60:63], 0
 v_mul_f32 v136, v136, v20
 v_mul_f32 v137, v137, v21
 v_mfma_f32_16x16x32_bf16 v[236:239], v[40:43], v[76:79], v[236:239]
 v_mul_f32 v138, v138, v22
 v_mul_f32 v139, v139, v23
 v_mfma_f32_16x16x32_bf16 v[236:239], v[44:47], a[12:15], v[236:239]
 s_waitcnt lgkmcnt(4)
 v_cvt_pk_bf16_f32 v90, v136, v137
 v_lshlrev_b32 v16, 16, v92
 v_mfma_f32_16x16x32_bf16 v[176:179], v[24:27], a[16:19], v[176:179]
 s_waitcnt lgkmcnt(2)
 ds_read_b64_tr_b16 v[36:37], v7 offset:12288
 v_cvt_pk_bf16_f32 v91, v138, v139
 v_mfma_f32_16x16x32_bf16 v[176:179], v[28:31], a[32:35], v[176:179]
 s_waitcnt lgkmcnt(1)
 ds_read_b64_tr_b16 v[38:39], v7 offset:12544
 v_and_b32 v17, s73, v92
 v_mfma_f32_16x16x32_bf16 v[176:179], v[32:35], a[48:51], v[176:179]
 ds_read_b64_tr_b16 v[40:41], v7 offset:14336
 v_lshlrev_b32 v18, 16, v93
 v_mfma_f32_16x16x32_bf16 v[180:183], v[24:27], a[20:23], v[180:183]
 ds_read_b64_tr_b16 v[42:43], v7 offset:14592
 v_and_b32 v19, s73, v93
 v_mfma_f32_16x16x32_bf16 v[180:183], v[28:31], a[36:39], v[180:183]
 ds_read_b64_tr_b16 v[44:45], v7 offset:16384
 v_mul_f32 v124, v124, v16
 v_mfma_f32_16x16x32_bf16 v[180:183], v[32:35], a[52:55], v[180:183]
 ds_read_b64_tr_b16 v[46:47], v7 offset:16640
 v_mul_f32 v125, v125, v17
 v_mfma_f32_16x16x32_bf16 v[184:187], v[24:27], a[24:27], v[184:187]
 buffer_store_dwordx4 v[88:91], v2, s[32:35], s59 offen sc1
 v_mfma_f32_16x16x32_bf16 v[184:187], v[28:31], a[40:43], v[184:187]
 s_add_u32 s59, s67, 262144
 v_mul_f32 v126, v126, v18
 v_mul_f32 v127, v127, v19
 v_mfma_f32_16x16x32_bf16 v[184:187], v[32:35], a[56:59], v[184:187]
 v_cvt_pk_bf16_f32 v92, v124, v125
 v_lshlrev_b32 v20, 16, v94
 v_mfma_f32_16x16x32_bf16 v[188:191], v[24:27], a[28:31], v[188:191]
 v_cvt_pk_bf16_f32 v93, v126, v127
 v_and_b32 v21, s73, v94
 v_mfma_f32_16x16x32_bf16 v[188:191], v[28:31], a[44:47], v[188:191]
 v_lshlrev_b32 v22, 16, v95
 v_and_b32 v23, s73, v95
 v_mfma_f32_16x16x32_bf16 v[188:191], v[32:35], a[60:63], v[188:191]
 s_waitcnt lgkmcnt(4)
 v_mul_f32 v140, v140, v20
 v_mul_f32 v141, v141, v21
 v_mfma_f32_16x16x32_bf16 v[192:195], v[36:39], a[16:19], v[192:195]
 s_waitcnt lgkmcnt(2)
 ds_read_b64_tr_b16 v[24:25], v6 offset:18432
 v_mul_f32 v142, v142, v22
 v_mfma_f32_16x16x32_bf16 v[192:195], v[40:43], a[32:35], v[192:195]
 s_waitcnt lgkmcnt(1)
 ds_read_b64_tr_b16 v[26:27], v6 offset:18688
 v_mul_f32 v143, v143, v23
 v_mfma_f32_16x16x32_bf16 v[192:195], v[44:47], a[48:51], v[192:195]
 ds_read_b64_tr_b16 v[28:29], v6 offset:20480
 v_cvt_pk_bf16_f32 v94, v140, v141
 v_mfma_f32_16x16x32_bf16 v[196:199], v[36:39], a[20:23], v[196:199]
 ds_read_b64_tr_b16 v[30:31], v6 offset:20736
 v_cvt_pk_bf16_f32 v95, v142, v143
 v_mfma_f32_16x16x32_bf16 v[196:199], v[40:43], a[36:39], v[196:199]
 ds_read_b64_tr_b16 v[32:33], v6 offset:22528
 v_lshlrev_b32 v16, 16, v96
 v_mfma_f32_16x16x32_bf16 v[196:199], v[44:47], a[52:55], v[196:199]
 ds_read_b64_tr_b16 v[34:35], v6 offset:22784
 v_and_b32 v17, s73, v96
 v_mfma_f32_16x16x32_bf16 v[200:203], v[36:39], a[24:27], v[200:203]
 buffer_store_dwordx4 v[92:95], v2, s[32:35], s59 offen sc1
 v_mfma_f32_16x16x32_bf16 v[200:203], v[40:43], a[40:43], v[200:203]
 v_lshlrev_b32 v18, 16, v97
 v_and_b32 v19, s73, v97
 v_mfma_f32_16x16x32_bf16 v[200:203], v[44:47], a[56:59], v[200:203]
 v_mul_f32 v144, v144, v16
 v_mul_f32 v145, v145, v17
 v_mfma_f32_16x16x32_bf16 v[204:207], v[36:39], a[28:31], v[204:207]
 s_add_u32 s59, s64, 393216
 v_mul_f32 v146, v146, v18
 v_mul_f32 v147, v147, v19
 v_mfma_f32_16x16x32_bf16 v[204:207], v[40:43], a[44:47], v[204:207]
 v_cvt_pk_bf16_f32 v96, v144, v145
 v_lshlrev_b32 v20, 16, v98
 v_mfma_f32_16x16x32_bf16 v[204:207], v[44:47], a[60:63], v[204:207]
 s_waitcnt lgkmcnt(4)
 v_cvt_pk_bf16_f32 v97, v146, v147
 v_and_b32 v21, s73, v98
 v_mfma_f32_16x16x32_bf16 v[208:211], v[24:27], a[16:19], v[208:211]
 s_waitcnt lgkmcnt(2)
 ds_read_b64_tr_b16 v[36:37], v7 offset:18432
 v_lshlrev_b32 v22, 16, v99
 v_mfma_f32_16x16x32_bf16 v[208:211], v[28:31], a[32:35], v[208:211]
 s_waitcnt lgkmcnt(1)
 ds_read_b64_tr_b16 v[38:39], v7 offset:18688
 v_and_b32 v23, s73, v99
 v_mfma_f32_16x16x32_bf16 v[208:211], v[32:35], a[48:51], v[208:211]
 ds_read_b64_tr_b16 v[40:41], v7 offset:20480
 v_mul_f32 v160, v160, v20
 v_mfma_f32_16x16x32_bf16 v[212:215], v[24:27], a[20:23], v[212:215]
 ds_read_b64_tr_b16 v[42:43], v7 offset:20736
 v_mul_f32 v161, v161, v21
 v_mfma_f32_16x16x32_bf16 v[212:215], v[28:31], a[36:39], v[212:215]
 ds_read_b64_tr_b16 v[44:45], v7 offset:22528
 v_mul_f32 v162, v162, v22
 v_mfma_f32_16x16x32_bf16 v[212:215], v[32:35], a[52:55], v[212:215]
 ds_read_b64_tr_b16 v[46:47], v7 offset:22784
 v_mul_f32 v163, v163, v23
 v_mfma_f32_16x16x32_bf16 v[216:219], v[24:27], a[24:27], v[216:219]
 v_add_u32 v6, 0xfffe8000, v6
 v_add_u32 v7, 0xfffe8000, v7
 v_mfma_f32_16x16x32_bf16 v[216:219], v[28:31], a[40:43], v[216:219]
 v_cvt_pk_bf16_f32 v98, v160, v161
 v_cvt_pk_bf16_f32 v99, v162, v163
 v_mfma_f32_16x16x32_bf16 v[216:219], v[32:35], a[56:59], v[216:219]
 v_lshlrev_b32 v16, 16, v100
 v_and_b32 v17, s73, v100
 v_mfma_f32_16x16x32_bf16 v[220:223], v[24:27], a[28:31], v[220:223]
 buffer_store_dwordx4 v[96:99], v2, s[32:35], s59 offen sc1
 v_mfma_f32_16x16x32_bf16 v[220:223], v[28:31], a[44:47], v[220:223]
 v_lshlrev_b32 v18, 16, v101
 v_and_b32 v19, s73, v101
 v_mfma_f32_16x16x32_bf16 v[220:223], v[32:35], a[60:63], v[220:223]
 s_waitcnt vmcnt(11)
 s_barrier
 s_waitcnt lgkmcnt(4)
 v_mfma_f32_16x16x32_bf16 v[224:227], v[36:39], a[16:19], v[224:227]
 s_waitcnt lgkmcnt(2)
 ds_read_b64_tr_b16 v[24:25], v6 offset:0
 v_mul_f32 v148, v148, v16
 v_mfma_f32_16x16x32_bf16 v[224:227], v[40:43], a[32:35], v[224:227]
 s_waitcnt lgkmcnt(1)
 ds_read_b64_tr_b16 v[26:27], v6 offset:256
 v_mul_f32 v149, v149, v17
 v_mfma_f32_16x16x32_bf16 v[224:227], v[44:47], a[48:51], v[224:227]
 s_add_u32 s59, s65, 393216
 ds_read_b64_tr_b16 v[28:29], v6 offset:2048
 v_mul_f32 v150, v150, v18
 v_mfma_f32_16x16x32_bf16 v[228:231], v[36:39], a[20:23], v[228:231]
 ds_read_b64_tr_b16 v[30:31], v6 offset:2304
 v_mul_f32 v151, v151, v19
 v_mfma_f32_16x16x32_bf16 v[228:231], v[40:43], a[36:39], v[228:231]
 ds_read_b64_tr_b16 v[32:33], v6 offset:4096
 v_cvt_pk_bf16_f32 v100, v148, v149
 v_mfma_f32_16x16x32_bf16 v[228:231], v[44:47], a[52:55], v[228:231]
 ds_read_b64_tr_b16 v[34:35], v6 offset:4352
 v_cvt_pk_bf16_f32 v101, v150, v151
 v_mfma_f32_16x16x32_bf16 v[232:235], v[36:39], a[24:27], v[232:235]
 v_lshlrev_b32 v20, 16, v102
 v_and_b32 v21, s73, v102
 v_mfma_f32_16x16x32_bf16 v[232:235], v[40:43], a[40:43], v[232:235]
 v_lshlrev_b32 v22, 16, v103
 v_and_b32 v23, s73, v103
 v_mfma_f32_16x16x32_bf16 v[232:235], v[44:47], a[56:59], v[232:235]
 v_mul_f32 v164, v164, v20
 v_mul_f32 v165, v165, v21
 v_mfma_f32_16x16x32_bf16 v[236:239], v[36:39], a[28:31], v[236:239]
 v_mul_f32 v166, v166, v22
 v_mul_f32 v167, v167, v23
 v_mfma_f32_16x16x32_bf16 v[236:239], v[40:43], a[44:47], v[236:239]
 v_cvt_pk_bf16_f32 v102, v164, v165
 v_lshlrev_b32 v16, 16, v104
 v_mfma_f32_16x16x32_bf16 v[236:239], v[44:47], a[60:63], v[236:239]
 s_waitcnt lgkmcnt(4)
 v_cvt_pk_bf16_f32 v103, v166, v167
 v_and_b32 v17, s73, v104
 v_mfma_f32_16x16x32_bf16 v[176:179], v[24:27], a[64:67], v[176:179]
 s_waitcnt lgkmcnt(2)
 ds_read_b64_tr_b16 v[36:37], v7 offset:0
 v_lshlrev_b32 v18, 16, v105
 v_mfma_f32_16x16x32_bf16 v[176:179], v[28:31], a[80:83], v[176:179]
 s_waitcnt lgkmcnt(1)
 ds_read_b64_tr_b16 v[38:39], v7 offset:256
 v_and_b32 v19, s73, v105
 v_mfma_f32_16x16x32_bf16 v[176:179], v[32:35], a[96:99], v[176:179]
 ds_read_b64_tr_b16 v[40:41], v7 offset:2048
 v_mul_f32 v152, v152, v16
 v_mfma_f32_16x16x32_bf16 v[180:183], v[24:27], a[68:71], v[180:183]
 ds_read_b64_tr_b16 v[42:43], v7 offset:2304
 v_mul_f32 v153, v153, v17
 v_mfma_f32_16x16x32_bf16 v[180:183], v[28:31], a[84:87], v[180:183]
 ds_read_b64_tr_b16 v[44:45], v7 offset:4096
 v_mul_f32 v154, v154, v18
 v_mfma_f32_16x16x32_bf16 v[180:183], v[32:35], a[100:103], v[180:183]
 ds_read_b64_tr_b16 v[46:47], v7 offset:4352
 v_mul_f32 v155, v155, v19
 v_mfma_f32_16x16x32_bf16 v[184:187], v[24:27], a[72:75], v[184:187]
 buffer_store_dwordx4 v[100:103], v2, s[32:35], s59 offen sc1
 v_mfma_f32_16x16x32_bf16 v[184:187], v[28:31], a[88:91], v[184:187]
 s_add_u32 m0, s71, 114688
 v_cvt_pk_bf16_f32 v104, v152, v153
 v_cvt_pk_bf16_f32 v105, v154, v155
 v_mfma_f32_16x16x32_bf16 v[184:187], v[32:35], a[104:107], v[184:187]
 s_add_u32 s58, s85, 0
 buffer_load_dwordx4 v4, s[40:43], s58 offen nt lds
 v_mfma_f32_16x16x32_bf16 v[188:191], v[24:27], a[76:79], v[188:191]
 s_add_u32 s59, s66, 393216
 v_lshlrev_b32 v20, 16, v106
 v_and_b32 v21, s73, v106
 v_mfma_f32_16x16x32_bf16 v[188:191], v[28:31], a[92:95], v[188:191]
 v_lshlrev_b32 v22, 16, v107
 v_and_b32 v23, s73, v107
 v_mfma_f32_16x16x32_bf16 v[188:191], v[32:35], a[108:111], v[188:191]
 s_waitcnt lgkmcnt(4)
 v_mul_f32 v168, v168, v20
 v_mul_f32 v169, v169, v21
 v_mfma_f32_16x16x32_bf16 v[192:195], v[36:39], a[64:67], v[192:195]
 s_waitcnt lgkmcnt(2)
 ds_read_b64_tr_b16 v[24:25], v6 offset:6144
 v_mul_f32 v170, v170, v22
 v_mfma_f32_16x16x32_bf16 v[192:195], v[40:43], a[80:83], v[192:195]
 s_waitcnt lgkmcnt(1)
 ds_read_b64_tr_b16 v[26:27], v6 offset:6400
 v_mul_f32 v171, v171, v23
 v_mfma_f32_16x16x32_bf16 v[192:195], v[44:47], a[96:99], v[192:195]
 ds_read_b64_tr_b16 v[28:29], v6 offset:8192
 v_cvt_pk_bf16_f32 v106, v168, v169
 v_mfma_f32_16x16x32_bf16 v[196:199], v[36:39], a[68:71], v[196:199]
 ds_read_b64_tr_b16 v[30:31], v6 offset:8448
 v_cvt_pk_bf16_f32 v107, v170, v171
 v_mfma_f32_16x16x32_bf16 v[196:199], v[40:43], a[84:87], v[196:199]
 ds_read_b64_tr_b16 v[32:33], v6 offset:10240
 v_lshlrev_b32 v16, 16, v108
 v_mfma_f32_16x16x32_bf16 v[196:199], v[44:47], a[100:103], v[196:199]
 ds_read_b64_tr_b16 v[34:35], v6 offset:10496
 v_and_b32 v17, s73, v108
 v_mfma_f32_16x16x32_bf16 v[200:203], v[36:39], a[72:75], v[200:203]
 buffer_store_dwordx4 v[104:107], v2, s[32:35], s59 offen sc1
 v_mfma_f32_16x16x32_bf16 v[200:203], v[40:43], a[88:91], v[200:203]
 s_add_u32 m0, s71, 115712
 v_lshlrev_b32 v18, 16, v109
 v_and_b32 v19, s73, v109
 v_mfma_f32_16x16x32_bf16 v[200:203], v[44:47], a[104:107], v[200:203]
 s_add_u32 s58, s85, 147456
 buffer_load_dwordx4 v4, s[40:43], s58 offen nt lds
 v_mfma_f32_16x16x32_bf16 v[204:207], v[36:39], a[76:79], v[204:207]
 v_mul_f32 v156, v156, v16
 v_mul_f32 v157, v157, v17
 v_mfma_f32_16x16x32_bf16 v[204:207], v[40:43], a[92:95], v[204:207]
 s_add_u32 s59, s67, 393216
 v_mul_f32 v158, v158, v18
 v_mul_f32 v159, v159, v19
 v_mfma_f32_16x16x32_bf16 v[204:207], v[44:47], a[108:111], v[204:207]
 s_waitcnt lgkmcnt(4)
 v_cvt_pk_bf16_f32 v108, v156, v157
 v_lshlrev_b32 v20, 16, v110
 v_mfma_f32_16x16x32_bf16 v[208:211], v[24:27], a[64:67], v[208:211]
 s_waitcnt lgkmcnt(2)
 ds_read_b64_tr_b16 v[36:37], v7 offset:6144
 v_cvt_pk_bf16_f32 v109, v158, v159
 v_mfma_f32_16x16x32_bf16 v[208:211], v[28:31], a[80:83], v[208:211]
 s_waitcnt lgkmcnt(1)
 ds_read_b64_tr_b16 v[38:39], v7 offset:6400
 v_and_b32 v21, s73, v110
 v_mfma_f32_16x16x32_bf16 v[208:211], v[32:35], a[96:99], v[208:211]
 ds_read_b64_tr_b16 v[40:41], v7 offset:8192
 v_lshlrev_b32 v22, 16, v111
 v_mfma_f32_16x16x32_bf16 v[212:215], v[24:27], a[68:71], v[212:215]
 ds_read_b64_tr_b16 v[42:43], v7 offset:8448
 v_and_b32 v23, s73, v111
 v_mfma_f32_16x16x32_bf16 v[212:215], v[28:31], a[84:87], v[212:215]
 ds_read_b64_tr_b16 v[44:45], v7 offset:10240
 v_mul_f32 v172, v172, v20
 v_mfma_f32_16x16x32_bf16 v[212:215], v[32:35], a[100:103], v[212:215]
 ds_read_b64_tr_b16 v[46:47], v7 offset:10496
 v_mul_f32 v173, v173, v21
 v_mfma_f32_16x16x32_bf16 v[216:219], v[24:27], a[72:75], v[216:219]
 v_mul_f32 v174, v174, v22
 v_mul_f32 v175, v175, v23
 v_mfma_f32_16x16x32_bf16 v[216:219], v[28:31], a[88:91], v[216:219]
 s_add_u32 m0, s71, 116736
 v_cvt_pk_bf16_f32 v110, v172, v173
 v_mfma_f32_16x16x32_bf16 v[216:219], v[32:35], a[104:107], v[216:219]
 s_add_u32 s58, s85, 294912
 buffer_load_dwordx4 v4, s[40:43], s58 offen nt lds
 v_mfma_f32_16x16x32_bf16 v[220:223], v[24:27], a[76:79], v[220:223]
 v_cvt_pk_bf16_f32 v111, v174, v175
 v_mfma_f32_16x16x32_bf16 v[220:223], v[28:31], a[92:95], v[220:223]
 v_mfma_f32_16x16x32_bf16 v[220:223], v[32:35], a[108:111], v[220:223]
 s_waitcnt vmcnt(13)
 s_barrier
 s_waitcnt lgkmcnt(4)
 buffer_store_dwordx4 v[108:111], v2, s[32:35], s59 offen sc1
 v_mfma_f32_16x16x32_bf16 v[224:227], v[36:39], a[64:67], v[224:227]
 s_waitcnt lgkmcnt(2)
 ds_read_b64_tr_b16 v[24:25], v6 offset:24576
 v_mfma_f32_16x16x32_bf16 v[224:227], v[40:43], a[80:83], v[224:227]
 s_waitcnt lgkmcnt(1)
 ds_read_b64_tr_b16 v[26:27], v6 offset:24832
 v_mfma_f32_16x16x32_bf16 v[224:227], v[44:47], a[96:99], v[224:227]
 ds_read_b64_tr_b16 v[28:29], v6 offset:26624
 v_mfma_f32_16x16x32_bf16 v[228:231], v[36:39], a[68:71], v[228:231]
 ds_read_b64_tr_b16 v[30:31], v6 offset:26880
 v_mfma_f32_16x16x32_bf16 v[228:231], v[40:43], a[84:87], v[228:231]
 ds_read_b64_tr_b16 v[32:33], v6 offset:28672
 v_mfma_f32_16x16x32_bf16 v[228:231], v[44:47], a[100:103], v[228:231]
 ds_read_b64_tr_b16 v[34:35], v6 offset:28928
 v_mfma_f32_16x16x32_bf16 v[232:235], v[36:39], a[72:75], v[232:235]
 v_mfma_f32_16x16x32_bf16 v[232:235], v[40:43], a[88:91], v[232:235]
 v_mfma_f32_16x16x32_bf16 v[232:235], v[44:47], a[104:107], v[232:235]
 v_mfma_f32_16x16x32_bf16 v[236:239], v[36:39], a[76:79], v[236:239]
 v_mfma_f32_16x16x32_bf16 v[236:239], v[40:43], a[92:95], v[236:239]
 v_mfma_f32_16x16x32_bf16 v[236:239], v[44:47], a[108:111], v[236:239]
 s_waitcnt lgkmcnt(4)
 v_mfma_f32_16x16x32_bf16 v[176:179], v[24:27], a[112:115], v[176:179]
 s_waitcnt lgkmcnt(2)
 ds_read_b64_tr_b16 v[36:37], v7 offset:24576
 v_mfma_f32_16x16x32_bf16 v[176:179], v[28:31], a[128:131], v[176:179]
 s_waitcnt lgkmcnt(1)
 ds_read_b64_tr_b16 v[38:39], v7 offset:24832
 v_mfma_f32_16x16x32_bf16 v[176:179], v[32:35], a[144:147], v[176:179]
 ds_read_b64_tr_b16 v[40:41], v7 offset:26624
 v_mfma_f32_16x16x32_bf16 v[180:183], v[24:27], a[116:119], v[180:183]
 ds_read_b64_tr_b16 v[42:43], v7 offset:26880
 v_mfma_f32_16x16x32_bf16 v[180:183], v[28:31], a[132:135], v[180:183]
 ds_read_b64_tr_b16 v[44:45], v7 offset:28672
 v_mfma_f32_16x16x32_bf16 v[180:183], v[32:35], a[148:151], v[180:183]
 s_mul_i32 s80, s86, 256
 ds_read_b64_tr_b16 v[46:47], v7 offset:28928
 v_mfma_f32_16x16x32_bf16 v[184:187], v[24:27], a[120:123], v[184:187]
 s_add_u32 m0, s70, 139264
 v_mfma_f32_16x16x32_bf16 v[184:187], v[28:31], a[136:139], v[184:187]
 s_add_u32 s58, s80, 0
 buffer_load_dwordx4 v5, s[20:23], s58 offen nt lds
 v_mfma_f32_16x16x32_bf16 v[184:187], v[32:35], a[152:155], v[184:187]
 v_mfma_f32_16x16x32_bf16 v[188:191], v[24:27], a[124:127], v[188:191]
 s_add_u32 m0, s70, 143360
 v_mfma_f32_16x16x32_bf16 v[188:191], v[28:31], a[140:143], v[188:191]
 s_add_u32 s58, s80, 262144
 buffer_load_dwordx4 v5, s[20:23], s58 offen nt lds
 v_mfma_f32_16x16x32_bf16 v[188:191], v[32:35], a[156:159], v[188:191]
 s_waitcnt lgkmcnt(4)
 v_mfma_f32_16x16x32_bf16 v[192:195], v[36:39], a[112:115], v[192:195]
 s_waitcnt lgkmcnt(2)
 ds_read_b64_tr_b16 v[24:25], v6 offset:30720
 v_mfma_f32_16x16x32_bf16 v[192:195], v[40:43], a[128:131], v[192:195]
 s_waitcnt lgkmcnt(1)
 ds_read_b64_tr_b16 v[26:27], v6 offset:30976
 v_mfma_f32_16x16x32_bf16 v[192:195], v[44:47], a[144:147], v[192:195]
 ds_read_b64_tr_b16 v[28:29], v6 offset:32768
 v_mfma_f32_16x16x32_bf16 v[196:199], v[36:39], a[116:119], v[196:199]
 ds_read_b64_tr_b16 v[30:31], v6 offset:33024
 v_mfma_f32_16x16x32_bf16 v[196:199], v[40:43], a[132:135], v[196:199]
 ds_read_b64_tr_b16 v[32:33], v6 offset:34816
 v_mfma_f32_16x16x32_bf16 v[196:199], v[44:47], a[148:151], v[196:199]
 ds_read_b64_tr_b16 v[34:35], v6 offset:35072
 v_mfma_f32_16x16x32_bf16 v[200:203], v[36:39], a[120:123], v[200:203]
 s_add_u32 m0, s70, 147456
 v_mfma_f32_16x16x32_bf16 v[200:203], v[40:43], a[136:139], v[200:203]
 s_add_u32 s58, s80, 524288
 buffer_load_dwordx4 v5, s[20:23], s58 offen nt lds
 v_mfma_f32_16x16x32_bf16 v[200:203], v[44:47], a[152:155], v[200:203]
 s_mul_i32 s81, s87, 256
 v_mfma_f32_16x16x32_bf16 v[204:207], v[36:39], a[124:127], v[204:207]
 s_add_u32 m0, s70, 151552
 s_add_u32 s58, s81, 0
 buffer_load_dwordx4 v5, s[20:23], s58 offen nt lds
 v_mfma_f32_16x16x32_bf16 v[204:207], v[40:43], a[140:143], v[204:207]
 v_mfma_f32_16x16x32_bf16 v[204:207], v[44:47], a[156:159], v[204:207]
 s_waitcnt lgkmcnt(4)
 v_mfma_f32_16x16x32_bf16 v[208:211], v[24:27], a[112:115], v[208:211]
 s_waitcnt lgkmcnt(2)
 ds_read_b64_tr_b16 v[36:37], v7 offset:30720
 v_mfma_f32_16x16x32_bf16 v[208:211], v[28:31], a[128:131], v[208:211]
 s_waitcnt lgkmcnt(1)
 ds_read_b64_tr_b16 v[38:39], v7 offset:30976
 v_mfma_f32_16x16x32_bf16 v[208:211], v[32:35], a[144:147], v[208:211]
 ds_read_b64_tr_b16 v[40:41], v7 offset:32768
 v_mfma_f32_16x16x32_bf16 v[212:215], v[24:27], a[116:119], v[212:215]
 ds_read_b64_tr_b16 v[42:43], v7 offset:33024
 v_mfma_f32_16x16x32_bf16 v[212:215], v[28:31], a[132:135], v[212:215]
 ds_read_b64_tr_b16 v[44:45], v7 offset:34816
 v_mfma_f32_16x16x32_bf16 v[212:215], v[32:35], a[148:151], v[212:215]
 s_add_u32 m0, s70, 155648
 ds_read_b64_tr_b16 v[46:47], v7 offset:35072
 v_mfma_f32_16x16x32_bf16 v[216:219], v[24:27], a[120:123], v[216:219]
 s_add_u32 s58, s81, 262144
 buffer_load_dwordx4 v5, s[20:23], s58 offen nt lds
 v_mfma_f32_16x16x32_bf16 v[216:219], v[28:31], a[136:139], v[216:219]
 v_mfma_f32_16x16x32_bf16 v[216:219], v[32:35], a[152:155], v[216:219]
 s_add_u32 m0, s70, 159744
 v_mfma_f32_16x16x32_bf16 v[220:223], v[24:27], a[124:127], v[220:223]
 s_add_u32 s58, s81, 524288
 buffer_load_dwordx4 v5, s[20:23], s58 offen nt lds
 v_mfma_f32_16x16x32_bf16 v[220:223], v[28:31], a[140:143], v[220:223]
 v_mfma_f32_16x16x32_bf16 v[220:223], v[32:35], a[156:159], v[220:223]
 s_waitcnt vmcnt(16)
 s_barrier
 s_waitcnt lgkmcnt(4)
 v_mfma_f32_16x16x32_bf16 v[224:227], v[36:39], a[112:115], v[224:227]
 s_waitcnt lgkmcnt(2)
 ds_read_b64_tr_b16 v[24:25], v6 offset:49152
 v_mfma_f32_16x16x32_bf16 v[224:227], v[40:43], a[128:131], v[224:227]
 s_waitcnt lgkmcnt(1)
 ds_read_b64_tr_b16 v[26:27], v6 offset:49408
 v_mfma_f32_16x16x32_bf16 v[224:227], v[44:47], a[144:147], v[224:227]
 ds_read_b64_tr_b16 v[28:29], v6 offset:51200
 v_mfma_f32_16x16x32_bf16 v[228:231], v[36:39], a[116:119], v[228:231]
 ds_read_b64_tr_b16 v[30:31], v6 offset:51456
 v_mfma_f32_16x16x32_bf16 v[228:231], v[40:43], a[132:135], v[228:231]
 ds_read_b64_tr_b16 v[32:33], v6 offset:53248
 v_mfma_f32_16x16x32_bf16 v[228:231], v[44:47], a[148:151], v[228:231]
 ds_read_b64_tr_b16 v[34:35], v6 offset:53504
 v_mfma_f32_16x16x32_bf16 v[232:235], v[36:39], a[120:123], v[232:235]
 v_mfma_f32_16x16x32_bf16 v[232:235], v[40:43], a[136:139], v[232:235]
 v_mfma_f32_16x16x32_bf16 v[232:235], v[44:47], a[152:155], v[232:235]
 v_mfma_f32_16x16x32_bf16 v[236:239], v[36:39], a[124:127], v[236:239]
 v_mfma_f32_16x16x32_bf16 v[236:239], v[40:43], a[140:143], v[236:239]
 v_mfma_f32_16x16x32_bf16 v[236:239], v[44:47], a[156:159], v[236:239]
 s_waitcnt lgkmcnt(4)
 v_mfma_f32_16x16x32_bf16 v[176:179], v[24:27], a[160:163], v[176:179]
 s_waitcnt lgkmcnt(2)
 ds_read_b64_tr_b16 v[36:37], v7 offset:49152
 v_mfma_f32_16x16x32_bf16 v[176:179], v[28:31], a[176:179], v[176:179]
 s_waitcnt lgkmcnt(1)
 ds_read_b64_tr_b16 v[38:39], v7 offset:49408
 v_mfma_f32_16x16x32_bf16 v[176:179], v[32:35], a[192:195], v[176:179]
 ds_read_b64_tr_b16 v[40:41], v7 offset:51200
 v_mfma_f32_16x16x32_bf16 v[180:183], v[24:27], a[164:167], v[180:183]
 ds_read_b64_tr_b16 v[42:43], v7 offset:51456
 v_mfma_f32_16x16x32_bf16 v[180:183], v[28:31], a[180:183], v[180:183]
 ds_read_b64_tr_b16 v[44:45], v7 offset:53248
 v_mfma_f32_16x16x32_bf16 v[180:183], v[32:35], a[196:199], v[180:183]
 s_mul_i32 s82, s88, 256
 ds_read_b64_tr_b16 v[46:47], v7 offset:53504
 v_mfma_f32_16x16x32_bf16 v[184:187], v[24:27], a[168:171], v[184:187]
 s_add_u32 m0, s70, 40960
 v_mfma_f32_16x16x32_bf16 v[184:187], v[28:31], a[184:187], v[184:187]
 s_add_u32 s58, s82, 0
 buffer_load_dwordx4 v5, s[20:23], s58 offen nt lds
 v_mfma_f32_16x16x32_bf16 v[184:187], v[32:35], a[200:203], v[184:187]
 v_mfma_f32_16x16x32_bf16 v[188:191], v[24:27], a[172:175], v[188:191]
 s_add_u32 m0, s70, 45056
 v_mfma_f32_16x16x32_bf16 v[188:191], v[28:31], a[188:191], v[188:191]
 s_add_u32 s58, s82, 262144
 buffer_load_dwordx4 v5, s[20:23], s58 offen nt lds
 v_mfma_f32_16x16x32_bf16 v[188:191], v[32:35], a[204:207], v[188:191]
 s_waitcnt lgkmcnt(4)
 v_mfma_f32_16x16x32_bf16 v[192:195], v[36:39], a[160:163], v[192:195]
 s_waitcnt lgkmcnt(2)
 ds_read_b64_tr_b16 v[24:25], v6 offset:55296
 v_mfma_f32_16x16x32_bf16 v[192:195], v[40:43], a[176:179], v[192:195]
 s_waitcnt lgkmcnt(1)
 ds_read_b64_tr_b16 v[26:27], v6 offset:55552
 v_mfma_f32_16x16x32_bf16 v[192:195], v[44:47], a[192:195], v[192:195]
 ds_read_b64_tr_b16 v[28:29], v6 offset:57344
 v_mfma_f32_16x16x32_bf16 v[196:199], v[36:39], a[164:167], v[196:199]
 ds_read_b64_tr_b16 v[30:31], v6 offset:57600
 v_mfma_f32_16x16x32_bf16 v[196:199], v[40:43], a[180:183], v[196:199]
 ds_read_b64_tr_b16 v[32:33], v6 offset:59392
 v_mfma_f32_16x16x32_bf16 v[196:199], v[44:47], a[196:199], v[196:199]
 s_add_u32 m0, s70, 49152
 ds_read_b64_tr_b16 v[34:35], v6 offset:59648
 v_mfma_f32_16x16x32_bf16 v[200:203], v[36:39], a[168:171], v[200:203]
 s_add_u32 s58, s82, 524288
 buffer_load_dwordx4 v5, s[20:23], s58 offen nt lds
 v_mfma_f32_16x16x32_bf16 v[200:203], v[40:43], a[184:187], v[200:203]
 s_mul_i32 s83, s89, 256
 v_mfma_f32_16x16x32_bf16 v[200:203], v[44:47], a[200:203], v[200:203]
 s_add_u32 m0, s70, 53248
 v_mfma_f32_16x16x32_bf16 v[204:207], v[36:39], a[172:175], v[204:207]
 s_add_u32 s58, s83, 0
 buffer_load_dwordx4 v5, s[20:23], s58 offen nt lds
 v_mfma_f32_16x16x32_bf16 v[204:207], v[40:43], a[188:191], v[204:207]
 v_mfma_f32_16x16x32_bf16 v[204:207], v[44:47], a[204:207], v[204:207]
 s_waitcnt lgkmcnt(4)
 v_mfma_f32_16x16x32_bf16 v[208:211], v[24:27], a[160:163], v[208:211]
 s_waitcnt lgkmcnt(2)
 ds_read_b64_tr_b16 v[36:37], v7 offset:55296
 v_mfma_f32_16x16x32_bf16 v[208:211], v[28:31], a[176:179], v[208:211]
 s_waitcnt lgkmcnt(1)
 ds_read_b64_tr_b16 v[38:39], v7 offset:55552
 v_mfma_f32_16x16x32_bf16 v[208:211], v[32:35], a[192:195], v[208:211]
 ds_read_b64_tr_b16 v[40:41], v7 offset:57344
 v_mfma_f32_16x16x32_bf16 v[212:215], v[24:27], a[164:167], v[212:215]
 ds_read_b64_tr_b16 v[42:43], v7 offset:57600
 v_mfma_f32_16x16x32_bf16 v[212:215], v[28:31], a[180:183], v[212:215]
 ds_read_b64_tr_b16 v[44:45], v7 offset:59392
 v_mfma_f32_16x16x32_bf16 v[212:215], v[32:35], a[196:199], v[212:215]
 ds_read_b64_tr_b16 v[46:47], v7 offset:59648
 v_mfma_f32_16x16x32_bf16 v[216:219], v[24:27], a[168:171], v[216:219]
 s_add_u32 m0, s70, 57344
 v_add_u32 v6, 0x12000, v6
 v_add_u32 v7, 0x12000, v7
 v_mfma_f32_16x16x32_bf16 v[216:219], v[28:31], a[184:187], v[216:219]
 s_add_u32 s58, s83, 262144
 buffer_load_dwordx4 v5, s[20:23], s58 offen nt lds
 v_mfma_f32_16x16x32_bf16 v[216:219], v[32:35], a[200:203], v[216:219]
 s_add_u32 m0, s70, 61440
 v_mfma_f32_16x16x32_bf16 v[220:223], v[24:27], a[172:175], v[220:223]
 s_add_u32 s58, s83, 524288
 buffer_load_dwordx4 v5, s[20:23], s58 offen nt lds
 v_mfma_f32_16x16x32_bf16 v[220:223], v[28:31], a[188:191], v[220:223]
 v_mfma_f32_16x16x32_bf16 v[220:223], v[32:35], a[204:207], v[220:223]
 s_waitcnt vmcnt(13)
 s_barrier
 s_waitcnt lgkmcnt(4)
 v_mfma_f32_16x16x32_bf16 v[224:227], v[36:39], a[160:163], v[224:227]
 s_waitcnt lgkmcnt(2)
 ds_read_b64_tr_b16 v[24:25], v6 offset:0
 v_mfma_f32_16x16x32_bf16 v[224:227], v[40:43], a[176:179], v[224:227]
 s_waitcnt lgkmcnt(1)
 ds_read_b64_tr_b16 v[26:27], v6 offset:256
 v_mfma_f32_16x16x32_bf16 v[224:227], v[44:47], a[192:195], v[224:227]
 ds_read_b64_tr_b16 v[28:29], v6 offset:2048
 v_mfma_f32_16x16x32_bf16 v[228:231], v[36:39], a[164:167], v[228:231]
 ds_read_b64_tr_b16 v[30:31], v6 offset:2304
 v_mfma_f32_16x16x32_bf16 v[228:231], v[40:43], a[180:183], v[228:231]
 ds_read_b64_tr_b16 v[32:33], v6 offset:4096
 v_mfma_f32_16x16x32_bf16 v[228:231], v[44:47], a[196:199], v[228:231]
 ds_read_b64_tr_b16 v[34:35], v6 offset:4352
 v_mfma_f32_16x16x32_bf16 v[232:235], v[36:39], a[168:171], v[232:235]
 v_mfma_f32_16x16x32_bf16 v[232:235], v[40:43], a[184:187], v[232:235]
 v_mfma_f32_16x16x32_bf16 v[232:235], v[44:47], a[200:203], v[232:235]
 v_mfma_f32_16x16x32_bf16 v[236:239], v[36:39], a[172:175], v[236:239]
 v_mfma_f32_16x16x32_bf16 v[236:239], v[40:43], a[188:191], v[236:239]
 v_mfma_f32_16x16x32_bf16 v[236:239], v[44:47], a[204:207], v[236:239]
 s_waitcnt lgkmcnt(4)
 v_mfma_f32_16x16x32_bf16 v[176:179], v[24:27], a[208:211], v[176:179]
 s_waitcnt lgkmcnt(2)
 ds_read_b64_tr_b16 v[36:37], v7 offset:0
 v_mfma_f32_16x16x32_bf16 v[176:179], v[28:31], a[224:227], v[176:179]
 s_waitcnt lgkmcnt(1)
 ds_read_b64_tr_b16 v[38:39], v7 offset:256
 v_mfma_f32_16x16x32_bf16 v[176:179], v[32:35], a[240:243], v[176:179]
 ds_read_b64_tr_b16 v[40:41], v7 offset:2048
 v_mfma_f32_16x16x32_bf16 v[180:183], v[24:27], a[212:215], v[180:183]
 ds_read_b64_tr_b16 v[42:43], v7 offset:2304
 v_mfma_f32_16x16x32_bf16 v[180:183], v[28:31], a[228:231], v[180:183]
 ds_read_b64_tr_b16 v[44:45], v7 offset:4096
 v_mfma_f32_16x16x32_bf16 v[180:183], v[32:35], a[244:247], v[180:183]
 s_mul_i32 s84, s90, 256
 ds_read_b64_tr_b16 v[46:47], v7 offset:4352
 v_mfma_f32_16x16x32_bf16 v[184:187], v[24:27], a[216:219], v[184:187]
 s_add_u32 m0, s70, 65536
 v_mfma_f32_16x16x32_bf16 v[184:187], v[28:31], a[232:235], v[184:187]
 s_add_u32 s58, s84, 0
 buffer_load_dwordx4 v5, s[20:23], s58 offen nt lds
 v_mfma_f32_16x16x32_bf16 v[184:187], v[32:35], a[248:251], v[184:187]
 s_add_u32 m0, s70, 69632
 v_mfma_f32_16x16x32_bf16 v[188:191], v[24:27], a[220:223], v[188:191]
 s_add_u32 s58, s84, 262144
 buffer_load_dwordx4 v5, s[20:23], s58 offen nt lds
 v_mfma_f32_16x16x32_bf16 v[188:191], v[28:31], a[236:239], v[188:191]
 s_add_u32 m0, s70, 73728
 v_mfma_f32_16x16x32_bf16 v[188:191], v[32:35], a[252:255], v[188:191]
 s_waitcnt lgkmcnt(4)
 s_add_u32 s58, s84, 524288
 buffer_load_dwordx4 v5, s[20:23], s58 offen nt lds
 v_mfma_f32_16x16x32_bf16 v[192:195], v[36:39], a[208:211], v[192:195]
 s_waitcnt lgkmcnt(2)
 ds_read_b64_tr_b16 v[24:25], v6 offset:6144
 v_mfma_f32_16x16x32_bf16 v[192:195], v[40:43], a[224:227], v[192:195]
 s_waitcnt lgkmcnt(1)
 ds_read_b64_tr_b16 v[26:27], v6 offset:6400
 v_mfma_f32_16x16x32_bf16 v[192:195], v[44:47], a[240:243], v[192:195]
 ds_read_b64_tr_b16 v[28:29], v6 offset:8192
 v_mfma_f32_16x16x32_bf16 v[196:199], v[36:39], a[212:215], v[196:199]
 ds_read_b64_tr_b16 v[30:31], v6 offset:8448
 v_mfma_f32_16x16x32_bf16 v[196:199], v[40:43], a[228:231], v[196:199]
 ds_read_b64_tr_b16 v[32:33], v6 offset:10240
 v_mfma_f32_16x16x32_bf16 v[196:199], v[44:47], a[244:247], v[196:199]
 s_mul_i32 s85, s91, 256
 ds_read_b64_tr_b16 v[34:35], v6 offset:10496
 v_mfma_f32_16x16x32_bf16 v[200:203], v[36:39], a[216:219], v[200:203]
 s_add_u32 m0, s70, 77824
 v_mfma_f32_16x16x32_bf16 v[200:203], v[40:43], a[232:235], v[200:203]
 s_add_u32 s58, s85, 0
 buffer_load_dwordx4 v5, s[20:23], s58 offen nt lds
 v_mfma_f32_16x16x32_bf16 v[200:203], v[44:47], a[248:251], v[200:203]
 s_add_u32 m0, s70, 81920
 v_mfma_f32_16x16x32_bf16 v[204:207], v[36:39], a[220:223], v[204:207]
 s_add_u32 s58, s85, 262144
 buffer_load_dwordx4 v5, s[20:23], s58 offen nt lds
 v_mfma_f32_16x16x32_bf16 v[204:207], v[40:43], a[236:239], v[204:207]
 s_add_u32 m0, s70, 86016
 v_mfma_f32_16x16x32_bf16 v[204:207], v[44:47], a[252:255], v[204:207]
 s_waitcnt lgkmcnt(4)
 s_add_u32 s58, s85, 524288
 buffer_load_dwordx4 v5, s[20:23], s58 offen nt lds
 v_mfma_f32_16x16x32_bf16 v[208:211], v[24:27], a[208:211], v[208:211]
 s_waitcnt lgkmcnt(2)
 ds_read_b64_tr_b16 v[36:37], v7 offset:6144
 v_mfma_f32_16x16x32_bf16 v[208:211], v[28:31], a[224:227], v[208:211]
 s_waitcnt lgkmcnt(1)
 ds_read_b64_tr_b16 v[38:39], v7 offset:6400
 v_mfma_f32_16x16x32_bf16 v[208:211], v[32:35], a[240:243], v[208:211]
 ds_read_b64_tr_b16 v[40:41], v7 offset:8192
 v_mfma_f32_16x16x32_bf16 v[212:215], v[24:27], a[212:215], v[212:215]
 ds_read_b64_tr_b16 v[42:43], v7 offset:8448
 v_mfma_f32_16x16x32_bf16 v[212:215], v[28:31], a[228:231], v[212:215]
 ds_read_b64_tr_b16 v[44:45], v7 offset:10240
 v_mfma_f32_16x16x32_bf16 v[212:215], v[32:35], a[244:247], v[212:215]
 ds_read_b64_tr_b16 v[46:47], v7 offset:10496
 v_mfma_f32_16x16x32_bf16 v[216:219], v[24:27], a[216:219], v[216:219]
 v_lshrrev_b32 v10, 4, v1
 v_bfe_u32 v11, v1, 2, 2
 v_mfma_f32_16x16x32_bf16 v[216:219], v[28:31], a[232:235], v[216:219]
 v_lshl_add_u32 v12, v10, 3, v11
 v_and_b32 v10, 1, v10
 v_mfma_f32_16x16x32_bf16 v[216:219], v[32:35], a[248:251], v[216:219]
 v_lshlrev_b32 v12, 7, v12
 v_lshrrev_b32 v11, 1, v11
 v_mfma_f32_16x16x32_bf16 v[220:223], v[24:27], a[220:223], v[220:223]
 v_add_u32 v12, 139264, v12
 v_lshl_or_b32 v10, v10, 1, v11
 v_mfma_f32_16x16x32_bf16 v[220:223], v[28:31], a[236:239], v[220:223]
 v_lshlrev_b32 v10, 1, v10
 v_and_b32 v11, 3, v1
 v_mfma_f32_16x16x32_bf16 v[220:223], v[32:35], a[252:255], v[220:223]
 s_waitcnt vmcnt(12)
 s_barrier
 s_waitcnt lgkmcnt(4)
 v_xor_b32 v10, v10, v11
 v_lshl_add_u32 v6, v10, 4, v12
 v_xor_b32 v10, 4, v10
 v_lshl_add_u32 v7, v10, 4, v12
 v_mfma_f32_16x16x32_bf16 v[224:227], v[36:39], a[208:211], v[224:227]
 s_waitcnt lgkmcnt(2)
 ds_read_b64_tr_b16 v[24:25], v6 offset:0
 v_mfma_f32_16x16x32_bf16 v[224:227], v[40:43], a[224:227], v[224:227]
 s_waitcnt lgkmcnt(1)
 ds_read_b64_tr_b16 v[26:27], v6 offset:512
 v_mfma_f32_16x16x32_bf16 v[224:227], v[44:47], a[240:243], v[224:227]
 ds_read_b64_tr_b16 v[28:29], v6 offset:4096
 v_mfma_f32_16x16x32_bf16 v[228:231], v[36:39], a[212:215], v[228:231]
 ds_read_b64_tr_b16 v[30:31], v6 offset:4608
 v_mfma_f32_16x16x32_bf16 v[228:231], v[40:43], a[228:231], v[228:231]
 ds_read_b64_tr_b16 v[32:33], v6 offset:8192
 v_mfma_f32_16x16x32_bf16 v[228:231], v[44:47], a[244:247], v[228:231]
 ds_read_b64_tr_b16 v[34:35], v6 offset:8704
 v_mfma_f32_16x16x32_bf16 v[232:235], v[36:39], a[216:219], v[232:235]
 v_mfma_f32_16x16x32_bf16 v[232:235], v[40:43], a[232:235], v[232:235]
 v_mfma_f32_16x16x32_bf16 v[232:235], v[44:47], a[248:251], v[232:235]
 v_mfma_f32_16x16x32_bf16 v[236:239], v[36:39], a[220:223], v[236:239]
 v_mfma_f32_16x16x32_bf16 v[236:239], v[40:43], a[236:239], v[236:239]
 v_mfma_f32_16x16x32_bf16 v[236:239], v[44:47], a[252:255], v[236:239]
 s_waitcnt lgkmcnt(4)
 v_mfma_f32_16x16x32_bf16 v[112:115], v[24:27], v[48:51], 0
 s_waitcnt lgkmcnt(2)
 ds_read_b64_tr_b16 v[36:37], v6 offset:8
 v_mfma_f32_16x16x32_bf16 v[112:115], v[28:31], v[64:67], v[112:115]
 s_waitcnt lgkmcnt(1)
 ds_read_b64_tr_b16 v[38:39], v6 offset:520
 v_mfma_f32_16x16x32_bf16 v[112:115], v[32:35], a[0:3], v[112:115]
 ds_read_b64_tr_b16 v[40:41], v6 offset:4104
 v_lshrrev_b32 v13, 4, v1
 v_mfma_f32_16x16x32_bf16 v[116:119], v[24:27], v[52:55], 0
 ds_read_b64_tr_b16 v[42:43], v6 offset:4616
 v_and_b32 v14, 15, v1
 v_mfma_f32_16x16x32_bf16 v[116:119], v[28:31], v[68:71], v[116:119]
 ds_read_b64_tr_b16 v[44:45], v6 offset:8200
 v_lshlrev_b32 v15, 8, v13
 v_mfma_f32_16x16x32_bf16 v[116:119], v[32:35], a[4:7], v[116:119]
 ds_read_b64_tr_b16 v[46:47], v6 offset:8712
 v_or_b32 v240, 0, v13
 v_mfma_f32_16x16x32_bf16 v[120:123], v[24:27], v[56:59], 0
 v_add_u32 v15, s72, v15
 v_or_b32 v241, 4, v13
 v_mfma_f32_16x16x32_bf16 v[120:123], v[28:31], v[72:75], v[120:123]
 s_add_u32 m0, s70, 90112
 v_xor_b32 v240, v240, v14
 v_or_b32 v242, 8, v13
 v_mfma_f32_16x16x32_bf16 v[120:123], v[32:35], a[8:11], v[120:123]
 s_add_u32 s58, s80, 128
 buffer_load_dwordx4 v5, s[20:23], s58 offen nt lds
 v_mfma_f32_16x16x32_bf16 v[124:127], v[24:27], v[60:63], 0
 v_lshl_add_u32 v240, v240, 4, v15
 v_xor_b32 v241, v241, v14
 v_mfma_f32_16x16x32_bf16 v[124:127], v[28:31], v[76:79], v[124:127]
 v_xor_b32 v242, v242, v14
 v_or_b32 v243, 12, v13
 v_mfma_f32_16x16x32_bf16 v[124:127], v[32:35], a[12:15], v[124:127]
 s_waitcnt lgkmcnt(4)
 v_lshl_add_u32 v241, v241, 4, v15
 v_or_b32 v244, 0, v13
 v_mfma_f32_16x16x32_bf16 v[128:131], v[36:39], v[48:51], 0
 s_waitcnt lgkmcnt(2)
 ds_read_b64_tr_b16 v[24:25], v7 offset:0
 v_lshl_add_u32 v242, v242, 4, v15
 v_mfma_f32_16x16x32_bf16 v[128:131], v[40:43], v[64:67], v[128:131]
 s_waitcnt lgkmcnt(1)
 ds_read_b64_tr_b16 v[26:27], v7 offset:512
 v_xor_b32 v243, v243, v14
 v_mfma_f32_16x16x32_bf16 v[128:131], v[44:47], a[0:3], v[128:131]
 ds_read_b64_tr_b16 v[28:29], v7 offset:4096
 v_lshlrev_b32 v244, 1, v244
 v_mfma_f32_16x16x32_bf16 v[132:135], v[36:39], v[52:55], 0
 ds_read_b64_tr_b16 v[30:31], v7 offset:4608
 v_lshl_add_u32 v243, v243, 4, v15
 v_mfma_f32_16x16x32_bf16 v[132:135], v[40:43], v[68:71], v[132:135]
 ds_read_b64_tr_b16 v[32:33], v7 offset:8192
 v_xor_b32 v244, v244, v14
 v_mfma_f32_16x16x32_bf16 v[132:135], v[44:47], a[4:7], v[132:135]
 ds_read_b64_tr_b16 v[34:35], v7 offset:8704
 v_or_b32 v245, 4, v13
 v_mfma_f32_16x16x32_bf16 v[136:139], v[36:39], v[56:59], 0
 v_lshl_add_u32 v244, v244, 4, v15
 v_mul_f32 v16, s74, v176
 v_mfma_f32_16x16x32_bf16 v[136:139], v[40:43], v[72:75], v[136:139]
 s_add_u32 m0, s70, 94208
 v_lshlrev_b32 v245, 1, v245
 v_mul_f32 v17, s74, v177
 v_mfma_f32_16x16x32_bf16 v[136:139], v[44:47], a[8:11], v[136:139]
 s_add_u32 s58, s80, 262272
 buffer_load_dwordx4 v5, s[20:23], s58 offen nt lds
 v_mfma_f32_16x16x32_bf16 v[140:143], v[36:39], v[60:63], 0
 v_exp_f32 v16, v16
 v_mfma_f32_16x16x32_bf16 v[140:143], v[40:43], v[76:79], v[140:143]
 v_exp_f32 v17, v17
 v_mfma_f32_16x16x32_bf16 v[140:143], v[44:47], a[12:15], v[140:143]
 s_waitcnt lgkmcnt(4)
 v_xor_b32 v245, v245, v14
 v_mul_f32 v18, s74, v178
 v_mfma_f32_16x16x32_bf16 v[144:147], v[24:27], v[48:51], 0
 s_waitcnt lgkmcnt(2)
 ds_read_b64_tr_b16 v[36:37], v7 offset:8
 v_mul_f32 v19, s74, v179
 v_mfma_f32_16x16x32_bf16 v[144:147], v[28:31], v[64:67], v[144:147]
 s_waitcnt lgkmcnt(1)
 ds_read_b64_tr_b16 v[38:39], v7 offset:520
 v_lshl_add_u32 v245, v245, 4, v15
 v_mfma_f32_16x16x32_bf16 v[144:147], v[32:35], a[0:3], v[144:147]
 ds_read_b64_tr_b16 v[40:41], v7 offset:4104
 v_add_f32 v16, 1.0, v16
 v_mfma_f32_16x16x32_bf16 v[148:151], v[24:27], v[52:55], 0
 ds_read_b64_tr_b16 v[42:43], v7 offset:4616
 v_add_f32 v17, 1.0, v17
 v_mfma_f32_16x16x32_bf16 v[148:151], v[28:31], v[68:71], v[148:151]
 ds_read_b64_tr_b16 v[44:45], v7 offset:8200
 v_mfma_f32_16x16x32_bf16 v[148:151], v[32:35], a[4:7], v[148:151]
 ds_read_b64_tr_b16 v[46:47], v7 offset:8712
 v_mfma_f32_16x16x32_bf16 v[152:155], v[24:27], v[56:59], 0
 v_exp_f32 v18, v18
 v_mfma_f32_16x16x32_bf16 v[152:155], v[28:31], v[72:75], v[152:155]
 s_add_u32 m0, s70, 98304
 v_exp_f32 v19, v19
 v_mfma_f32_16x16x32_bf16 v[152:155], v[32:35], a[8:11], v[152:155]
 s_add_u32 s58, s80, 524416
 buffer_load_dwordx4 v5, s[20:23], s58 offen nt lds
 v_mfma_f32_16x16x32_bf16 v[156:159], v[24:27], v[60:63], 0
 v_rcp_f32 v16, v16
 v_mfma_f32_16x16x32_bf16 v[156:159], v[28:31], v[76:79], v[156:159]
 v_rcp_f32 v17, v17
 v_mfma_f32_16x16x32_bf16 v[156:159], v[32:35], a[12:15], v[156:159]
 s_waitcnt lgkmcnt(4)
 v_add_f32 v18, 1.0, v18
 v_add_f32 v19, 1.0, v19
 v_mfma_f32_16x16x32_bf16 v[160:163], v[36:39], v[48:51], 0
 s_waitcnt lgkmcnt(2)
 ds_read_b64_tr_b16 v[24:25], v6 offset:12288
 v_mul_f32 v176, v176, v16
 v_mfma_f32_16x16x32_bf16 v[160:163], v[40:43], v[64:67], v[160:163]
 s_waitcnt lgkmcnt(1)
 ds_read_b64_tr_b16 v[26:27], v6 offset:12800
 v_mul_f32 v177, v177, v17
 v_mfma_f32_16x16x32_bf16 v[160:163], v[44:47], a[0:3], v[160:163]
 ds_read_b64_tr_b16 v[28:29], v6 offset:16384
 v_mul_f32 v176, v176, v208
 v_mfma_f32_16x16x32_bf16 v[164:167], v[36:39], v[52:55], 0
 ds_read_b64_tr_b16 v[30:31], v6 offset:16896
 v_mul_f32 v177, v177, v209
 v_mfma_f32_16x16x32_bf16 v[164:167], v[40:43], v[68:71], v[164:167]
 ds_read_b64_tr_b16 v[32:33], v6 offset:20480
 v_mul_f32 v20, s74, v192
 v_mfma_f32_16x16x32_bf16 v[164:167], v[44:47], a[4:7], v[164:167]
 ds_read_b64_tr_b16 v[34:35], v6 offset:20992
 v_cvt_pk_bf16_f32 v176, v176, v177
 v_mfma_f32_16x16x32_bf16 v[168:171], v[36:39], v[56:59], 0
 v_rcp_f32 v18, v18
 v_mfma_f32_16x16x32_bf16 v[168:171], v[40:43], v[72:75], v[168:171]
 v_rcp_f32 v19, v19
 v_mfma_f32_16x16x32_bf16 v[168:171], v[44:47], a[8:11], v[168:171]
 v_exp_f32 v20, v20
 v_mfma_f32_16x16x32_bf16 v[172:175], v[36:39], v[60:63], 0
 v_mul_f32 v178, v178, v18
 v_mul_f32 v179, v179, v19
 v_mfma_f32_16x16x32_bf16 v[172:175], v[40:43], v[76:79], v[172:175]
 v_mul_f32 v21, s74, v193
 v_mul_f32 v22, s74, v194
 v_mfma_f32_16x16x32_bf16 v[172:175], v[44:47], a[12:15], v[172:175]
 s_waitcnt lgkmcnt(4)
 v_mul_f32 v178, v178, v210
 v_mul_f32 v179, v179, v211
 v_mfma_f32_16x16x32_bf16 v[112:115], v[24:27], a[16:19], v[112:115]
 s_waitcnt lgkmcnt(2)
 ds_read_b64_tr_b16 v[36:37], v6 offset:12296
 v_mul_f32 v23, s74, v195
 v_mfma_f32_16x16x32_bf16 v[112:115], v[28:31], a[32:35], v[112:115]
 s_waitcnt lgkmcnt(1)
 ds_read_b64_tr_b16 v[38:39], v6 offset:12808
 v_cvt_pk_bf16_f32 v177, v178, v179
 v_mfma_f32_16x16x32_bf16 v[112:115], v[32:35], a[48:51], v[112:115]
 ds_read_b64_tr_b16 v[40:41], v6 offset:16392
 v_add_f32 v20, 1.0, v20
 v_mfma_f32_16x16x32_bf16 v[116:119], v[24:27], a[20:23], v[116:119]
 ds_read_b64_tr_b16 v[42:43], v6 offset:16904
 v_mfma_f32_16x16x32_bf16 v[116:119], v[28:31], a[36:39], v[116:119]
 ds_read_b64_tr_b16 v[44:45], v6 offset:20488
 v_mfma_f32_16x16x32_bf16 v[116:119], v[32:35], a[52:55], v[116:119]
 ds_read_b64_tr_b16 v[46:47], v6 offset:21000
 v_mfma_f32_16x16x32_bf16 v[120:123], v[24:27], a[24:27], v[120:123]
 v_exp_f32 v21, v21
 v_mfma_f32_16x16x32_bf16 v[120:123], v[28:31], a[40:43], v[120:123]
 s_add_u32 m0, s70, 102400
 v_exp_f32 v22, v22
 v_mfma_f32_16x16x32_bf16 v[120:123], v[32:35], a[56:59], v[120:123]
 s_add_u32 s58, s81, 128
 buffer_load_dwordx4 v5, s[20:23], s58 offen nt lds
 v_mfma_f32_16x16x32_bf16 v[124:127], v[24:27], a[28:31], v[124:127]
 v_exp_f32 v23, v23
 v_mfma_f32_16x16x32_bf16 v[124:127], v[28:31], a[44:47], v[124:127]
 v_rcp_f32 v20, v20
 v_mfma_f32_16x16x32_bf16 v[124:127], v[32:35], a[60:63], v[124:127]
 s_waitcnt lgkmcnt(4)
 v_add_f32 v21, 1.0, v21
 v_add_f32 v22, 1.0, v22
 v_mfma_f32_16x16x32_bf16 v[128:131], v[36:39], a[16:19], v[128:131]
 s_waitcnt lgkmcnt(2)
 ds_read_b64_tr_b16 v[24:25], v7 offset:12288
 v_add_f32 v23, 1.0, v23
 v_mfma_f32_16x16x32_bf16 v[128:131], v[40:43], a[32:35], v[128:131]
 s_waitcnt lgkmcnt(1)
 ds_read_b64_tr_b16 v[26:27], v7 offset:12800
 v_mul_f32 v192, v192, v20
 v_mfma_f32_16x16x32_bf16 v[128:131], v[44:47], a[48:51], v[128:131]
 ds_read_b64_tr_b16 v[28:29], v7 offset:16384
 v_mul_f32 v16, s74, v180
 v_mfma_f32_16x16x32_bf16 v[132:135], v[36:39], a[20:23], v[132:135]
 ds_read_b64_tr_b16 v[30:31], v7 offset:16896
 v_mul_f32 v192, v192, v224
 v_mfma_f32_16x16x32_bf16 v[132:135], v[40:43], a[36:39], v[132:135]
 ds_read_b64_tr_b16 v[32:33], v7 offset:20480
 v_mul_f32 v17, s74, v181
 v_mfma_f32_16x16x32_bf16 v[132:135], v[44:47], a[52:55], v[132:135]
 ds_read_b64_tr_b16 v[34:35], v7 offset:20992
 v_mul_f32 v18, s74, v182
 v_mfma_f32_16x16x32_bf16 v[136:139], v[36:39], a[24:27], v[136:139]
 v_rcp_f32 v21, v21
 v_mfma_f32_16x16x32_bf16 v[136:139], v[40:43], a[40:43], v[136:139]
 s_add_u32 m0, s70, 106496
 v_rcp_f32 v22, v22
 v_mfma_f32_16x16x32_bf16 v[136:139], v[44:47], a[56:59], v[136:139]
 s_add_u32 s58, s81, 262272
 buffer_load_dwordx4 v5, s[20:23], s58 offen nt lds
 v_mfma_f32_16x16x32_bf16 v[140:143], v[36:39], a[28:31], v[140:143]
 v_rcp_f32 v23, v23
 v_mfma_f32_16x16x32_bf16 v[140:143], v[40:43], a[44:47], v[140:143]
 v_exp_f32 v16, v16
 v_mfma_f32_16x16x32_bf16 v[140:143], v[44:47], a[60:63], v[140:143]
 s_waitcnt lgkmcnt(4)
 v_exp_f32 v17, v17
 v_mfma_f32_16x16x32_bf16 v[144:147], v[24:27], a[16:19], v[144:147]
 s_waitcnt lgkmcnt(2)
 ds_read_b64_tr_b16 v[36:37], v7 offset:12296
 v_mul_f32 v193, v193, v21
 v_mfma_f32_16x16x32_bf16 v[144:147], v[28:31], a[32:35], v[144:147]
 s_waitcnt lgkmcnt(1)
 ds_read_b64_tr_b16 v[38:39], v7 offset:12808
 v_mul_f32 v194, v194, v22
 v_mfma_f32_16x16x32_bf16 v[144:147], v[32:35], a[48:51], v[144:147]
 ds_read_b64_tr_b16 v[40:41], v7 offset:16392
 v_mul_f32 v195, v195, v23
 v_mfma_f32_16x16x32_bf16 v[148:151], v[24:27], a[20:23], v[148:151]
 ds_read_b64_tr_b16 v[42:43], v7 offset:16904
 v_mul_f32 v193, v193, v225
 v_mfma_f32_16x16x32_bf16 v[148:151], v[28:31], a[36:39], v[148:151]
 ds_read_b64_tr_b16 v[44:45], v7 offset:20488
 v_mul_f32 v194, v194, v226
 v_mfma_f32_16x16x32_bf16 v[148:151], v[32:35], a[52:55], v[148:151]
 ds_read_b64_tr_b16 v[46:47], v7 offset:21000
 v_mul_f32 v195, v195, v227
 v_mfma_f32_16x16x32_bf16 v[152:155], v[24:27], a[24:27], v[152:155]
 v_add_u32 v6, 0xfffe8000, v6
 v_add_u32 v7, 0xfffe8000, v7
 v_mfma_f32_16x16x32_bf16 v[152:155], v[28:31], a[40:43], v[152:155]
 s_add_u32 m0, s70, 110592
 v_exp_f32 v18, v18
 v_mfma_f32_16x16x32_bf16 v[152:155], v[32:35], a[56:59], v[152:155]
 s_add_u32 s58, s81, 524416
 buffer_load_dwordx4 v5, s[20:23], s58 offen nt lds
 v_mfma_f32_16x16x32_bf16 v[156:159], v[24:27], a[28:31], v[156:159]
 v_cvt_pk_bf16_f32 v178, v192, v193
 v_cvt_pk_bf16_f32 v179, v194, v195
 v_mfma_f32_16x16x32_bf16 v[156:159], v[28:31], a[44:47], v[156:159]
 v_mul_f32 v19, s74, v183
 v_add_f32 v16, 1.0, v16
 v_mfma_f32_16x16x32_bf16 v[156:159], v[32:35], a[60:63], v[156:159]
 s_waitcnt vmcnt(12)
 s_barrier
 s_waitcnt lgkmcnt(4)
 buffer_store_dwordx4 v[176:179], v2, s[32:35], s68 offen offset:0 sc1
 v_mfma_f32_16x16x32_bf16 v[160:163], v[36:39], a[16:19], v[160:163]
 s_waitcnt lgkmcnt(2)
 ds_read_b64_tr_b16 v[24:25], v6 offset:0
 v_add_f32 v17, 1.0, v17
 v_mfma_f32_16x16x32_bf16 v[160:163], v[40:43], a[32:35], v[160:163]
 s_waitcnt lgkmcnt(1)
 ds_read_b64_tr_b16 v[26:27], v6 offset:512
 v_add_f32 v18, 1.0, v18
 v_mfma_f32_16x16x32_bf16 v[160:163], v[44:47], a[48:51], v[160:163]
 ds_read_b64_tr_b16 v[28:29], v6 offset:4096
 v_mfma_f32_16x16x32_bf16 v[164:167], v[36:39], a[20:23], v[164:167]
 ds_read_b64_tr_b16 v[30:31], v6 offset:4608
 v_mfma_f32_16x16x32_bf16 v[164:167], v[40:43], a[36:39], v[164:167]
 ds_read_b64_tr_b16 v[32:33], v6 offset:8192
 v_mfma_f32_16x16x32_bf16 v[164:167], v[44:47], a[52:55], v[164:167]
 ds_read_b64_tr_b16 v[34:35], v6 offset:8704
 v_mfma_f32_16x16x32_bf16 v[168:171], v[36:39], a[24:27], v[168:171]
 v_exp_f32 v19, v19
 v_mfma_f32_16x16x32_bf16 v[168:171], v[40:43], a[40:43], v[168:171]
 v_rcp_f32 v16, v16
 v_mfma_f32_16x16x32_bf16 v[168:171], v[44:47], a[56:59], v[168:171]
 v_rcp_f32 v17, v17
 v_mfma_f32_16x16x32_bf16 v[172:175], v[36:39], a[28:31], v[172:175]
 v_rcp_f32 v18, v18
 v_mfma_f32_16x16x32_bf16 v[172:175], v[40:43], a[44:47], v[172:175]
 v_add_f32 v19, 1.0, v19
 v_mul_f32 v180, v180, v16
 v_mfma_f32_16x16x32_bf16 v[172:175], v[44:47], a[60:63], v[172:175]
 s_waitcnt lgkmcnt(4)
 v_mul_f32 v181, v181, v17
 v_mul_f32 v182, v182, v18
 v_mfma_f32_16x16x32_bf16 v[112:115], v[24:27], a[64:67], v[112:115]
 s_waitcnt lgkmcnt(2)
 ds_read_b64_tr_b16 v[36:37], v6 offset:8
 v_mul_f32 v180, v180, v212
 v_mfma_f32_16x16x32_bf16 v[112:115], v[28:31], a[80:83], v[112:115]
 s_waitcnt lgkmcnt(1)
 ds_read_b64_tr_b16 v[38:39], v6 offset:520
 v_mul_f32 v181, v181, v213
 v_mfma_f32_16x16x32_bf16 v[112:115], v[32:35], a[96:99], v[112:115]
 ds_read_b64_tr_b16 v[40:41], v6 offset:4104
 v_mul_f32 v182, v182, v214
 v_mfma_f32_16x16x32_bf16 v[116:119], v[24:27], a[68:71], v[116:119]
 ds_read_b64_tr_b16 v[42:43], v6 offset:4616
 v_cvt_pk_bf16_f32 v180, v180, v181
 v_mfma_f32_16x16x32_bf16 v[116:119], v[28:31], a[84:87], v[116:119]
 ds_read_b64_tr_b16 v[44:45], v6 offset:8200
 v_mul_f32 v20, s74, v196
 v_mfma_f32_16x16x32_bf16 v[116:119], v[32:35], a[100:103], v[116:119]
 ds_read_b64_tr_b16 v[46:47], v6 offset:8712
 v_mul_f32 v21, s74, v197
 v_mfma_f32_16x16x32_bf16 v[120:123], v[24:27], a[72:75], v[120:123]
 v_rcp_f32 v19, v19
 v_mfma_f32_16x16x32_bf16 v[120:123], v[28:31], a[88:91], v[120:123]
 s_add_u32 m0, s70, 114688
 v_exp_f32 v20, v20
 v_mfma_f32_16x16x32_bf16 v[120:123], v[32:35], a[104:107], v[120:123]
 s_add_u32 s58, s82, 128
 buffer_load_dwordx4 v5, s[20:23], s58 offen nt lds
 v_mfma_f32_16x16x32_bf16 v[124:127], v[24:27], a[76:79], v[124:127]
 v_exp_f32 v21, v21
 v_mfma_f32_16x16x32_bf16 v[124:127], v[28:31], a[92:95], v[124:127]
 v_mul_f32 v183, v183, v19
 v_mul_f32 v22, s74, v198
 v_mfma_f32_16x16x32_bf16 v[124:127], v[32:35], a[108:111], v[124:127]
 s_waitcnt lgkmcnt(4)
 v_mul_f32 v23, s74, v199
 v_add_f32 v20, 1.0, v20
 v_mfma_f32_16x16x32_bf16 v[128:131], v[36:39], a[64:67], v[128:131]
 s_waitcnt lgkmcnt(2)
 ds_read_b64_tr_b16 v[24:25], v7 offset:0
 v_mul_f32 v183, v183, v215
 v_mfma_f32_16x16x32_bf16 v[128:131], v[40:43], a[80:83], v[128:131]
 s_waitcnt lgkmcnt(1)
 ds_read_b64_tr_b16 v[26:27], v7 offset:512
 v_add_f32 v21, 1.0, v21
 v_mfma_f32_16x16x32_bf16 v[128:131], v[44:47], a[96:99], v[128:131]
 ds_read_b64_tr_b16 v[28:29], v7 offset:4096
 v_cvt_pk_bf16_f32 v181, v182, v183
 v_mfma_f32_16x16x32_bf16 v[132:135], v[36:39], a[68:71], v[132:135]
 ds_read_b64_tr_b16 v[30:31], v7 offset:4608
 v_mfma_f32_16x16x32_bf16 v[132:135], v[40:43], a[84:87], v[132:135]
 ds_read_b64_tr_b16 v[32:33], v7 offset:8192
 v_mfma_f32_16x16x32_bf16 v[132:135], v[44:47], a[100:103], v[132:135]
 ds_read_b64_tr_b16 v[34:35], v7 offset:8704
 v_mfma_f32_16x16x32_bf16 v[136:139], v[36:39], a[72:75], v[136:139]
 v_exp_f32 v22, v22
 v_mfma_f32_16x16x32_bf16 v[136:139], v[40:43], a[88:91], v[136:139]
 s_add_u32 m0, s70, 118784
 v_exp_f32 v23, v23
 v_mfma_f32_16x16x32_bf16 v[136:139], v[44:47], a[104:107], v[136:139]
 s_add_u32 s58, s82, 262272
 buffer_load_dwordx4 v5, s[20:23], s58 offen nt lds
 v_mfma_f32_16x16x32_bf16 v[140:143], v[36:39], a[76:79], v[140:143]
 v_rcp_f32 v20, v20
 v_mfma_f32_16x16x32_bf16 v[140:143], v[40:43], a[92:95], v[140:143]
 v_rcp_f32 v21, v21
 v_mfma_f32_16x16x32_bf16 v[140:143], v[44:47], a[108:111], v[140:143]
 s_waitcnt lgkmcnt(4)
 v_add_f32 v22, 1.0, v22
 v_add_f32 v23, 1.0, v23
 v_mfma_f32_16x16x32_bf16 v[144:147], v[24:27], a[64:67], v[144:147]
 s_waitcnt lgkmcnt(2)
 ds_read_b64_tr_b16 v[36:37], v7 offset:8
 v_mul_f32 v196, v196, v20
 v_mfma_f32_16x16x32_bf16 v[144:147], v[28:31], a[80:83], v[144:147]
 s_waitcnt lgkmcnt(1)
 ds_read_b64_tr_b16 v[38:39], v7 offset:520
 v_mul_f32 v197, v197, v21
 v_mfma_f32_16x16x32_bf16 v[144:147], v[32:35], a[96:99], v[144:147]
 ds_read_b64_tr_b16 v[40:41], v7 offset:4104
 v_mul_f32 v196, v196, v228
 v_mfma_f32_16x16x32_bf16 v[148:151], v[24:27], a[68:71], v[148:151]
 ds_read_b64_tr_b16 v[42:43], v7 offset:4616
 v_mul_f32 v197, v197, v229
 v_mfma_f32_16x16x32_bf16 v[148:151], v[28:31], a[84:87], v[148:151]
 ds_read_b64_tr_b16 v[44:45], v7 offset:8200
 v_mul_f32 v16, s74, v184
 v_mfma_f32_16x16x32_bf16 v[148:151], v[32:35], a[100:103], v[148:151]
 ds_read_b64_tr_b16 v[46:47], v7 offset:8712
 v_cvt_pk_bf16_f32 v182, v196, v197
 v_mfma_f32_16x16x32_bf16 v[152:155], v[24:27], a[72:75], v[152:155]
 v_rcp_f32 v22, v22
 v_mfma_f32_16x16x32_bf16 v[152:155], v[28:31], a[88:91], v[152:155]
 s_add_u32 m0, s70, 122880
 v_rcp_f32 v23, v23
 v_mfma_f32_16x16x32_bf16 v[152:155], v[32:35], a[104:107], v[152:155]
 s_add_u32 s58, s82, 524416
 buffer_load_dwordx4 v5, s[20:23], s58 offen nt lds
 v_mfma_f32_16x16x32_bf16 v[156:159], v[24:27], a[76:79], v[156:159]
 v_exp_f32 v16, v16
 v_mfma_f32_16x16x32_bf16 v[156:159], v[28:31], a[92:95], v[156:159]
 v_mul_f32 v198, v198, v22
 v_mul_f32 v199, v199, v23
 v_mfma_f32_16x16x32_bf16 v[156:159], v[32:35], a[108:111], v[156:159]
 s_waitcnt lgkmcnt(4)
 v_mul_f32 v17, s74, v185
 v_mul_f32 v18, s74, v186
 v_mfma_f32_16x16x32_bf16 v[160:163], v[36:39], a[64:67], v[160:163]
 s_waitcnt lgkmcnt(2)
 ds_read_b64_tr_b16 v[24:25], v6 offset:12288
 v_mul_f32 v198, v198, v230
 v_mfma_f32_16x16x32_bf16 v[160:163], v[40:43], a[80:83], v[160:163]
 s_waitcnt lgkmcnt(1)
 ds_read_b64_tr_b16 v[26:27], v6 offset:12800
 v_mul_f32 v199, v199, v231
 v_mfma_f32_16x16x32_bf16 v[160:163], v[44:47], a[96:99], v[160:163]
 ds_read_b64_tr_b16 v[28:29], v6 offset:16384
 v_mul_f32 v19, s74, v187
 v_mfma_f32_16x16x32_bf16 v[164:167], v[36:39], a[68:71], v[164:167]
 ds_read_b64_tr_b16 v[30:31], v6 offset:16896
 v_cvt_pk_bf16_f32 v183, v198, v199
 v_mfma_f32_16x16x32_bf16 v[164:167], v[40:43], a[84:87], v[164:167]
 ds_read_b64_tr_b16 v[32:33], v6 offset:20480
 v_add_f32 v16, 1.0, v16
 v_mfma_f32_16x16x32_bf16 v[164:167], v[44:47], a[100:103], v[164:167]
 ds_read_b64_tr_b16 v[34:35], v6 offset:20992
 v_mfma_f32_16x16x32_bf16 v[168:171], v[36:39], a[72:75], v[168:171]
 buffer_store_dwordx4 v[180:183], v2, s[32:35], s68 offen offset:1024 sc1
 v_mfma_f32_16x16x32_bf16 v[168:171], v[40:43], a[88:91], v[168:171]
 v_exp_f32 v17, v17
 v_mfma_f32_16x16x32_bf16 v[168:171], v[44:47], a[104:107], v[168:171]
 v_exp_f32 v18, v18
 v_mfma_f32_16x16x32_bf16 v[172:175], v[36:39], a[76:79], v[172:175]
 v_exp_f32 v19, v19
 v_mfma_f32_16x16x32_bf16 v[172:175], v[40:43], a[92:95], v[172:175]
 v_rcp_f32 v16, v16
 v_mfma_f32_16x16x32_bf16 v[172:175], v[44:47], a[108:111], v[172:175]
 s_waitcnt lgkmcnt(4)
 v_add_f32 v17, 1.0, v17
 v_add_f32 v18, 1.0, v18
 v_mfma_f32_16x16x32_bf16 v[112:115], v[24:27], a[112:115], v[112:115]
 s_waitcnt lgkmcnt(2)
 ds_read_b64_tr_b16 v[36:37], v6 offset:12296
 v_add_f32 v19, 1.0, v19
 v_mfma_f32_16x16x32_bf16 v[112:115], v[28:31], a[128:131], v[112:115]
 s_waitcnt lgkmcnt(1)
 ds_read_b64_tr_b16 v[38:39], v6 offset:12808
 v_mul_f32 v184, v184, v16
 v_mfma_f32_16x16x32_bf16 v[112:115], v[32:35], a[144:147], v[112:115]
 ds_read_b64_tr_b16 v[40:41], v6 offset:16392
 v_mul_f32 v20, s74, v200
 v_mfma_f32_16x16x32_bf16 v[116:119], v[24:27], a[116:119], v[116:119]
 ds_read_b64_tr_b16 v[42:43], v6 offset:16904
 v_mul_f32 v184, v184, v216
 v_mfma_f32_16x16x32_bf16 v[116:119], v[28:31], a[132:135], v[116:119]
 ds_read_b64_tr_b16 v[44:45], v6 offset:20488
 v_mul_f32 v21, s74, v201
 v_mfma_f32_16x16x32_bf16 v[116:119], v[32:35], a[148:151], v[116:119]
 ds_read_b64_tr_b16 v[46:47], v6 offset:21000
 v_mul_f32 v22, s74, v202
 v_mfma_f32_16x16x32_bf16 v[120:123], v[24:27], a[120:123], v[120:123]
 v_rcp_f32 v17, v17
 v_mfma_f32_16x16x32_bf16 v[120:123], v[28:31], a[136:139], v[120:123]
 s_add_u32 m0, s70, 126976
 v_rcp_f32 v18, v18
 v_mfma_f32_16x16x32_bf16 v[120:123], v[32:35], a[152:155], v[120:123]
 s_add_u32 s58, s83, 128
 buffer_load_dwordx4 v5, s[20:23], s58 offen nt lds
 v_mfma_f32_16x16x32_bf16 v[124:127], v[24:27], a[124:127], v[124:127]
 v_rcp_f32 v19, v19
 v_mfma_f32_16x16x32_bf16 v[124:127], v[28:31], a[140:143], v[124:127]
 v_exp_f32 v20, v20
 v_mfma_f32_16x16x32_bf16 v[124:127], v[32:35], a[156:159], v[124:127]
 s_waitcnt lgkmcnt(4)
 v_exp_f32 v21, v21
 v_mfma_f32_16x16x32_bf16 v[128:131], v[36:39], a[112:115], v[128:131]
 s_waitcnt lgkmcnt(2)
 ds_read_b64_tr_b16 v[24:25], v7 offset:12288
 v_mul_f32 v185, v185, v17
 v_mfma_f32_16x16x32_bf16 v[128:131], v[40:43], a[128:131], v[128:131]
 s_waitcnt lgkmcnt(1)
 ds_read_b64_tr_b16 v[26:27], v7 offset:12800
 v_mul_f32 v186, v186, v18
 v_mfma_f32_16x16x32_bf16 v[128:131], v[44:47], a[144:147], v[128:131]
 ds_read_b64_tr_b16 v[28:29], v7 offset:16384
 v_mul_f32 v187, v187, v19
 v_mfma_f32_16x16x32_bf16 v[132:135], v[36:39], a[116:119], v[132:135]
 ds_read_b64_tr_b16 v[30:31], v7 offset:16896
 v_mul_f32 v185, v185, v217
 v_mfma_f32_16x16x32_bf16 v[132:135], v[40:43], a[132:135], v[132:135]
 ds_read_b64_tr_b16 v[32:33], v7 offset:20480
 v_mul_f32 v186, v186, v218
 v_mfma_f32_16x16x32_bf16 v[132:135], v[44:47], a[148:151], v[132:135]
 ds_read_b64_tr_b16 v[34:35], v7 offset:20992
 v_mul_f32 v187, v187, v219
 v_mfma_f32_16x16x32_bf16 v[136:139], v[36:39], a[120:123], v[136:139]
 v_exp_f32 v22, v22
 v_mfma_f32_16x16x32_bf16 v[136:139], v[40:43], a[136:139], v[136:139]
 s_add_u32 m0, s70, 131072
 v_cvt_pk_bf16_f32 v184, v184, v185
 v_cvt_pk_bf16_f32 v185, v186, v187
 v_mfma_f32_16x16x32_bf16 v[136:139], v[44:47], a[152:155], v[136:139]
 s_add_u32 s58, s83, 262272
 buffer_load_dwordx4 v5, s[20:23], s58 offen nt lds
 v_mfma_f32_16x16x32_bf16 v[140:143], v[36:39], a[124:127], v[140:143]
 v_mul_f32 v23, s74, v203
 v_add_f32 v20, 1.0, v20
 v_mfma_f32_16x16x32_bf16 v[140:143], v[40:43], a[140:143], v[140:143]
 v_add_f32 v21, 1.0, v21
 v_add_f32 v22, 1.0, v22
 v_mfma_f32_16x16x32_bf16 v[140:143], v[44:47], a[156:159], v[140:143]
 s_waitcnt lgkmcnt(4)
 v_exp_f32 v23, v23
 v_mfma_f32_16x16x32_bf16 v[144:147], v[24:27], a[112:115], v[144:147]
 s_waitcnt lgkmcnt(2)
 ds_read_b64_tr_b16 v[36:37], v7 offset:12296
 v_mfma_f32_16x16x32_bf16 v[144:147], v[28:31], a[128:131], v[144:147]
 s_waitcnt lgkmcnt(1)
 ds_read_b64_tr_b16 v[38:39], v7 offset:12808
 v_add_f32 v23, 1.0, v23
 v_mfma_f32_16x16x32_bf16 v[144:147], v[32:35], a[144:147], v[144:147]
 ds_read_b64_tr_b16 v[40:41], v7 offset:16392
 v_mfma_f32_16x16x32_bf16 v[148:151], v[24:27], a[116:119], v[148:151]
 ds_read_b64_tr_b16 v[42:43], v7 offset:16904
 v_mfma_f32_16x16x32_bf16 v[148:151], v[28:31], a[132:135], v[148:151]
 ds_read_b64_tr_b16 v[44:45], v7 offset:20488
 v_mfma_f32_16x16x32_bf16 v[148:151], v[32:35], a[148:151], v[148:151]
 ds_read_b64_tr_b16 v[46:47], v7 offset:21000
 v_mfma_f32_16x16x32_bf16 v[152:155], v[24:27], a[120:123], v[152:155]
 v_rcp_f32 v20, v20
 v_mfma_f32_16x16x32_bf16 v[152:155], v[28:31], a[136:139], v[152:155]
 s_add_u32 m0, s70, 135168
 v_rcp_f32 v21, v21
 v_mfma_f32_16x16x32_bf16 v[152:155], v[32:35], a[152:155], v[152:155]
 s_add_u32 s58, s83, 524416
 buffer_load_dwordx4 v5, s[20:23], s58 offen nt lds
 v_mfma_f32_16x16x32_bf16 v[156:159], v[24:27], a[124:127], v[156:159]
 v_rcp_f32 v22, v22
 v_mfma_f32_16x16x32_bf16 v[156:159], v[28:31], a[140:143], v[156:159]
 v_rcp_f32 v23, v23
 v_mfma_f32_16x16x32_bf16 v[156:159], v[32:35], a[156:159], v[156:159]
 s_waitcnt vmcnt(14)
 s_barrier
 s_waitcnt lgkmcnt(4)
 v_mfma_f32_16x16x32_bf16 v[160:163], v[36:39], a[112:115], v[160:163]
 s_waitcnt lgkmcnt(2)
 ds_read_b64_tr_b16 v[24:25], v6 offset:24576
 v_mul_f32 v200, v200, v20
 v_mfma_f32_16x16x32_bf16 v[160:163], v[40:43], a[128:131], v[160:163]
 s_waitcnt lgkmcnt(1)
 ds_read_b64_tr_b16 v[26:27], v6 offset:25088
 v_mul_f32 v201, v201, v21
 v_mfma_f32_16x16x32_bf16 v[160:163], v[44:47], a[144:147], v[160:163]
 ds_read_b64_tr_b16 v[28:29], v6 offset:28672
 v_mul_f32 v202, v202, v22
 v_mfma_f32_16x16x32_bf16 v[164:167], v[36:39], a[116:119], v[164:167]
 ds_read_b64_tr_b16 v[30:31], v6 offset:29184
 v_mul_f32 v203, v203, v23
 v_mfma_f32_16x16x32_bf16 v[164:167], v[40:43], a[132:135], v[164:167]
 ds_read_b64_tr_b16 v[32:33], v6 offset:32768
 v_mul_f32 v200, v200, v232
 v_mfma_f32_16x16x32_bf16 v[164:167], v[44:47], a[148:151], v[164:167]
 ds_read_b64_tr_b16 v[34:35], v6 offset:33280
 v_mul_f32 v201, v201, v233
 v_mfma_f32_16x16x32_bf16 v[168:171], v[36:39], a[120:123], v[168:171]
 v_mul_f32 v202, v202, v234
 v_mul_f32 v203, v203, v235
 v_mfma_f32_16x16x32_bf16 v[168:171], v[40:43], a[136:139], v[168:171]
 v_cvt_pk_bf16_f32 v186, v200, v201
 v_mul_f32 v16, s74, v188
 v_mfma_f32_16x16x32_bf16 v[168:171], v[44:47], a[152:155], v[168:171]
 v_cvt_pk_bf16_f32 v187, v202, v203
 v_mul_f32 v17, s74, v189
 v_mfma_f32_16x16x32_bf16 v[172:175], v[36:39], a[124:127], v[172:175]
 v_exp_f32 v16, v16
 v_mfma_f32_16x16x32_bf16 v[172:175], v[40:43], a[140:143], v[172:175]
 buffer_store_dwordx4 v[184:187], v2, s[32:35], s68 offen offset:2048 sc1
 v_mfma_f32_16x16x32_bf16 v[172:175], v[44:47], a[156:159], v[172:175]
 s_waitcnt lgkmcnt(4)
 v_exp_f32 v17, v17
 v_mfma_f32_16x16x32_bf16 v[112:115], v[24:27], a[160:163], v[112:115]
 s_waitcnt lgkmcnt(2)
 ds_read_b64_tr_b16 v[36:37], v6 offset:24584
 v_mul_f32 v18, s74, v190
 v_mfma_f32_16x16x32_bf16 v[112:115], v[28:31], a[176:179], v[112:115]
 s_waitcnt lgkmcnt(1)
 ds_read_b64_tr_b16 v[38:39], v6 offset:25096
 v_mul_f32 v19, s74, v191
 v_mfma_f32_16x16x32_bf16 v[112:115], v[32:35], a[192:195], v[112:115]
 ds_read_b64_tr_b16 v[40:41], v6 offset:28680
 v_add_f32 v16, 1.0, v16
 v_mfma_f32_16x16x32_bf16 v[116:119], v[24:27], a[164:167], v[116:119]
 ds_read_b64_tr_b16 v[42:43], v6 offset:29192
 v_add_f32 v17, 1.0, v17
 v_mfma_f32_16x16x32_bf16 v[116:119], v[28:31], a[180:183], v[116:119]
 ds_read_b64_tr_b16 v[44:45], v6 offset:32776
 v_mfma_f32_16x16x32_bf16 v[116:119], v[32:35], a[196:199], v[116:119]
 ds_read_b64_tr_b16 v[46:47], v6 offset:33288
 v_mfma_f32_16x16x32_bf16 v[120:123], v[24:27], a[168:171], v[120:123]
 s_add_u32 m0, s70, 139264
 v_exp_f32 v18, v18
 v_mfma_f32_16x16x32_bf16 v[120:123], v[28:31], a[184:187], v[120:123]
 s_add_u32 s58, s84, 128
 buffer_load_dwordx4 v5, s[20:23], s58 offen nt lds
 v_mfma_f32_16x16x32_bf16 v[120:123], v[32:35], a[200:203], v[120:123]
 s_add_u32 m0, s70, 143360
 v_exp_f32 v19, v19
 v_mfma_f32_16x16x32_bf16 v[124:127], v[24:27], a[172:175], v[124:127]
 s_add_u32 s58, s84, 262272
 buffer_load_dwordx4 v5, s[20:23], s58 offen nt lds
 v_mfma_f32_16x16x32_bf16 v[124:127], v[28:31], a[188:191], v[124:127]
 v_rcp_f32 v16, v16
 v_mfma_f32_16x16x32_bf16 v[124:127], v[32:35], a[204:207], v[124:127]
 s_waitcnt lgkmcnt(4)
 v_rcp_f32 v17, v17
 v_mfma_f32_16x16x32_bf16 v[128:131], v[36:39], a[160:163], v[128:131]
 s_waitcnt lgkmcnt(2)
 ds_read_b64_tr_b16 v[24:25], v7 offset:24576
 v_add_f32 v18, 1.0, v18
 v_mfma_f32_16x16x32_bf16 v[128:131], v[40:43], a[176:179], v[128:131]
 s_waitcnt lgkmcnt(1)
 ds_read_b64_tr_b16 v[26:27], v7 offset:25088
 v_add_f32 v19, 1.0, v19
 v_mfma_f32_16x16x32_bf16 v[128:131], v[44:47], a[192:195], v[128:131]
 ds_read_b64_tr_b16 v[28:29], v7 offset:28672
 v_mul_f32 v188, v188, v16
 v_mfma_f32_16x16x32_bf16 v[132:135], v[36:39], a[164:167], v[132:135]
 ds_read_b64_tr_b16 v[30:31], v7 offset:29184
 v_mul_f32 v189, v189, v17
 v_mfma_f32_16x16x32_bf16 v[132:135], v[40:43], a[180:183], v[132:135]
 ds_read_b64_tr_b16 v[32:33], v7 offset:32768
 v_mul_f32 v188, v188, v220
 v_mfma_f32_16x16x32_bf16 v[132:135], v[44:47], a[196:199], v[132:135]
 s_add_u32 m0, s70, 147456
 ds_read_b64_tr_b16 v[34:35], v7 offset:33280
 v_mul_f32 v189, v189, v221
 v_mfma_f32_16x16x32_bf16 v[136:139], v[36:39], a[168:171], v[136:139]
 s_add_u32 s58, s84, 524416
 buffer_load_dwordx4 v5, s[20:23], s58 offen nt lds
 v_mfma_f32_16x16x32_bf16 v[136:139], v[40:43], a[184:187], v[136:139]
 s_add_u32 m0, s72, 0
 v_rcp_f32 v18, v18
 v_mfma_f32_16x16x32_bf16 v[136:139], v[44:47], a[200:203], v[136:139]
 s_mov_b32 s58, 0
 buffer_load_dwordx4 v240, s[24:27], s58 offen offset:0 nt lds
 v_mfma_f32_16x16x32_bf16 v[140:143], v[36:39], a[172:175], v[140:143]
 v_rcp_f32 v19, v19
 v_mfma_f32_16x16x32_bf16 v[140:143], v[40:43], a[188:191], v[140:143]
 buffer_load_dwordx4 v241, s[24:27], s58 offen offset:1024 nt lds
 v_mfma_f32_16x16x32_bf16 v[140:143], v[44:47], a[204:207], v[140:143]
 s_waitcnt lgkmcnt(4)
 v_mul_f32 v190, v190, v18
 v_mul_f32 v191, v191, v19
 v_mfma_f32_16x16x32_bf16 v[144:147], v[24:27], a[160:163], v[144:147]
 s_waitcnt lgkmcnt(2)
 ds_read_b64_tr_b16 v[36:37], v7 offset:24584
 v_cvt_pk_bf16_f32 v188, v188, v189
 v_mfma_f32_16x16x32_bf16 v[144:147], v[28:31], a[176:179], v[144:147]
 s_waitcnt lgkmcnt(1)
 ds_read_b64_tr_b16 v[38:39], v7 offset:25096
 v_mul_f32 v190, v190, v222
 v_mfma_f32_16x16x32_bf16 v[144:147], v[32:35], a[192:195], v[144:147]
 ds_read_b64_tr_b16 v[40:41], v7 offset:28680
 v_mul_f32 v191, v191, v223
 v_mfma_f32_16x16x32_bf16 v[148:151], v[24:27], a[164:167], v[148:151]
 ds_read_b64_tr_b16 v[42:43], v7 offset:29192
 v_mul_f32 v20, s74, v204
 v_mfma_f32_16x16x32_bf16 v[148:151], v[28:31], a[180:183], v[148:151]
 ds_read_b64_tr_b16 v[44:45], v7 offset:32776
 v_cvt_pk_bf16_f32 v189, v190, v191
 v_mfma_f32_16x16x32_bf16 v[148:151], v[32:35], a[196:199], v[148:151]
 ds_read_b64_tr_b16 v[46:47], v7 offset:33288
 v_mul_f32 v21, s74, v205
 v_mfma_f32_16x16x32_bf16 v[152:155], v[24:27], a[168:171], v[152:155]
 v_exp_f32 v20, v20
 v_mfma_f32_16x16x32_bf16 v[152:155], v[28:31], a[184:187], v[152:155]
 buffer_load_dwordx4 v242, s[24:27], s58 offen offset:2048 nt lds
 v_mfma_f32_16x16x32_bf16 v[152:155], v[32:35], a[200:203], v[152:155]
 v_exp_f32 v21, v21
 v_mfma_f32_16x16x32_bf16 v[156:159], v[24:27], a[172:175], v[156:159]
 buffer_load_dwordx4 v243, s[24:27], s58 offen offset:3072 nt lds
 v_mfma_f32_16x16x32_bf16 v[156:159], v[28:31], a[188:191], v[156:159]
 v_mul_f32 v22, s74, v206
 v_mul_f32 v23, s74, v207
 v_mfma_f32_16x16x32_bf16 v[156:159], v[32:35], a[204:207], v[156:159]
 s_waitcnt lgkmcnt(4)
 v_add_f32 v20, 1.0, v20
 v_add_f32 v21, 1.0, v21
 v_mfma_f32_16x16x32_bf16 v[160:163], v[36:39], a[160:163], v[160:163]
 s_waitcnt lgkmcnt(2)
 ds_read_b64_tr_b16 v[24:25], v6 offset:36864
 v_mfma_f32_16x16x32_bf16 v[160:163], v[40:43], a[176:179], v[160:163]
 s_waitcnt lgkmcnt(1)
 ds_read_b64_tr_b16 v[26:27], v6 offset:37376
 v_mfma_f32_16x16x32_bf16 v[160:163], v[44:47], a[192:195], v[160:163]
 ds_read_b64_tr_b16 v[28:29], v6 offset:40960
 v_mfma_f32_16x16x32_bf16 v[164:167], v[36:39], a[164:167], v[164:167]
 ds_read_b64_tr_b16 v[30:31], v6 offset:41472
 v_mfma_f32_16x16x32_bf16 v[164:167], v[40:43], a[180:183], v[164:167]
 ds_read_b64_tr_b16 v[32:33], v6 offset:45056
 v_mfma_f32_16x16x32_bf16 v[164:167], v[44:47], a[196:199], v[164:167]
 ds_read_b64_tr_b16 v[34:35], v6 offset:45568
 v_mfma_f32_16x16x32_bf16 v[168:171], v[36:39], a[168:171], v[168:171]
 v_exp_f32 v22, v22
 v_mfma_f32_16x16x32_bf16 v[168:171], v[40:43], a[184:187], v[168:171]
 v_exp_f32 v23, v23
 v_mfma_f32_16x16x32_bf16 v[168:171], v[44:47], a[200:203], v[168:171]
 v_rcp_f32 v20, v20
 v_mfma_f32_16x16x32_bf16 v[172:175], v[36:39], a[172:175], v[172:175]
 v_rcp_f32 v21, v21
 v_mfma_f32_16x16x32_bf16 v[172:175], v[40:43], a[188:191], v[172:175]
 v_add_f32 v22, 1.0, v22
 v_add_f32 v23, 1.0, v23
 v_mfma_f32_16x16x32_bf16 v[172:175], v[44:47], a[204:207], v[172:175]
 s_waitcnt lgkmcnt(4)
 v_mul_f32 v204, v204, v20
 v_mul_f32 v205, v205, v21
 v_mfma_f32_16x16x32_bf16 v[112:115], v[24:27], a[208:211], v[112:115]
 s_waitcnt lgkmcnt(2)
 ds_read_b64_tr_b16 v[36:37], v6 offset:36872
 v_mfma_f32_16x16x32_bf16 v[112:115], v[28:31], a[224:227], v[112:115]
 s_waitcnt lgkmcnt(1)
 ds_read_b64_tr_b16 v[38:39], v6 offset:37384
 v_mul_f32 v204, v204, v236
 v_mfma_f32_16x16x32_bf16 v[112:115], v[32:35], a[240:243], v[112:115]
 ds_read_b64_tr_b16 v[40:41], v6 offset:40968
 v_mul_f32 v205, v205, v237
 v_mfma_f32_16x16x32_bf16 v[116:119], v[24:27], a[212:215], v[116:119]
 ds_read_b64_tr_b16 v[42:43], v6 offset:41480
 v_mfma_f32_16x16x32_bf16 v[116:119], v[28:31], a[228:231], v[116:119]
 ds_read_b64_tr_b16 v[44:45], v6 offset:45064
 v_cvt_pk_bf16_f32 v190, v204, v205
 v_mfma_f32_16x16x32_bf16 v[116:119], v[32:35], a[244:247], v[116:119]
 ds_read_b64_tr_b16 v[46:47], v6 offset:45576
 v_mfma_f32_16x16x32_bf16 v[120:123], v[24:27], a[216:219], v[120:123]
 s_add_u32 m0, s70, 151552
 v_rcp_f32 v22, v22
 v_mfma_f32_16x16x32_bf16 v[120:123], v[28:31], a[232:235], v[120:123]
 s_add_u32 s58, s85, 128
 buffer_load_dwordx4 v5, s[20:23], s58 offen nt lds
 v_mfma_f32_16x16x32_bf16 v[120:123], v[32:35], a[248:251], v[120:123]
 s_add_u32 m0, s70, 155648
 v_rcp_f32 v23, v23
 v_mfma_f32_16x16x32_bf16 v[124:127], v[24:27], a[220:223], v[124:127]
 s_add_u32 s58, s85, 262272
 buffer_load_dwordx4 v5, s[20:23], s58 offen nt lds
 v_mfma_f32_16x16x32_bf16 v[124:127], v[28:31], a[236:239], v[124:127]
 v_mul_f32 v206, v206, v22
 v_mul_f32 v207, v207, v23
 v_mfma_f32_16x16x32_bf16 v[124:127], v[32:35], a[252:255], v[124:127]
 s_waitcnt lgkmcnt(4)
 v_mfma_f32_16x16x32_bf16 v[128:131], v[36:39], a[208:211], v[128:131]
 s_waitcnt lgkmcnt(2)
 ds_read_b64_tr_b16 v[24:25], v7 offset:36864
 v_mul_f32 v206, v206, v238
 v_mfma_f32_16x16x32_bf16 v[128:131], v[40:43], a[224:227], v[128:131]
 s_waitcnt lgkmcnt(1)
 ds_read_b64_tr_b16 v[26:27], v7 offset:37376
 v_mul_f32 v207, v207, v239
 v_mfma_f32_16x16x32_bf16 v[128:131], v[44:47], a[240:243], v[128:131]
 ds_read_b64_tr_b16 v[28:29], v7 offset:40960
 v_mfma_f32_16x16x32_bf16 v[132:135], v[36:39], a[212:215], v[132:135]
 ds_read_b64_tr_b16 v[30:31], v7 offset:41472
 v_cvt_pk_bf16_f32 v191, v206, v207
 v_mfma_f32_16x16x32_bf16 v[132:135], v[40:43], a[228:231], v[132:135]
 ds_read_b64_tr_b16 v[32:33], v7 offset:45056
 v_mfma_f32_16x16x32_bf16 v[132:135], v[44:47], a[244:247], v[132:135]
 s_add_u32 m0, s70, 159744
 ds_read_b64_tr_b16 v[34:35], v7 offset:45568
 v_mfma_f32_16x16x32_bf16 v[136:139], v[36:39], a[216:219], v[136:139]
 s_add_u32 s58, s85, 524416
 buffer_load_dwordx4 v5, s[20:23], s58 offen nt lds
 v_mfma_f32_16x16x32_bf16 v[136:139], v[40:43], a[232:235], v[136:139]
 s_add_u32 m0, s72, 16384
 buffer_store_dwordx4 v[188:191], v2, s[32:35], s68 offen offset:3072 sc1
 v_mfma_f32_16x16x32_bf16 v[136:139], v[44:47], a[248:251], v[136:139]
 s_mov_b32 s58, 16384
 buffer_load_dwordx4 v240, s[24:27], s58 offen offset:0 nt lds
 v_mfma_f32_16x16x32_bf16 v[140:143], v[36:39], a[220:223], v[140:143]
 v_mfma_f32_16x16x32_bf16 v[140:143], v[40:43], a[236:239], v[140:143]
 buffer_load_dwordx4 v241, s[24:27], s58 offen offset:1024 nt lds
 v_mfma_f32_16x16x32_bf16 v[140:143], v[44:47], a[252:255], v[140:143]
 s_waitcnt lgkmcnt(4)
 v_mfma_f32_16x16x32_bf16 v[144:147], v[24:27], a[208:211], v[144:147]
 s_waitcnt lgkmcnt(2)
 ds_read_b64_tr_b16 v[36:37], v7 offset:36872
 v_mfma_f32_16x16x32_bf16 v[144:147], v[28:31], a[224:227], v[144:147]
 s_waitcnt lgkmcnt(1)
 ds_read_b64_tr_b16 v[38:39], v7 offset:37384
 v_mfma_f32_16x16x32_bf16 v[144:147], v[32:35], a[240:243], v[144:147]
 ds_read_b64_tr_b16 v[40:41], v7 offset:40968
 v_mfma_f32_16x16x32_bf16 v[148:151], v[24:27], a[212:215], v[148:151]
 ds_read_b64_tr_b16 v[42:43], v7 offset:41480
 v_mfma_f32_16x16x32_bf16 v[148:151], v[28:31], a[228:231], v[148:151]
 ds_read_b64_tr_b16 v[44:45], v7 offset:45064
 v_mfma_f32_16x16x32_bf16 v[148:151], v[32:35], a[244:247], v[148:151]
 ds_read_b64_tr_b16 v[46:47], v7 offset:45576
 v_mfma_f32_16x16x32_bf16 v[152:155], v[24:27], a[216:219], v[152:155]
 v_mfma_f32_16x16x32_bf16 v[152:155], v[28:31], a[232:235], v[152:155]
 buffer_load_dwordx4 v242, s[24:27], s58 offen offset:2048 nt lds
 v_mfma_f32_16x16x32_bf16 v[152:155], v[32:35], a[248:251], v[152:155]
 v_mfma_f32_16x16x32_bf16 v[156:159], v[24:27], a[220:223], v[156:159]
 buffer_load_dwordx4 v243, s[24:27], s58 offen offset:3072 nt lds
 v_mfma_f32_16x16x32_bf16 v[156:159], v[28:31], a[236:239], v[156:159]
 v_mfma_f32_16x16x32_bf16 v[156:159], v[32:35], a[252:255], v[156:159]
 s_waitcnt vmcnt(24)
 s_barrier
 s_waitcnt lgkmcnt(4)
 v_mfma_f32_16x16x32_bf16 v[160:163], v[36:39], a[208:211], v[160:163]
 s_waitcnt lgkmcnt(2)
 ds_read_b64_tr_b16 v[24:25], v6 offset:49152
 v_mfma_f32_16x16x32_bf16 v[160:163], v[40:43], a[224:227], v[160:163]
 s_waitcnt lgkmcnt(1)
 ds_read_b64_tr_b16 v[26:27], v6 offset:49664
 v_mfma_f32_16x16x32_bf16 v[160:163], v[44:47], a[240:243], v[160:163]
 ds_read_b64_tr_b16 v[28:29], v6 offset:53248
 v_mfma_f32_16x16x32_bf16 v[164:167], v[36:39], a[212:215], v[164:167]
 ds_read_b64_tr_b16 v[30:31], v6 offset:53760
 v_mfma_f32_16x16x32_bf16 v[164:167], v[40:43], a[228:231], v[164:167]
 ds_read_b64_tr_b16 v[32:33], v6 offset:57344
 v_mfma_f32_16x16x32_bf16 v[164:167], v[44:47], a[244:247], v[164:167]
 ds_read_b64_tr_b16 v[34:35], v6 offset:57856
 v_mfma_f32_16x16x32_bf16 v[168:171], v[36:39], a[216:219], v[168:171]
 v_mfma_f32_16x16x32_bf16 v[168:171], v[40:43], a[232:235], v[168:171]
 v_mfma_f32_16x16x32_bf16 v[168:171], v[44:47], a[248:251], v[168:171]
 v_mfma_f32_16x16x32_bf16 v[172:175], v[36:39], a[220:223], v[172:175]
 v_mfma_f32_16x16x32_bf16 v[172:175], v[40:43], a[236:239], v[172:175]
 v_mfma_f32_16x16x32_bf16 v[172:175], v[44:47], a[252:255], v[172:175]
 s_waitcnt lgkmcnt(4)
 v_mfma_f32_16x16x32_bf16 v[176:179], v[24:27], v[48:51], 0
 s_waitcnt lgkmcnt(2)
 ds_read_b64_tr_b16 v[36:37], v6 offset:49160
 v_mfma_f32_16x16x32_bf16 v[176:179], v[28:31], v[64:67], v[176:179]
 s_waitcnt lgkmcnt(1)
 ds_read_b64_tr_b16 v[38:39], v6 offset:49672
 v_mfma_f32_16x16x32_bf16 v[176:179], v[32:35], a[0:3], v[176:179]
 ds_read_b64_tr_b16 v[40:41], v6 offset:53256
 v_lshrrev_b32 v13, 4, v1
 v_mfma_f32_16x16x32_bf16 v[180:183], v[24:27], v[52:55], 0
 ds_read_b64_tr_b16 v[42:43], v6 offset:53768
 v_and_b32 v14, 15, v1
 v_mfma_f32_16x16x32_bf16 v[180:183], v[28:31], v[68:71], v[180:183]
 ds_read_b64_tr_b16 v[44:45], v6 offset:57352
 v_mul_f32 v112, s75, v112
 v_mfma_f32_16x16x32_bf16 v[180:183], v[32:35], a[4:7], v[180:183]
 ds_read_b64_tr_b16 v[46:47], v6 offset:57864
 v_lshlrev_b32 v15, 8, v14
 v_mfma_f32_16x16x32_bf16 v[184:187], v[24:27], v[56:59], 0
 v_xor_b32 v14, v13, v14
 v_lshrrev_b32 v13, 2, v1
 v_mfma_f32_16x16x32_bf16 v[184:187], v[28:31], v[72:75], v[184:187]
 s_add_u32 m0, s72, 32768
 v_mul_f32 v113, s75, v113
 v_mul_f32 v114, s75, v114
 v_mfma_f32_16x16x32_bf16 v[184:187], v[32:35], a[8:11], v[184:187]
 s_mov_b32 s58, 32768
 buffer_load_dwordx4 v240, s[24:27], s58 offen offset:0 nt lds
 v_mfma_f32_16x16x32_bf16 v[188:191], v[24:27], v[60:63], 0
 v_xor_b32 v246, 0, v14
 v_xor_b32 v247, 4, v14
 v_mfma_f32_16x16x32_bf16 v[188:191], v[28:31], v[76:79], v[188:191]
 v_xor_b32 v248, 8, v14
 v_xor_b32 v249, 12, v14
 v_mfma_f32_16x16x32_bf16 v[188:191], v[32:35], a[12:15], v[188:191]
 s_waitcnt lgkmcnt(4)
 v_lshl_add_u32 v246, v246, 4, v15
 v_lshl_add_u32 v247, v247, 4, v15
 v_mfma_f32_16x16x32_bf16 v[192:195], v[36:39], v[48:51], 0
 s_waitcnt lgkmcnt(2)
 ds_read_b64_tr_b16 v[24:25], v7 offset:49152
 v_lshl_add_u32 v248, v248, 4, v15
 v_mfma_f32_16x16x32_bf16 v[192:195], v[40:43], v[64:67], v[192:195]
 s_waitcnt lgkmcnt(1)
 ds_read_b64_tr_b16 v[26:27], v7 offset:49664
 v_lshl_add_u32 v249, v249, 4, v15
 v_mfma_f32_16x16x32_bf16 v[192:195], v[44:47], a[0:3], v[192:195]
 ds_read_b64_tr_b16 v[28:29], v7 offset:53248
 v_and_b32 v14, 3, v1
 v_mfma_f32_16x16x32_bf16 v[196:199], v[36:39], v[52:55], 0
 ds_read_b64_tr_b16 v[30:31], v7 offset:53760
 v_mul_f32 v115, s75, v115
 v_mfma_f32_16x16x32_bf16 v[196:199], v[40:43], v[68:71], v[196:199]
 ds_read_b64_tr_b16 v[32:33], v7 offset:57344
 v_lshlrev_b32 v14, 3, v14
 v_mfma_f32_16x16x32_bf16 v[196:199], v[44:47], a[4:7], v[196:199]
 ds_read_b64_tr_b16 v[34:35], v7 offset:57856
 v_cvt_pk_bf16_f32 v80, v112, v113
 v_mfma_f32_16x16x32_bf16 v[200:203], v[36:39], v[56:59], 0
 buffer_load_dwordx4 v241, s[24:27], s58 offen offset:1024 nt lds
 v_mfma_f32_16x16x32_bf16 v[200:203], v[40:43], v[72:75], v[200:203]
 v_lshl_add_u32 v15, v13, 8, v14
 v_and_b32 v13, 7, v13
 v_mfma_f32_16x16x32_bf16 v[200:203], v[44:47], a[8:11], v[200:203]
 v_cvt_pk_bf16_f32 v81, v114, v115
 v_mul_f32 v116, s75, v116
 v_mfma_f32_16x16x32_bf16 v[204:207], v[36:39], v[60:63], 0
 v_add_u32 v15, 65536, v15
 v_xor_b32 v16, 0, v13
 v_mfma_f32_16x16x32_bf16 v[204:207], v[40:43], v[76:79], v[204:207]
 buffer_load_dwordx4 v242, s[24:27], s58 offen offset:2048 nt lds
 v_mfma_f32_16x16x32_bf16 v[204:207], v[44:47], a[12:15], v[204:207]
 s_waitcnt lgkmcnt(4)
 v_lshl_add_u32 v16, v16, 5, v15
 v_xor_b32 v17, 1, v13
 v_mfma_f32_16x16x32_bf16 v[208:211], v[24:27], v[48:51], 0
 s_waitcnt lgkmcnt(2)
 ds_read_b64_tr_b16 v[36:37], v7 offset:49160
 v_xor_b32 v18, 2, v13
 v_mfma_f32_16x16x32_bf16 v[208:211], v[28:31], v[64:67], v[208:211]
 s_waitcnt lgkmcnt(1)
 ds_read_b64_tr_b16 v[38:39], v7 offset:49672
 v_lshl_add_u32 v17, v17, 5, v15
 v_mfma_f32_16x16x32_bf16 v[208:211], v[32:35], a[0:3], v[208:211]
 ds_read_b64_tr_b16 v[40:41], v7 offset:53256
 v_lshl_add_u32 v18, v18, 5, v15
 v_mfma_f32_16x16x32_bf16 v[212:215], v[24:27], v[52:55], 0
 ds_read_b64_tr_b16 v[42:43], v7 offset:53768
 v_xor_b32 v19, 3, v13
 v_mfma_f32_16x16x32_bf16 v[212:215], v[28:31], v[68:71], v[212:215]
 ds_read_b64_tr_b16 v[44:45], v7 offset:57352
 v_xor_b32 v20, 4, v13
 v_mfma_f32_16x16x32_bf16 v[212:215], v[32:35], a[4:7], v[212:215]
 ds_read_b64_tr_b16 v[46:47], v7 offset:57864
 v_lshl_add_u32 v19, v19, 5, v15
 v_mfma_f32_16x16x32_bf16 v[216:219], v[24:27], v[56:59], 0
 v_add_u32 v6, 0xc000, v6
 v_add_u32 v7, 0xc000, v7
 v_mfma_f32_16x16x32_bf16 v[216:219], v[28:31], v[72:75], v[216:219]
 v_lshl_add_u32 v20, v20, 5, v15
 v_xor_b32 v21, 5, v13
 v_mfma_f32_16x16x32_bf16 v[216:219], v[32:35], a[8:11], v[216:219]
 v_xor_b32 v22, 6, v13
 v_xor_b32 v23, 7, v13
 v_mfma_f32_16x16x32_bf16 v[220:223], v[24:27], v[60:63], 0
 buffer_load_dwordx4 v243, s[24:27], s58 offen offset:3072 nt lds
 v_mfma_f32_16x16x32_bf16 v[220:223], v[28:31], v[76:79], v[220:223]
 v_lshl_add_u32 v21, v21, 5, v15
 v_lshl_add_u32 v22, v22, 5, v15
 v_mfma_f32_16x16x32_bf16 v[220:223], v[32:35], a[12:15], v[220:223]
 s_waitcnt lgkmcnt(4)
 v_lshl_add_u32 v23, v23, 5, v15
 v_mul_f32 v117, s75, v117
 v_mfma_f32_16x16x32_bf16 v[224:227], v[36:39], v[48:51], 0
 s_waitcnt lgkmcnt(2)
 ds_read_b64_tr_b16 v[24:25], v6 offset:12288
 v_mul_f32 v118, s75, v118
 v_mfma_f32_16x16x32_bf16 v[224:227], v[40:43], v[64:67], v[224:227]
 s_waitcnt lgkmcnt(1)
 ds_read_b64_tr_b16 v[26:27], v6 offset:12800
 v_mul_f32 v119, s75, v119
 v_mfma_f32_16x16x32_bf16 v[224:227], v[44:47], a[0:3], v[224:227]
 ds_read_b64_tr_b16 v[28:29], v6 offset:16384
 v_cvt_pk_bf16_f32 v84, v116, v117
 v_mfma_f32_16x16x32_bf16 v[228:231], v[36:39], v[52:55], 0
 ds_read_b64_tr_b16 v[30:31], v6 offset:16896
 v_cvt_pk_bf16_f32 v85, v118, v119
 v_mfma_f32_16x16x32_bf16 v[228:231], v[40:43], v[68:71], v[228:231]
 ds_read_b64_tr_b16 v[32:33], v6 offset:20480
 v_mul_f32 v120, s75, v120
 v_mfma_f32_16x16x32_bf16 v[228:231], v[44:47], a[4:7], v[228:231]
 ds_read_b64_tr_b16 v[34:35], v6 offset:20992
 v_mul_f32 v121, s75, v121
 v_mfma_f32_16x16x32_bf16 v[232:235], v[36:39], v[56:59], 0
 v_mul_f32 v122, s75, v122
 v_mul_f32 v123, s75, v123
 v_mfma_f32_16x16x32_bf16 v[232:235], v[40:43], v[72:75], v[232:235]
 v_cvt_pk_bf16_f32 v88, v120, v121
 v_mul_f32 v124, s75, v124
 v_mfma_f32_16x16x32_bf16 v[232:235], v[44:47], a[8:11], v[232:235]
 v_cvt_pk_bf16_f32 v89, v122, v123
 v_mul_f32 v125, s75, v125
 v_mfma_f32_16x16x32_bf16 v[236:239], v[36:39], v[60:63], 0
 v_mul_f32 v126, s75, v126
 v_mul_f32 v127, s75, v127
 v_mfma_f32_16x16x32_bf16 v[236:239], v[40:43], v[76:79], v[236:239]
 v_cvt_pk_bf16_f32 v92, v124, v125
 v_mul_f32 v128, s75, v128
 v_mfma_f32_16x16x32_bf16 v[236:239], v[44:47], a[12:15], v[236:239]
 s_waitcnt lgkmcnt(4)
 v_cvt_pk_bf16_f32 v93, v126, v127
 v_mul_f32 v129, s75, v129
 v_mfma_f32_16x16x32_bf16 v[176:179], v[24:27], a[16:19], v[176:179]
 s_waitcnt lgkmcnt(2)
 ds_read_b64_tr_b16 v[36:37], v6 offset:12296
 v_mul_f32 v130, s75, v130
 v_mfma_f32_16x16x32_bf16 v[176:179], v[28:31], a[32:35], v[176:179]
 s_waitcnt lgkmcnt(1)
 ds_read_b64_tr_b16 v[38:39], v6 offset:12808
 v_mul_f32 v131, s75, v131
 v_mfma_f32_16x16x32_bf16 v[176:179], v[32:35], a[48:51], v[176:179]
 ds_read_b64_tr_b16 v[40:41], v6 offset:16392
 v_cvt_pk_bf16_f32 v82, v128, v129
 v_mfma_f32_16x16x32_bf16 v[180:183], v[24:27], a[20:23], v[180:183]
 ds_read_b64_tr_b16 v[42:43], v6 offset:16904
 v_cvt_pk_bf16_f32 v83, v130, v131
 v_mfma_f32_16x16x32_bf16 v[180:183], v[28:31], a[36:39], v[180:183]
 ds_read_b64_tr_b16 v[44:45], v6 offset:20488
 v_mul_f32 v132, s75, v132
 v_mfma_f32_16x16x32_bf16 v[180:183], v[32:35], a[52:55], v[180:183]
 ds_read_b64_tr_b16 v[46:47], v6 offset:21000
 v_mul_f32 v133, s75, v133
 v_mfma_f32_16x16x32_bf16 v[184:187], v[24:27], a[24:27], v[184:187]
 v_mul_f32 v134, s75, v134
 v_mul_f32 v135, s75, v135
 v_mfma_f32_16x16x32_bf16 v[184:187], v[28:31], a[40:43], v[184:187]
 s_add_u32 m0, s72, 49152
 v_cvt_pk_bf16_f32 v86, v132, v133
 v_mul_f32 v136, s75, v136
 v_mfma_f32_16x16x32_bf16 v[184:187], v[32:35], a[56:59], v[184:187]
 s_mov_b32 s58, 49152
 buffer_load_dwordx4 v240, s[24:27], s58 offen offset:0 nt lds
 v_mfma_f32_16x16x32_bf16 v[188:191], v[24:27], a[28:31], v[188:191]
 v_cvt_pk_bf16_f32 v87, v134, v135
 v_mul_f32 v137, s75, v137
 v_mfma_f32_16x16x32_bf16 v[188:191], v[28:31], a[44:47], v[188:191]
 v_mul_f32 v138, s75, v138
 v_mul_f32 v139, s75, v139
 v_mfma_f32_16x16x32_bf16 v[188:191], v[32:35], a[60:63], v[188:191]
 s_waitcnt lgkmcnt(4)
 v_cvt_pk_bf16_f32 v90, v136, v137
 v_mul_f32 v140, s75, v140
 v_mfma_f32_16x16x32_bf16 v[192:195], v[36:39], a[16:19], v[192:195]
 s_waitcnt lgkmcnt(2)
 ds_read_b64_tr_b16 v[24:25], v7 offset:12288
 v_cvt_pk_bf16_f32 v91, v138, v139
 v_mfma_f32_16x16x32_bf16 v[192:195], v[40:43], a[32:35], v[192:195]
 s_waitcnt lgkmcnt(1)
 ds_read_b64_tr_b16 v[26:27], v7 offset:12800
 v_mul_f32 v141, s75, v141
 v_mfma_f32_16x16x32_bf16 v[192:195], v[44:47], a[48:51], v[192:195]
 ds_read_b64_tr_b16 v[28:29], v7 offset:16384
 v_mul_f32 v142, s75, v142
 v_mfma_f32_16x16x32_bf16 v[196:199], v[36:39], a[20:23], v[196:199]
 ds_read_b64_tr_b16 v[30:31], v7 offset:16896
 v_mul_f32 v143, s75, v143
 v_mfma_f32_16x16x32_bf16 v[196:199], v[40:43], a[36:39], v[196:199]
 ds_read_b64_tr_b16 v[32:33], v7 offset:20480
 v_cvt_pk_bf16_f32 v94, v140, v141
 v_mfma_f32_16x16x32_bf16 v[196:199], v[44:47], a[52:55], v[196:199]
 ds_read_b64_tr_b16 v[34:35], v7 offset:20992
 v_cvt_pk_bf16_f32 v95, v142, v143
 v_mfma_f32_16x16x32_bf16 v[200:203], v[36:39], a[24:27], v[200:203]
 buffer_load_dwordx4 v241, s[24:27], s58 offen offset:1024 nt lds
 v_mfma_f32_16x16x32_bf16 v[200:203], v[40:43], a[40:43], v[200:203]
 v_mul_f32 v144, s75, v144
 v_mul_f32 v145, s75, v145
 v_mfma_f32_16x16x32_bf16 v[200:203], v[44:47], a[56:59], v[200:203]
 v_mul_f32 v146, s75, v146
 v_mul_f32 v147, s75, v147
 v_mfma_f32_16x16x32_bf16 v[204:207], v[36:39], a[28:31], v[204:207]
 v_cvt_pk_bf16_f32 v96, v144, v145
 v_mul_f32 v148, s75, v148
 v_mfma_f32_16x16x32_bf16 v[204:207], v[40:43], a[44:47], v[204:207]
 buffer_load_dwordx4 v242, s[24:27], s58 offen offset:2048 nt lds
 v_mfma_f32_16x16x32_bf16 v[204:207], v[44:47], a[60:63], v[204:207]
 s_waitcnt lgkmcnt(4)
 v_cvt_pk_bf16_f32 v97, v146, v147
 v_mul_f32 v149, s75, v149
 v_mfma_f32_16x16x32_bf16 v[208:211], v[24:27], a[16:19], v[208:211]
 s_waitcnt lgkmcnt(2)
 ds_read_b64_tr_b16 v[36:37], v7 offset:12296
 v_mul_f32 v150, s75, v150
 v_mfma_f32_16x16x32_bf16 v[208:211], v[28:31], a[32:35], v[208:211]
 s_waitcnt lgkmcnt(1)
 ds_read_b64_tr_b16 v[38:39], v7 offset:12808
 v_mul_f32 v151, s75, v151
 v_mfma_f32_16x16x32_bf16 v[208:211], v[32:35], a[48:51], v[208:211]
 ds_read_b64_tr_b16 v[40:41], v7 offset:16392
 v_cvt_pk_bf16_f32 v100, v148, v149
 v_mfma_f32_16x16x32_bf16 v[212:215], v[24:27], a[20:23], v[212:215]
 ds_read_b64_tr_b16 v[42:43], v7 offset:16904
 v_cvt_pk_bf16_f32 v101, v150, v151
 v_mfma_f32_16x16x32_bf16 v[212:215], v[28:31], a[36:39], v[212:215]
 ds_read_b64_tr_b16 v[44:45], v7 offset:20488
 v_mul_f32 v152, s75, v152
 v_mfma_f32_16x16x32_bf16 v[212:215], v[32:35], a[52:55], v[212:215]
 ds_read_b64_tr_b16 v[46:47], v7 offset:21000
 v_mul_f32 v153, s75, v153
 v_mfma_f32_16x16x32_bf16 v[216:219], v[24:27], a[24:27], v[216:219]
 v_mul_f32 v154, s75, v154
 v_mul_f32 v155, s75, v155
 v_mfma_f32_16x16x32_bf16 v[216:219], v[28:31], a[40:43], v[216:219]
 v_cvt_pk_bf16_f32 v104, v152, v153
 v_mul_f32 v156, s75, v156
 v_mfma_f32_16x16x32_bf16 v[216:219], v[32:35], a[56:59], v[216:219]
 buffer_load_dwordx4 v243, s[24:27], s58 offen offset:3072 nt lds
 v_mfma_f32_16x16x32_bf16 v[220:223], v[24:27], a[28:31], v[220:223]
 v_cvt_pk_bf16_f32 v105, v154, v155
 v_mul_f32 v157, s75, v157
 v_mfma_f32_16x16x32_bf16 v[220:223], v[28:31], a[44:47], v[220:223]
 v_mul_f32 v158, s75, v158
 v_mul_f32 v159, s75, v159
 v_mfma_f32_16x16x32_bf16 v[220:223], v[32:35], a[60:63], v[220:223]
 s_waitcnt vmcnt(24)
 s_barrier
 s_waitcnt lgkmcnt(4)
 v_mfma_f32_16x16x32_bf16 v[224:227], v[36:39], a[16:19], v[224:227]
 s_waitcnt lgkmcnt(2)
 ds_read_b64_tr_b16 v[24:25], v6 offset:24576
 v_cvt_pk_bf16_f32 v108, v156, v157
 v_mfma_f32_16x16x32_bf16 v[224:227], v[40:43], a[32:35], v[224:227]
 s_waitcnt lgkmcnt(1)
 ds_read_b64_tr_b16 v[26:27], v6 offset:25088
 v_cvt_pk_bf16_f32 v109, v158, v159
 v_mfma_f32_16x16x32_bf16 v[224:227], v[44:47], a[48:51], v[224:227]
 ds_read_b64_tr_b16 v[28:29], v6 offset:28672
 v_mul_f32 v160, s75, v160
 v_mfma_f32_16x16x32_bf16 v[228:231], v[36:39], a[20:23], v[228:231]
 ds_read_b64_tr_b16 v[30:31], v6 offset:29184
 v_mul_f32 v161, s75, v161
 v_mfma_f32_16x16x32_bf16 v[228:231], v[40:43], a[36:39], v[228:231]
 ds_read_b64_tr_b16 v[32:33], v6 offset:32768
 v_mul_f32 v162, s75, v162
 v_mfma_f32_16x16x32_bf16 v[228:231], v[44:47], a[52:55], v[228:231]
 ds_read_b64_tr_b16 v[34:35], v6 offset:33280
 v_mul_f32 v163, s75, v163
 v_mfma_f32_16x16x32_bf16 v[232:235], v[36:39], a[24:27], v[232:235]
 v_cvt_pk_bf16_f32 v98, v160, v161
 v_mul_f32 v164, s75, v164
 v_mfma_f32_16x16x32_bf16 v[232:235], v[40:43], a[40:43], v[232:235]
 v_cvt_pk_bf16_f32 v99, v162, v163
 v_mul_f32 v165, s75, v165
 v_mfma_f32_16x16x32_bf16 v[232:235], v[44:47], a[56:59], v[232:235]
 v_mul_f32 v166, s75, v166
 v_mul_f32 v167, s75, v167
 v_mfma_f32_16x16x32_bf16 v[236:239], v[36:39], a[28:31], v[236:239]
 v_cvt_pk_bf16_f32 v102, v164, v165
 v_mul_f32 v168, s75, v168
 v_mfma_f32_16x16x32_bf16 v[236:239], v[40:43], a[44:47], v[236:239]
 v_cvt_pk_bf16_f32 v103, v166, v167
 v_mul_f32 v169, s75, v169
 v_mfma_f32_16x16x32_bf16 v[236:239], v[44:47], a[60:63], v[236:239]
 s_waitcnt lgkmcnt(4)
 v_mul_f32 v170, s75, v170
 v_mul_f32 v171, s75, v171
 v_mfma_f32_16x16x32_bf16 v[176:179], v[24:27], a[64:67], v[176:179]
 s_waitcnt lgkmcnt(2)
 ds_read_b64_tr_b16 v[36:37], v6 offset:24584
 v_cvt_pk_bf16_f32 v106, v168, v169
 v_mfma_f32_16x16x32_bf16 v[176:179], v[28:31], a[80:83], v[176:179]
 s_waitcnt lgkmcnt(1)
 ds_read_b64_tr_b16 v[38:39], v6 offset:25096
 v_cvt_pk_bf16_f32 v107, v170, v171
 v_mfma_f32_16x16x32_bf16 v[176:179], v[32:35], a[96:99], v[176:179]
 ds_read_b64_tr_b16 v[40:41], v6 offset:28680
 v_mul_f32 v172, s75, v172
 v_mfma_f32_16x16x32_bf16 v[180:183], v[24:27], a[68:71], v[180:183]
 ds_read_b64_tr_b16 v[42:43], v6 offset:29192
 v_mul_f32 v173, s75, v173
 v_mfma_f32_16x16x32_bf16 v[180:183], v[28:31], a[84:87], v[180:183]
 ds_read_b64_tr_b16 v[44:45], v6 offset:32776
 v_mul_f32 v174, s75, v174
 v_mfma_f32_16x16x32_bf16 v[180:183], v[32:35], a[100:103], v[180:183]
 ds_read_b64_tr_b16 v[46:47], v6 offset:33288
 v_mul_f32 v175, s75, v175
 v_mfma_f32_16x16x32_bf16 v[184:187], v[24:27], a[72:75], v[184:187]
 v_cvt_pk_bf16_f32 v110, v172, v173
 v_mfma_f32_16x16x32_bf16 v[184:187], v[28:31], a[88:91], v[184:187]
 s_add_u32 m0, s72, 65536
 v_cvt_pk_bf16_f32 v111, v174, v175
 v_mfma_f32_16x16x32_bf16 v[184:187], v[32:35], a[104:107], v[184:187]
 s_mov_b32 s58, 16384
 buffer_load_dwordx4 v244, s[28:31], s58 offen offset:0 nt lds
 v_mfma_f32_16x16x32_bf16 v[188:191], v[24:27], a[76:79], v[188:191]
 v_mfma_f32_16x16x32_bf16 v[188:191], v[28:31], a[92:95], v[188:191]
 v_mfma_f32_16x16x32_bf16 v[188:191], v[32:35], a[108:111], v[188:191]
 s_waitcnt lgkmcnt(4)
 v_mfma_f32_16x16x32_bf16 v[192:195], v[36:39], a[64:67], v[192:195]
 s_waitcnt lgkmcnt(2)
 ds_read_b64_tr_b16 v[24:25], v7 offset:24576
 v_mfma_f32_16x16x32_bf16 v[192:195], v[40:43], a[80:83], v[192:195]
 s_waitcnt lgkmcnt(1)
 ds_read_b64_tr_b16 v[26:27], v7 offset:25088
 v_mfma_f32_16x16x32_bf16 v[192:195], v[44:47], a[96:99], v[192:195]
 ds_read_b64_tr_b16 v[28:29], v7 offset:28672
 v_mfma_f32_16x16x32_bf16 v[196:199], v[36:39], a[68:71], v[196:199]
 ds_read_b64_tr_b16 v[30:31], v7 offset:29184
 v_mfma_f32_16x16x32_bf16 v[196:199], v[40:43], a[84:87], v[196:199]
 ds_read_b64_tr_b16 v[32:33], v7 offset:32768
 v_mfma_f32_16x16x32_bf16 v[196:199], v[44:47], a[100:103], v[196:199]
 ds_read_b64_tr_b16 v[34:35], v7 offset:33280
 v_mfma_f32_16x16x32_bf16 v[200:203], v[36:39], a[72:75], v[200:203]
 buffer_load_dwordx4 v245, s[28:31], s58 offen offset:1024 nt lds
 v_mfma_f32_16x16x32_bf16 v[200:203], v[40:43], a[88:91], v[200:203]
 v_mfma_f32_16x16x32_bf16 v[200:203], v[44:47], a[104:107], v[200:203]
 v_mfma_f32_16x16x32_bf16 v[204:207], v[36:39], a[76:79], v[204:207]
 v_mfma_f32_16x16x32_bf16 v[204:207], v[40:43], a[92:95], v[204:207]
 buffer_load_dwordx4 v244, s[28:31], s58 offen offset:2048 nt lds
 v_mfma_f32_16x16x32_bf16 v[204:207], v[44:47], a[108:111], v[204:207]
 s_waitcnt lgkmcnt(4)
 v_mfma_f32_16x16x32_bf16 v[208:211], v[24:27], a[64:67], v[208:211]
 s_waitcnt lgkmcnt(2)
 ds_read_b64_tr_b16 v[36:37], v7 offset:24584
 v_mfma_f32_16x16x32_bf16 v[208:211], v[28:31], a[80:83], v[208:211]
 s_waitcnt lgkmcnt(1)
 ds_read_b64_tr_b16 v[38:39], v7 offset:25096
 v_mfma_f32_16x16x32_bf16 v[208:211], v[32:35], a[96:99], v[208:211]
 ds_read_b64_tr_b16 v[40:41], v7 offset:28680
 v_mfma_f32_16x16x32_bf16 v[212:215], v[24:27], a[68:71], v[212:215]
 ds_read_b64_tr_b16 v[42:43], v7 offset:29192
 v_mfma_f32_16x16x32_bf16 v[212:215], v[28:31], a[84:87], v[212:215]
 ds_read_b64_tr_b16 v[44:45], v7 offset:32776
 v_mfma_f32_16x16x32_bf16 v[212:215], v[32:35], a[100:103], v[212:215]
 ds_read_b64_tr_b16 v[46:47], v7 offset:33288
 v_mfma_f32_16x16x32_bf16 v[216:219], v[24:27], a[72:75], v[216:219]
 v_mfma_f32_16x16x32_bf16 v[216:219], v[28:31], a[88:91], v[216:219]
 v_mfma_f32_16x16x32_bf16 v[216:219], v[32:35], a[104:107], v[216:219]
 buffer_load_dwordx4 v245, s[28:31], s58 offen offset:3072 nt lds
 v_mfma_f32_16x16x32_bf16 v[220:223], v[24:27], a[76:79], v[220:223]
 v_mfma_f32_16x16x32_bf16 v[220:223], v[28:31], a[92:95], v[220:223]
 v_mfma_f32_16x16x32_bf16 v[220:223], v[32:35], a[108:111], v[220:223]
 s_waitcnt lgkmcnt(4)
 v_mfma_f32_16x16x32_bf16 v[224:227], v[36:39], a[64:67], v[224:227]
 s_waitcnt lgkmcnt(2)
 ds_read_b64_tr_b16 v[24:25], v6 offset:36864
 v_mfma_f32_16x16x32_bf16 v[224:227], v[40:43], a[80:83], v[224:227]
 s_waitcnt lgkmcnt(1)
 ds_read_b64_tr_b16 v[26:27], v6 offset:37376
 v_mfma_f32_16x16x32_bf16 v[224:227], v[44:47], a[96:99], v[224:227]
 ds_read_b64_tr_b16 v[28:29], v6 offset:40960
 v_mfma_f32_16x16x32_bf16 v[228:231], v[36:39], a[68:71], v[228:231]
 ds_read_b64_tr_b16 v[30:31], v6 offset:41472
 v_mfma_f32_16x16x32_bf16 v[228:231], v[40:43], a[84:87], v[228:231]
 ds_read_b64_tr_b16 v[32:33], v6 offset:45056
 v_mfma_f32_16x16x32_bf16 v[228:231], v[44:47], a[100:103], v[228:231]
 ds_read_b64_tr_b16 v[34:35], v6 offset:45568
 v_mfma_f32_16x16x32_bf16 v[232:235], v[36:39], a[72:75], v[232:235]
 v_mfma_f32_16x16x32_bf16 v[232:235], v[40:43], a[88:91], v[232:235]
 v_mfma_f32_16x16x32_bf16 v[232:235], v[44:47], a[104:107], v[232:235]
 v_mfma_f32_16x16x32_bf16 v[236:239], v[36:39], a[76:79], v[236:239]
 v_mfma_f32_16x16x32_bf16 v[236:239], v[40:43], a[92:95], v[236:239]
 v_mfma_f32_16x16x32_bf16 v[236:239], v[44:47], a[108:111], v[236:239]
 s_waitcnt lgkmcnt(4)
 v_mfma_f32_16x16x32_bf16 v[176:179], v[24:27], a[112:115], v[176:179]
 s_waitcnt lgkmcnt(2)
 ds_read_b64_tr_b16 v[36:37], v6 offset:36872
 v_mfma_f32_16x16x32_bf16 v[176:179], v[28:31], a[128:131], v[176:179]
 s_waitcnt lgkmcnt(1)
 ds_read_b64_tr_b16 v[38:39], v6 offset:37384
 v_mfma_f32_16x16x32_bf16 v[176:179], v[32:35], a[144:147], v[176:179]
 ds_read_b64_tr_b16 v[40:41], v6 offset:40968
 v_mfma_f32_16x16x32_bf16 v[180:183], v[24:27], a[116:119], v[180:183]
 ds_read_b64_tr_b16 v[42:43], v6 offset:41480
 v_mfma_f32_16x16x32_bf16 v[180:183], v[28:31], a[132:135], v[180:183]
 ds_read_b64_tr_b16 v[44:45], v6 offset:45064
 v_mfma_f32_16x16x32_bf16 v[180:183], v[32:35], a[148:151], v[180:183]
 ds_read_b64_tr_b16 v[46:47], v6 offset:45576
 v_mfma_f32_16x16x32_bf16 v[184:187], v[24:27], a[120:123], v[184:187]
 v_mfma_f32_16x16x32_bf16 v[184:187], v[28:31], a[136:139], v[184:187]
 v_mfma_f32_16x16x32_bf16 v[184:187], v[32:35], a[152:155], v[184:187]
 v_mfma_f32_16x16x32_bf16 v[188:191], v[24:27], a[124:127], v[188:191]
 v_mfma_f32_16x16x32_bf16 v[188:191], v[28:31], a[140:143], v[188:191]
 v_mfma_f32_16x16x32_bf16 v[188:191], v[32:35], a[156:159], v[188:191]
 s_waitcnt lgkmcnt(4)
 v_mfma_f32_16x16x32_bf16 v[192:195], v[36:39], a[112:115], v[192:195]
 s_waitcnt lgkmcnt(2)
 ds_read_b64_tr_b16 v[24:25], v7 offset:36864
 v_mfma_f32_16x16x32_bf16 v[192:195], v[40:43], a[128:131], v[192:195]
 s_waitcnt lgkmcnt(1)
 ds_read_b64_tr_b16 v[26:27], v7 offset:37376
 v_mfma_f32_16x16x32_bf16 v[192:195], v[44:47], a[144:147], v[192:195]
 ds_read_b64_tr_b16 v[28:29], v7 offset:40960
 v_mfma_f32_16x16x32_bf16 v[196:199], v[36:39], a[116:119], v[196:199]
 ds_read_b64_tr_b16 v[30:31], v7 offset:41472
 v_mfma_f32_16x16x32_bf16 v[196:199], v[40:43], a[132:135], v[196:199]
 ds_read_b64_tr_b16 v[32:33], v7 offset:45056
 v_mfma_f32_16x16x32_bf16 v[196:199], v[44:47], a[148:151], v[196:199]
 ds_read_b64_tr_b16 v[34:35], v7 offset:45568
 v_mfma_f32_16x16x32_bf16 v[200:203], v[36:39], a[120:123], v[200:203]
 v_mfma_f32_16x16x32_bf16 v[200:203], v[40:43], a[136:139], v[200:203]
 v_mfma_f32_16x16x32_bf16 v[200:203], v[44:47], a[152:155], v[200:203]
 v_mfma_f32_16x16x32_bf16 v[204:207], v[36:39], a[124:127], v[204:207]
 v_mfma_f32_16x16x32_bf16 v[204:207], v[40:43], a[140:143], v[204:207]
 v_mfma_f32_16x16x32_bf16 v[204:207], v[44:47], a[156:159], v[204:207]
 s_waitcnt lgkmcnt(4)
 v_mfma_f32_16x16x32_bf16 v[208:211], v[24:27], a[112:115], v[208:211]
 s_waitcnt lgkmcnt(2)
 ds_read_b64_tr_b16 v[36:37], v7 offset:36872
 v_mfma_f32_16x16x32_bf16 v[208:211], v[28:31], a[128:131], v[208:211]
 s_waitcnt lgkmcnt(1)
 ds_read_b64_tr_b16 v[38:39], v7 offset:37384
 v_mfma_f32_16x16x32_bf16 v[208:211], v[32:35], a[144:147], v[208:211]
 ds_read_b64_tr_b16 v[40:41], v7 offset:40968
 v_mfma_f32_16x16x32_bf16 v[212:215], v[24:27], a[116:119], v[212:215]
 ds_read_b64_tr_b16 v[42:43], v7 offset:41480
 v_mfma_f32_16x16x32_bf16 v[212:215], v[28:31], a[132:135], v[212:215]
 ds_read_b64_tr_b16 v[44:45], v7 offset:45064
 v_mfma_f32_16x16x32_bf16 v[212:215], v[32:35], a[148:151], v[212:215]
 ds_read_b64_tr_b16 v[46:47], v7 offset:45576
 v_mfma_f32_16x16x32_bf16 v[216:219], v[24:27], a[120:123], v[216:219]
 v_mfma_f32_16x16x32_bf16 v[216:219], v[28:31], a[136:139], v[216:219]
 v_mfma_f32_16x16x32_bf16 v[216:219], v[32:35], a[152:155], v[216:219]
 v_mfma_f32_16x16x32_bf16 v[220:223], v[24:27], a[124:127], v[220:223]
 v_mfma_f32_16x16x32_bf16 v[220:223], v[28:31], a[140:143], v[220:223]
 v_mfma_f32_16x16x32_bf16 v[220:223], v[32:35], a[156:159], v[220:223]
 s_waitcnt vmcnt(12)
 s_barrier
 s_waitcnt lgkmcnt(4)
 v_mfma_f32_16x16x32_bf16 v[224:227], v[36:39], a[112:115], v[224:227]
 s_waitcnt lgkmcnt(2)
 ds_read_b64_tr_b16 v[24:25], v6 offset:49152
 v_mfma_f32_16x16x32_bf16 v[224:227], v[40:43], a[128:131], v[224:227]
 s_waitcnt lgkmcnt(1)
 ds_read_b64_tr_b16 v[26:27], v6 offset:49664
 v_mfma_f32_16x16x32_bf16 v[224:227], v[44:47], a[144:147], v[224:227]
 ds_read_b64_tr_b16 v[28:29], v6 offset:53248
 v_mfma_f32_16x16x32_bf16 v[228:231], v[36:39], a[116:119], v[228:231]
 ds_read_b64_tr_b16 v[30:31], v6 offset:53760
 v_mfma_f32_16x16x32_bf16 v[228:231], v[40:43], a[132:135], v[228:231]
 ds_read_b64_tr_b16 v[32:33], v6 offset:57344
 v_mfma_f32_16x16x32_bf16 v[228:231], v[44:47], a[148:151], v[228:231]
 ds_read_b64_tr_b16 v[34:35], v6 offset:57856
 v_mfma_f32_16x16x32_bf16 v[232:235], v[36:39], a[120:123], v[232:235]
 v_mfma_f32_16x16x32_bf16 v[232:235], v[40:43], a[136:139], v[232:235]
 v_mfma_f32_16x16x32_bf16 v[232:235], v[44:47], a[152:155], v[232:235]
 v_mfma_f32_16x16x32_bf16 v[236:239], v[36:39], a[124:127], v[236:239]
 v_mfma_f32_16x16x32_bf16 v[236:239], v[40:43], a[140:143], v[236:239]
 v_mfma_f32_16x16x32_bf16 v[236:239], v[44:47], a[156:159], v[236:239]
 s_waitcnt lgkmcnt(4)
 v_mfma_f32_16x16x32_bf16 v[176:179], v[24:27], a[160:163], v[176:179]
 s_waitcnt lgkmcnt(2)
 ds_read_b64_tr_b16 v[36:37], v6 offset:49160
 v_mfma_f32_16x16x32_bf16 v[176:179], v[28:31], a[176:179], v[176:179]
 s_waitcnt lgkmcnt(1)
 ds_read_b64_tr_b16 v[38:39], v6 offset:49672
 v_mfma_f32_16x16x32_bf16 v[176:179], v[32:35], a[192:195], v[176:179]
 ds_read_b64_tr_b16 v[40:41], v6 offset:53256
 v_mfma_f32_16x16x32_bf16 v[180:183], v[24:27], a[164:167], v[180:183]
 ds_read_b64_tr_b16 v[42:43], v6 offset:53768
 v_mfma_f32_16x16x32_bf16 v[180:183], v[28:31], a[180:183], v[180:183]
 ds_read_b64_tr_b16 v[44:45], v6 offset:57352
 v_mfma_f32_16x16x32_bf16 v[180:183], v[32:35], a[196:199], v[180:183]
 ds_read_b64_tr_b16 v[46:47], v6 offset:57864
 v_mfma_f32_16x16x32_bf16 v[184:187], v[24:27], a[168:171], v[184:187]
 v_mfma_f32_16x16x32_bf16 v[184:187], v[28:31], a[184:187], v[184:187]
 s_add_u32 m0, s72, 81920
 v_mfma_f32_16x16x32_bf16 v[184:187], v[32:35], a[200:203], v[184:187]
 s_mov_b32 s58, 32768
 buffer_load_dwordx4 v244, s[28:31], s58 offen offset:0 nt lds
 v_mfma_f32_16x16x32_bf16 v[188:191], v[24:27], a[172:175], v[188:191]
 v_mfma_f32_16x16x32_bf16 v[188:191], v[28:31], a[188:191], v[188:191]
 v_mfma_f32_16x16x32_bf16 v[188:191], v[32:35], a[204:207], v[188:191]
 s_waitcnt lgkmcnt(4)
 v_mfma_f32_16x16x32_bf16 v[192:195], v[36:39], a[160:163], v[192:195]
 s_waitcnt lgkmcnt(2)
 ds_read_b64_tr_b16 v[24:25], v7 offset:49152
 v_mfma_f32_16x16x32_bf16 v[192:195], v[40:43], a[176:179], v[192:195]
 s_waitcnt lgkmcnt(1)
 ds_read_b64_tr_b16 v[26:27], v7 offset:49664
 v_mfma_f32_16x16x32_bf16 v[192:195], v[44:47], a[192:195], v[192:195]
 ds_read_b64_tr_b16 v[28:29], v7 offset:53248
 v_mfma_f32_16x16x32_bf16 v[196:199], v[36:39], a[164:167], v[196:199]
 ds_read_b64_tr_b16 v[30:31], v7 offset:53760
 v_mfma_f32_16x16x32_bf16 v[196:199], v[40:43], a[180:183], v[196:199]
 ds_read_b64_tr_b16 v[32:33], v7 offset:57344
 v_mfma_f32_16x16x32_bf16 v[196:199], v[44:47], a[196:199], v[196:199]
 ds_read_b64_tr_b16 v[34:35], v7 offset:57856
 v_mfma_f32_16x16x32_bf16 v[200:203], v[36:39], a[168:171], v[200:203]
 buffer_load_dwordx4 v245, s[28:31], s58 offen offset:1024 nt lds
 v_mfma_f32_16x16x32_bf16 v[200:203], v[40:43], a[184:187], v[200:203]
 v_mfma_f32_16x16x32_bf16 v[200:203], v[44:47], a[200:203], v[200:203]
 v_mfma_f32_16x16x32_bf16 v[204:207], v[36:39], a[172:175], v[204:207]
 v_mfma_f32_16x16x32_bf16 v[204:207], v[40:43], a[188:191], v[204:207]
 buffer_load_dwordx4 v244, s[28:31], s58 offen offset:2048 nt lds
 v_mfma_f32_16x16x32_bf16 v[204:207], v[44:47], a[204:207], v[204:207]
 s_waitcnt lgkmcnt(4)
 v_mfma_f32_16x16x32_bf16 v[208:211], v[24:27], a[160:163], v[208:211]
 s_waitcnt lgkmcnt(2)
 ds_read_b64_tr_b16 v[36:37], v7 offset:49160
 v_mfma_f32_16x16x32_bf16 v[208:211], v[28:31], a[176:179], v[208:211]
 s_waitcnt lgkmcnt(1)
 ds_read_b64_tr_b16 v[38:39], v7 offset:49672
 v_mfma_f32_16x16x32_bf16 v[208:211], v[32:35], a[192:195], v[208:211]
 ds_read_b64_tr_b16 v[40:41], v7 offset:53256
 v_mfma_f32_16x16x32_bf16 v[212:215], v[24:27], a[164:167], v[212:215]
 ds_read_b64_tr_b16 v[42:43], v7 offset:53768
 v_mfma_f32_16x16x32_bf16 v[212:215], v[28:31], a[180:183], v[212:215]
 ds_read_b64_tr_b16 v[44:45], v7 offset:57352
 v_mfma_f32_16x16x32_bf16 v[212:215], v[32:35], a[196:199], v[212:215]
 ds_read_b64_tr_b16 v[46:47], v7 offset:57864
 v_mfma_f32_16x16x32_bf16 v[216:219], v[24:27], a[168:171], v[216:219]
 v_add_u32 v6, 0xc000, v6
 v_add_u32 v7, 0xc000, v7
 v_mfma_f32_16x16x32_bf16 v[216:219], v[28:31], a[184:187], v[216:219]
 v_mfma_f32_16x16x32_bf16 v[216:219], v[32:35], a[200:203], v[216:219]
 v_mfma_f32_16x16x32_bf16 v[220:223], v[24:27], a[172:175], v[220:223]
 buffer_load_dwordx4 v245, s[28:31], s58 offen offset:3072 nt lds
 v_mfma_f32_16x16x32_bf16 v[220:223], v[28:31], a[188:191], v[220:223]
 v_mfma_f32_16x16x32_bf16 v[220:223], v[32:35], a[204:207], v[220:223]
 s_waitcnt lgkmcnt(4)
 v_mfma_f32_16x16x32_bf16 v[224:227], v[36:39], a[160:163], v[224:227]
 s_waitcnt lgkmcnt(2)
 ds_read_b64_tr_b16 v[24:25], v6 offset:12288
 v_mfma_f32_16x16x32_bf16 v[224:227], v[40:43], a[176:179], v[224:227]
 s_waitcnt lgkmcnt(1)
 ds_read_b64_tr_b16 v[26:27], v6 offset:12800
 v_mfma_f32_16x16x32_bf16 v[224:227], v[44:47], a[192:195], v[224:227]
 ds_read_b64_tr_b16 v[28:29], v6 offset:16384
 v_mfma_f32_16x16x32_bf16 v[228:231], v[36:39], a[164:167], v[228:231]
 ds_read_b64_tr_b16 v[30:31], v6 offset:16896
 v_mfma_f32_16x16x32_bf16 v[228:231], v[40:43], a[180:183], v[228:231]
 ds_read_b64_tr_b16 v[32:33], v6 offset:20480
 v_mfma_f32_16x16x32_bf16 v[228:231], v[44:47], a[196:199], v[228:231]
 ds_read_b64_tr_b16 v[34:35], v6 offset:20992
 v_mfma_f32_16x16x32_bf16 v[232:235], v[36:39], a[168:171], v[232:235]
 v_mfma_f32_16x16x32_bf16 v[232:235], v[40:43], a[184:187], v[232:235]
 v_mfma_f32_16x16x32_bf16 v[232:235], v[44:47], a[200:203], v[232:235]
 v_mfma_f32_16x16x32_bf16 v[236:239], v[36:39], a[172:175], v[236:239]
 v_mfma_f32_16x16x32_bf16 v[236:239], v[40:43], a[188:191], v[236:239]
 v_mov_b32 v13, 0x3f803f80
 v_mfma_f32_16x16x32_bf16 v[236:239], v[44:47], a[204:207], v[236:239]
 s_waitcnt lgkmcnt(4)
 v_mfma_f32_16x16x32_bf16 v[176:179], v[24:27], a[208:211], v[176:179]
 s_waitcnt lgkmcnt(2)
 ds_read_b64_tr_b16 v[36:37], v6 offset:12296
 v_accvgpr_write_b32 a192, v13
 v_mfma_f32_16x16x32_bf16 v[176:179], v[28:31], a[224:227], v[176:179]
 s_waitcnt lgkmcnt(1)
 ds_read_b64_tr_b16 v[38:39], v6 offset:12808
 v_accvgpr_write_b32 a193, v13
 v_accvgpr_write_b32 a194, v13
 v_mfma_f32_16x16x32_bf16 v[176:179], v[32:35], a[240:243], v[176:179]
 ds_read_b64_tr_b16 v[40:41], v6 offset:16392
 v_accvgpr_write_b32 a195, v13
 v_mfma_f32_16x16x32_bf16 v[180:183], v[24:27], a[212:215], v[180:183]
 ds_read_b64_tr_b16 v[42:43], v6 offset:16904
 v_mfma_f32_16x16x32_bf16 v[180:183], v[28:31], a[228:231], v[180:183]
 ds_read_b64_tr_b16 v[44:45], v6 offset:20488
 v_mfma_f32_16x16x32_bf16 v[180:183], v[32:35], a[244:247], v[180:183]
 ds_read_b64_tr_b16 v[46:47], v6 offset:21000
 v_mfma_f32_16x16x32_bf16 v[184:187], v[24:27], a[216:219], v[184:187]
 v_mfma_f32_16x16x32_bf16 v[184:187], v[28:31], a[232:235], v[184:187]
 s_add_u32 m0, s72, 98304
 v_mfma_f32_16x16x32_bf16 v[184:187], v[32:35], a[248:251], v[184:187]
 s_mov_b32 s58, 49152
 buffer_load_dwordx4 v244, s[28:31], s58 offen offset:0 nt lds
 v_mul_f32 v176, s75, v176
 v_mfma_f32_16x16x32_bf16 v[188:191], v[24:27], a[220:223], v[188:191]
 v_mul_f32 v177, s75, v177
 v_mul_f32 v178, s75, v178
 v_mul_f32 v179, s75, v179
 v_mfma_f32_16x16x32_bf16 v[188:191], v[28:31], a[236:239], v[188:191]
 v_mfma_f32_16x16x32_bf16 v[188:191], v[32:35], a[252:255], v[188:191]
 s_waitcnt lgkmcnt(4)
 v_cvt_pk_bf16_f32 v48, v176, v177
 v_cvt_pk_bf16_f32 v49, v178, v179
 v_mul_f32 v180, s75, v180
 v_mfma_f32_16x16x32_bf16 v[192:195], v[36:39], a[208:211], v[192:195]
 s_waitcnt lgkmcnt(2)
 ds_read_b64_tr_b16 v[24:25], v7 offset:12288
 v_mul_f32 v181, s75, v181
 v_mul_f32 v182, s75, v182
 v_mul_f32 v183, s75, v183
 v_mfma_f32_16x16x32_bf16 v[192:195], v[40:43], a[224:227], v[192:195]
 s_waitcnt lgkmcnt(1)
 ds_read_b64_tr_b16 v[26:27], v7 offset:12800
 v_mfma_f32_16x16x32_bf16 v[192:195], v[44:47], a[240:243], v[192:195]
 ds_read_b64_tr_b16 v[28:29], v7 offset:16384
 v_cvt_pk_bf16_f32 v52, v180, v181
 v_cvt_pk_bf16_f32 v53, v182, v183
 v_mfma_f32_16x16x32_bf16 v[196:199], v[36:39], a[212:215], v[196:199]
 ds_read_b64_tr_b16 v[30:31], v7 offset:16896
 v_mul_f32 v184, s75, v184
 v_mul_f32 v185, s75, v185
 v_mfma_f32_16x16x32_bf16 v[196:199], v[40:43], a[228:231], v[196:199]
 ds_read_b64_tr_b16 v[32:33], v7 offset:20480
 v_mul_f32 v186, s75, v186
 v_mul_f32 v187, s75, v187
 v_mfma_f32_16x16x32_bf16 v[196:199], v[44:47], a[244:247], v[196:199]
 ds_read_b64_tr_b16 v[34:35], v7 offset:20992
 v_cvt_pk_bf16_f32 v56, v184, v185
 v_mul_f32 v188, s75, v188
 v_mfma_f32_16x16x32_bf16 v[200:203], v[36:39], a[216:219], v[200:203]
 buffer_load_dwordx4 v245, s[28:31], s58 offen offset:1024 nt lds
 v_cvt_pk_bf16_f32 v57, v186, v187
 v_mul_f32 v189, s75, v189
 v_mfma_f32_16x16x32_bf16 v[200:203], v[40:43], a[232:235], v[200:203]
 v_mul_f32 v190, s75, v190
 v_mul_f32 v191, s75, v191
 v_mfma_f32_16x16x32_bf16 v[200:203], v[44:47], a[248:251], v[200:203]
 v_cvt_pk_bf16_f32 v60, v188, v189
 v_mul_f32 v192, s75, v192
 v_mul_f32 v193, s75, v193
 v_mfma_f32_16x16x32_bf16 v[204:207], v[36:39], a[220:223], v[204:207]
 v_cvt_pk_bf16_f32 v61, v190, v191
 v_mul_f32 v194, s75, v194
 v_mul_f32 v195, s75, v195
 v_mfma_f32_16x16x32_bf16 v[204:207], v[40:43], a[236:239], v[204:207]
 buffer_load_dwordx4 v244, s[28:31], s58 offen offset:2048 nt lds
 v_cvt_pk_bf16_f32 v50, v192, v193
 v_mfma_f32_16x16x32_bf16 v[204:207], v[44:47], a[252:255], v[204:207]
 s_waitcnt lgkmcnt(4)
 v_cvt_pk_bf16_f32 v51, v194, v195
 v_mul_f32 v196, s75, v196
 v_mul_f32 v197, s75, v197
 v_mul_f32 v198, s75, v198
 v_mfma_f32_16x16x32_bf16 v[208:211], v[24:27], a[208:211], v[208:211]
 s_waitcnt lgkmcnt(2)
 ds_read_b64_tr_b16 v[36:37], v7 offset:12296
 v_mul_f32 v199, s75, v199
 v_mfma_f32_16x16x32_bf16 v[208:211], v[28:31], a[224:227], v[208:211]
 s_waitcnt lgkmcnt(1)
 ds_read_b64_tr_b16 v[38:39], v7 offset:12808
 v_cvt_pk_bf16_f32 v54, v196, v197
 v_mfma_f32_16x16x32_bf16 v[208:211], v[32:35], a[240:243], v[208:211]
 ds_read_b64_tr_b16 v[40:41], v7 offset:16392
 v_cvt_pk_bf16_f32 v55, v198, v199
 v_mul_f32 v200, s75, v200
 v_mfma_f32_16x16x32_bf16 v[212:215], v[24:27], a[212:215], v[212:215]
 ds_read_b64_tr_b16 v[42:43], v7 offset:16904
 v_mul_f32 v201, s75, v201
 v_mul_f32 v202, s75, v202
 v_mul_f32 v203, s75, v203
 v_mfma_f32_16x16x32_bf16 v[212:215], v[28:31], a[228:231], v[212:215]
 ds_read_b64_tr_b16 v[44:45], v7 offset:20488
 v_mfma_f32_16x16x32_bf16 v[212:215], v[32:35], a[244:247], v[212:215]
 ds_read_b64_tr_b16 v[46:47], v7 offset:21000
 v_cvt_pk_bf16_f32 v58, v200, v201
 v_cvt_pk_bf16_f32 v59, v202, v203
 v_mfma_f32_16x16x32_bf16 v[216:219], v[24:27], a[216:219], v[216:219]
 v_mul_f32 v204, s75, v204
 v_mul_f32 v205, s75, v205
 v_mul_f32 v206, s75, v206
 v_mul_f32 v207, s75, v207
 v_mfma_f32_16x16x32_bf16 v[216:219], v[28:31], a[232:235], v[216:219]
 v_mfma_f32_16x16x32_bf16 v[216:219], v[32:35], a[248:251], v[216:219]
 buffer_load_dwordx4 v245, s[28:31], s58 offen offset:3072 nt lds
 v_cvt_pk_bf16_f32 v62, v204, v205
 v_cvt_pk_bf16_f32 v63, v206, v207
 v_mfma_f32_16x16x32_bf16 v[220:223], v[24:27], a[220:223], v[220:223]
 v_mul_f32 v208, s75, v208
 v_mul_f32 v209, s75, v209
 v_mul_f32 v210, s75, v210
 v_mfma_f32_16x16x32_bf16 v[220:223], v[28:31], a[236:239], v[220:223]
 v_mul_f32 v211, s75, v211
 v_mfma_f32_16x16x32_bf16 v[220:223], v[32:35], a[252:255], v[220:223]
 s_waitcnt lgkmcnt(4)
 v_cvt_pk_bf16_f32 v64, v208, v209
 v_mul_f32 v212, s75, v212
 v_mul_f32 v213, s75, v213
 v_mul_f32 v214, s75, v214
 v_mfma_f32_16x16x32_bf16 v[224:227], v[36:39], a[208:211], v[224:227]
 s_waitcnt lgkmcnt(2)
 ds_read_b128 a[128:131], v246 offset:0
 v_cvt_pk_bf16_f32 v65, v210, v211
 v_mul_f32 v215, s75, v215
 v_mfma_f32_16x16x32_bf16 v[224:227], v[40:43], a[224:227], v[224:227]
 s_waitcnt lgkmcnt(1)
 ds_read_b128 a[132:135], v247 offset:0
 v_cvt_pk_bf16_f32 v68, v212, v213
 v_mfma_f32_16x16x32_bf16 v[224:227], v[44:47], a[240:243], v[224:227]
 ds_read_b128 a[136:139], v248 offset:0
 v_cvt_pk_bf16_f32 v69, v214, v215
 v_mul_f32 v216, s75, v216
 v_mul_f32 v217, s75, v217
 v_mfma_f32_16x16x32_bf16 v[228:231], v[36:39], a[212:215], v[228:231]
 ds_read_b128 a[140:143], v249 offset:0
 v_mul_f32 v218, s75, v218
 v_mul_f32 v219, s75, v219
 v_mfma_f32_16x16x32_bf16 v[228:231], v[40:43], a[228:231], v[228:231]
 ds_read_b128 a[144:147], v246 offset:4096
 v_cvt_pk_bf16_f32 v72, v216, v217
 v_mfma_f32_16x16x32_bf16 v[228:231], v[44:47], a[244:247], v[228:231]
 ds_read_b128 a[148:151], v247 offset:4096
 v_cvt_pk_bf16_f32 v73, v218, v219
 v_mul_f32 v220, s75, v220
 v_mul_f32 v221, s75, v221
 v_mul_f32 v222, s75, v222
 v_mfma_f32_16x16x32_bf16 v[232:235], v[36:39], a[216:219], v[232:235]
 ds_read_b128 a[152:155], v248 offset:4096
 v_mul_f32 v223, s75, v223
 v_mfma_f32_16x16x32_bf16 v[232:235], v[40:43], a[232:235], v[232:235]
 ds_read_b128 a[156:159], v249 offset:4096
 v_cvt_pk_bf16_f32 v76, v220, v221
 v_mfma_f32_16x16x32_bf16 v[232:235], v[44:47], a[248:251], v[232:235]
 s_load_dwordx2 s[8:9], s[0:1], 0
 s_load_dwordx4 s[12:15], s[0:1], 72
 v_cvt_pk_bf16_f32 v77, v222, v223
 v_mul_f32 v224, s75, v224
 v_mul_f32 v225, s75, v225
 v_mul_f32 v226, s75, v226
 v_mfma_f32_16x16x32_bf16 v[236:239], v[36:39], a[220:223], v[236:239]
 v_mul_f32 v227, s75, v227
 v_mfma_f32_16x16x32_bf16 v[236:239], v[40:43], a[236:239], v[236:239]
 v_cvt_pk_bf16_f32 v66, v224, v225
 v_mfma_f32_16x16x32_bf16 v[236:239], v[44:47], a[252:255], v[236:239]
 v_cvt_pk_bf16_f32 v67, v226, v227
 v_mul_f32 v228, s75, v228
 v_mul_f32 v229, s75, v229
 v_mul_f32 v230, s75, v230
 v_mul_f32 v231, s75, v231
 v_cvt_pk_bf16_f32 v70, v228, v229
 v_cvt_pk_bf16_f32 v71, v230, v231
 v_mul_f32 v232, s75, v232
 v_mul_f32 v233, s75, v233
 v_mul_f32 v234, s75, v234
 v_mul_f32 v235, s75, v235
 v_cvt_pk_bf16_f32 v74, v232, v233
 v_mul_f32 v236, s75, v236
 v_cvt_pk_bf16_f32 v75, v234, v235
 v_mul_f32 v237, s75, v237
 v_mul_f32 v238, s75, v238
 v_mul_f32 v239, s75, v239
 v_cvt_pk_bf16_f32 v78, v236, v237
 v_cvt_pk_bf16_f32 v79, v238, v239
 s_branch L_ab_done
L_light:
 v_mfma_f32_16x16x32_bf16 v[112:115], v[24:27], v[48:51], 0
 s_waitcnt lgkmcnt(2)
 ds_read_b64_tr_b16 v[36:37], v7 offset:24576
 v_mfma_f32_16x16x32_bf16 v[112:115], v[28:31], v[64:67], v[112:115]
 s_waitcnt lgkmcnt(1)
 ds_read_b64_tr_b16 v[38:39], v7 offset:25088
 v_mfma_f32_16x16x32_bf16 v[112:115], v[32:35], a[0:3], v[112:115]
 ds_read_b64_tr_b16 v[40:41], v7 offset:28672
 v_mul_f32 v16, s74, v176
 v_mfma_f32_16x16x32_bf16 v[116:119], v[24:27], v[52:55], 0
 ds_read_b64_tr_b16 v[42:43], v7 offset:29184
 v_mul_f32 v17, s74, v177
 v_mfma_f32_16x16x32_bf16 v[116:119], v[28:31], v[68:71], v[116:119]
 ds_read_b64_tr_b16 v[44:45], v7 offset:32768
 v_mul_f32 v18, s74, v178
 v_mul_f32 v19, s74, v179
 v_mfma_f32_16x16x32_bf16 v[116:119], v[32:35], a[4:7], v[116:119]
 ds_read_b64_tr_b16 v[46:47], v7 offset:33280
 v_mfma_f32_16x16x32_bf16 v[120:123], v[24:27], v[56:59], 0
 s_mul_i32 s80, s86, 256
 v_exp_f32 v16, v16
 v_mfma_f32_16x16x32_bf16 v[120:123], v[28:31], v[72:75], v[120:123]
 s_add_u32 m0, s70, 139264
 v_exp_f32 v17, v17
 v_mfma_f32_16x16x32_bf16 v[120:123], v[32:35], a[8:11], v[120:123]
 s_add_u32 s58, s80, 0
 buffer_load_dwordx4 v5, s[20:23], s58 offen nt lds
 v_mfma_f32_16x16x32_bf16 v[124:127], v[24:27], v[60:63], 0
 v_exp_f32 v18, v18
 v_mfma_f32_16x16x32_bf16 v[124:127], v[28:31], v[76:79], v[124:127]
 v_exp_f32 v19, v19
 v_add_f32 v16, 1.0, v16
 v_mfma_f32_16x16x32_bf16 v[124:127], v[32:35], a[12:15], v[124:127]
 s_waitcnt lgkmcnt(4)
 v_add_f32 v17, 1.0, v17
 v_add_f32 v18, 1.0, v18
 v_mfma_f32_16x16x32_bf16 v[128:131], v[36:39], v[48:51], 0
 s_waitcnt lgkmcnt(2)
 ds_read_b64_tr_b16 v[24:25], v8 offset:24576
 v_add_f32 v19, 1.0, v19
 v_mul_f32 v20, s74, v192
 v_mfma_f32_16x16x32_bf16 v[128:131], v[40:43], v[64:67], v[128:131]
 s_waitcnt lgkmcnt(1)
 ds_read_b64_tr_b16 v[26:27], v8 offset:25088
 v_mul_f32 v21, s74, v193
 v_mfma_f32_16x16x32_bf16 v[128:131], v[44:47], a[0:3], v[128:131]
 ds_read_b64_tr_b16 v[28:29], v8 offset:28672
 v_mul_f32 v22, s74, v194
 v_mfma_f32_16x16x32_bf16 v[132:135], v[36:39], v[52:55], 0
 ds_read_b64_tr_b16 v[30:31], v8 offset:29184
 v_rcp_f32 v16, v16
 v_mfma_f32_16x16x32_bf16 v[132:135], v[40:43], v[68:71], v[132:135]
 ds_read_b64_tr_b16 v[32:33], v8 offset:32768
 v_mul_f32 v23, s74, v195
 v_mfma_f32_16x16x32_bf16 v[132:135], v[44:47], a[4:7], v[132:135]
 ds_read_b64_tr_b16 v[34:35], v8 offset:33280
 v_rcp_f32 v17, v17
 v_mfma_f32_16x16x32_bf16 v[136:139], v[36:39], v[56:59], 0
 v_rcp_f32 v18, v18
 v_mfma_f32_16x16x32_bf16 v[136:139], v[40:43], v[72:75], v[136:139]
 s_add_u32 m0, s70, 143360
 v_rcp_f32 v19, v19
 v_mfma_f32_16x16x32_bf16 v[136:139], v[44:47], a[8:11], v[136:139]
 s_add_u32 s58, s80, 262144
 buffer_load_dwordx4 v5, s[20:23], s58 offen nt lds
 v_mul_f32 v176, v176, v16
 v_mfma_f32_16x16x32_bf16 v[140:143], v[36:39], v[60:63], 0
 v_exp_f32 v20, v20
 v_mfma_f32_16x16x32_bf16 v[140:143], v[40:43], v[76:79], v[140:143]
 v_exp_f32 v21, v21
 v_mfma_f32_16x16x32_bf16 v[140:143], v[44:47], a[12:15], v[140:143]
 s_waitcnt lgkmcnt(4)
 v_exp_f32 v22, v22
 v_mul_f32 v177, v177, v17
 v_mfma_f32_16x16x32_bf16 v[144:147], v[24:27], v[48:51], 0
 s_waitcnt lgkmcnt(2)
 ds_read_b64_tr_b16 v[36:37], v9 offset:24576
 v_mul_f32 v178, v178, v18
 v_mfma_f32_16x16x32_bf16 v[144:147], v[28:31], v[64:67], v[144:147]
 s_waitcnt lgkmcnt(1)
 ds_read_b64_tr_b16 v[38:39], v9 offset:25088
 v_mul_f32 v179, v179, v19
 v_cvt_pk_bf16_f32 v80, v176, v177
 v_mfma_f32_16x16x32_bf16 v[144:147], v[32:35], a[0:3], v[144:147]
 ds_read_b64_tr_b16 v[40:41], v9 offset:28672
 v_add_f32 v20, 1.0, v20
 v_mfma_f32_16x16x32_bf16 v[148:151], v[24:27], v[52:55], 0
 ds_read_b64_tr_b16 v[42:43], v9 offset:29184
 v_cvt_pk_bf16_f32 v81, v178, v179
 v_mfma_f32_16x16x32_bf16 v[148:151], v[28:31], v[68:71], v[148:151]
 ds_read_b64_tr_b16 v[44:45], v9 offset:32768
 v_exp_f32 v23, v23
 v_mfma_f32_16x16x32_bf16 v[148:151], v[32:35], a[4:7], v[148:151]
 ds_read_b64_tr_b16 v[46:47], v9 offset:33280
 v_add_f32 v21, 1.0, v21
 v_mfma_f32_16x16x32_bf16 v[152:155], v[24:27], v[56:59], 0
 v_rcp_f32 v20, v20
 v_mfma_f32_16x16x32_bf16 v[152:155], v[28:31], v[72:75], v[152:155]
 s_add_u32 m0, s70, 147456
 v_rcp_f32 v21, v21
 v_add_f32 v22, 1.0, v22
 v_mfma_f32_16x16x32_bf16 v[152:155], v[32:35], a[8:11], v[152:155]
 s_add_u32 s58, s80, 524288
 buffer_load_dwordx4 v5, s[20:23], s58 offen nt lds
 v_mfma_f32_16x16x32_bf16 v[156:159], v[24:27], v[60:63], 0
 v_rcp_f32 v22, v22
 v_add_f32 v23, 1.0, v23
 v_mfma_f32_16x16x32_bf16 v[156:159], v[28:31], v[76:79], v[156:159]
 v_mul_f32 v192, v192, v20
 v_mul_f32 v193, v193, v21
 v_mfma_f32_16x16x32_bf16 v[156:159], v[32:35], a[12:15], v[156:159]
 s_waitcnt lgkmcnt(4)
 v_rcp_f32 v23, v23
 v_mfma_f32_16x16x32_bf16 v[160:163], v[36:39], v[48:51], 0
 s_waitcnt lgkmcnt(2)
 ds_read_b64_tr_b16 v[24:25], v6 offset:36864
 v_mul_f32 v194, v194, v22
 v_cvt_pk_bf16_f32 v82, v192, v193
 v_mfma_f32_16x16x32_bf16 v[160:163], v[40:43], v[64:67], v[160:163]
 s_waitcnt lgkmcnt(1)
 ds_read_b64_tr_b16 v[26:27], v6 offset:37376
 v_mul_f32 v195, v195, v23
 v_mfma_f32_16x16x32_bf16 v[160:163], v[44:47], a[0:3], v[160:163]
 ds_read_b64_tr_b16 v[28:29], v6 offset:40960
 v_mul_f32 v16, s74, v180
 v_mul_f32 v17, s74, v181
 v_mfma_f32_16x16x32_bf16 v[164:167], v[36:39], v[52:55], 0
 ds_read_b64_tr_b16 v[30:31], v6 offset:41472
 v_cvt_pk_bf16_f32 v83, v194, v195
 v_mfma_f32_16x16x32_bf16 v[164:167], v[40:43], v[68:71], v[164:167]
 ds_read_b64_tr_b16 v[32:33], v6 offset:45056
 v_mul_f32 v18, s74, v182
 v_mfma_f32_16x16x32_bf16 v[164:167], v[44:47], a[4:7], v[164:167]
 ds_read_b64_tr_b16 v[34:35], v6 offset:45568
 v_mul_f32 v19, s74, v183
 v_mfma_f32_16x16x32_bf16 v[168:171], v[36:39], v[56:59], 0
 v_exp_f32 v16, v16
 v_mfma_f32_16x16x32_bf16 v[168:171], v[40:43], v[72:75], v[168:171]
 v_exp_f32 v17, v17
 v_mfma_f32_16x16x32_bf16 v[168:171], v[44:47], a[8:11], v[168:171]
 v_exp_f32 v18, v18
 v_add_f32 v16, 1.0, v16
 v_mfma_f32_16x16x32_bf16 v[172:175], v[36:39], v[60:63], 0
 v_exp_f32 v19, v19
 v_mfma_f32_16x16x32_bf16 v[172:175], v[40:43], v[76:79], v[172:175]
 v_rcp_f32 v16, v16
 v_add_f32 v17, 1.0, v17
 v_mfma_f32_16x16x32_bf16 v[172:175], v[44:47], a[12:15], v[172:175]
 s_waitcnt lgkmcnt(4)
 v_add_f32 v18, 1.0, v18
 v_add_f32 v19, 1.0, v19
 v_mfma_f32_16x16x32_bf16 v[112:115], v[24:27], a[16:19], v[112:115]
 s_waitcnt lgkmcnt(2)
 ds_read_b64_tr_b16 v[36:37], v7 offset:36864
 v_mul_f32 v180, v180, v16
 v_mfma_f32_16x16x32_bf16 v[112:115], v[28:31], a[32:35], v[112:115]
 s_waitcnt lgkmcnt(1)
 ds_read_b64_tr_b16 v[38:39], v7 offset:37376
 v_rcp_f32 v17, v17
 v_mfma_f32_16x16x32_bf16 v[112:115], v[32:35], a[48:51], v[112:115]
 ds_read_b64_tr_b16 v[40:41], v7 offset:40960
 v_mul_f32 v20, s74, v196
 v_mfma_f32_16x16x32_bf16 v[116:119], v[24:27], a[20:23], v[116:119]
 ds_read_b64_tr_b16 v[42:43], v7 offset:41472
 v_mul_f32 v181, v181, v17
 v_mfma_f32_16x16x32_bf16 v[116:119], v[28:31], a[36:39], v[116:119]
 ds_read_b64_tr_b16 v[44:45], v7 offset:45056
 v_rcp_f32 v18, v18
 v_mfma_f32_16x16x32_bf16 v[116:119], v[32:35], a[52:55], v[116:119]
 ds_read_b64_tr_b16 v[46:47], v7 offset:45568
 v_cvt_pk_bf16_f32 v84, v180, v181
 v_mfma_f32_16x16x32_bf16 v[120:123], v[24:27], a[24:27], v[120:123]
 s_mul_i32 s81, s87, 256
 v_rcp_f32 v19, v19
 v_mul_f32 v182, v182, v18
 v_mfma_f32_16x16x32_bf16 v[120:123], v[28:31], a[40:43], v[120:123]
 s_add_u32 m0, s70, 151552
 v_exp_f32 v20, v20
 v_mfma_f32_16x16x32_bf16 v[120:123], v[32:35], a[56:59], v[120:123]
 s_add_u32 s58, s81, 0
 buffer_load_dwordx4 v5, s[20:23], s58 offen nt lds
 v_mfma_f32_16x16x32_bf16 v[124:127], v[24:27], a[28:31], v[124:127]
 v_mul_f32 v183, v183, v19
 v_mul_f32 v21, s74, v197
 v_mul_f32 v22, s74, v198
 v_mfma_f32_16x16x32_bf16 v[124:127], v[28:31], a[44:47], v[124:127]
 v_mul_f32 v23, s74, v199
 v_add_f32 v20, 1.0, v20
 v_mfma_f32_16x16x32_bf16 v[124:127], v[32:35], a[60:63], v[124:127]
 s_waitcnt lgkmcnt(4)
 v_exp_f32 v21, v21
 v_cvt_pk_bf16_f32 v85, v182, v183
 v_mfma_f32_16x16x32_bf16 v[128:131], v[36:39], a[16:19], v[128:131]
 s_waitcnt lgkmcnt(2)
 ds_read_b64_tr_b16 v[24:25], v8 offset:36864
 v_mfma_f32_16x16x32_bf16 v[128:131], v[40:43], a[32:35], v[128:131]
 s_waitcnt lgkmcnt(1)
 ds_read_b64_tr_b16 v[26:27], v8 offset:37376
 v_add_f32 v21, 1.0, v21
 v_mfma_f32_16x16x32_bf16 v[128:131], v[44:47], a[48:51], v[128:131]
 ds_read_b64_tr_b16 v[28:29], v8 offset:40960
 v_exp_f32 v22, v22
 v_mfma_f32_16x16x32_bf16 v[132:135], v[36:39], a[20:23], v[132:135]
 ds_read_b64_tr_b16 v[30:31], v8 offset:41472
 v_mul_f32 v16, s74, v184
 v_mfma_f32_16x16x32_bf16 v[132:135], v[40:43], a[36:39], v[132:135]
 ds_read_b64_tr_b16 v[32:33], v8 offset:45056
 v_add_f32 v22, 1.0, v22
 v_mfma_f32_16x16x32_bf16 v[132:135], v[44:47], a[52:55], v[132:135]
 ds_read_b64_tr_b16 v[34:35], v8 offset:45568
 v_exp_f32 v23, v23
 v_mfma_f32_16x16x32_bf16 v[136:139], v[36:39], a[24:27], v[136:139]
 v_rcp_f32 v20, v20
 v_mfma_f32_16x16x32_bf16 v[136:139], v[40:43], a[40:43], v[136:139]
 s_add_u32 m0, s70, 155648
 v_rcp_f32 v21, v21
 v_add_f32 v23, 1.0, v23
 v_mfma_f32_16x16x32_bf16 v[136:139], v[44:47], a[56:59], v[136:139]
 s_add_u32 s58, s81, 262144
 buffer_load_dwordx4 v5, s[20:23], s58 offen nt lds
 v_mfma_f32_16x16x32_bf16 v[140:143], v[36:39], a[28:31], v[140:143]
 v_rcp_f32 v22, v22
 v_mfma_f32_16x16x32_bf16 v[140:143], v[40:43], a[44:47], v[140:143]
 v_rcp_f32 v23, v23
 v_mul_f32 v196, v196, v20
 v_mfma_f32_16x16x32_bf16 v[140:143], v[44:47], a[60:63], v[140:143]
 s_waitcnt lgkmcnt(4)
 v_exp_f32 v16, v16
 v_mfma_f32_16x16x32_bf16 v[144:147], v[24:27], a[16:19], v[144:147]
 s_waitcnt lgkmcnt(2)
 ds_read_b64_tr_b16 v[36:37], v9 offset:36864
 v_mul_f32 v197, v197, v21
 v_mul_f32 v198, v198, v22
 v_mfma_f32_16x16x32_bf16 v[144:147], v[28:31], a[32:35], v[144:147]
 s_waitcnt lgkmcnt(1)
 ds_read_b64_tr_b16 v[38:39], v9 offset:37376
 v_mul_f32 v199, v199, v23
 v_mfma_f32_16x16x32_bf16 v[144:147], v[32:35], a[48:51], v[144:147]
 ds_read_b64_tr_b16 v[40:41], v9 offset:40960
 v_cvt_pk_bf16_f32 v86, v196, v197
 v_mfma_f32_16x16x32_bf16 v[148:151], v[24:27], a[20:23], v[148:151]
 ds_read_b64_tr_b16 v[42:43], v9 offset:41472
 v_cvt_pk_bf16_f32 v87, v198, v199
 v_mul_f32 v17, s74, v185
 v_mfma_f32_16x16x32_bf16 v[148:151], v[28:31], a[36:39], v[148:151]
 ds_read_b64_tr_b16 v[44:45], v9 offset:45056
 v_mul_f32 v18, s74, v186
 v_mfma_f32_16x16x32_bf16 v[148:151], v[32:35], a[52:55], v[148:151]
 ds_read_b64_tr_b16 v[46:47], v9 offset:45568
 v_mul_f32 v19, s74, v187
 v_add_f32 v16, 1.0, v16
 v_mfma_f32_16x16x32_bf16 v[152:155], v[24:27], a[24:27], v[152:155]
 v_exp_f32 v17, v17
 v_mfma_f32_16x16x32_bf16 v[152:155], v[28:31], a[40:43], v[152:155]
 s_add_u32 m0, s70, 159744
 v_exp_f32 v18, v18
 v_mfma_f32_16x16x32_bf16 v[152:155], v[32:35], a[56:59], v[152:155]
 s_add_u32 s58, s81, 524288
 buffer_load_dwordx4 v5, s[20:23], s58 offen nt lds
 v_add_f32 v17, 1.0, v17
 v_mfma_f32_16x16x32_bf16 v[156:159], v[24:27], a[28:31], v[156:159]
 v_exp_f32 v19, v19
 v_mfma_f32_16x16x32_bf16 v[156:159], v[28:31], a[44:47], v[156:159]
 v_rcp_f32 v16, v16
 v_mfma_f32_16x16x32_bf16 v[156:159], v[32:35], a[60:63], v[156:159]
 s_waitcnt vmcnt(15)
 s_barrier
 s_waitcnt lgkmcnt(4)
 v_add_f32 v18, 1.0, v18
 v_mfma_f32_16x16x32_bf16 v[160:163], v[36:39], a[16:19], v[160:163]
 s_waitcnt lgkmcnt(2)
 ds_read_b64_tr_b16 v[24:25], v6 offset:49152
 v_add_f32 v19, 1.0, v19
 v_mfma_f32_16x16x32_bf16 v[160:163], v[40:43], a[32:35], v[160:163]
 s_waitcnt lgkmcnt(1)
 ds_read_b64_tr_b16 v[26:27], v6 offset:49664
 v_rcp_f32 v17, v17
 v_mfma_f32_16x16x32_bf16 v[160:163], v[44:47], a[48:51], v[160:163]
 ds_read_b64_tr_b16 v[28:29], v6 offset:53248
 v_mul_f32 v184, v184, v16
 v_mfma_f32_16x16x32_bf16 v[164:167], v[36:39], a[20:23], v[164:167]
 ds_read_b64_tr_b16 v[30:31], v6 offset:53760
 v_mul_f32 v185, v185, v17
 v_mfma_f32_16x16x32_bf16 v[164:167], v[40:43], a[36:39], v[164:167]
 ds_read_b64_tr_b16 v[32:33], v6 offset:57344
 v_rcp_f32 v18, v18
 v_mfma_f32_16x16x32_bf16 v[164:167], v[44:47], a[52:55], v[164:167]
 ds_read_b64_tr_b16 v[34:35], v6 offset:57856
 v_cvt_pk_bf16_f32 v88, v184, v185
 v_mfma_f32_16x16x32_bf16 v[168:171], v[36:39], a[24:27], v[168:171]
 v_rcp_f32 v19, v19
 v_mul_f32 v186, v186, v18
 v_mfma_f32_16x16x32_bf16 v[168:171], v[40:43], a[40:43], v[168:171]
 v_mul_f32 v20, s74, v200
 v_mul_f32 v21, s74, v201
 v_mfma_f32_16x16x32_bf16 v[168:171], v[44:47], a[56:59], v[168:171]
 v_mul_f32 v187, v187, v19
 v_mul_f32 v22, s74, v202
 v_mfma_f32_16x16x32_bf16 v[172:175], v[36:39], a[28:31], v[172:175]
 v_exp_f32 v20, v20
 v_mul_f32 v23, s74, v203
 v_mfma_f32_16x16x32_bf16 v[172:175], v[40:43], a[44:47], v[172:175]
 v_exp_f32 v21, v21
 v_mfma_f32_16x16x32_bf16 v[172:175], v[44:47], a[60:63], v[172:175]
 s_waitcnt lgkmcnt(4)
 v_exp_f32 v22, v22
 v_cvt_pk_bf16_f32 v89, v186, v187
 v_mfma_f32_16x16x32_bf16 v[112:115], v[24:27], a[64:67], v[112:115]
 s_waitcnt lgkmcnt(2)
 ds_read_b64_tr_b16 v[36:37], v7 offset:49152
 v_add_f32 v20, 1.0, v20
 v_mfma_f32_16x16x32_bf16 v[112:115], v[28:31], a[80:83], v[112:115]
 s_waitcnt lgkmcnt(1)
 ds_read_b64_tr_b16 v[38:39], v7 offset:49664
 v_add_f32 v21, 1.0, v21
 v_mfma_f32_16x16x32_bf16 v[112:115], v[32:35], a[96:99], v[112:115]
 ds_read_b64_tr_b16 v[40:41], v7 offset:53248
 v_exp_f32 v23, v23
 v_mfma_f32_16x16x32_bf16 v[116:119], v[24:27], a[68:71], v[116:119]
 ds_read_b64_tr_b16 v[42:43], v7 offset:53760
 v_add_f32 v22, 1.0, v22
 v_mfma_f32_16x16x32_bf16 v[116:119], v[28:31], a[84:87], v[116:119]
 ds_read_b64_tr_b16 v[44:45], v7 offset:57344
 v_add_f32 v23, 1.0, v23
 v_mfma_f32_16x16x32_bf16 v[116:119], v[32:35], a[100:103], v[116:119]
 ds_read_b64_tr_b16 v[46:47], v7 offset:57856
 v_rcp_f32 v20, v20
 v_mfma_f32_16x16x32_bf16 v[120:123], v[24:27], a[72:75], v[120:123]
 s_mul_i32 s82, s88, 256
 v_rcp_f32 v21, v21
 v_mfma_f32_16x16x32_bf16 v[120:123], v[28:31], a[88:91], v[120:123]
 s_add_u32 m0, s70, 40960
 v_rcp_f32 v22, v22
 v_mul_f32 v200, v200, v20
 v_mfma_f32_16x16x32_bf16 v[120:123], v[32:35], a[104:107], v[120:123]
 s_add_u32 s58, s82, 0
 buffer_load_dwordx4 v5, s[20:23], s58 offen nt lds
 v_mfma_f32_16x16x32_bf16 v[124:127], v[24:27], a[76:79], v[124:127]
 v_rcp_f32 v23, v23
 v_mfma_f32_16x16x32_bf16 v[124:127], v[28:31], a[92:95], v[124:127]
 v_mul_f32 v201, v201, v21
 v_mul_f32 v202, v202, v22
 v_mul_f32 v16, s74, v188
 v_mfma_f32_16x16x32_bf16 v[124:127], v[32:35], a[108:111], v[124:127]
 s_waitcnt lgkmcnt(4)
 v_mul_f32 v203, v203, v23
 v_mul_f32 v17, s74, v189
 v_mfma_f32_16x16x32_bf16 v[128:131], v[36:39], a[64:67], v[128:131]
 s_waitcnt lgkmcnt(2)
 ds_read_b64_tr_b16 v[24:25], v8 offset:49152
 v_cvt_pk_bf16_f32 v90, v200, v201
 v_mul_f32 v18, s74, v190
 v_mfma_f32_16x16x32_bf16 v[128:131], v[40:43], a[80:83], v[128:131]
 s_waitcnt lgkmcnt(1)
 ds_read_b64_tr_b16 v[26:27], v8 offset:49664
 v_cvt_pk_bf16_f32 v91, v202, v203
 v_mfma_f32_16x16x32_bf16 v[128:131], v[44:47], a[96:99], v[128:131]
 ds_read_b64_tr_b16 v[28:29], v8 offset:53248
 v_mul_f32 v19, s74, v191
 v_mfma_f32_16x16x32_bf16 v[132:135], v[36:39], a[68:71], v[132:135]
 ds_read_b64_tr_b16 v[30:31], v8 offset:53760
 v_exp_f32 v16, v16
 v_mfma_f32_16x16x32_bf16 v[132:135], v[40:43], a[84:87], v[132:135]
 ds_read_b64_tr_b16 v[32:33], v8 offset:57344
 v_mfma_f32_16x16x32_bf16 v[132:135], v[44:47], a[100:103], v[132:135]
 ds_read_b64_tr_b16 v[34:35], v8 offset:57856
 v_add_f32 v16, 1.0, v16
 v_mfma_f32_16x16x32_bf16 v[136:139], v[36:39], a[72:75], v[136:139]
 s_add_u32 m0, s70, 45056
 v_exp_f32 v17, v17
 v_mfma_f32_16x16x32_bf16 v[136:139], v[40:43], a[88:91], v[136:139]
 s_add_u32 s58, s82, 262144
 buffer_load_dwordx4 v5, s[20:23], s58 offen nt lds
 v_mfma_f32_16x16x32_bf16 v[136:139], v[44:47], a[104:107], v[136:139]
 v_exp_f32 v18, v18
 v_add_f32 v17, 1.0, v17
 v_mfma_f32_16x16x32_bf16 v[140:143], v[36:39], a[76:79], v[140:143]
 v_exp_f32 v19, v19
 v_mfma_f32_16x16x32_bf16 v[140:143], v[40:43], a[92:95], v[140:143]
 v_rcp_f32 v16, v16
 v_mfma_f32_16x16x32_bf16 v[140:143], v[44:47], a[108:111], v[140:143]
 s_waitcnt lgkmcnt(4)
 v_rcp_f32 v17, v17
 v_add_f32 v18, 1.0, v18
 v_mfma_f32_16x16x32_bf16 v[144:147], v[24:27], a[64:67], v[144:147]
 s_waitcnt lgkmcnt(2)
 ds_read_b64_tr_b16 v[36:37], v9 offset:49152
 v_add_f32 v19, 1.0, v19
 v_mfma_f32_16x16x32_bf16 v[144:147], v[28:31], a[80:83], v[144:147]
 s_waitcnt lgkmcnt(1)
 ds_read_b64_tr_b16 v[38:39], v9 offset:49664
 v_rcp_f32 v18, v18
 v_mfma_f32_16x16x32_bf16 v[144:147], v[32:35], a[96:99], v[144:147]
 ds_read_b64_tr_b16 v[40:41], v9 offset:53248
 v_mul_f32 v188, v188, v16
 v_mfma_f32_16x16x32_bf16 v[148:151], v[24:27], a[68:71], v[148:151]
 ds_read_b64_tr_b16 v[42:43], v9 offset:53760
 v_mul_f32 v189, v189, v17
 v_mfma_f32_16x16x32_bf16 v[148:151], v[28:31], a[84:87], v[148:151]
 ds_read_b64_tr_b16 v[44:45], v9 offset:57344
 v_rcp_f32 v19, v19
 v_mfma_f32_16x16x32_bf16 v[148:151], v[32:35], a[100:103], v[148:151]
 ds_read_b64_tr_b16 v[46:47], v9 offset:57856
 v_mul_f32 v190, v190, v18
 v_mfma_f32_16x16x32_bf16 v[152:155], v[24:27], a[72:75], v[152:155]
 v_add_u32 v6, 0xc000, v6
 v_add_u32 v7, 0xc000, v7
 v_mul_f32 v191, v191, v19
 v_mfma_f32_16x16x32_bf16 v[152:155], v[28:31], a[88:91], v[152:155]
 s_add_u32 m0, s70, 49152
 v_add_u32 v8, 0xc000, v8
 v_add_u32 v9, 0xc000, v9
 v_mfma_f32_16x16x32_bf16 v[152:155], v[32:35], a[104:107], v[152:155]
 s_add_u32 s58, s82, 524288
 buffer_load_dwordx4 v5, s[20:23], s58 offen nt lds
 v_mfma_f32_16x16x32_bf16 v[156:159], v[24:27], a[76:79], v[156:159]
 v_cvt_pk_bf16_f32 v92, v188, v189
 v_cvt_pk_bf16_f32 v93, v190, v191
 v_mul_f32 v20, s74, v204
 v_mfma_f32_16x16x32_bf16 v[156:159], v[28:31], a[92:95], v[156:159]
 v_mul_f32 v21, s74, v205
 v_mul_f32 v22, s74, v206
 v_mfma_f32_16x16x32_bf16 v[156:159], v[32:35], a[108:111], v[156:159]
 s_waitcnt lgkmcnt(4)
 v_exp_f32 v20, v20
 v_mul_f32 v23, s74, v207
 v_mfma_f32_16x16x32_bf16 v[160:163], v[36:39], a[64:67], v[160:163]
 s_waitcnt lgkmcnt(2)
 ds_read_b64_tr_b16 v[24:25], v6 offset:12288
 v_mfma_f32_16x16x32_bf16 v[160:163], v[40:43], a[80:83], v[160:163]
 s_waitcnt lgkmcnt(1)
 ds_read_b64_tr_b16 v[26:27], v6 offset:12800
 v_add_f32 v20, 1.0, v20
 v_mfma_f32_16x16x32_bf16 v[160:163], v[44:47], a[96:99], v[160:163]
 ds_read_b64_tr_b16 v[28:29], v6 offset:16384
 v_exp_f32 v21, v21
 v_mfma_f32_16x16x32_bf16 v[164:167], v[36:39], a[68:71], v[164:167]
 ds_read_b64_tr_b16 v[30:31], v6 offset:16896
 v_mfma_f32_16x16x32_bf16 v[164:167], v[40:43], a[84:87], v[164:167]
 ds_read_b64_tr_b16 v[32:33], v6 offset:20480
 v_exp_f32 v22, v22
 v_mfma_f32_16x16x32_bf16 v[164:167], v[44:47], a[100:103], v[164:167]
 ds_read_b64_tr_b16 v[34:35], v6 offset:20992
 v_add_f32 v21, 1.0, v21
 v_mfma_f32_16x16x32_bf16 v[168:171], v[36:39], a[72:75], v[168:171]
 v_exp_f32 v23, v23
 v_add_f32 v22, 1.0, v22
 v_mfma_f32_16x16x32_bf16 v[168:171], v[40:43], a[88:91], v[168:171]
 v_rcp_f32 v20, v20
 v_mfma_f32_16x16x32_bf16 v[168:171], v[44:47], a[104:107], v[168:171]
 v_rcp_f32 v21, v21
 v_mfma_f32_16x16x32_bf16 v[172:175], v[36:39], a[76:79], v[172:175]
 v_rcp_f32 v22, v22
 v_add_f32 v23, 1.0, v23
 v_mfma_f32_16x16x32_bf16 v[172:175], v[40:43], a[92:95], v[172:175]
 v_mul_f32 v204, v204, v20
 v_mul_f32 v205, v205, v21
 v_mfma_f32_16x16x32_bf16 v[172:175], v[44:47], a[108:111], v[172:175]
 s_waitcnt lgkmcnt(4)
 v_rcp_f32 v23, v23
 v_mul_f32 v206, v206, v22
 v_mfma_f32_16x16x32_bf16 v[112:115], v[24:27], a[112:115], v[112:115]
 s_waitcnt lgkmcnt(2)
 ds_read_b64_tr_b16 v[36:37], v7 offset:12288
 v_cvt_pk_bf16_f32 v94, v204, v205
 v_mfma_f32_16x16x32_bf16 v[112:115], v[28:31], a[128:131], v[112:115]
 s_waitcnt lgkmcnt(1)
 ds_read_b64_tr_b16 v[38:39], v7 offset:12800
 v_mul_f32 v207, v207, v23
 v_mfma_f32_16x16x32_bf16 v[112:115], v[32:35], a[144:147], v[112:115]
 ds_read_b64_tr_b16 v[40:41], v7 offset:16384
 v_mul_f32 v16, s74, v208
 v_mul_f32 v17, s74, v209
 v_mfma_f32_16x16x32_bf16 v[116:119], v[24:27], a[116:119], v[116:119]
 ds_read_b64_tr_b16 v[42:43], v7 offset:16896
 v_cvt_pk_bf16_f32 v95, v206, v207
 v_mfma_f32_16x16x32_bf16 v[116:119], v[28:31], a[132:135], v[116:119]
 ds_read_b64_tr_b16 v[44:45], v7 offset:20480
 v_mul_f32 v18, s74, v210
 v_mul_f32 v19, s74, v211
 v_mfma_f32_16x16x32_bf16 v[116:119], v[32:35], a[148:151], v[116:119]
 ds_read_b64_tr_b16 v[46:47], v7 offset:20992
 v_mfma_f32_16x16x32_bf16 v[120:123], v[24:27], a[120:123], v[120:123]
 s_mul_i32 s83, s89, 256
 v_exp_f32 v16, v16
 v_mfma_f32_16x16x32_bf16 v[120:123], v[28:31], a[136:139], v[120:123]
 s_add_u32 m0, s70, 53248
 v_exp_f32 v17, v17
 v_mfma_f32_16x16x32_bf16 v[120:123], v[32:35], a[152:155], v[120:123]
 s_add_u32 s58, s83, 0
 buffer_load_dwordx4 v5, s[20:23], s58 offen nt lds
 v_mfma_f32_16x16x32_bf16 v[124:127], v[24:27], a[124:127], v[124:127]
 v_exp_f32 v18, v18
 v_add_f32 v16, 1.0, v16
 v_mfma_f32_16x16x32_bf16 v[124:127], v[28:31], a[140:143], v[124:127]
 v_exp_f32 v19, v19
 v_mfma_f32_16x16x32_bf16 v[124:127], v[32:35], a[156:159], v[124:127]
 s_waitcnt lgkmcnt(4)
 v_rcp_f32 v16, v16
 v_add_f32 v17, 1.0, v17
 v_mfma_f32_16x16x32_bf16 v[128:131], v[36:39], a[112:115], v[128:131]
 s_waitcnt lgkmcnt(2)
 ds_read_b64_tr_b16 v[24:25], v8 offset:12288
 v_add_f32 v18, 1.0, v18
 v_mfma_f32_16x16x32_bf16 v[128:131], v[40:43], a[128:131], v[128:131]
 s_waitcnt lgkmcnt(1)
 ds_read_b64_tr_b16 v[26:27], v8 offset:12800
 v_add_f32 v19, 1.0, v19
 v_mfma_f32_16x16x32_bf16 v[128:131], v[44:47], a[144:147], v[128:131]
 ds_read_b64_tr_b16 v[28:29], v8 offset:16384
 v_rcp_f32 v17, v17
 v_mfma_f32_16x16x32_bf16 v[132:135], v[36:39], a[116:119], v[132:135]
 ds_read_b64_tr_b16 v[30:31], v8 offset:16896
 v_mul_f32 v208, v208, v16
 v_mfma_f32_16x16x32_bf16 v[132:135], v[40:43], a[132:135], v[132:135]
 ds_read_b64_tr_b16 v[32:33], v8 offset:20480
 v_rcp_f32 v18, v18
 v_mfma_f32_16x16x32_bf16 v[132:135], v[44:47], a[148:151], v[132:135]
 ds_read_b64_tr_b16 v[34:35], v8 offset:20992
 v_mul_f32 v209, v209, v17
 v_mfma_f32_16x16x32_bf16 v[136:139], v[36:39], a[120:123], v[136:139]
 v_rcp_f32 v19, v19
 v_mul_f32 v210, v210, v18
 v_mfma_f32_16x16x32_bf16 v[136:139], v[40:43], a[136:139], v[136:139]
 s_add_u32 m0, s70, 57344
 v_cvt_pk_bf16_f32 v96, v208, v209
 v_mul_f32 v20, s74, v224
 v_mfma_f32_16x16x32_bf16 v[136:139], v[44:47], a[152:155], v[136:139]
 s_add_u32 s58, s83, 262144
 buffer_load_dwordx4 v5, s[20:23], s58 offen nt lds
 v_mfma_f32_16x16x32_bf16 v[140:143], v[36:39], a[124:127], v[140:143]
 v_exp_f32 v20, v20
 v_mul_f32 v211, v211, v19
 v_mfma_f32_16x16x32_bf16 v[140:143], v[40:43], a[140:143], v[140:143]
 v_mul_f32 v21, s74, v225
 v_mul_f32 v22, s74, v226
 v_mfma_f32_16x16x32_bf16 v[140:143], v[44:47], a[156:159], v[140:143]
 s_waitcnt lgkmcnt(4)
 v_cvt_pk_bf16_f32 v97, v210, v211
 v_mul_f32 v23, s74, v227
 v_add_f32 v20, 1.0, v20
 v_mfma_f32_16x16x32_bf16 v[144:147], v[24:27], a[112:115], v[144:147]
 s_waitcnt lgkmcnt(2)
 ds_read_b64_tr_b16 v[36:37], v9 offset:12288
 v_mfma_f32_16x16x32_bf16 v[144:147], v[28:31], a[128:131], v[144:147]
 s_waitcnt lgkmcnt(1)
 ds_read_b64_tr_b16 v[38:39], v9 offset:12800
 v_exp_f32 v21, v21
 v_mfma_f32_16x16x32_bf16 v[144:147], v[32:35], a[144:147], v[144:147]
 ds_read_b64_tr_b16 v[40:41], v9 offset:16384
 v_mfma_f32_16x16x32_bf16 v[148:151], v[24:27], a[116:119], v[148:151]
 ds_read_b64_tr_b16 v[42:43], v9 offset:16896
 v_exp_f32 v22, v22
 v_mfma_f32_16x16x32_bf16 v[148:151], v[28:31], a[132:135], v[148:151]
 ds_read_b64_tr_b16 v[44:45], v9 offset:20480
 v_add_f32 v21, 1.0, v21
 v_mfma_f32_16x16x32_bf16 v[148:151], v[32:35], a[148:151], v[148:151]
 ds_read_b64_tr_b16 v[46:47], v9 offset:20992
 v_add_f32 v22, 1.0, v22
 v_mfma_f32_16x16x32_bf16 v[152:155], v[24:27], a[120:123], v[152:155]
 v_exp_f32 v23, v23
 v_mul_f32 v16, s74, v212
 v_mfma_f32_16x16x32_bf16 v[152:155], v[28:31], a[136:139], v[152:155]
 s_add_u32 m0, s70, 61440
 v_rcp_f32 v20, v20
 v_mfma_f32_16x16x32_bf16 v[152:155], v[32:35], a[152:155], v[152:155]
 s_add_u32 s58, s83, 524288
 buffer_load_dwordx4 v5, s[20:23], s58 offen nt lds
 v_add_f32 v23, 1.0, v23
 v_mfma_f32_16x16x32_bf16 v[156:159], v[24:27], a[124:127], v[156:159]
 v_rcp_f32 v21, v21
 v_mfma_f32_16x16x32_bf16 v[156:159], v[28:31], a[140:143], v[156:159]
 v_rcp_f32 v22, v22
 v_mul_f32 v224, v224, v20
 v_mfma_f32_16x16x32_bf16 v[156:159], v[32:35], a[156:159], v[156:159]
 s_waitcnt vmcnt(13)
 s_barrier
 s_waitcnt lgkmcnt(4)
 v_mfma_f32_16x16x32_bf16 v[160:163], v[36:39], a[112:115], v[160:163]
 s_waitcnt lgkmcnt(2)
 ds_read_b64_tr_b16 v[24:25], v6 offset:24576
 v_mul_f32 v225, v225, v21
 v_mfma_f32_16x16x32_bf16 v[160:163], v[40:43], a[128:131], v[160:163]
 s_waitcnt lgkmcnt(1)
 ds_read_b64_tr_b16 v[26:27], v6 offset:25088
 v_rcp_f32 v23, v23
 v_mfma_f32_16x16x32_bf16 v[160:163], v[44:47], a[144:147], v[160:163]
 ds_read_b64_tr_b16 v[28:29], v6 offset:28672
 v_mul_f32 v226, v226, v22
 v_mfma_f32_16x16x32_bf16 v[164:167], v[36:39], a[116:119], v[164:167]
 ds_read_b64_tr_b16 v[30:31], v6 offset:29184
 v_mul_f32 v227, v227, v23
 v_cvt_pk_bf16_f32 v98, v224, v225
 v_mfma_f32_16x16x32_bf16 v[164:167], v[40:43], a[132:135], v[164:167]
 ds_read_b64_tr_b16 v[32:33], v6 offset:32768
 v_mul_f32 v17, s74, v213
 v_mfma_f32_16x16x32_bf16 v[164:167], v[44:47], a[148:151], v[164:167]
 ds_read_b64_tr_b16 v[34:35], v6 offset:33280
 v_cvt_pk_bf16_f32 v99, v226, v227
 v_mul_f32 v18, s74, v214
 v_mfma_f32_16x16x32_bf16 v[168:171], v[36:39], a[120:123], v[168:171]
 v_exp_f32 v16, v16
 v_mfma_f32_16x16x32_bf16 v[168:171], v[40:43], a[136:139], v[168:171]
 v_exp_f32 v17, v17
 v_mul_f32 v19, s74, v215
 v_mfma_f32_16x16x32_bf16 v[168:171], v[44:47], a[152:155], v[168:171]
 v_exp_f32 v18, v18
 v_mfma_f32_16x16x32_bf16 v[172:175], v[36:39], a[124:127], v[172:175]
 v_exp_f32 v19, v19
 v_mfma_f32_16x16x32_bf16 v[172:175], v[40:43], a[140:143], v[172:175]
 v_add_f32 v16, 1.0, v16
 v_add_f32 v17, 1.0, v17
 v_add_f32 v18, 1.0, v18
 v_mfma_f32_16x16x32_bf16 v[172:175], v[44:47], a[156:159], v[172:175]
 s_waitcnt lgkmcnt(4)
 v_add_f32 v19, 1.0, v19
 v_mul_f32 v20, s74, v228
 v_mfma_f32_16x16x32_bf16 v[112:115], v[24:27], a[160:163], v[112:115]
 s_waitcnt lgkmcnt(2)
 ds_read_b64_tr_b16 v[36:37], v7 offset:24576
 v_rcp_f32 v16, v16
 v_mfma_f32_16x16x32_bf16 v[112:115], v[28:31], a[176:179], v[112:115]
 s_waitcnt lgkmcnt(1)
 ds_read_b64_tr_b16 v[38:39], v7 offset:25088
 v_mul_f32 v21, s74, v229
 v_mfma_f32_16x16x32_bf16 v[112:115], v[32:35], a[192:195], v[112:115]
 ds_read_b64_tr_b16 v[40:41], v7 offset:28672
 v_rcp_f32 v17, v17
 v_mfma_f32_16x16x32_bf16 v[116:119], v[24:27], a[164:167], v[116:119]
 ds_read_b64_tr_b16 v[42:43], v7 offset:29184
 v_mul_f32 v212, v212, v16
 v_mfma_f32_16x16x32_bf16 v[116:119], v[28:31], a[180:183], v[116:119]
 ds_read_b64_tr_b16 v[44:45], v7 offset:32768
 v_rcp_f32 v18, v18
 v_mfma_f32_16x16x32_bf16 v[116:119], v[32:35], a[196:199], v[116:119]
 ds_read_b64_tr_b16 v[46:47], v7 offset:33280
 v_mul_f32 v213, v213, v17
 v_mfma_f32_16x16x32_bf16 v[120:123], v[24:27], a[168:171], v[120:123]
 s_mul_i32 s84, s90, 256
 v_rcp_f32 v19, v19
 v_mfma_f32_16x16x32_bf16 v[120:123], v[28:31], a[184:187], v[120:123]
 s_add_u32 m0, s70, 65536
 v_exp_f32 v20, v20
 v_mul_f32 v214, v214, v18
 v_mfma_f32_16x16x32_bf16 v[120:123], v[32:35], a[200:203], v[120:123]
 s_add_u32 s58, s84, 0
 buffer_load_dwordx4 v5, s[20:23], s58 offen nt lds
 v_mfma_f32_16x16x32_bf16 v[124:127], v[24:27], a[172:175], v[124:127]
 v_exp_f32 v21, v21
 v_mul_f32 v215, v215, v19
 v_mfma_f32_16x16x32_bf16 v[124:127], v[28:31], a[188:191], v[124:127]
 v_cvt_pk_bf16_f32 v100, v212, v213
 v_mul_f32 v22, s74, v230
 v_mfma_f32_16x16x32_bf16 v[124:127], v[32:35], a[204:207], v[124:127]
 s_waitcnt lgkmcnt(4)
 v_cvt_pk_bf16_f32 v101, v214, v215
 v_mul_f32 v23, s74, v231
 v_add_f32 v20, 1.0, v20
 v_mfma_f32_16x16x32_bf16 v[128:131], v[36:39], a[160:163], v[128:131]
 s_waitcnt lgkmcnt(2)
 ds_read_b64_tr_b16 v[24:25], v8 offset:24576
 v_add_f32 v21, 1.0, v21
 v_mfma_f32_16x16x32_bf16 v[128:131], v[40:43], a[176:179], v[128:131]
 s_waitcnt lgkmcnt(1)
 ds_read_b64_tr_b16 v[26:27], v8 offset:25088
 v_exp_f32 v22, v22
 v_mfma_f32_16x16x32_bf16 v[128:131], v[44:47], a[192:195], v[128:131]
 ds_read_b64_tr_b16 v[28:29], v8 offset:28672
 v_mul_f32 v16, s74, v216
 v_mfma_f32_16x16x32_bf16 v[132:135], v[36:39], a[164:167], v[132:135]
 ds_read_b64_tr_b16 v[30:31], v8 offset:29184
 v_add_f32 v22, 1.0, v22
 v_mfma_f32_16x16x32_bf16 v[132:135], v[40:43], a[180:183], v[132:135]
 ds_read_b64_tr_b16 v[32:33], v8 offset:32768
 v_exp_f32 v23, v23
 v_mfma_f32_16x16x32_bf16 v[132:135], v[44:47], a[196:199], v[132:135]
 ds_read_b64_tr_b16 v[34:35], v8 offset:33280
 v_mul_f32 v17, s74, v217
 v_mfma_f32_16x16x32_bf16 v[136:139], v[36:39], a[168:171], v[136:139]
 v_rcp_f32 v20, v20
 v_add_f32 v23, 1.0, v23
 v_mfma_f32_16x16x32_bf16 v[136:139], v[40:43], a[184:187], v[136:139]
 s_add_u32 m0, s70, 69632
 v_rcp_f32 v21, v21
 v_mfma_f32_16x16x32_bf16 v[136:139], v[44:47], a[200:203], v[136:139]
 s_add_u32 s58, s84, 262144
 buffer_load_dwordx4 v5, s[20:23], s58 offen nt lds
 v_mul_f32 v228, v228, v20
 v_mfma_f32_16x16x32_bf16 v[140:143], v[36:39], a[172:175], v[140:143]
 v_rcp_f32 v22, v22
 v_mfma_f32_16x16x32_bf16 v[140:143], v[40:43], a[188:191], v[140:143]
 v_rcp_f32 v23, v23
 v_mul_f32 v229, v229, v21
 v_mfma_f32_16x16x32_bf16 v[140:143], v[44:47], a[204:207], v[140:143]
 s_waitcnt lgkmcnt(4)
 v_exp_f32 v16, v16
 v_mfma_f32_16x16x32_bf16 v[144:147], v[24:27], a[160:163], v[144:147]
 s_waitcnt lgkmcnt(2)
 ds_read_b64_tr_b16 v[36:37], v9 offset:24576
 v_mul_f32 v230, v230, v22
 v_mfma_f32_16x16x32_bf16 v[144:147], v[28:31], a[176:179], v[144:147]
 s_waitcnt lgkmcnt(1)
 ds_read_b64_tr_b16 v[38:39], v9 offset:25088
 v_mul_f32 v231, v231, v23
 v_cvt_pk_bf16_f32 v102, v228, v229
 v_mfma_f32_16x16x32_bf16 v[144:147], v[32:35], a[192:195], v[144:147]
 ds_read_b64_tr_b16 v[40:41], v9 offset:28672
 v_mul_f32 v18, s74, v218
 v_mfma_f32_16x16x32_bf16 v[148:151], v[24:27], a[164:167], v[148:151]
 ds_read_b64_tr_b16 v[42:43], v9 offset:29184
 v_cvt_pk_bf16_f32 v103, v230, v231
 v_mul_f32 v19, s74, v219
 v_mfma_f32_16x16x32_bf16 v[148:151], v[28:31], a[180:183], v[148:151]
 ds_read_b64_tr_b16 v[44:45], v9 offset:32768
 v_add_f32 v16, 1.0, v16
 v_mfma_f32_16x16x32_bf16 v[148:151], v[32:35], a[196:199], v[148:151]
 ds_read_b64_tr_b16 v[46:47], v9 offset:33280
 v_exp_f32 v17, v17
 v_mfma_f32_16x16x32_bf16 v[152:155], v[24:27], a[168:171], v[152:155]
 v_exp_f32 v18, v18
 v_mfma_f32_16x16x32_bf16 v[152:155], v[28:31], a[184:187], v[152:155]
 s_add_u32 m0, s70, 73728
 v_exp_f32 v19, v19
 v_add_f32 v17, 1.0, v17
 v_mfma_f32_16x16x32_bf16 v[152:155], v[32:35], a[200:203], v[152:155]
 s_add_u32 s58, s84, 524288
 buffer_load_dwordx4 v5, s[20:23], s58 offen nt lds
 v_mfma_f32_16x16x32_bf16 v[156:159], v[24:27], a[172:175], v[156:159]
 v_rcp_f32 v16, v16
 v_mfma_f32_16x16x32_bf16 v[156:159], v[28:31], a[188:191], v[156:159]
 v_rcp_f32 v17, v17
 v_add_f32 v18, 1.0, v18
 v_mfma_f32_16x16x32_bf16 v[156:159], v[32:35], a[204:207], v[156:159]
 s_waitcnt lgkmcnt(4)
 v_add_f32 v19, 1.0, v19
 v_mul_f32 v216, v216, v16
 v_mfma_f32_16x16x32_bf16 v[160:163], v[36:39], a[160:163], v[160:163]
 s_waitcnt lgkmcnt(2)
 ds_read_b64_tr_b16 v[24:25], v6 offset:36864
 v_rcp_f32 v18, v18
 v_mfma_f32_16x16x32_bf16 v[160:163], v[40:43], a[176:179], v[160:163]
 s_waitcnt lgkmcnt(1)
 ds_read_b64_tr_b16 v[26:27], v6 offset:37376
 v_mul_f32 v217, v217, v17
 v_mfma_f32_16x16x32_bf16 v[160:163], v[44:47], a[192:195], v[160:163]
 ds_read_b64_tr_b16 v[28:29], v6 offset:40960
 v_rcp_f32 v19, v19
 v_mfma_f32_16x16x32_bf16 v[164:167], v[36:39], a[164:167], v[164:167]
 ds_read_b64_tr_b16 v[30:31], v6 offset:41472
 v_mul_f32 v218, v218, v18
 v_mfma_f32_16x16x32_bf16 v[164:167], v[40:43], a[180:183], v[164:167]
 ds_read_b64_tr_b16 v[32:33], v6 offset:45056
 v_mul_f32 v219, v219, v19
 v_cvt_pk_bf16_f32 v104, v216, v217
 v_mfma_f32_16x16x32_bf16 v[164:167], v[44:47], a[196:199], v[164:167]
 ds_read_b64_tr_b16 v[34:35], v6 offset:45568
 v_mul_f32 v20, s74, v232
 v_mfma_f32_16x16x32_bf16 v[168:171], v[36:39], a[168:171], v[168:171]
 v_cvt_pk_bf16_f32 v105, v218, v219
 v_mul_f32 v21, s74, v233
 v_mfma_f32_16x16x32_bf16 v[168:171], v[40:43], a[184:187], v[168:171]
 v_exp_f32 v20, v20
 v_mul_f32 v22, s74, v234
 v_mfma_f32_16x16x32_bf16 v[168:171], v[44:47], a[200:203], v[168:171]
 v_exp_f32 v21, v21
 v_mfma_f32_16x16x32_bf16 v[172:175], v[36:39], a[172:175], v[172:175]
 v_exp_f32 v22, v22
 v_mul_f32 v23, s74, v235
 v_mfma_f32_16x16x32_bf16 v[172:175], v[40:43], a[188:191], v[172:175]
 v_add_f32 v20, 1.0, v20
 v_add_f32 v21, 1.0, v21
 v_mfma_f32_16x16x32_bf16 v[172:175], v[44:47], a[204:207], v[172:175]
 s_waitcnt lgkmcnt(4)
 v_exp_f32 v23, v23
 v_add_f32 v22, 1.0, v22
 v_mfma_f32_16x16x32_bf16 v[112:115], v[24:27], a[208:211], v[112:115]
 s_waitcnt lgkmcnt(2)
 ds_read_b64_tr_b16 v[36:37], v7 offset:36864
 v_mul_f32 v16, s74, v220
 v_mfma_f32_16x16x32_bf16 v[112:115], v[28:31], a[224:227], v[112:115]
 s_waitcnt lgkmcnt(1)
 ds_read_b64_tr_b16 v[38:39], v7 offset:37376
 v_add_f32 v23, 1.0, v23
 v_mul_f32 v17, s74, v221
 v_mfma_f32_16x16x32_bf16 v[112:115], v[32:35], a[240:243], v[112:115]
 ds_read_b64_tr_b16 v[40:41], v7 offset:40960
 v_mul_f32 v18, s74, v222
 v_mfma_f32_16x16x32_bf16 v[116:119], v[24:27], a[212:215], v[116:119]
 ds_read_b64_tr_b16 v[42:43], v7 offset:41472
 v_mul_f32 v19, s74, v223
 v_mfma_f32_16x16x32_bf16 v[116:119], v[28:31], a[228:231], v[116:119]
 ds_read_b64_tr_b16 v[44:45], v7 offset:45056
 v_rcp_f32 v20, v20
 v_mfma_f32_16x16x32_bf16 v[116:119], v[32:35], a[244:247], v[116:119]
 ds_read_b64_tr_b16 v[46:47], v7 offset:45568
 v_mfma_f32_16x16x32_bf16 v[120:123], v[24:27], a[216:219], v[120:123]
 s_mul_i32 s85, s91, 256
 v_rcp_f32 v21, v21
 v_mul_f32 v232, v232, v20
 v_mfma_f32_16x16x32_bf16 v[120:123], v[28:31], a[232:235], v[120:123]
 s_add_u32 m0, s70, 77824
 v_rcp_f32 v22, v22
 v_mfma_f32_16x16x32_bf16 v[120:123], v[32:35], a[248:251], v[120:123]
 s_add_u32 s58, s85, 0
 buffer_load_dwordx4 v5, s[20:23], s58 offen nt lds
 v_mul_f32 v233, v233, v21
 v_mfma_f32_16x16x32_bf16 v[124:127], v[24:27], a[220:223], v[124:127]
 v_rcp_f32 v23, v23
 v_mfma_f32_16x16x32_bf16 v[124:127], v[28:31], a[236:239], v[124:127]
 v_exp_f32 v16, v16
 v_mul_f32 v234, v234, v22
 v_mfma_f32_16x16x32_bf16 v[124:127], v[32:35], a[252:255], v[124:127]
 s_waitcnt lgkmcnt(4)
 v_exp_f32 v17, v17
 v_mfma_f32_16x16x32_bf16 v[128:131], v[36:39], a[208:211], v[128:131]
 s_waitcnt lgkmcnt(2)
 ds_read_b64_tr_b16 v[24:25], v8 offset:36864
 v_mul_f32 v235, v235, v23
 v_cvt_pk_bf16_f32 v106, v232, v233
 v_mfma_f32_16x16x32_bf16 v[128:131], v[40:43], a[224:227], v[128:131]
 s_waitcnt lgkmcnt(1)
 ds_read_b64_tr_b16 v[26:27], v8 offset:37376
 v_add_f32 v16, 1.0, v16
 v_mfma_f32_16x16x32_bf16 v[128:131], v[44:47], a[240:243], v[128:131]
 ds_read_b64_tr_b16 v[28:29], v8 offset:40960
 v_cvt_pk_bf16_f32 v107, v234, v235
 v_add_f32 v17, 1.0, v17
 v_mfma_f32_16x16x32_bf16 v[132:135], v[36:39], a[212:215], v[132:135]
 ds_read_b64_tr_b16 v[30:31], v8 offset:41472
 v_mfma_f32_16x16x32_bf16 v[132:135], v[40:43], a[228:231], v[132:135]
 ds_read_b64_tr_b16 v[32:33], v8 offset:45056
 v_exp_f32 v18, v18
 v_mfma_f32_16x16x32_bf16 v[132:135], v[44:47], a[244:247], v[132:135]
 s_add_u32 m0, s70, 81920
 ds_read_b64_tr_b16 v[34:35], v8 offset:45568
 v_mul_f32 v20, s74, v236
 v_mfma_f32_16x16x32_bf16 v[136:139], v[36:39], a[216:219], v[136:139]
 s_add_u32 s58, s85, 262144
 buffer_load_dwordx4 v5, s[20:23], s58 offen nt lds
 v_add_f32 v18, 1.0, v18
 v_mfma_f32_16x16x32_bf16 v[136:139], v[40:43], a[232:235], v[136:139]
 v_exp_f32 v19, v19
 v_mfma_f32_16x16x32_bf16 v[136:139], v[44:47], a[248:251], v[136:139]
 v_rcp_f32 v16, v16
 v_mul_f32 v21, s74, v237
 v_mfma_f32_16x16x32_bf16 v[140:143], v[36:39], a[220:223], v[140:143]
 s_add_u32 m0, s70, 86016
 v_rcp_f32 v17, v17
 v_mfma_f32_16x16x32_bf16 v[140:143], v[40:43], a[236:239], v[140:143]
 s_add_u32 s58, s85, 524288
 buffer_load_dwordx4 v5, s[20:23], s58 offen nt lds
 v_add_f32 v19, 1.0, v19
 v_mfma_f32_16x16x32_bf16 v[140:143], v[44:47], a[252:255], v[140:143]
 s_waitcnt lgkmcnt(4)
 v_rcp_f32 v18, v18
 v_mfma_f32_16x16x32_bf16 v[144:147], v[24:27], a[208:211], v[144:147]
 s_waitcnt lgkmcnt(2)
 ds_read_b64_tr_b16 v[36:37], v9 offset:36864
 v_mul_f32 v220, v220, v16
 v_mfma_f32_16x16x32_bf16 v[144:147], v[28:31], a[224:227], v[144:147]
 s_waitcnt lgkmcnt(1)
 ds_read_b64_tr_b16 v[38:39], v9 offset:37376
 v_rcp_f32 v19, v19
 v_mfma_f32_16x16x32_bf16 v[144:147], v[32:35], a[240:243], v[144:147]
 ds_read_b64_tr_b16 v[40:41], v9 offset:40960
 v_mul_f32 v221, v221, v17
 v_mul_f32 v222, v222, v18
 v_mfma_f32_16x16x32_bf16 v[148:151], v[24:27], a[212:215], v[148:151]
 ds_read_b64_tr_b16 v[42:43], v9 offset:41472
 v_mul_f32 v223, v223, v19
 v_mfma_f32_16x16x32_bf16 v[148:151], v[28:31], a[228:231], v[148:151]
 ds_read_b64_tr_b16 v[44:45], v9 offset:45056
 v_cvt_pk_bf16_f32 v108, v220, v221
 v_mfma_f32_16x16x32_bf16 v[148:151], v[32:35], a[244:247], v[148:151]
 ds_read_b64_tr_b16 v[46:47], v9 offset:45568
 v_cvt_pk_bf16_f32 v109, v222, v223
 v_mul_f32 v22, s74, v238
 v_mfma_f32_16x16x32_bf16 v[152:155], v[24:27], a[216:219], v[152:155]
 v_lshrrev_b32 v10, 4, v1
 v_bfe_u32 v11, v1, 2, 2
 v_mul_f32 v23, s74, v239
 v_mfma_f32_16x16x32_bf16 v[152:155], v[28:31], a[232:235], v[152:155]
 v_lshl_add_u32 v12, v10, 3, v11
 v_and_b32 v10, 1, v10
 v_mfma_f32_16x16x32_bf16 v[152:155], v[32:35], a[248:251], v[152:155]
 v_lshlrev_b32 v12, 7, v12
 v_lshrrev_b32 v11, 1, v11
 v_mfma_f32_16x16x32_bf16 v[156:159], v[24:27], a[220:223], v[156:159]
 v_add_u32 v12, 139264, v12
 v_lshl_or_b32 v10, v10, 1, v11
 v_mfma_f32_16x16x32_bf16 v[156:159], v[28:31], a[236:239], v[156:159]
 v_lshlrev_b32 v10, 1, v10
 v_and_b32 v11, 3, v1
 v_mfma_f32_16x16x32_bf16 v[156:159], v[32:35], a[252:255], v[156:159]
 s_waitcnt vmcnt(12)
 s_barrier
 s_waitcnt lgkmcnt(4)
 v_xor_b32 v10, v10, v11
 v_lshl_add_u32 v6, v10, 4, v12
 v_xor_b32 v10, 4, v10
 v_lshl_add_u32 v7, v10, 4, v12
 v_mfma_f32_16x16x32_bf16 v[160:163], v[36:39], a[208:211], v[160:163]
 s_waitcnt lgkmcnt(2)
 ds_read_b64_tr_b16 v[24:25], v6 offset:0
 v_exp_f32 v20, v20
 v_mfma_f32_16x16x32_bf16 v[160:163], v[40:43], a[224:227], v[160:163]
 s_waitcnt lgkmcnt(1)
 ds_read_b64_tr_b16 v[26:27], v6 offset:512
 v_exp_f32 v21, v21
 v_mfma_f32_16x16x32_bf16 v[160:163], v[44:47], a[240:243], v[160:163]
 ds_read_b64_tr_b16 v[28:29], v6 offset:4096
 v_add_f32 v20, 1.0, v20
 v_mfma_f32_16x16x32_bf16 v[164:167], v[36:39], a[212:215], v[164:167]
 ds_read_b64_tr_b16 v[30:31], v6 offset:4608
 v_exp_f32 v22, v22
 v_mfma_f32_16x16x32_bf16 v[164:167], v[40:43], a[228:231], v[164:167]
 ds_read_b64_tr_b16 v[32:33], v6 offset:8192
 v_add_f32 v21, 1.0, v21
 v_mfma_f32_16x16x32_bf16 v[164:167], v[44:47], a[244:247], v[164:167]
 ds_read_b64_tr_b16 v[34:35], v6 offset:8704
 v_exp_f32 v23, v23
 v_mfma_f32_16x16x32_bf16 v[168:171], v[36:39], a[216:219], v[168:171]
 v_rcp_f32 v20, v20
 v_add_f32 v22, 1.0, v22
 v_mfma_f32_16x16x32_bf16 v[168:171], v[40:43], a[232:235], v[168:171]
 v_rcp_f32 v21, v21
 v_mfma_f32_16x16x32_bf16 v[168:171], v[44:47], a[248:251], v[168:171]
 v_rcp_f32 v22, v22
 v_add_f32 v23, 1.0, v23
 v_mfma_f32_16x16x32_bf16 v[172:175], v[36:39], a[220:223], v[172:175]
 v_mul_f32 v236, v236, v20
 v_mul_f32 v237, v237, v21
 v_mfma_f32_16x16x32_bf16 v[172:175], v[40:43], a[236:239], v[172:175]
 v_rcp_f32 v23, v23
 v_mul_f32 v238, v238, v22
 v_mfma_f32_16x16x32_bf16 v[172:175], v[44:47], a[252:255], v[172:175]
 s_waitcnt lgkmcnt(4)
 v_mul_f32 v239, v239, v23
 v_cvt_pk_bf16_f32 v110, v236, v237
 v_cvt_pk_bf16_f32 v111, v238, v239
 v_mfma_f32_16x16x32_bf16 v[176:179], v[24:27], v[48:51], 0
 s_waitcnt lgkmcnt(2)
 ds_read_b64_tr_b16 v[36:37], v6 offset:8
 v_mfma_f32_16x16x32_bf16 v[176:179], v[28:31], v[64:67], v[176:179]
 s_waitcnt lgkmcnt(1)
 ds_read_b64_tr_b16 v[38:39], v6 offset:520
 v_mfma_f32_16x16x32_bf16 v[176:179], v[32:35], a[0:3], v[176:179]
 ds_read_b64_tr_b16 v[40:41], v6 offset:4104
 v_lshrrev_b32 v13, 4, v1
 v_mfma_f32_16x16x32_bf16 v[180:183], v[24:27], v[52:55], 0
 ds_read_b64_tr_b16 v[42:43], v6 offset:4616
 v_and_b32 v14, 15, v1
 v_mfma_f32_16x16x32_bf16 v[180:183], v[28:31], v[68:71], v[180:183]
 ds_read_b64_tr_b16 v[44:45], v6 offset:8200
 v_lshlrev_b32 v15, 8, v13
 v_mfma_f32_16x16x32_bf16 v[180:183], v[32:35], a[4:7], v[180:183]
 ds_read_b64_tr_b16 v[46:47], v6 offset:8712
 v_or_b32 v240, 0, v13
 v_mfma_f32_16x16x32_bf16 v[184:187], v[24:27], v[56:59], 0
 v_add_u32 v15, s72, v15
 v_or_b32 v241, 4, v13
 v_mfma_f32_16x16x32_bf16 v[184:187], v[28:31], v[72:75], v[184:187]
 s_add_u32 m0, s70, 90112
 v_xor_b32 v240, v240, v14
 v_or_b32 v242, 8, v13
 v_mfma_f32_16x16x32_bf16 v[184:187], v[32:35], a[8:11], v[184:187]
 s_add_u32 s58, s80, 128
 buffer_load_dwordx4 v5, s[20:23], s58 offen nt lds
 v_mfma_f32_16x16x32_bf16 v[188:191], v[24:27], v[60:63], 0
 v_lshl_add_u32 v240, v240, 4, v15
 v_xor_b32 v241, v241, v14
 v_mfma_f32_16x16x32_bf16 v[188:191], v[28:31], v[76:79], v[188:191]
 v_xor_b32 v242, v242, v14
 v_or_b32 v243, 12, v13
 v_mfma_f32_16x16x32_bf16 v[188:191], v[32:35], a[12:15], v[188:191]
 s_waitcnt lgkmcnt(4)
 v_lshl_add_u32 v241, v241, 4, v15
 v_or_b32 v244, 0, v13
 v_mfma_f32_16x16x32_bf16 v[192:195], v[36:39], v[48:51], 0
 s_waitcnt lgkmcnt(2)
 ds_read_b64_tr_b16 v[24:25], v7 offset:0
 v_lshl_add_u32 v242, v242, 4, v15
 v_mfma_f32_16x16x32_bf16 v[192:195], v[40:43], v[64:67], v[192:195]
 s_waitcnt lgkmcnt(1)
 ds_read_b64_tr_b16 v[26:27], v7 offset:512
 v_xor_b32 v243, v243, v14
 v_mfma_f32_16x16x32_bf16 v[192:195], v[44:47], a[0:3], v[192:195]
 ds_read_b64_tr_b16 v[28:29], v7 offset:4096
 v_lshlrev_b32 v244, 1, v244
 v_mfma_f32_16x16x32_bf16 v[196:199], v[36:39], v[52:55], 0
 ds_read_b64_tr_b16 v[30:31], v7 offset:4608
 v_lshl_add_u32 v243, v243, 4, v15
 v_mfma_f32_16x16x32_bf16 v[196:199], v[40:43], v[68:71], v[196:199]
 ds_read_b64_tr_b16 v[32:33], v7 offset:8192
 v_xor_b32 v244, v244, v14
 v_mfma_f32_16x16x32_bf16 v[196:199], v[44:47], a[4:7], v[196:199]
 ds_read_b64_tr_b16 v[34:35], v7 offset:8704
 v_or_b32 v245, 4, v13
 v_mfma_f32_16x16x32_bf16 v[200:203], v[36:39], v[56:59], 0
 v_lshl_add_u32 v244, v244, 4, v15
 v_lshlrev_b32 v16, 16, v80
 v_mfma_f32_16x16x32_bf16 v[200:203], v[40:43], v[72:75], v[200:203]
 s_add_u32 m0, s70, 94208
 v_lshlrev_b32 v245, 1, v245
 v_and_b32 v17, s73, v80
 v_mfma_f32_16x16x32_bf16 v[200:203], v[44:47], a[8:11], v[200:203]
 s_add_u32 s58, s80, 262272
 buffer_load_dwordx4 v5, s[20:23], s58 offen nt lds
 v_mfma_f32_16x16x32_bf16 v[204:207], v[36:39], v[60:63], 0
 v_xor_b32 v245, v245, v14
 v_lshlrev_b32 v18, 16, v81
 v_mfma_f32_16x16x32_bf16 v[204:207], v[40:43], v[76:79], v[204:207]
 v_and_b32 v19, s73, v81
 v_mul_f32 v112, v112, v16
 v_mfma_f32_16x16x32_bf16 v[204:207], v[44:47], a[12:15], v[204:207]
 s_waitcnt lgkmcnt(4)
 v_lshl_add_u32 v245, v245, 4, v15
 v_mul_f32 v113, v113, v17
 v_mfma_f32_16x16x32_bf16 v[208:211], v[24:27], v[48:51], 0
 s_waitcnt lgkmcnt(2)
 ds_read_b64_tr_b16 v[36:37], v7 offset:8
 v_mul_f32 v114, v114, v18
 v_mfma_f32_16x16x32_bf16 v[208:211], v[28:31], v[64:67], v[208:211]
 s_waitcnt lgkmcnt(1)
 ds_read_b64_tr_b16 v[38:39], v7 offset:520
 v_mul_f32 v115, v115, v19
 v_mfma_f32_16x16x32_bf16 v[208:211], v[32:35], a[0:3], v[208:211]
 s_add_u32 s59, s64, 262144
 ds_read_b64_tr_b16 v[40:41], v7 offset:4104
 v_cvt_pk_bf16_f32 v80, v112, v113
 v_mfma_f32_16x16x32_bf16 v[212:215], v[24:27], v[52:55], 0
 ds_read_b64_tr_b16 v[42:43], v7 offset:4616
 v_cvt_pk_bf16_f32 v81, v114, v115
 v_mfma_f32_16x16x32_bf16 v[212:215], v[28:31], v[68:71], v[212:215]
 ds_read_b64_tr_b16 v[44:45], v7 offset:8200
 v_lshlrev_b32 v20, 16, v82
 v_mfma_f32_16x16x32_bf16 v[212:215], v[32:35], a[4:7], v[212:215]
 ds_read_b64_tr_b16 v[46:47], v7 offset:8712
 v_and_b32 v21, s73, v82
 v_mfma_f32_16x16x32_bf16 v[216:219], v[24:27], v[56:59], 0
 v_lshlrev_b32 v22, 16, v83
 v_and_b32 v23, s73, v83
 v_mfma_f32_16x16x32_bf16 v[216:219], v[28:31], v[72:75], v[216:219]
 s_add_u32 m0, s70, 98304
 v_mul_f32 v128, v128, v20
 v_mul_f32 v129, v129, v21
 v_mfma_f32_16x16x32_bf16 v[216:219], v[32:35], a[8:11], v[216:219]
 s_add_u32 s58, s80, 524416
 buffer_load_dwordx4 v5, s[20:23], s58 offen nt lds
 v_mfma_f32_16x16x32_bf16 v[220:223], v[24:27], v[60:63], 0
 v_mul_f32 v130, v130, v22
 v_mul_f32 v131, v131, v23
 v_mfma_f32_16x16x32_bf16 v[220:223], v[28:31], v[76:79], v[220:223]
 v_cvt_pk_bf16_f32 v82, v128, v129
 v_lshlrev_b32 v16, 16, v84
 v_mfma_f32_16x16x32_bf16 v[220:223], v[32:35], a[12:15], v[220:223]
 s_waitcnt lgkmcnt(4)
 v_cvt_pk_bf16_f32 v83, v130, v131
 v_and_b32 v17, s73, v84
 v_mfma_f32_16x16x32_bf16 v[224:227], v[36:39], v[48:51], 0
 s_waitcnt lgkmcnt(2)
 ds_read_b64_tr_b16 v[24:25], v6 offset:12288
 v_lshlrev_b32 v18, 16, v85
 v_mfma_f32_16x16x32_bf16 v[224:227], v[40:43], v[64:67], v[224:227]
 s_waitcnt lgkmcnt(1)
 ds_read_b64_tr_b16 v[26:27], v6 offset:12800
 v_and_b32 v19, s73, v85
 v_mfma_f32_16x16x32_bf16 v[224:227], v[44:47], a[0:3], v[224:227]
 ds_read_b64_tr_b16 v[28:29], v6 offset:16384
 v_mul_f32 v116, v116, v16
 v_mfma_f32_16x16x32_bf16 v[228:231], v[36:39], v[52:55], 0
 ds_read_b64_tr_b16 v[30:31], v6 offset:16896
 v_mul_f32 v117, v117, v17
 v_mfma_f32_16x16x32_bf16 v[228:231], v[40:43], v[68:71], v[228:231]
 ds_read_b64_tr_b16 v[32:33], v6 offset:20480
 v_mul_f32 v118, v118, v18
 v_mfma_f32_16x16x32_bf16 v[228:231], v[44:47], a[4:7], v[228:231]
 ds_read_b64_tr_b16 v[34:35], v6 offset:20992
 v_mul_f32 v119, v119, v19
 v_mfma_f32_16x16x32_bf16 v[232:235], v[36:39], v[56:59], 0
 buffer_store_dwordx4 v[80:83], v2, s[32:35], s59 offen sc1
 v_mfma_f32_16x16x32_bf16 v[232:235], v[40:43], v[72:75], v[232:235]
 s_add_u32 s59, s65, 262144
 v_cvt_pk_bf16_f32 v84, v116, v117
 v_cvt_pk_bf16_f32 v85, v118, v119
 v_mfma_f32_16x16x32_bf16 v[232:235], v[44:47], a[8:11], v[232:235]
 v_lshlrev_b32 v20, 16, v86
 v_and_b32 v21, s73, v86
 v_mfma_f32_16x16x32_bf16 v[236:239], v[36:39], v[60:63], 0
 v_lshlrev_b32 v22, 16, v87
 v_and_b32 v23, s73, v87
 v_mfma_f32_16x16x32_bf16 v[236:239], v[40:43], v[76:79], v[236:239]
 v_mul_f32 v132, v132, v20
 v_mul_f32 v133, v133, v21
 v_mfma_f32_16x16x32_bf16 v[236:239], v[44:47], a[12:15], v[236:239]
 s_waitcnt lgkmcnt(4)
 v_mul_f32 v134, v134, v22
 v_mul_f32 v135, v135, v23
 v_mfma_f32_16x16x32_bf16 v[176:179], v[24:27], a[16:19], v[176:179]
 s_waitcnt lgkmcnt(2)
 ds_read_b64_tr_b16 v[36:37], v6 offset:12296
 v_cvt_pk_bf16_f32 v86, v132, v133
 v_mfma_f32_16x16x32_bf16 v[176:179], v[28:31], a[32:35], v[176:179]
 s_waitcnt lgkmcnt(1)
 ds_read_b64_tr_b16 v[38:39], v6 offset:12808
 v_cvt_pk_bf16_f32 v87, v134, v135
 v_mfma_f32_16x16x32_bf16 v[176:179], v[32:35], a[48:51], v[176:179]
 ds_read_b64_tr_b16 v[40:41], v6 offset:16392
 v_lshlrev_b32 v16, 16, v88
 v_mfma_f32_16x16x32_bf16 v[180:183], v[24:27], a[20:23], v[180:183]
 ds_read_b64_tr_b16 v[42:43], v6 offset:16904
 v_and_b32 v17, s73, v88
 v_mfma_f32_16x16x32_bf16 v[180:183], v[28:31], a[36:39], v[180:183]
 ds_read_b64_tr_b16 v[44:45], v6 offset:20488
 v_lshlrev_b32 v18, 16, v89
 v_mfma_f32_16x16x32_bf16 v[180:183], v[32:35], a[52:55], v[180:183]
 ds_read_b64_tr_b16 v[46:47], v6 offset:21000
 v_and_b32 v19, s73, v89
 v_mfma_f32_16x16x32_bf16 v[184:187], v[24:27], a[24:27], v[184:187]
 buffer_store_dwordx4 v[84:87], v2, s[32:35], s59 offen sc1
 v_mfma_f32_16x16x32_bf16 v[184:187], v[28:31], a[40:43], v[184:187]
 s_add_u32 m0, s70, 102400
 v_mul_f32 v120, v120, v16
 v_mul_f32 v121, v121, v17
 v_mfma_f32_16x16x32_bf16 v[184:187], v[32:35], a[56:59], v[184:187]
 s_add_u32 s58, s81, 128
 buffer_load_dwordx4 v5, s[20:23], s58 offen nt lds
 v_mfma_f32_16x16x32_bf16 v[188:191], v[24:27], a[28:31], v[188:191]
 s_add_u32 s59, s66, 262144
 v_mul_f32 v122, v122, v18
 v_mul_f32 v123, v123, v19
 v_mfma_f32_16x16x32_bf16 v[188:191], v[28:31], a[44:47], v[188:191]
 v_cvt_pk_bf16_f32 v88, v120, v121
 v_lshlrev_b32 v20, 16, v90
 v_mfma_f32_16x16x32_bf16 v[188:191], v[32:35], a[60:63], v[188:191]
 s_waitcnt lgkmcnt(4)
 v_cvt_pk_bf16_f32 v89, v122, v123
 v_and_b32 v21, s73, v90
 v_mfma_f32_16x16x32_bf16 v[192:195], v[36:39], a[16:19], v[192:195]
 s_waitcnt lgkmcnt(2)
 ds_read_b64_tr_b16 v[24:25], v7 offset:12288
 v_lshlrev_b32 v22, 16, v91
 v_mfma_f32_16x16x32_bf16 v[192:195], v[40:43], a[32:35], v[192:195]
 s_waitcnt lgkmcnt(1)
 ds_read_b64_tr_b16 v[26:27], v7 offset:12800
 v_and_b32 v23, s73, v91
 v_mfma_f32_16x16x32_bf16 v[192:195], v[44:47], a[48:51], v[192:195]
 ds_read_b64_tr_b16 v[28:29], v7 offset:16384
 v_mul_f32 v136, v136, v20
 v_mfma_f32_16x16x32_bf16 v[196:199], v[36:39], a[20:23], v[196:199]
 ds_read_b64_tr_b16 v[30:31], v7 offset:16896
 v_mul_f32 v137, v137, v21
 v_mfma_f32_16x16x32_bf16 v[196:199], v[40:43], a[36:39], v[196:199]
 ds_read_b64_tr_b16 v[32:33], v7 offset:20480
 v_mul_f32 v138, v138, v22
 v_mfma_f32_16x16x32_bf16 v[196:199], v[44:47], a[52:55], v[196:199]
 ds_read_b64_tr_b16 v[34:35], v7 offset:20992
 v_mul_f32 v139, v139, v23
 v_mfma_f32_16x16x32_bf16 v[200:203], v[36:39], a[24:27], v[200:203]
 v_cvt_pk_bf16_f32 v90, v136, v137
 v_lshlrev_b32 v16, 16, v92
 v_mfma_f32_16x16x32_bf16 v[200:203], v[40:43], a[40:43], v[200:203]
 s_add_u32 m0, s70, 106496
 v_cvt_pk_bf16_f32 v91, v138, v139
 v_and_b32 v17, s73, v92
 v_mfma_f32_16x16x32_bf16 v[200:203], v[44:47], a[56:59], v[200:203]
 s_add_u32 s58, s81, 262272
 buffer_load_dwordx4 v5, s[20:23], s58 offen nt lds
 v_mfma_f32_16x16x32_bf16 v[204:207], v[36:39], a[28:31], v[204:207]
 buffer_store_dwordx4 v[88:91], v2, s[32:35], s59 offen sc1
 v_mfma_f32_16x16x32_bf16 v[204:207], v[40:43], a[44:47], v[204:207]
 v_lshlrev_b32 v18, 16, v93
 v_and_b32 v19, s73, v93
 v_mfma_f32_16x16x32_bf16 v[204:207], v[44:47], a[60:63], v[204:207]
 s_waitcnt lgkmcnt(4)
 v_mul_f32 v124, v124, v16
 v_mul_f32 v125, v125, v17
 v_mfma_f32_16x16x32_bf16 v[208:211], v[24:27], a[16:19], v[208:211]
 s_waitcnt lgkmcnt(2)
 ds_read_b64_tr_b16 v[36:37], v7 offset:12296
 v_mul_f32 v126, v126, v18
 v_mfma_f32_16x16x32_bf16 v[208:211], v[28:31], a[32:35], v[208:211]
 s_waitcnt lgkmcnt(1)
 ds_read_b64_tr_b16 v[38:39], v7 offset:12808
 v_mul_f32 v127, v127, v19
 v_mfma_f32_16x16x32_bf16 v[208:211], v[32:35], a[48:51], v[208:211]
 s_add_u32 s59, s67, 262144
 ds_read_b64_tr_b16 v[40:41], v7 offset:16392
 v_cvt_pk_bf16_f32 v92, v124, v125
 v_mfma_f32_16x16x32_bf16 v[212:215], v[24:27], a[20:23], v[212:215]
 ds_read_b64_tr_b16 v[42:43], v7 offset:16904
 v_cvt_pk_bf16_f32 v93, v126, v127
 v_mfma_f32_16x16x32_bf16 v[212:215], v[28:31], a[36:39], v[212:215]
 ds_read_b64_tr_b16 v[44:45], v7 offset:20488
 v_lshlrev_b32 v20, 16, v94
 v_mfma_f32_16x16x32_bf16 v[212:215], v[32:35], a[52:55], v[212:215]
 ds_read_b64_tr_b16 v[46:47], v7 offset:21000
 v_and_b32 v21, s73, v94
 v_mfma_f32_16x16x32_bf16 v[216:219], v[24:27], a[24:27], v[216:219]
 v_add_u32 v6, 0xfffe8000, v6
 v_add_u32 v7, 0xfffe8000, v7
 v_mfma_f32_16x16x32_bf16 v[216:219], v[28:31], a[40:43], v[216:219]
 s_add_u32 m0, s70, 110592
 v_lshlrev_b32 v22, 16, v95
 v_and_b32 v23, s73, v95
 v_mfma_f32_16x16x32_bf16 v[216:219], v[32:35], a[56:59], v[216:219]
 s_add_u32 s58, s81, 524416
 buffer_load_dwordx4 v5, s[20:23], s58 offen nt lds
 v_mfma_f32_16x16x32_bf16 v[220:223], v[24:27], a[28:31], v[220:223]
 v_mul_f32 v140, v140, v20
 v_mul_f32 v141, v141, v21
 v_mfma_f32_16x16x32_bf16 v[220:223], v[28:31], a[44:47], v[220:223]
 v_mul_f32 v142, v142, v22
 v_mul_f32 v143, v143, v23
 v_mfma_f32_16x16x32_bf16 v[220:223], v[32:35], a[60:63], v[220:223]
 s_waitcnt vmcnt(15)
 s_barrier
 s_waitcnt lgkmcnt(4)
 v_mfma_f32_16x16x32_bf16 v[224:227], v[36:39], a[16:19], v[224:227]
 s_waitcnt lgkmcnt(2)
 ds_read_b64_tr_b16 v[24:25], v6 offset:0
 v_cvt_pk_bf16_f32 v94, v140, v141
 v_mfma_f32_16x16x32_bf16 v[224:227], v[40:43], a[32:35], v[224:227]
 s_waitcnt lgkmcnt(1)
 ds_read_b64_tr_b16 v[26:27], v6 offset:512
 v_cvt_pk_bf16_f32 v95, v142, v143
 v_mfma_f32_16x16x32_bf16 v[224:227], v[44:47], a[48:51], v[224:227]
 ds_read_b64_tr_b16 v[28:29], v6 offset:4096
 v_lshlrev_b32 v16, 16, v96
 v_mfma_f32_16x16x32_bf16 v[228:231], v[36:39], a[20:23], v[228:231]
 ds_read_b64_tr_b16 v[30:31], v6 offset:4608
 v_and_b32 v17, s73, v96
 v_mfma_f32_16x16x32_bf16 v[228:231], v[40:43], a[36:39], v[228:231]
 ds_read_b64_tr_b16 v[32:33], v6 offset:8192
 v_lshlrev_b32 v18, 16, v97
 v_mfma_f32_16x16x32_bf16 v[228:231], v[44:47], a[52:55], v[228:231]
 ds_read_b64_tr_b16 v[34:35], v6 offset:8704
 v_and_b32 v19, s73, v97
 v_mfma_f32_16x16x32_bf16 v[232:235], v[36:39], a[24:27], v[232:235]
 buffer_store_dwordx4 v[92:95], v2, s[32:35], s59 offen sc1
 v_mfma_f32_16x16x32_bf16 v[232:235], v[40:43], a[40:43], v[232:235]
 v_mul_f32 v144, v144, v16
 v_mul_f32 v145, v145, v17
 v_mfma_f32_16x16x32_bf16 v[232:235], v[44:47], a[56:59], v[232:235]
 s_add_u32 s59, s64, 393216
 v_mul_f32 v146, v146, v18
 v_mul_f32 v147, v147, v19
 v_mfma_f32_16x16x32_bf16 v[236:239], v[36:39], a[28:31], v[236:239]
 v_cvt_pk_bf16_f32 v96, v144, v145
 v_lshlrev_b32 v20, 16, v98
 v_mfma_f32_16x16x32_bf16 v[236:239], v[40:43], a[44:47], v[236:239]
 v_cvt_pk_bf16_f32 v97, v146, v147
 v_and_b32 v21, s73, v98
 v_mfma_f32_16x16x32_bf16 v[236:239], v[44:47], a[60:63], v[236:239]
 s_waitcnt lgkmcnt(4)
 v_lshlrev_b32 v22, 16, v99
 v_and_b32 v23, s73, v99
 v_mfma_f32_16x16x32_bf16 v[176:179], v[24:27], a[64:67], v[176:179]
 s_waitcnt lgkmcnt(2)
 ds_read_b64_tr_b16 v[36:37], v6 offset:8
 v_mul_f32 v160, v160, v20
 v_mfma_f32_16x16x32_bf16 v[176:179], v[28:31], a[80:83], v[176:179]
 s_waitcnt lgkmcnt(1)
 ds_read_b64_tr_b16 v[38:39], v6 offset:520
 v_mul_f32 v161, v161, v21
 v_mfma_f32_16x16x32_bf16 v[176:179], v[32:35], a[96:99], v[176:179]
 ds_read_b64_tr_b16 v[40:41], v6 offset:4104
 v_mul_f32 v162, v162, v22
 v_mfma_f32_16x16x32_bf16 v[180:183], v[24:27], a[68:71], v[180:183]
 ds_read_b64_tr_b16 v[42:43], v6 offset:4616
 v_mul_f32 v163, v163, v23
 v_mfma_f32_16x16x32_bf16 v[180:183], v[28:31], a[84:87], v[180:183]
 ds_read_b64_tr_b16 v[44:45], v6 offset:8200
 v_cvt_pk_bf16_f32 v98, v160, v161
 v_mfma_f32_16x16x32_bf16 v[180:183], v[32:35], a[100:103], v[180:183]
 ds_read_b64_tr_b16 v[46:47], v6 offset:8712
 v_cvt_pk_bf16_f32 v99, v162, v163
 v_mfma_f32_16x16x32_bf16 v[184:187], v[24:27], a[72:75], v[184:187]
 v_lshlrev_b32 v16, 16, v100
 v_and_b32 v17, s73, v100
 v_mfma_f32_16x16x32_bf16 v[184:187], v[28:31], a[88:91], v[184:187]
 s_add_u32 m0, s70, 114688
 buffer_store_dwordx4 v[96:99], v2, s[32:35], s59 offen sc1
 v_mfma_f32_16x16x32_bf16 v[184:187], v[32:35], a[104:107], v[184:187]
 s_add_u32 s58, s82, 128
 buffer_load_dwordx4 v5, s[20:23], s58 offen nt lds
 v_mfma_f32_16x16x32_bf16 v[188:191], v[24:27], a[76:79], v[188:191]
 v_lshlrev_b32 v18, 16, v101
 v_and_b32 v19, s73, v101
 v_mfma_f32_16x16x32_bf16 v[188:191], v[28:31], a[92:95], v[188:191]
 v_mul_f32 v148, v148, v16
 v_mul_f32 v149, v149, v17
 v_mfma_f32_16x16x32_bf16 v[188:191], v[32:35], a[108:111], v[188:191]
 s_waitcnt lgkmcnt(4)
 v_mul_f32 v150, v150, v18
 v_mul_f32 v151, v151, v19
 v_mfma_f32_16x16x32_bf16 v[192:195], v[36:39], a[64:67], v[192:195]
 s_waitcnt lgkmcnt(2)
 ds_read_b64_tr_b16 v[24:25], v7 offset:0
 v_cvt_pk_bf16_f32 v100, v148, v149
 v_mfma_f32_16x16x32_bf16 v[192:195], v[40:43], a[80:83], v[192:195]
 s_waitcnt lgkmcnt(1)
 ds_read_b64_tr_b16 v[26:27], v7 offset:512
 v_cvt_pk_bf16_f32 v101, v150, v151
 v_mfma_f32_16x16x32_bf16 v[192:195], v[44:47], a[96:99], v[192:195]
 s_add_u32 s59, s65, 393216
 ds_read_b64_tr_b16 v[28:29], v7 offset:4096
 v_lshlrev_b32 v20, 16, v102
 v_mfma_f32_16x16x32_bf16 v[196:199], v[36:39], a[68:71], v[196:199]
 ds_read_b64_tr_b16 v[30:31], v7 offset:4608
 v_and_b32 v21, s73, v102
 v_mfma_f32_16x16x32_bf16 v[196:199], v[40:43], a[84:87], v[196:199]
 ds_read_b64_tr_b16 v[32:33], v7 offset:8192
 v_lshlrev_b32 v22, 16, v103
 v_mfma_f32_16x16x32_bf16 v[196:199], v[44:47], a[100:103], v[196:199]
 ds_read_b64_tr_b16 v[34:35], v7 offset:8704
 v_and_b32 v23, s73, v103
 v_mfma_f32_16x16x32_bf16 v[200:203], v[36:39], a[72:75], v[200:203]
 v_mul_f32 v164, v164, v20
 v_mul_f32 v165, v165, v21
 v_mfma_f32_16x16x32_bf16 v[200:203], v[40:43], a[88:91], v[200:203]
 s_add_u32 m0, s70, 118784
 v_mul_f32 v166, v166, v22
 v_mul_f32 v167, v167, v23
 v_mfma_f32_16x16x32_bf16 v[200:203], v[44:47], a[104:107], v[200:203]
 s_add_u32 s58, s82, 262272
 buffer_load_dwordx4 v5, s[20:23], s58 offen nt lds
 v_mfma_f32_16x16x32_bf16 v[204:207], v[36:39], a[76:79], v[204:207]
 v_cvt_pk_bf16_f32 v102, v164, v165
 v_cvt_pk_bf16_f32 v103, v166, v167
 v_mfma_f32_16x16x32_bf16 v[204:207], v[40:43], a[92:95], v[204:207]
 v_lshlrev_b32 v16, 16, v104
 v_and_b32 v17, s73, v104
 v_mfma_f32_16x16x32_bf16 v[204:207], v[44:47], a[108:111], v[204:207]
 s_waitcnt lgkmcnt(4)
 buffer_store_dwordx4 v[100:103], v2, s[32:35], s59 offen sc1
 v_mfma_f32_16x16x32_bf16 v[208:211], v[24:27], a[64:67], v[208:211]
 s_waitcnt lgkmcnt(2)
 ds_read_b64_tr_b16 v[36:37], v7 offset:8
 v_lshlrev_b32 v18, 16, v105
 v_mfma_f32_16x16x32_bf16 v[208:211], v[28:31], a[80:83], v[208:211]
 s_waitcnt lgkmcnt(1)
 ds_read_b64_tr_b16 v[38:39], v7 offset:520
 v_and_b32 v19, s73, v105
 v_mfma_f32_16x16x32_bf16 v[208:211], v[32:35], a[96:99], v[208:211]
 ds_read_b64_tr_b16 v[40:41], v7 offset:4104
 v_mul_f32 v152, v152, v16
 v_mfma_f32_16x16x32_bf16 v[212:215], v[24:27], a[68:71], v[212:215]
 ds_read_b64_tr_b16 v[42:43], v7 offset:4616
 v_mul_f32 v153, v153, v17
 v_mfma_f32_16x16x32_bf16 v[212:215], v[28:31], a[84:87], v[212:215]
 s_add_u32 s59, s66, 393216
 ds_read_b64_tr_b16 v[44:45], v7 offset:8200
 v_mul_f32 v154, v154, v18
 v_mfma_f32_16x16x32_bf16 v[212:215], v[32:35], a[100:103], v[212:215]
 ds_read_b64_tr_b16 v[46:47], v7 offset:8712
 v_mul_f32 v155, v155, v19
 v_mfma_f32_16x16x32_bf16 v[216:219], v[24:27], a[72:75], v[216:219]
 v_cvt_pk_bf16_f32 v104, v152, v153
 v_lshlrev_b32 v20, 16, v106
 v_mfma_f32_16x16x32_bf16 v[216:219], v[28:31], a[88:91], v[216:219]
 s_add_u32 m0, s70, 122880
 v_cvt_pk_bf16_f32 v105, v154, v155
 v_and_b32 v21, s73, v106
 v_mfma_f32_16x16x32_bf16 v[216:219], v[32:35], a[104:107], v[216:219]
 s_add_u32 s58, s82, 524416
 buffer_load_dwordx4 v5, s[20:23], s58 offen nt lds
 v_mfma_f32_16x16x32_bf16 v[220:223], v[24:27], a[76:79], v[220:223]
 v_lshlrev_b32 v22, 16, v107
 v_and_b32 v23, s73, v107
 v_mfma_f32_16x16x32_bf16 v[220:223], v[28:31], a[92:95], v[220:223]
 v_mul_f32 v168, v168, v20
 v_mul_f32 v169, v169, v21
 v_mfma_f32_16x16x32_bf16 v[220:223], v[32:35], a[108:111], v[220:223]
 s_waitcnt lgkmcnt(4)
 v_mul_f32 v170, v170, v22
 v_mul_f32 v171, v171, v23
 v_mfma_f32_16x16x32_bf16 v[224:227], v[36:39], a[64:67], v[224:227]
 s_waitcnt lgkmcnt(2)
 ds_read_b64_tr_b16 v[24:25], v6 offset:12288
 v_cvt_pk_bf16_f32 v106, v168, v169
 v_mfma_f32_16x16x32_bf16 v[224:227], v[40:43], a[80:83], v[224:227]
 s_waitcnt lgkmcnt(1)
 ds_read_b64_tr_b16 v[26:27], v6 offset:12800
 v_cvt_pk_bf16_f32 v107, v170, v171
 v_mfma_f32_16x16x32_bf16 v[224:227], v[44:47], a[96:99], v[224:227]
 ds_read_b64_tr_b16 v[28:29], v6 offset:16384
 v_lshlrev_b32 v16, 16, v108
 v_mfma_f32_16x16x32_bf16 v[228:231], v[36:39], a[68:71], v[228:231]
 ds_read_b64_tr_b16 v[30:31], v6 offset:16896
 v_and_b32 v17, s73, v108
 v_mfma_f32_16x16x32_bf16 v[228:231], v[40:43], a[84:87], v[228:231]
 ds_read_b64_tr_b16 v[32:33], v6 offset:20480
 v_lshlrev_b32 v18, 16, v109
 v_mfma_f32_16x16x32_bf16 v[228:231], v[44:47], a[100:103], v[228:231]
 ds_read_b64_tr_b16 v[34:35], v6 offset:20992
 v_and_b32 v19, s73, v109
 v_mfma_f32_16x16x32_bf16 v[232:235], v[36:39], a[72:75], v[232:235]
 buffer_store_dwordx4 v[104:107], v2, s[32:35], s59 offen sc1
 v_mfma_f32_16x16x32_bf16 v[232:235], v[40:43], a[88:91], v[232:235]
 v_mul_f32 v156, v156, v16
 v_mul_f32 v157, v157, v17
 v_mfma_f32_16x16x32_bf16 v[232:235], v[44:47], a[104:107], v[232:235]
 s_add_u32 s59, s67, 393216
 v_mul_f32 v158, v158, v18
 v_mul_f32 v159, v159, v19
 v_mfma_f32_16x16x32_bf16 v[236:239], v[36:39], a[76:79], v[236:239]
 v_cvt_pk_bf16_f32 v108, v156, v157
 v_lshlrev_b32 v20, 16, v110
 v_mfma_f32_16x16x32_bf16 v[236:239], v[40:43], a[92:95], v[236:239]
 v_cvt_pk_bf16_f32 v109, v158, v159
 v_and_b32 v21, s73, v110
 v_mfma_f32_16x16x32_bf16 v[236:239], v[44:47], a[108:111], v[236:239]
 s_waitcnt lgkmcnt(4)
 v_lshlrev_b32 v22, 16, v111
 v_and_b32 v23, s73, v111
 v_mfma_f32_16x16x32_bf16 v[176:179], v[24:27], a[112:115], v[176:179]
 s_waitcnt lgkmcnt(2)
 ds_read_b64_tr_b16 v[36:37], v6 offset:12296
 v_mul_f32 v172, v172, v20
 v_mfma_f32_16x16x32_bf16 v[176:179], v[28:31], a[128:131], v[176:179]
 s_waitcnt lgkmcnt(1)
 ds_read_b64_tr_b16 v[38:39], v6 offset:12808
 v_mul_f32 v173, v173, v21
 v_mfma_f32_16x16x32_bf16 v[176:179], v[32:35], a[144:147], v[176:179]
 ds_read_b64_tr_b16 v[40:41], v6 offset:16392
 v_mul_f32 v174, v174, v22
 v_mfma_f32_16x16x32_bf16 v[180:183], v[24:27], a[116:119], v[180:183]
 ds_read_b64_tr_b16 v[42:43], v6 offset:16904
 v_mul_f32 v175, v175, v23
 v_mfma_f32_16x16x32_bf16 v[180:183], v[28:31], a[132:135], v[180:183]
 ds_read_b64_tr_b16 v[44:45], v6 offset:20488
 v_cvt_pk_bf16_f32 v110, v172, v173
 v_mfma_f32_16x16x32_bf16 v[180:183], v[32:35], a[148:151], v[180:183]
 ds_read_b64_tr_b16 v[46:47], v6 offset:21000
 v_cvt_pk_bf16_f32 v111, v174, v175
 v_mfma_f32_16x16x32_bf16 v[184:187], v[24:27], a[120:123], v[184:187]
 v_mfma_f32_16x16x32_bf16 v[184:187], v[28:31], a[136:139], v[184:187]
 s_add_u32 m0, s70, 126976
 buffer_store_dwordx4 v[108:111], v2, s[32:35], s59 offen sc1
 v_mfma_f32_16x16x32_bf16 v[184:187], v[32:35], a[152:155], v[184:187]
 s_add_u32 s58, s83, 128
 buffer_load_dwordx4 v5, s[20:23], s58 offen nt lds
 v_mfma_f32_16x16x32_bf16 v[188:191], v[24:27], a[124:127], v[188:191]
 v_mfma_f32_16x16x32_bf16 v[188:191], v[28:31], a[140:143], v[188:191]
 v_mfma_f32_16x16x32_bf16 v[188:191], v[32:35], a[156:159], v[188:191]
 s_waitcnt lgkmcnt(4)
 v_mfma_f32_16x16x32_bf16 v[192:195], v[36:39], a[112:115], v[192:195]
 s_waitcnt lgkmcnt(2)
 ds_read_b64_tr_b16 v[24:25], v7 offset:12288
 v_mfma_f32_16x16x32_bf16 v[192:195], v[40:43], a[128:131], v[192:195]
 s_waitcnt lgkmcnt(1)
 ds_read_b64_tr_b16 v[26:27], v7 offset:12800
 v_mfma_f32_16x16x32_bf16 v[192:195], v[44:47], a[144:147], v[192:195]
 ds_read_b64_tr_b16 v[28:29], v7 offset:16384
 v_mfma_f32_16x16x32_bf16 v[196:199], v[36:39], a[116:119], v[196:199]
 ds_read_b64_tr_b16 v[30:31], v7 offset:16896
 v_mfma_f32_16x16x32_bf16 v[196:199], v[40:43], a[132:135], v[196:199]
 ds_read_b64_tr_b16 v[32:33], v7 offset:20480
 v_mfma_f32_16x16x32_bf16 v[196:199], v[44:47], a[148:151], v[196:199]
 ds_read_b64_tr_b16 v[34:35], v7 offset:20992
 v_mfma_f32_16x16x32_bf16 v[200:203], v[36:39], a[120:123], v[200:203]
 v_mfma_f32_16x16x32_bf16 v[200:203], v[40:43], a[136:139], v[200:203]
 s_add_u32 m0, s70, 131072
 v_mfma_f32_16x16x32_bf16 v[200:203], v[44:47], a[152:155], v[200:203]
 s_add_u32 s58, s83, 262272
 buffer_load_dwordx4 v5, s[20:23], s58 offen nt lds
 v_mfma_f32_16x16x32_bf16 v[204:207], v[36:39], a[124:127], v[204:207]
 v_mfma_f32_16x16x32_bf16 v[204:207], v[40:43], a[140:143], v[204:207]
 v_mfma_f32_16x16x32_bf16 v[204:207], v[44:47], a[156:159], v[204:207]
 s_waitcnt lgkmcnt(4)
 v_mfma_f32_16x16x32_bf16 v[208:211], v[24:27], a[112:115], v[208:211]
 s_waitcnt lgkmcnt(2)
 ds_read_b64_tr_b16 v[36:37], v7 offset:12296
 v_mfma_f32_16x16x32_bf16 v[208:211], v[28:31], a[128:131], v[208:211]
 s_waitcnt lgkmcnt(1)
 ds_read_b64_tr_b16 v[38:39], v7 offset:12808
 v_mfma_f32_16x16x32_bf16 v[208:211], v[32:35], a[144:147], v[208:211]
 ds_read_b64_tr_b16 v[40:41], v7 offset:16392
 v_mfma_f32_16x16x32_bf16 v[212:215], v[24:27], a[116:119], v[212:215]
 ds_read_b64_tr_b16 v[42:43], v7 offset:16904
 v_mfma_f32_16x16x32_bf16 v[212:215], v[28:31], a[132:135], v[212:215]
 ds_read_b64_tr_b16 v[44:45], v7 offset:20488
 v_mfma_f32_16x16x32_bf16 v[212:215], v[32:35], a[148:151], v[212:215]
 ds_read_b64_tr_b16 v[46:47], v7 offset:21000
 v_mfma_f32_16x16x32_bf16 v[216:219], v[24:27], a[120:123], v[216:219]
 v_mfma_f32_16x16x32_bf16 v[216:219], v[28:31], a[136:139], v[216:219]
 s_add_u32 m0, s70, 135168
 v_mfma_f32_16x16x32_bf16 v[216:219], v[32:35], a[152:155], v[216:219]
 s_add_u32 s58, s83, 524416
 buffer_load_dwordx4 v5, s[20:23], s58 offen nt lds
 v_mfma_f32_16x16x32_bf16 v[220:223], v[24:27], a[124:127], v[220:223]
 v_mfma_f32_16x16x32_bf16 v[220:223], v[28:31], a[140:143], v[220:223]
 v_mfma_f32_16x16x32_bf16 v[220:223], v[32:35], a[156:159], v[220:223]
 s_waitcnt vmcnt(20)
 s_barrier
 s_waitcnt lgkmcnt(4)
 v_mfma_f32_16x16x32_bf16 v[224:227], v[36:39], a[112:115], v[224:227]
 s_waitcnt lgkmcnt(2)
 ds_read_b64_tr_b16 v[24:25], v6 offset:24576
 v_mfma_f32_16x16x32_bf16 v[224:227], v[40:43], a[128:131], v[224:227]
 s_waitcnt lgkmcnt(1)
 ds_read_b64_tr_b16 v[26:27], v6 offset:25088
 v_mfma_f32_16x16x32_bf16 v[224:227], v[44:47], a[144:147], v[224:227]
 ds_read_b64_tr_b16 v[28:29], v6 offset:28672
 v_mfma_f32_16x16x32_bf16 v[228:231], v[36:39], a[116:119], v[228:231]
 ds_read_b64_tr_b16 v[30:31], v6 offset:29184
 v_mfma_f32_16x16x32_bf16 v[228:231], v[40:43], a[132:135], v[228:231]
 ds_read_b64_tr_b16 v[32:33], v6 offset:32768
 v_mfma_f32_16x16x32_bf16 v[228:231], v[44:47], a[148:151], v[228:231]
 ds_read_b64_tr_b16 v[34:35], v6 offset:33280
 v_mfma_f32_16x16x32_bf16 v[232:235], v[36:39], a[120:123], v[232:235]
 v_mfma_f32_16x16x32_bf16 v[232:235], v[40:43], a[136:139], v[232:235]
 v_mfma_f32_16x16x32_bf16 v[232:235], v[44:47], a[152:155], v[232:235]
 v_mfma_f32_16x16x32_bf16 v[236:239], v[36:39], a[124:127], v[236:239]
 v_mfma_f32_16x16x32_bf16 v[236:239], v[40:43], a[140:143], v[236:239]
 v_mfma_f32_16x16x32_bf16 v[236:239], v[44:47], a[156:159], v[236:239]
 s_waitcnt lgkmcnt(4)
 v_mfma_f32_16x16x32_bf16 v[176:179], v[24:27], a[160:163], v[176:179]
 s_waitcnt lgkmcnt(2)
 ds_read_b64_tr_b16 v[36:37], v6 offset:24584
 v_mfma_f32_16x16x32_bf16 v[176:179], v[28:31], a[176:179], v[176:179]
 s_waitcnt lgkmcnt(1)
 ds_read_b64_tr_b16 v[38:39], v6 offset:25096
 v_mfma_f32_16x16x32_bf16 v[176:179], v[32:35], a[192:195], v[176:179]
 ds_read_b64_tr_b16 v[40:41], v6 offset:28680
 v_mfma_f32_16x16x32_bf16 v[180:183], v[24:27], a[164:167], v[180:183]
 ds_read_b64_tr_b16 v[42:43], v6 offset:29192
 v_mfma_f32_16x16x32_bf16 v[180:183], v[28:31], a[180:183], v[180:183]
 ds_read_b64_tr_b16 v[44:45], v6 offset:32776
 v_mfma_f32_16x16x32_bf16 v[180:183], v[32:35], a[196:199], v[180:183]
 ds_read_b64_tr_b16 v[46:47], v6 offset:33288
 v_mfma_f32_16x16x32_bf16 v[184:187], v[24:27], a[168:171], v[184:187]
 s_add_u32 m0, s70, 139264
 v_mfma_f32_16x16x32_bf16 v[184:187], v[28:31], a[184:187], v[184:187]
 s_add_u32 s58, s84, 128
 buffer_load_dwordx4 v5, s[20:23], s58 offen nt lds
 v_mfma_f32_16x16x32_bf16 v[184:187], v[32:35], a[200:203], v[184:187]
 s_add_u32 m0, s70, 143360
 v_mfma_f32_16x16x32_bf16 v[188:191], v[24:27], a[172:175], v[188:191]
 s_add_u32 s58, s84, 262272
 buffer_load_dwordx4 v5, s[20:23], s58 offen nt lds
 v_mfma_f32_16x16x32_bf16 v[188:191], v[28:31], a[188:191], v[188:191]
 v_mfma_f32_16x16x32_bf16 v[188:191], v[32:35], a[204:207], v[188:191]
 s_waitcnt lgkmcnt(4)
 v_mfma_f32_16x16x32_bf16 v[192:195], v[36:39], a[160:163], v[192:195]
 s_waitcnt lgkmcnt(2)
 ds_read_b64_tr_b16 v[24:25], v7 offset:24576
 v_mfma_f32_16x16x32_bf16 v[192:195], v[40:43], a[176:179], v[192:195]
 s_waitcnt lgkmcnt(1)
 ds_read_b64_tr_b16 v[26:27], v7 offset:25088
 v_mfma_f32_16x16x32_bf16 v[192:195], v[44:47], a[192:195], v[192:195]
 ds_read_b64_tr_b16 v[28:29], v7 offset:28672
 v_mfma_f32_16x16x32_bf16 v[196:199], v[36:39], a[164:167], v[196:199]
 ds_read_b64_tr_b16 v[30:31], v7 offset:29184
 v_mfma_f32_16x16x32_bf16 v[196:199], v[40:43], a[180:183], v[196:199]
 ds_read_b64_tr_b16 v[32:33], v7 offset:32768
 v_mfma_f32_16x16x32_bf16 v[196:199], v[44:47], a[196:199], v[196:199]
 s_add_u32 m0, s70, 147456
 ds_read_b64_tr_b16 v[34:35], v7 offset:33280
 v_mfma_f32_16x16x32_bf16 v[200:203], v[36:39], a[168:171], v[200:203]
 s_add_u32 s58, s84, 524416
 buffer_load_dwordx4 v5, s[20:23], s58 offen nt lds
 v_mfma_f32_16x16x32_bf16 v[200:203], v[40:43], a[184:187], v[200:203]
 s_add_u32 m0, s72, 0
 v_mfma_f32_16x16x32_bf16 v[200:203], v[44:47], a[200:203], v[200:203]
 s_mov_b32 s58, 0
 buffer_load_dwordx4 v240, s[24:27], s58 offen offset:0 nt lds
 v_mfma_f32_16x16x32_bf16 v[204:207], v[36:39], a[172:175], v[204:207]
 v_mfma_f32_16x16x32_bf16 v[204:207], v[40:43], a[188:191], v[204:207]
 buffer_load_dwordx4 v241, s[24:27], s58 offen offset:1024 nt lds
 v_mfma_f32_16x16x32_bf16 v[204:207], v[44:47], a[204:207], v[204:207]
 s_waitcnt lgkmcnt(4)
 v_mfma_f32_16x16x32_bf16 v[208:211], v[24:27], a[160:163], v[208:211]
 s_waitcnt lgkmcnt(2)
 ds_read_b64_tr_b16 v[36:37], v7 offset:24584
 v_mfma_f32_16x16x32_bf16 v[208:211], v[28:31], a[176:179], v[208:211]
 s_waitcnt lgkmcnt(1)
 ds_read_b64_tr_b16 v[38:39], v7 offset:25096
 v_mfma_f32_16x16x32_bf16 v[208:211], v[32:35], a[192:195], v[208:211]
 ds_read_b64_tr_b16 v[40:41], v7 offset:28680
 v_mfma_f32_16x16x32_bf16 v[212:215], v[24:27], a[164:167], v[212:215]
 ds_read_b64_tr_b16 v[42:43], v7 offset:29192
 v_mfma_f32_16x16x32_bf16 v[212:215], v[28:31], a[180:183], v[212:215]
 ds_read_b64_tr_b16 v[44:45], v7 offset:32776
 v_mfma_f32_16x16x32_bf16 v[212:215], v[32:35], a[196:199], v[212:215]
 ds_read_b64_tr_b16 v[46:47], v7 offset:33288
 v_mfma_f32_16x16x32_bf16 v[216:219], v[24:27], a[168:171], v[216:219]
 v_mfma_f32_16x16x32_bf16 v[216:219], v[28:31], a[184:187], v[216:219]
 buffer_load_dwordx4 v242, s[24:27], s58 offen offset:2048 nt lds
 v_mfma_f32_16x16x32_bf16 v[216:219], v[32:35], a[200:203], v[216:219]
 v_mfma_f32_16x16x32_bf16 v[220:223], v[24:27], a[172:175], v[220:223]
 buffer_load_dwordx4 v243, s[24:27], s58 offen offset:3072 nt lds
 v_mfma_f32_16x16x32_bf16 v[220:223], v[28:31], a[188:191], v[220:223]
 v_mfma_f32_16x16x32_bf16 v[220:223], v[32:35], a[204:207], v[220:223]
 s_waitcnt lgkmcnt(4)
 v_mfma_f32_16x16x32_bf16 v[224:227], v[36:39], a[160:163], v[224:227]
 s_waitcnt lgkmcnt(2)
 ds_read_b64_tr_b16 v[24:25], v6 offset:36864
 v_mfma_f32_16x16x32_bf16 v[224:227], v[40:43], a[176:179], v[224:227]
 s_waitcnt lgkmcnt(1)
 ds_read_b64_tr_b16 v[26:27], v6 offset:37376
 v_mfma_f32_16x16x32_bf16 v[224:227], v[44:47], a[192:195], v[224:227]
 ds_read_b64_tr_b16 v[28:29], v6 offset:40960
 v_mfma_f32_16x16x32_bf16 v[228:231], v[36:39], a[164:167], v[228:231]
 ds_read_b64_tr_b16 v[30:31], v6 offset:41472
 v_mfma_f32_16x16x32_bf16 v[228:231], v[40:43], a[180:183], v[228:231]
 ds_read_b64_tr_b16 v[32:33], v6 offset:45056
 v_mfma_f32_16x16x32_bf16 v[228:231], v[44:47], a[196:199], v[228:231]
 ds_read_b64_tr_b16 v[34:35], v6 offset:45568
 v_mfma_f32_16x16x32_bf16 v[232:235], v[36:39], a[168:171], v[232:235]
 v_mfma_f32_16x16x32_bf16 v[232:235], v[40:43], a[184:187], v[232:235]
 v_mfma_f32_16x16x32_bf16 v[232:235], v[44:47], a[200:203], v[232:235]
 v_mfma_f32_16x16x32_bf16 v[236:239], v[36:39], a[172:175], v[236:239]
 v_mfma_f32_16x16x32_bf16 v[236:239], v[40:43], a[188:191], v[236:239]
 v_mfma_f32_16x16x32_bf16 v[236:239], v[44:47], a[204:207], v[236:239]
 s_waitcnt lgkmcnt(4)
 v_mfma_f32_16x16x32_bf16 v[176:179], v[24:27], a[208:211], v[176:179]
 s_waitcnt lgkmcnt(2)
 ds_read_b64_tr_b16 v[36:37], v6 offset:36872
 v_mfma_f32_16x16x32_bf16 v[176:179], v[28:31], a[224:227], v[176:179]
 s_waitcnt lgkmcnt(1)
 ds_read_b64_tr_b16 v[38:39], v6 offset:37384
 v_mfma_f32_16x16x32_bf16 v[176:179], v[32:35], a[240:243], v[176:179]
 ds_read_b64_tr_b16 v[40:41], v6 offset:40968
 v_mfma_f32_16x16x32_bf16 v[180:183], v[24:27], a[212:215], v[180:183]
 ds_read_b64_tr_b16 v[42:43], v6 offset:41480
 v_mfma_f32_16x16x32_bf16 v[180:183], v[28:31], a[228:231], v[180:183]
 ds_read_b64_tr_b16 v[44:45], v6 offset:45064
 v_mfma_f32_16x16x32_bf16 v[180:183], v[32:35], a[244:247], v[180:183]
 ds_read_b64_tr_b16 v[46:47], v6 offset:45576
 v_mfma_f32_16x16x32_bf16 v[184:187], v[24:27], a[216:219], v[184:187]
 s_add_u32 m0, s70, 151552
 v_mfma_f32_16x16x32_bf16 v[184:187], v[28:31], a[232:235], v[184:187]
 s_add_u32 s58, s85, 128
 buffer_load_dwordx4 v5, s[20:23], s58 offen nt lds
 v_mfma_f32_16x16x32_bf16 v[184:187], v[32:35], a[248:251], v[184:187]
 s_add_u32 m0, s70, 155648
 v_mfma_f32_16x16x32_bf16 v[188:191], v[24:27], a[220:223], v[188:191]
 s_add_u32 s58, s85, 262272
 buffer_load_dwordx4 v5, s[20:23], s58 offen nt lds
 v_mfma_f32_16x16x32_bf16 v[188:191], v[28:31], a[236:239], v[188:191]
 v_mfma_f32_16x16x32_bf16 v[188:191], v[32:35], a[252:255], v[188:191]
 s_waitcnt lgkmcnt(4)
 v_mfma_f32_16x16x32_bf16 v[192:195], v[36:39], a[208:211], v[192:195]
 s_waitcnt lgkmcnt(2)
 ds_read_b64_tr_b16 v[24:25], v7 offset:36864
 v_mfma_f32_16x16x32_bf16 v[192:195], v[40:43], a[224:227], v[192:195]
 s_waitcnt lgkmcnt(1)
 ds_read_b64_tr_b16 v[26:27], v7 offset:37376
 v_mfma_f32_16x16x32_bf16 v[192:195], v[44:47], a[240:243], v[192:195]
 ds_read_b64_tr_b16 v[28:29], v7 offset:40960
 v_mfma_f32_16x16x32_bf16 v[196:199], v[36:39], a[212:215], v[196:199]
 ds_read_b64_tr_b16 v[30:31], v7 offset:41472
 v_mfma_f32_16x16x32_bf16 v[196:199], v[40:43], a[228:231], v[196:199]
 ds_read_b64_tr_b16 v[32:33], v7 offset:45056
 v_mfma_f32_16x16x32_bf16 v[196:199], v[44:47], a[244:247], v[196:199]
 s_add_u32 m0, s70, 159744
 ds_read_b64_tr_b16 v[34:35], v7 offset:45568
 v_mfma_f32_16x16x32_bf16 v[200:203], v[36:39], a[216:219], v[200:203]
 s_add_u32 s58, s85, 524416
 buffer_load_dwordx4 v5, s[20:23], s58 offen nt lds
 v_mfma_f32_16x16x32_bf16 v[200:203], v[40:43], a[232:235], v[200:203]
 s_add_u32 m0, s72, 16384
 v_mfma_f32_16x16x32_bf16 v[200:203], v[44:47], a[248:251], v[200:203]
 s_mov_b32 s58, 16384
 buffer_load_dwordx4 v240, s[24:27], s58 offen offset:0 nt lds
 v_mfma_f32_16x16x32_bf16 v[204:207], v[36:39], a[220:223], v[204:207]
 v_mfma_f32_16x16x32_bf16 v[204:207], v[40:43], a[236:239], v[204:207]
 buffer_load_dwordx4 v241, s[24:27], s58 offen offset:1024 nt lds
 v_mfma_f32_16x16x32_bf16 v[204:207], v[44:47], a[252:255], v[204:207]
 s_waitcnt lgkmcnt(4)
 v_mfma_f32_16x16x32_bf16 v[208:211], v[24:27], a[208:211], v[208:211]
 s_waitcnt lgkmcnt(2)
 ds_read_b64_tr_b16 v[36:37], v7 offset:36872
 v_mfma_f32_16x16x32_bf16 v[208:211], v[28:31], a[224:227], v[208:211]
 s_waitcnt lgkmcnt(1)
 ds_read_b64_tr_b16 v[38:39], v7 offset:37384
 v_mfma_f32_16x16x32_bf16 v[208:211], v[32:35], a[240:243], v[208:211]
 ds_read_b64_tr_b16 v[40:41], v7 offset:40968
 v_mfma_f32_16x16x32_bf16 v[212:215], v[24:27], a[212:215], v[212:215]
 ds_read_b64_tr_b16 v[42:43], v7 offset:41480
 v_mfma_f32_16x16x32_bf16 v[212:215], v[28:31], a[228:231], v[212:215]
 ds_read_b64_tr_b16 v[44:45], v7 offset:45064
 v_mfma_f32_16x16x32_bf16 v[212:215], v[32:35], a[244:247], v[212:215]
 ds_read_b64_tr_b16 v[46:47], v7 offset:45576
 v_mfma_f32_16x16x32_bf16 v[216:219], v[24:27], a[216:219], v[216:219]
 v_mfma_f32_16x16x32_bf16 v[216:219], v[28:31], a[232:235], v[216:219]
 buffer_load_dwordx4 v242, s[24:27], s58 offen offset:2048 nt lds
 v_mfma_f32_16x16x32_bf16 v[216:219], v[32:35], a[248:251], v[216:219]
 v_mfma_f32_16x16x32_bf16 v[220:223], v[24:27], a[220:223], v[220:223]
 buffer_load_dwordx4 v243, s[24:27], s58 offen offset:3072 nt lds
 v_mfma_f32_16x16x32_bf16 v[220:223], v[28:31], a[236:239], v[220:223]
 v_mfma_f32_16x16x32_bf16 v[220:223], v[32:35], a[252:255], v[220:223]
 s_waitcnt vmcnt(25)
 s_barrier
 s_waitcnt lgkmcnt(4)
 v_mfma_f32_16x16x32_bf16 v[224:227], v[36:39], a[208:211], v[224:227]
 s_waitcnt lgkmcnt(2)
 ds_read_b64_tr_b16 v[24:25], v6 offset:49152
 v_mfma_f32_16x16x32_bf16 v[224:227], v[40:43], a[224:227], v[224:227]
 s_waitcnt lgkmcnt(1)
 ds_read_b64_tr_b16 v[26:27], v6 offset:49664
 v_mfma_f32_16x16x32_bf16 v[224:227], v[44:47], a[240:243], v[224:227]
 ds_read_b64_tr_b16 v[28:29], v6 offset:53248
 v_mfma_f32_16x16x32_bf16 v[228:231], v[36:39], a[212:215], v[228:231]
 ds_read_b64_tr_b16 v[30:31], v6 offset:53760
 v_mfma_f32_16x16x32_bf16 v[228:231], v[40:43], a[228:231], v[228:231]
 ds_read_b64_tr_b16 v[32:33], v6 offset:57344
 v_mfma_f32_16x16x32_bf16 v[228:231], v[44:47], a[244:247], v[228:231]
 ds_read_b64_tr_b16 v[34:35], v6 offset:57856
 v_mfma_f32_16x16x32_bf16 v[232:235], v[36:39], a[216:219], v[232:235]
 v_mfma_f32_16x16x32_bf16 v[232:235], v[40:43], a[232:235], v[232:235]
 v_mfma_f32_16x16x32_bf16 v[232:235], v[44:47], a[248:251], v[232:235]
 v_mfma_f32_16x16x32_bf16 v[236:239], v[36:39], a[220:223], v[236:239]
 v_mfma_f32_16x16x32_bf16 v[236:239], v[40:43], a[236:239], v[236:239]
 v_mfma_f32_16x16x32_bf16 v[236:239], v[44:47], a[252:255], v[236:239]
 s_waitcnt lgkmcnt(4)
 v_mfma_f32_16x16x32_bf16 v[112:115], v[24:27], v[48:51], 0
 s_waitcnt lgkmcnt(2)
 ds_read_b64_tr_b16 v[36:37], v6 offset:49160
 v_mfma_f32_16x16x32_bf16 v[112:115], v[28:31], v[64:67], v[112:115]
 s_waitcnt lgkmcnt(1)
 ds_read_b64_tr_b16 v[38:39], v6 offset:49672
 v_mfma_f32_16x16x32_bf16 v[112:115], v[32:35], a[0:3], v[112:115]
 ds_read_b64_tr_b16 v[40:41], v6 offset:53256
 v_lshrrev_b32 v13, 4, v1
 v_mfma_f32_16x16x32_bf16 v[116:119], v[24:27], v[52:55], 0
 ds_read_b64_tr_b16 v[42:43], v6 offset:53768
 v_and_b32 v14, 15, v1
 v_mfma_f32_16x16x32_bf16 v[116:119], v[28:31], v[68:71], v[116:119]
 ds_read_b64_tr_b16 v[44:45], v6 offset:57352
 v_mul_f32 v176, s75, v176
 v_mfma_f32_16x16x32_bf16 v[116:119], v[32:35], a[4:7], v[116:119]
 ds_read_b64_tr_b16 v[46:47], v6 offset:57864
 v_lshlrev_b32 v15, 8, v14
 v_mfma_f32_16x16x32_bf16 v[120:123], v[24:27], v[56:59], 0
 v_xor_b32 v14, v13, v14
 v_lshrrev_b32 v13, 2, v1
 v_mfma_f32_16x16x32_bf16 v[120:123], v[28:31], v[72:75], v[120:123]
 s_add_u32 m0, s72, 32768
 v_mul_f32 v177, s75, v177
 v_mul_f32 v178, s75, v178
 v_mfma_f32_16x16x32_bf16 v[120:123], v[32:35], a[8:11], v[120:123]
 s_mov_b32 s58, 32768
 buffer_load_dwordx4 v240, s[24:27], s58 offen offset:0 nt lds
 v_mfma_f32_16x16x32_bf16 v[124:127], v[24:27], v[60:63], 0
 v_xor_b32 v246, 0, v14
 v_xor_b32 v247, 4, v14
 v_mfma_f32_16x16x32_bf16 v[124:127], v[28:31], v[76:79], v[124:127]
 v_xor_b32 v248, 8, v14
 v_xor_b32 v249, 12, v14
 v_mfma_f32_16x16x32_bf16 v[124:127], v[32:35], a[12:15], v[124:127]
 s_waitcnt lgkmcnt(4)
 v_lshl_add_u32 v246, v246, 4, v15
 v_lshl_add_u32 v247, v247, 4, v15
 v_mfma_f32_16x16x32_bf16 v[128:131], v[36:39], v[48:51], 0
 s_waitcnt lgkmcnt(2)
 ds_read_b64_tr_b16 v[24:25], v7 offset:49152
 v_lshl_add_u32 v248, v248, 4, v15
 v_mfma_f32_16x16x32_bf16 v[128:131], v[40:43], v[64:67], v[128:131]
 s_waitcnt lgkmcnt(1)
 ds_read_b64_tr_b16 v[26:27], v7 offset:49664
 v_lshl_add_u32 v249, v249, 4, v15
 v_mfma_f32_16x16x32_bf16 v[128:131], v[44:47], a[0:3], v[128:131]
 ds_read_b64_tr_b16 v[28:29], v7 offset:53248
 v_and_b32 v14, 3, v1
 v_mfma_f32_16x16x32_bf16 v[132:135], v[36:39], v[52:55], 0
 ds_read_b64_tr_b16 v[30:31], v7 offset:53760
 v_mul_f32 v179, s75, v179
 v_mfma_f32_16x16x32_bf16 v[132:135], v[40:43], v[68:71], v[132:135]
 ds_read_b64_tr_b16 v[32:33], v7 offset:57344
 v_lshlrev_b32 v14, 3, v14
 v_mfma_f32_16x16x32_bf16 v[132:135], v[44:47], a[4:7], v[132:135]
 ds_read_b64_tr_b16 v[34:35], v7 offset:57856
 v_cvt_pk_bf16_f32 v80, v176, v177
 v_mfma_f32_16x16x32_bf16 v[136:139], v[36:39], v[56:59], 0
 buffer_load_dwordx4 v241, s[24:27], s58 offen offset:1024 nt lds
 v_mfma_f32_16x16x32_bf16 v[136:139], v[40:43], v[72:75], v[136:139]
 v_lshl_add_u32 v15, v13, 8, v14
 v_and_b32 v13, 7, v13
 v_mfma_f32_16x16x32_bf16 v[136:139], v[44:47], a[8:11], v[136:139]
 v_cvt_pk_bf16_f32 v81, v178, v179
 v_mul_f32 v180, s75, v180
 v_mfma_f32_16x16x32_bf16 v[140:143], v[36:39], v[60:63], 0
 v_add_u32 v15, 65536, v15
 v_xor_b32 v16, 0, v13
 v_mfma_f32_16x16x32_bf16 v[140:143], v[40:43], v[76:79], v[140:143]
 buffer_load_dwordx4 v242, s[24:27], s58 offen offset:2048 nt lds
 v_mfma_f32_16x16x32_bf16 v[140:143], v[44:47], a[12:15], v[140:143]
 s_waitcnt lgkmcnt(4)
 v_lshl_add_u32 v16, v16, 5, v15
 v_xor_b32 v17, 1, v13
 v_mfma_f32_16x16x32_bf16 v[144:147], v[24:27], v[48:51], 0
 s_waitcnt lgkmcnt(2)
 ds_read_b64_tr_b16 v[36:37], v7 offset:49160
 v_xor_b32 v18, 2, v13
 v_mfma_f32_16x16x32_bf16 v[144:147], v[28:31], v[64:67], v[144:147]
 s_waitcnt lgkmcnt(1)
 ds_read_b64_tr_b16 v[38:39], v7 offset:49672
 v_lshl_add_u32 v17, v17, 5, v15
 v_mfma_f32_16x16x32_bf16 v[144:147], v[32:35], a[0:3], v[144:147]
 ds_read_b64_tr_b16 v[40:41], v7 offset:53256
 v_lshl_add_u32 v18, v18, 5, v15
 v_mfma_f32_16x16x32_bf16 v[148:151], v[24:27], v[52:55], 0
 ds_read_b64_tr_b16 v[42:43], v7 offset:53768
 v_xor_b32 v19, 3, v13
 v_mfma_f32_16x16x32_bf16 v[148:151], v[28:31], v[68:71], v[148:151]
 ds_read_b64_tr_b16 v[44:45], v7 offset:57352
 v_xor_b32 v20, 4, v13
 v_mfma_f32_16x16x32_bf16 v[148:151], v[32:35], a[4:7], v[148:151]
 ds_read_b64_tr_b16 v[46:47], v7 offset:57864
 v_lshl_add_u32 v19, v19, 5, v15
 v_mfma_f32_16x16x32_bf16 v[152:155], v[24:27], v[56:59], 0
 v_add_u32 v6, 0xc000, v6
 v_add_u32 v7, 0xc000, v7
 v_mfma_f32_16x16x32_bf16 v[152:155], v[28:31], v[72:75], v[152:155]
 v_lshl_add_u32 v20, v20, 5, v15
 v_xor_b32 v21, 5, v13
 v_mfma_f32_16x16x32_bf16 v[152:155], v[32:35], a[8:11], v[152:155]
 v_xor_b32 v22, 6, v13
 v_xor_b32 v23, 7, v13
 v_mfma_f32_16x16x32_bf16 v[156:159], v[24:27], v[60:63], 0
 buffer_load_dwordx4 v243, s[24:27], s58 offen offset:3072 nt lds
 v_mfma_f32_16x16x32_bf16 v[156:159], v[28:31], v[76:79], v[156:159]
 v_lshl_add_u32 v21, v21, 5, v15
 v_lshl_add_u32 v22, v22, 5, v15
 v_mfma_f32_16x16x32_bf16 v[156:159], v[32:35], a[12:15], v[156:159]
 s_waitcnt lgkmcnt(4)
 v_lshl_add_u32 v23, v23, 5, v15
 v_mul_f32 v181, s75, v181
 v_mfma_f32_16x16x32_bf16 v[160:163], v[36:39], v[48:51], 0
 s_waitcnt lgkmcnt(2)
 ds_read_b64_tr_b16 v[24:25], v6 offset:12288
 v_mul_f32 v182, s75, v182
 v_mfma_f32_16x16x32_bf16 v[160:163], v[40:43], v[64:67], v[160:163]
 s_waitcnt lgkmcnt(1)
 ds_read_b64_tr_b16 v[26:27], v6 offset:12800
 v_mul_f32 v183, s75, v183
 v_mfma_f32_16x16x32_bf16 v[160:163], v[44:47], a[0:3], v[160:163]
 ds_read_b64_tr_b16 v[28:29], v6 offset:16384
 v_cvt_pk_bf16_f32 v84, v180, v181
 v_mfma_f32_16x16x32_bf16 v[164:167], v[36:39], v[52:55], 0
 ds_read_b64_tr_b16 v[30:31], v6 offset:16896
 v_cvt_pk_bf16_f32 v85, v182, v183
 v_mfma_f32_16x16x32_bf16 v[164:167], v[40:43], v[68:71], v[164:167]
 ds_read_b64_tr_b16 v[32:33], v6 offset:20480
 v_mul_f32 v184, s75, v184
 v_mfma_f32_16x16x32_bf16 v[164:167], v[44:47], a[4:7], v[164:167]
 ds_read_b64_tr_b16 v[34:35], v6 offset:20992
 v_mul_f32 v185, s75, v185
 v_mfma_f32_16x16x32_bf16 v[168:171], v[36:39], v[56:59], 0
 v_mul_f32 v186, s75, v186
 v_mul_f32 v187, s75, v187
 v_mfma_f32_16x16x32_bf16 v[168:171], v[40:43], v[72:75], v[168:171]
 v_cvt_pk_bf16_f32 v88, v184, v185
 v_mul_f32 v188, s75, v188
 v_mfma_f32_16x16x32_bf16 v[168:171], v[44:47], a[8:11], v[168:171]
 v_cvt_pk_bf16_f32 v89, v186, v187
 v_mul_f32 v189, s75, v189
 v_mfma_f32_16x16x32_bf16 v[172:175], v[36:39], v[60:63], 0
 v_mul_f32 v190, s75, v190
 v_mul_f32 v191, s75, v191
 v_mfma_f32_16x16x32_bf16 v[172:175], v[40:43], v[76:79], v[172:175]
 v_cvt_pk_bf16_f32 v92, v188, v189
 v_mul_f32 v192, s75, v192
 v_mfma_f32_16x16x32_bf16 v[172:175], v[44:47], a[12:15], v[172:175]
 s_waitcnt lgkmcnt(4)
 v_cvt_pk_bf16_f32 v93, v190, v191
 v_mul_f32 v193, s75, v193
 v_mfma_f32_16x16x32_bf16 v[112:115], v[24:27], a[16:19], v[112:115]
 s_waitcnt lgkmcnt(2)
 ds_read_b64_tr_b16 v[36:37], v6 offset:12296
 v_mul_f32 v194, s75, v194
 v_mfma_f32_16x16x32_bf16 v[112:115], v[28:31], a[32:35], v[112:115]
 s_waitcnt lgkmcnt(1)
 ds_read_b64_tr_b16 v[38:39], v6 offset:12808
 v_mul_f32 v195, s75, v195
 v_mfma_f32_16x16x32_bf16 v[112:115], v[32:35], a[48:51], v[112:115]
 ds_read_b64_tr_b16 v[40:41], v6 offset:16392
 v_cvt_pk_bf16_f32 v82, v192, v193
 v_mfma_f32_16x16x32_bf16 v[116:119], v[24:27], a[20:23], v[116:119]
 ds_read_b64_tr_b16 v[42:43], v6 offset:16904
 v_cvt_pk_bf16_f32 v83, v194, v195
 v_mfma_f32_16x16x32_bf16 v[116:119], v[28:31], a[36:39], v[116:119]
 ds_read_b64_tr_b16 v[44:45], v6 offset:20488
 v_mul_f32 v196, s75, v196
 v_mfma_f32_16x16x32_bf16 v[116:119], v[32:35], a[52:55], v[116:119]
 ds_read_b64_tr_b16 v[46:47], v6 offset:21000
 v_mul_f32 v197, s75, v197
 v_mfma_f32_16x16x32_bf16 v[120:123], v[24:27], a[24:27], v[120:123]
 v_mul_f32 v198, s75, v198
 v_mul_f32 v199, s75, v199
 v_mfma_f32_16x16x32_bf16 v[120:123], v[28:31], a[40:43], v[120:123]
 s_add_u32 m0, s72, 49152
 v_cvt_pk_bf16_f32 v86, v196, v197
 v_mul_f32 v200, s75, v200
 v_mfma_f32_16x16x32_bf16 v[120:123], v[32:35], a[56:59], v[120:123]
 s_mov_b32 s58, 49152
 buffer_load_dwordx4 v240, s[24:27], s58 offen offset:0 nt lds
 v_mfma_f32_16x16x32_bf16 v[124:127], v[24:27], a[28:31], v[124:127]
 v_cvt_pk_bf16_f32 v87, v198, v199
 v_mul_f32 v201, s75, v201
 v_mfma_f32_16x16x32_bf16 v[124:127], v[28:31], a[44:47], v[124:127]
 v_mul_f32 v202, s75, v202
 v_mul_f32 v203, s75, v203
 v_mfma_f32_16x16x32_bf16 v[124:127], v[32:35], a[60:63], v[124:127]
 s_waitcnt lgkmcnt(4)
 v_cvt_pk_bf16_f32 v90, v200, v201
 v_mul_f32 v204, s75, v204
 v_mfma_f32_16x16x32_bf16 v[128:131], v[36:39], a[16:19], v[128:131]
 s_waitcnt lgkmcnt(2)
 ds_read_b64_tr_b16 v[24:25], v7 offset:12288
 v_cvt_pk_bf16_f32 v91, v202, v203
 v_mfma_f32_16x16x32_bf16 v[128:131], v[40:43], a[32:35], v[128:131]
 s_waitcnt lgkmcnt(1)
 ds_read_b64_tr_b16 v[26:27], v7 offset:12800
 v_mul_f32 v205, s75, v205
 v_mfma_f32_16x16x32_bf16 v[128:131], v[44:47], a[48:51], v[128:131]
 ds_read_b64_tr_b16 v[28:29], v7 offset:16384
 v_mul_f32 v206, s75, v206
 v_mfma_f32_16x16x32_bf16 v[132:135], v[36:39], a[20:23], v[132:135]
 ds_read_b64_tr_b16 v[30:31], v7 offset:16896
 v_mul_f32 v207, s75, v207
 v_mfma_f32_16x16x32_bf16 v[132:135], v[40:43], a[36:39], v[132:135]
 ds_read_b64_tr_b16 v[32:33], v7 offset:20480
 v_cvt_pk_bf16_f32 v94, v204, v205
 v_mfma_f32_16x16x32_bf16 v[132:135], v[44:47], a[52:55], v[132:135]
 ds_read_b64_tr_b16 v[34:35], v7 offset:20992
 v_cvt_pk_bf16_f32 v95, v206, v207
 v_mfma_f32_16x16x32_bf16 v[136:139], v[36:39], a[24:27], v[136:139]
 buffer_load_dwordx4 v241, s[24:27], s58 offen offset:1024 nt lds
 v_mfma_f32_16x16x32_bf16 v[136:139], v[40:43], a[40:43], v[136:139]
 v_mul_f32 v208, s75, v208
 v_mul_f32 v209, s75, v209
 v_mfma_f32_16x16x32_bf16 v[136:139], v[44:47], a[56:59], v[136:139]
 v_mul_f32 v210, s75, v210
 v_mul_f32 v211, s75, v211
 v_mfma_f32_16x16x32_bf16 v[140:143], v[36:39], a[28:31], v[140:143]
 v_cvt_pk_bf16_f32 v96, v208, v209
 v_mul_f32 v212, s75, v212
 v_mfma_f32_16x16x32_bf16 v[140:143], v[40:43], a[44:47], v[140:143]
 buffer_load_dwordx4 v242, s[24:27], s58 offen offset:2048 nt lds
 v_mfma_f32_16x16x32_bf16 v[140:143], v[44:47], a[60:63], v[140:143]
 s_waitcnt lgkmcnt(4)
 v_cvt_pk_bf16_f32 v97, v210, v211
 v_mul_f32 v213, s75, v213
 v_mfma_f32_16x16x32_bf16 v[144:147], v[24:27], a[16:19], v[144:147]
 s_waitcnt lgkmcnt(2)
 ds_read_b64_tr_b16 v[36:37], v7 offset:12296
 v_mul_f32 v214, s75, v214
 v_mfma_f32_16x16x32_bf16 v[144:147], v[28:31], a[32:35], v[144:147]
 s_waitcnt lgkmcnt(1)
 ds_read_b64_tr_b16 v[38:39], v7 offset:12808
 v_mul_f32 v215, s75, v215
 v_mfma_f32_16x16x32_bf16 v[144:147], v[32:35], a[48:51], v[144:147]
 ds_read_b64_tr_b16 v[40:41], v7 offset:16392
 v_cvt_pk_bf16_f32 v100, v212, v213
 v_mfma_f32_16x16x32_bf16 v[148:151], v[24:27], a[20:23], v[148:151]
 ds_read_b64_tr_b16 v[42:43], v7 offset:16904
 v_cvt_pk_bf16_f32 v101, v214, v215
 v_mfma_f32_16x16x32_bf16 v[148:151], v[28:31], a[36:39], v[148:151]
 ds_read_b64_tr_b16 v[44:45], v7 offset:20488
 v_mul_f32 v216, s75, v216
 v_mfma_f32_16x16x32_bf16 v[148:151], v[32:35], a[52:55], v[148:151]
 ds_read_b64_tr_b16 v[46:47], v7 offset:21000
 v_mul_f32 v217, s75, v217
 v_mfma_f32_16x16x32_bf16 v[152:155], v[24:27], a[24:27], v[152:155]
 v_mul_f32 v218, s75, v218
 v_mul_f32 v219, s75, v219
 v_mfma_f32_16x16x32_bf16 v[152:155], v[28:31], a[40:43], v[152:155]
 v_cvt_pk_bf16_f32 v104, v216, v217
 v_mul_f32 v220, s75, v220
 v_mfma_f32_16x16x32_bf16 v[152:155], v[32:35], a[56:59], v[152:155]
 buffer_load_dwordx4 v243, s[24:27], s58 offen offset:3072 nt lds
 v_mfma_f32_16x16x32_bf16 v[156:159], v[24:27], a[28:31], v[156:159]
 v_cvt_pk_bf16_f32 v105, v218, v219
 v_mul_f32 v221, s75, v221
 v_mfma_f32_16x16x32_bf16 v[156:159], v[28:31], a[44:47], v[156:159]
 v_mul_f32 v222, s75, v222
 v_mul_f32 v223, s75, v223
 v_mfma_f32_16x16x32_bf16 v[156:159], v[32:35], a[60:63], v[156:159]
 s_waitcnt vmcnt(22)
 s_barrier
 s_waitcnt lgkmcnt(4)
 v_mfma_f32_16x16x32_bf16 v[160:163], v[36:39], a[16:19], v[160:163]
 s_waitcnt lgkmcnt(2)
 ds_read_b64_tr_b16 v[24:25], v6 offset:24576
 v_cvt_pk_bf16_f32 v108, v220, v221
 v_mfma_f32_16x16x32_bf16 v[160:163], v[40:43], a[32:35], v[160:163]
 s_waitcnt lgkmcnt(1)
 ds_read_b64_tr_b16 v[26:27], v6 offset:25088
 v_cvt_pk_bf16_f32 v109, v222, v223
 v_mfma_f32_16x16x32_bf16 v[160:163], v[44:47], a[48:51], v[160:163]
 ds_read_b64_tr_b16 v[28:29], v6 offset:28672
 v_mul_f32 v224, s75, v224
 v_mfma_f32_16x16x32_bf16 v[164:167], v[36:39], a[20:23], v[164:167]
 ds_read_b64_tr_b16 v[30:31], v6 offset:29184
 v_mul_f32 v225, s75, v225
 v_mfma_f32_16x16x32_bf16 v[164:167], v[40:43], a[36:39], v[164:167]
 ds_read_b64_tr_b16 v[32:33], v6 offset:32768
 v_mul_f32 v226, s75, v226
 v_mfma_f32_16x16x32_bf16 v[164:167], v[44:47], a[52:55], v[164:167]
 ds_read_b64_tr_b16 v[34:35], v6 offset:33280
 v_mul_f32 v227, s75, v227
 v_mfma_f32_16x16x32_bf16 v[168:171], v[36:39], a[24:27], v[168:171]
 v_cvt_pk_bf16_f32 v98, v224, v225
 v_mul_f32 v228, s75, v228
 v_mfma_f32_16x16x32_bf16 v[168:171], v[40:43], a[40:43], v[168:171]
 v_cvt_pk_bf16_f32 v99, v226, v227
 v_mul_f32 v229, s75, v229
 v_mfma_f32_16x16x32_bf16 v[168:171], v[44:47], a[56:59], v[168:171]
 v_mul_f32 v230, s75, v230
 v_mul_f32 v231, s75, v231
 v_mfma_f32_16x16x32_bf16 v[172:175], v[36:39], a[28:31], v[172:175]
 v_cvt_pk_bf16_f32 v102, v228, v229
 v_mul_f32 v232, s75, v232
 v_mfma_f32_16x16x32_bf16 v[172:175], v[40:43], a[44:47], v[172:175]
 v_cvt_pk_bf16_f32 v103, v230, v231
 v_mul_f32 v233, s75, v233
 v_mfma_f32_16x16x32_bf16 v[172:175], v[44:47], a[60:63], v[172:175]
 s_waitcnt lgkmcnt(4)
 v_mul_f32 v234, s75, v234
 v_mul_f32 v235, s75, v235
 v_mfma_f32_16x16x32_bf16 v[112:115], v[24:27], a[64:67], v[112:115]
 s_waitcnt lgkmcnt(2)
 ds_read_b64_tr_b16 v[36:37], v6 offset:24584
 v_cvt_pk_bf16_f32 v106, v232, v233
 v_mfma_f32_16x16x32_bf16 v[112:115], v[28:31], a[80:83], v[112:115]
 s_waitcnt lgkmcnt(1)
 ds_read_b64_tr_b16 v[38:39], v6 offset:25096
 v_cvt_pk_bf16_f32 v107, v234, v235
 v_mfma_f32_16x16x32_bf16 v[112:115], v[32:35], a[96:99], v[112:115]
 ds_read_b64_tr_b16 v[40:41], v6 offset:28680
 v_mul_f32 v236, s75, v236
 v_mfma_f32_16x16x32_bf16 v[116:119], v[24:27], a[68:71], v[116:119]
 ds_read_b64_tr_b16 v[42:43], v6 offset:29192
 v_mul_f32 v237, s75, v237
 v_mfma_f32_16x16x32_bf16 v[116:119], v[28:31], a[84:87], v[116:119]
 ds_read_b64_tr_b16 v[44:45], v6 offset:32776
 v_mul_f32 v238, s75, v238
 v_mfma_f32_16x16x32_bf16 v[116:119], v[32:35], a[100:103], v[116:119]
 ds_read_b64_tr_b16 v[46:47], v6 offset:33288
 v_mul_f32 v239, s75, v239
 v_mfma_f32_16x16x32_bf16 v[120:123], v[24:27], a[72:75], v[120:123]
 v_cvt_pk_bf16_f32 v110, v236, v237
 v_mfma_f32_16x16x32_bf16 v[120:123], v[28:31], a[88:91], v[120:123]
 s_add_u32 m0, s72, 65536
 v_cvt_pk_bf16_f32 v111, v238, v239
 v_mfma_f32_16x16x32_bf16 v[120:123], v[32:35], a[104:107], v[120:123]
 s_mov_b32 s58, 16384
 buffer_load_dwordx4 v244, s[28:31], s58 offen offset:0 nt lds
 v_mfma_f32_16x16x32_bf16 v[124:127], v[24:27], a[76:79], v[124:127]
 v_mfma_f32_16x16x32_bf16 v[124:127], v[28:31], a[92:95], v[124:127]
 v_mfma_f32_16x16x32_bf16 v[124:127], v[32:35], a[108:111], v[124:127]
 s_waitcnt lgkmcnt(4)
 v_mfma_f32_16x16x32_bf16 v[128:131], v[36:39], a[64:67], v[128:131]
 s_waitcnt lgkmcnt(2)
 ds_read_b64_tr_b16 v[24:25], v7 offset:24576
 v_mfma_f32_16x16x32_bf16 v[128:131], v[40:43], a[80:83], v[128:131]
 s_waitcnt lgkmcnt(1)
 ds_read_b64_tr_b16 v[26:27], v7 offset:25088
 v_mfma_f32_16x16x32_bf16 v[128:131], v[44:47], a[96:99], v[128:131]
 ds_read_b64_tr_b16 v[28:29], v7 offset:28672
 v_mfma_f32_16x16x32_bf16 v[132:135], v[36:39], a[68:71], v[132:135]
 ds_read_b64_tr_b16 v[30:31], v7 offset:29184
 v_mfma_f32_16x16x32_bf16 v[132:135], v[40:43], a[84:87], v[132:135]
 ds_read_b64_tr_b16 v[32:33], v7 offset:32768
 v_mfma_f32_16x16x32_bf16 v[132:135], v[44:47], a[100:103], v[132:135]
 ds_read_b64_tr_b16 v[34:35], v7 offset:33280
 v_mfma_f32_16x16x32_bf16 v[136:139], v[36:39], a[72:75], v[136:139]
 buffer_load_dwordx4 v245, s[28:31], s58 offen offset:1024 nt lds
 v_mfma_f32_16x16x32_bf16 v[136:139], v[40:43], a[88:91], v[136:139]
 v_mfma_f32_16x16x32_bf16 v[136:139], v[44:47], a[104:107], v[136:139]
 v_mfma_f32_16x16x32_bf16 v[140:143], v[36:39], a[76:79], v[140:143]
 v_mfma_f32_16x16x32_bf16 v[140:143], v[40:43], a[92:95], v[140:143]
 buffer_load_dwordx4 v244, s[28:31], s58 offen offset:2048 nt lds
 v_mfma_f32_16x16x32_bf16 v[140:143], v[44:47], a[108:111], v[140:143]
 s_waitcnt lgkmcnt(4)
 v_mfma_f32_16x16x32_bf16 v[144:147], v[24:27], a[64:67], v[144:147]
 s_waitcnt lgkmcnt(2)
 ds_read_b64_tr_b16 v[36:37], v7 offset:24584
 v_mfma_f32_16x16x32_bf16 v[144:147], v[28:31], a[80:83], v[144:147]
 s_waitcnt lgkmcnt(1)
 ds_read_b64_tr_b16 v[38:39], v7 offset:25096
 v_mfma_f32_16x16x32_bf16 v[144:147], v[32:35], a[96:99], v[144:147]
 ds_read_b64_tr_b16 v[40:41], v7 offset:28680
 v_mfma_f32_16x16x32_bf16 v[148:151], v[24:27], a[68:71], v[148:151]
 ds_read_b64_tr_b16 v[42:43], v7 offset:29192
 v_mfma_f32_16x16x32_bf16 v[148:151], v[28:31], a[84:87], v[148:151]
 ds_read_b64_tr_b16 v[44:45], v7 offset:32776
 v_mfma_f32_16x16x32_bf16 v[148:151], v[32:35], a[100:103], v[148:151]
 ds_read_b64_tr_b16 v[46:47], v7 offset:33288
 v_mfma_f32_16x16x32_bf16 v[152:155], v[24:27], a[72:75], v[152:155]
 v_mfma_f32_16x16x32_bf16 v[152:155], v[28:31], a[88:91], v[152:155]
 v_mfma_f32_16x16x32_bf16 v[152:155], v[32:35], a[104:107], v[152:155]
 buffer_load_dwordx4 v245, s[28:31], s58 offen offset:3072 nt lds
 v_mfma_f32_16x16x32_bf16 v[156:159], v[24:27], a[76:79], v[156:159]
 v_mfma_f32_16x16x32_bf16 v[156:159], v[28:31], a[92:95], v[156:159]
 v_mfma_f32_16x16x32_bf16 v[156:159], v[32:35], a[108:111], v[156:159]
 s_waitcnt lgkmcnt(4)
 v_mfma_f32_16x16x32_bf16 v[160:163], v[36:39], a[64:67], v[160:163]
 s_waitcnt lgkmcnt(2)
 ds_read_b64_tr_b16 v[24:25], v6 offset:36864
 v_mfma_f32_16x16x32_bf16 v[160:163], v[40:43], a[80:83], v[160:163]
 s_waitcnt lgkmcnt(1)
 ds_read_b64_tr_b16 v[26:27], v6 offset:37376
 v_mfma_f32_16x16x32_bf16 v[160:163], v[44:47], a[96:99], v[160:163]
 ds_read_b64_tr_b16 v[28:29], v6 offset:40960
 v_mfma_f32_16x16x32_bf16 v[164:167], v[36:39], a[68:71], v[164:167]
 ds_read_b64_tr_b16 v[30:31], v6 offset:41472
 v_mfma_f32_16x16x32_bf16 v[164:167], v[40:43], a[84:87], v[164:167]
 ds_read_b64_tr_b16 v[32:33], v6 offset:45056
 v_mfma_f32_16x16x32_bf16 v[164:167], v[44:47], a[100:103], v[164:167]
 ds_read_b64_tr_b16 v[34:35], v6 offset:45568
 v_mfma_f32_16x16x32_bf16 v[168:171], v[36:39], a[72:75], v[168:171]
 v_mfma_f32_16x16x32_bf16 v[168:171], v[40:43], a[88:91], v[168:171]
 v_mfma_f32_16x16x32_bf16 v[168:171], v[44:47], a[104:107], v[168:171]
 v_mfma_f32_16x16x32_bf16 v[172:175], v[36:39], a[76:79], v[172:175]
 v_mfma_f32_16x16x32_bf16 v[172:175], v[40:43], a[92:95], v[172:175]
 v_mfma_f32_16x16x32_bf16 v[172:175], v[44:47], a[108:111], v[172:175]
 s_waitcnt lgkmcnt(4)
 v_mfma_f32_16x16x32_bf16 v[112:115], v[24:27], a[112:115], v[112:115]
 s_waitcnt lgkmcnt(2)
 ds_read_b64_tr_b16 v[36:37], v6 offset:36872
 v_mfma_f32_16x16x32_bf16 v[112:115], v[28:31], a[128:131], v[112:115]
 s_waitcnt lgkmcnt(1)
 ds_read_b64_tr_b16 v[38:39], v6 offset:37384
 v_mfma_f32_16x16x32_bf16 v[112:115], v[32:35], a[144:147], v[112:115]
 ds_read_b64_tr_b16 v[40:41], v6 offset:40968
 v_mfma_f32_16x16x32_bf16 v[116:119], v[24:27], a[116:119], v[116:119]
 ds_read_b64_tr_b16 v[42:43], v6 offset:41480
 v_mfma_f32_16x16x32_bf16 v[116:119], v[28:31], a[132:135], v[116:119]
 ds_read_b64_tr_b16 v[44:45], v6 offset:45064
 v_mfma_f32_16x16x32_bf16 v[116:119], v[32:35], a[148:151], v[116:119]
 ds_read_b64_tr_b16 v[46:47], v6 offset:45576
 v_mfma_f32_16x16x32_bf16 v[120:123], v[24:27], a[120:123], v[120:123]
 v_mfma_f32_16x16x32_bf16 v[120:123], v[28:31], a[136:139], v[120:123]
 v_mfma_f32_16x16x32_bf16 v[120:123], v[32:35], a[152:155], v[120:123]
 v_mfma_f32_16x16x32_bf16 v[124:127], v[24:27], a[124:127], v[124:127]
 v_mfma_f32_16x16x32_bf16 v[124:127], v[28:31], a[140:143], v[124:127]
 v_mfma_f32_16x16x32_bf16 v[124:127], v[32:35], a[156:159], v[124:127]
 s_waitcnt lgkmcnt(4)
 v_mfma_f32_16x16x32_bf16 v[128:131], v[36:39], a[112:115], v[128:131]
 s_waitcnt lgkmcnt(2)
 ds_read_b64_tr_b16 v[24:25], v7 offset:36864
 v_mfma_f32_16x16x32_bf16 v[128:131], v[40:43], a[128:131], v[128:131]
 s_waitcnt lgkmcnt(1)
 ds_read_b64_tr_b16 v[26:27], v7 offset:37376
 v_mfma_f32_16x16x32_bf16 v[128:131], v[44:47], a[144:147], v[128:131]
 ds_read_b64_tr_b16 v[28:29], v7 offset:40960
 v_mfma_f32_16x16x32_bf16 v[132:135], v[36:39], a[116:119], v[132:135]
 ds_read_b64_tr_b16 v[30:31], v7 offset:41472
 v_mfma_f32_16x16x32_bf16 v[132:135], v[40:43], a[132:135], v[132:135]
 ds_read_b64_tr_b16 v[32:33], v7 offset:45056
 v_mfma_f32_16x16x32_bf16 v[132:135], v[44:47], a[148:151], v[132:135]
 ds_read_b64_tr_b16 v[34:35], v7 offset:45568
 v_mfma_f32_16x16x32_bf16 v[136:139], v[36:39], a[120:123], v[136:139]
 v_mfma_f32_16x16x32_bf16 v[136:139], v[40:43], a[136:139], v[136:139]
 v_mfma_f32_16x16x32_bf16 v[136:139], v[44:47], a[152:155], v[136:139]
 v_mfma_f32_16x16x32_bf16 v[140:143], v[36:39], a[124:127], v[140:143]
 v_mfma_f32_16x16x32_bf16 v[140:143], v[40:43], a[140:143], v[140:143]
 v_mfma_f32_16x16x32_bf16 v[140:143], v[44:47], a[156:159], v[140:143]
 s_waitcnt lgkmcnt(4)
 v_mfma_f32_16x16x32_bf16 v[144:147], v[24:27], a[112:115], v[144:147]
 s_waitcnt lgkmcnt(2)
 ds_read_b64_tr_b16 v[36:37], v7 offset:36872
 v_mfma_f32_16x16x32_bf16 v[144:147], v[28:31], a[128:131], v[144:147]
 s_waitcnt lgkmcnt(1)
 ds_read_b64_tr_b16 v[38:39], v7 offset:37384
 v_mfma_f32_16x16x32_bf16 v[144:147], v[32:35], a[144:147], v[144:147]
 ds_read_b64_tr_b16 v[40:41], v7 offset:40968
 v_mfma_f32_16x16x32_bf16 v[148:151], v[24:27], a[116:119], v[148:151]
 ds_read_b64_tr_b16 v[42:43], v7 offset:41480
 v_mfma_f32_16x16x32_bf16 v[148:151], v[28:31], a[132:135], v[148:151]
 ds_read_b64_tr_b16 v[44:45], v7 offset:45064
 v_mfma_f32_16x16x32_bf16 v[148:151], v[32:35], a[148:151], v[148:151]
 ds_read_b64_tr_b16 v[46:47], v7 offset:45576
 v_mfma_f32_16x16x32_bf16 v[152:155], v[24:27], a[120:123], v[152:155]
 v_mfma_f32_16x16x32_bf16 v[152:155], v[28:31], a[136:139], v[152:155]
 v_mfma_f32_16x16x32_bf16 v[152:155], v[32:35], a[152:155], v[152:155]
 v_mfma_f32_16x16x32_bf16 v[156:159], v[24:27], a[124:127], v[156:159]
 v_mfma_f32_16x16x32_bf16 v[156:159], v[28:31], a[140:143], v[156:159]
 v_mfma_f32_16x16x32_bf16 v[156:159], v[32:35], a[156:159], v[156:159]
 s_waitcnt vmcnt(12)
 s_barrier
 s_waitcnt lgkmcnt(4)
 v_mfma_f32_16x16x32_bf16 v[160:163], v[36:39], a[112:115], v[160:163]
 s_waitcnt lgkmcnt(2)
 ds_read_b64_tr_b16 v[24:25], v6 offset:49152
 v_mfma_f32_16x16x32_bf16 v[160:163], v[40:43], a[128:131], v[160:163]
 s_waitcnt lgkmcnt(1)
 ds_read_b64_tr_b16 v[26:27], v6 offset:49664
 v_mfma_f32_16x16x32_bf16 v[160:163], v[44:47], a[144:147], v[160:163]
 ds_read_b64_tr_b16 v[28:29], v6 offset:53248
 v_mfma_f32_16x16x32_bf16 v[164:167], v[36:39], a[116:119], v[164:167]
 ds_read_b64_tr_b16 v[30:31], v6 offset:53760
 v_mfma_f32_16x16x32_bf16 v[164:167], v[40:43], a[132:135], v[164:167]
 ds_read_b64_tr_b16 v[32:33], v6 offset:57344
 v_mfma_f32_16x16x32_bf16 v[164:167], v[44:47], a[148:151], v[164:167]
 ds_read_b64_tr_b16 v[34:35], v6 offset:57856
 v_mfma_f32_16x16x32_bf16 v[168:171], v[36:39], a[120:123], v[168:171]
 v_mfma_f32_16x16x32_bf16 v[168:171], v[40:43], a[136:139], v[168:171]
 v_mfma_f32_16x16x32_bf16 v[168:171], v[44:47], a[152:155], v[168:171]
 v_mfma_f32_16x16x32_bf16 v[172:175], v[36:39], a[124:127], v[172:175]
 v_mfma_f32_16x16x32_bf16 v[172:175], v[40:43], a[140:143], v[172:175]
 v_mfma_f32_16x16x32_bf16 v[172:175], v[44:47], a[156:159], v[172:175]
 s_waitcnt lgkmcnt(4)
 v_mfma_f32_16x16x32_bf16 v[112:115], v[24:27], a[160:163], v[112:115]
 s_waitcnt lgkmcnt(2)
 ds_read_b64_tr_b16 v[36:37], v6 offset:49160
 v_mfma_f32_16x16x32_bf16 v[112:115], v[28:31], a[176:179], v[112:115]
 s_waitcnt lgkmcnt(1)
 ds_read_b64_tr_b16 v[38:39], v6 offset:49672
 v_mfma_f32_16x16x32_bf16 v[112:115], v[32:35], a[192:195], v[112:115]
 ds_read_b64_tr_b16 v[40:41], v6 offset:53256
 v_mfma_f32_16x16x32_bf16 v[116:119], v[24:27], a[164:167], v[116:119]
 ds_read_b64_tr_b16 v[42:43], v6 offset:53768
 v_mfma_f32_16x16x32_bf16 v[116:119], v[28:31], a[180:183], v[116:119]
 ds_read_b64_tr_b16 v[44:45], v6 offset:57352
 v_mfma_f32_16x16x32_bf16 v[116:119], v[32:35], a[196:199], v[116:119]
 ds_read_b64_tr_b16 v[46:47], v6 offset:57864
 v_mfma_f32_16x16x32_bf16 v[120:123], v[24:27], a[168:171], v[120:123]
 v_mfma_f32_16x16x32_bf16 v[120:123], v[28:31], a[184:187], v[120:123]
 s_add_u32 m0, s72, 81920
 v_mfma_f32_16x16x32_bf16 v[120:123], v[32:35], a[200:203], v[120:123]
 s_mov_b32 s58, 32768
 buffer_load_dwordx4 v244, s[28:31], s58 offen offset:0 nt lds
 v_mfma_f32_16x16x32_bf16 v[124:127], v[24:27], a[172:175], v[124:127]
 v_mfma_f32_16x16x32_bf16 v[124:127], v[28:31], a[188:191], v[124:127]
 v_mfma_f32_16x16x32_bf16 v[124:127], v[32:35], a[204:207], v[124:127]
 s_waitcnt lgkmcnt(4)
 v_mfma_f32_16x16x32_bf16 v[128:131], v[36:39], a[160:163], v[128:131]
 s_waitcnt lgkmcnt(2)
 ds_read_b64_tr_b16 v[24:25], v7 offset:49152
 v_mfma_f32_16x16x32_bf16 v[128:131], v[40:43], a[176:179], v[128:131]
 s_waitcnt lgkmcnt(1)
 ds_read_b64_tr_b16 v[26:27], v7 offset:49664
 v_mfma_f32_16x16x32_bf16 v[128:131], v[44:47], a[192:195], v[128:131]
 ds_read_b64_tr_b16 v[28:29], v7 offset:53248
 v_mfma_f32_16x16x32_bf16 v[132:135], v[36:39], a[164:167], v[132:135]
 ds_read_b64_tr_b16 v[30:31], v7 offset:53760
 v_mfma_f32_16x16x32_bf16 v[132:135], v[40:43], a[180:183], v[132:135]
 ds_read_b64_tr_b16 v[32:33], v7 offset:57344
 v_mfma_f32_16x16x32_bf16 v[132:135], v[44:47], a[196:199], v[132:135]
 ds_read_b64_tr_b16 v[34:35], v7 offset:57856
 v_mfma_f32_16x16x32_bf16 v[136:139], v[36:39], a[168:171], v[136:139]
 buffer_load_dwordx4 v245, s[28:31], s58 offen offset:1024 nt lds
 v_mfma_f32_16x16x32_bf16 v[136:139], v[40:43], a[184:187], v[136:139]
 v_mfma_f32_16x16x32_bf16 v[136:139], v[44:47], a[200:203], v[136:139]
 v_mfma_f32_16x16x32_bf16 v[140:143], v[36:39], a[172:175], v[140:143]
 v_mfma_f32_16x16x32_bf16 v[140:143], v[40:43], a[188:191], v[140:143]
 buffer_load_dwordx4 v244, s[28:31], s58 offen offset:2048 nt lds
 v_mfma_f32_16x16x32_bf16 v[140:143], v[44:47], a[204:207], v[140:143]
 s_waitcnt lgkmcnt(4)
 v_mfma_f32_16x16x32_bf16 v[144:147], v[24:27], a[160:163], v[144:147]
 s_waitcnt lgkmcnt(2)
 ds_read_b64_tr_b16 v[36:37], v7 offset:49160
 v_mfma_f32_16x16x32_bf16 v[144:147], v[28:31], a[176:179], v[144:147]
 s_waitcnt lgkmcnt(1)
 ds_read_b64_tr_b16 v[38:39], v7 offset:49672
 v_mfma_f32_16x16x32_bf16 v[144:147], v[32:35], a[192:195], v[144:147]
 ds_read_b64_tr_b16 v[40:41], v7 offset:53256
 v_mfma_f32_16x16x32_bf16 v[148:151], v[24:27], a[164:167], v[148:151]
 ds_read_b64_tr_b16 v[42:43], v7 offset:53768
 v_mfma_f32_16x16x32_bf16 v[148:151], v[28:31], a[180:183], v[148:151]
 ds_read_b64_tr_b16 v[44:45], v7 offset:57352
 v_mfma_f32_16x16x32_bf16 v[148:151], v[32:35], a[196:199], v[148:151]
 ds_read_b64_tr_b16 v[46:47], v7 offset:57864
 v_mfma_f32_16x16x32_bf16 v[152:155], v[24:27], a[168:171], v[152:155]
 v_add_u32 v6, 0xc000, v6
 v_add_u32 v7, 0xc000, v7
 v_mfma_f32_16x16x32_bf16 v[152:155], v[28:31], a[184:187], v[152:155]
 v_mfma_f32_16x16x32_bf16 v[152:155], v[32:35], a[200:203], v[152:155]
 v_mfma_f32_16x16x32_bf16 v[156:159], v[24:27], a[172:175], v[156:159]
 buffer_load_dwordx4 v245, s[28:31], s58 offen offset:3072 nt lds
 v_mfma_f32_16x16x32_bf16 v[156:159], v[28:31], a[188:191], v[156:159]
 v_mfma_f32_16x16x32_bf16 v[156:159], v[32:35], a[204:207], v[156:159]
 s_waitcnt lgkmcnt(4)
 v_mfma_f32_16x16x32_bf16 v[160:163], v[36:39], a[160:163], v[160:163]
 s_waitcnt lgkmcnt(2)
 ds_read_b64_tr_b16 v[24:25], v6 offset:12288
 v_mfma_f32_16x16x32_bf16 v[160:163], v[40:43], a[176:179], v[160:163]
 s_waitcnt lgkmcnt(1)
 ds_read_b64_tr_b16 v[26:27], v6 offset:12800
 v_mfma_f32_16x16x32_bf16 v[160:163], v[44:47], a[192:195], v[160:163]
 ds_read_b64_tr_b16 v[28:29], v6 offset:16384
 v_mfma_f32_16x16x32_bf16 v[164:167], v[36:39], a[164:167], v[164:167]
 ds_read_b64_tr_b16 v[30:31], v6 offset:16896
 v_mfma_f32_16x16x32_bf16 v[164:167], v[40:43], a[180:183], v[164:167]
 ds_read_b64_tr_b16 v[32:33], v6 offset:20480
 v_mfma_f32_16x16x32_bf16 v[164:167], v[44:47], a[196:199], v[164:167]
 ds_read_b64_tr_b16 v[34:35], v6 offset:20992
 v_mfma_f32_16x16x32_bf16 v[168:171], v[36:39], a[168:171], v[168:171]
 v_mfma_f32_16x16x32_bf16 v[168:171], v[40:43], a[184:187], v[168:171]
 v_mfma_f32_16x16x32_bf16 v[168:171], v[44:47], a[200:203], v[168:171]
 v_mfma_f32_16x16x32_bf16 v[172:175], v[36:39], a[172:175], v[172:175]
 v_mfma_f32_16x16x32_bf16 v[172:175], v[40:43], a[188:191], v[172:175]
 v_mov_b32 v13, 0x3f803f80
 v_mfma_f32_16x16x32_bf16 v[172:175], v[44:47], a[204:207], v[172:175]
 s_waitcnt lgkmcnt(4)
 v_mfma_f32_16x16x32_bf16 v[112:115], v[24:27], a[208:211], v[112:115]
 s_waitcnt lgkmcnt(2)
 ds_read_b64_tr_b16 v[36:37], v6 offset:12296
 v_accvgpr_write_b32 a192, v13
 v_mfma_f32_16x16x32_bf16 v[112:115], v[28:31], a[224:227], v[112:115]
 s_waitcnt lgkmcnt(1)
 ds_read_b64_tr_b16 v[38:39], v6 offset:12808
 v_accvgpr_write_b32 a193, v13
 v_accvgpr_write_b32 a194, v13
 v_mfma_f32_16x16x32_bf16 v[112:115], v[32:35], a[240:243], v[112:115]
 ds_read_b64_tr_b16 v[40:41], v6 offset:16392
 v_accvgpr_write_b32 a195, v13
 v_mfma_f32_16x16x32_bf16 v[116:119], v[24:27], a[212:215], v[116:119]
 ds_read_b64_tr_b16 v[42:43], v6 offset:16904
 v_mfma_f32_16x16x32_bf16 v[116:119], v[28:31], a[228:231], v[116:119]
 ds_read_b64_tr_b16 v[44:45], v6 offset:20488
 v_mfma_f32_16x16x32_bf16 v[116:119], v[32:35], a[244:247], v[116:119]
 ds_read_b64_tr_b16 v[46:47], v6 offset:21000
 v_mfma_f32_16x16x32_bf16 v[120:123], v[24:27], a[216:219], v[120:123]
 v_mfma_f32_16x16x32_bf16 v[120:123], v[28:31], a[232:235], v[120:123]
 s_add_u32 m0, s72, 98304
 v_mfma_f32_16x16x32_bf16 v[120:123], v[32:35], a[248:251], v[120:123]
 s_mov_b32 s58, 49152
 buffer_load_dwordx4 v244, s[28:31], s58 offen offset:0 nt lds
 v_mul_f32 v112, s75, v112
 v_mfma_f32_16x16x32_bf16 v[124:127], v[24:27], a[220:223], v[124:127]
 v_mul_f32 v113, s75, v113
 v_mul_f32 v114, s75, v114
 v_mul_f32 v115, s75, v115
 v_mfma_f32_16x16x32_bf16 v[124:127], v[28:31], a[236:239], v[124:127]
 v_mfma_f32_16x16x32_bf16 v[124:127], v[32:35], a[252:255], v[124:127]
 s_waitcnt lgkmcnt(4)
 v_cvt_pk_bf16_f32 v48, v112, v113
 v_cvt_pk_bf16_f32 v49, v114, v115
 v_mul_f32 v116, s75, v116
 v_mfma_f32_16x16x32_bf16 v[128:131], v[36:39], a[208:211], v[128:131]
 s_waitcnt lgkmcnt(2)
 ds_read_b64_tr_b16 v[24:25], v7 offset:12288
 v_mul_f32 v117, s75, v117
 v_mul_f32 v118, s75, v118
 v_mul_f32 v119, s75, v119
 v_mfma_f32_16x16x32_bf16 v[128:131], v[40:43], a[224:227], v[128:131]
 s_waitcnt lgkmcnt(1)
 ds_read_b64_tr_b16 v[26:27], v7 offset:12800
 v_mfma_f32_16x16x32_bf16 v[128:131], v[44:47], a[240:243], v[128:131]
 ds_read_b64_tr_b16 v[28:29], v7 offset:16384
 v_cvt_pk_bf16_f32 v52, v116, v117
 v_cvt_pk_bf16_f32 v53, v118, v119
 v_mfma_f32_16x16x32_bf16 v[132:135], v[36:39], a[212:215], v[132:135]
 ds_read_b64_tr_b16 v[30:31], v7 offset:16896
 v_mul_f32 v120, s75, v120
 v_mul_f32 v121, s75, v121
 v_mfma_f32_16x16x32_bf16 v[132:135], v[40:43], a[228:231], v[132:135]
 ds_read_b64_tr_b16 v[32:33], v7 offset:20480
 v_mul_f32 v122, s75, v122
 v_mul_f32 v123, s75, v123
 v_mfma_f32_16x16x32_bf16 v[132:135], v[44:47], a[244:247], v[132:135]
 ds_read_b64_tr_b16 v[34:35], v7 offset:20992
 v_cvt_pk_bf16_f32 v56, v120, v121
 v_mul_f32 v124, s75, v124
 v_mfma_f32_16x16x32_bf16 v[136:139], v[36:39], a[216:219], v[136:139]
 buffer_load_dwordx4 v245, s[28:31], s58 offen offset:1024 nt lds
 v_cvt_pk_bf16_f32 v57, v122, v123
 v_mul_f32 v125, s75, v125
 v_mfma_f32_16x16x32_bf16 v[136:139], v[40:43], a[232:235], v[136:139]
 v_mul_f32 v126, s75, v126
 v_mul_f32 v127, s75, v127
 v_mfma_f32_16x16x32_bf16 v[136:139], v[44:47], a[248:251], v[136:139]
 v_cvt_pk_bf16_f32 v60, v124, v125
 v_mul_f32 v128, s75, v128
 v_mul_f32 v129, s75, v129
 v_mfma_f32_16x16x32_bf16 v[140:143], v[36:39], a[220:223], v[140:143]
 v_cvt_pk_bf16_f32 v61, v126, v127
 v_mul_f32 v130, s75, v130
 v_mul_f32 v131, s75, v131
 v_mfma_f32_16x16x32_bf16 v[140:143], v[40:43], a[236:239], v[140:143]
 buffer_load_dwordx4 v244, s[28:31], s58 offen offset:2048 nt lds
 v_cvt_pk_bf16_f32 v50, v128, v129
 v_mfma_f32_16x16x32_bf16 v[140:143], v[44:47], a[252:255], v[140:143]
 s_waitcnt lgkmcnt(4)
 v_cvt_pk_bf16_f32 v51, v130, v131
 v_mul_f32 v132, s75, v132
 v_mul_f32 v133, s75, v133
 v_mul_f32 v134, s75, v134
 v_mfma_f32_16x16x32_bf16 v[144:147], v[24:27], a[208:211], v[144:147]
 s_waitcnt lgkmcnt(2)
 ds_read_b64_tr_b16 v[36:37], v7 offset:12296
 v_mul_f32 v135, s75, v135
 v_mfma_f32_16x16x32_bf16 v[144:147], v[28:31], a[224:227], v[144:147]
 s_waitcnt lgkmcnt(1)
 ds_read_b64_tr_b16 v[38:39], v7 offset:12808
 v_cvt_pk_bf16_f32 v54, v132, v133
 v_mfma_f32_16x16x32_bf16 v[144:147], v[32:35], a[240:243], v[144:147]
 ds_read_b64_tr_b16 v[40:41], v7 offset:16392
 v_cvt_pk_bf16_f32 v55, v134, v135
 v_mul_f32 v136, s75, v136
 v_mfma_f32_16x16x32_bf16 v[148:151], v[24:27], a[212:215], v[148:151]
 ds_read_b64_tr_b16 v[42:43], v7 offset:16904
 v_mul_f32 v137, s75, v137
 v_mul_f32 v138, s75, v138
 v_mul_f32 v139, s75, v139
 v_mfma_f32_16x16x32_bf16 v[148:151], v[28:31], a[228:231], v[148:151]
 ds_read_b64_tr_b16 v[44:45], v7 offset:20488
 v_mfma_f32_16x16x32_bf16 v[148:151], v[32:35], a[244:247], v[148:151]
 ds_read_b64_tr_b16 v[46:47], v7 offset:21000
 v_cvt_pk_bf16_f32 v58, v136, v137
 v_cvt_pk_bf16_f32 v59, v138, v139
 v_mfma_f32_16x16x32_bf16 v[152:155], v[24:27], a[216:219], v[152:155]
 v_mul_f32 v140, s75, v140
 v_mul_f32 v141, s75, v141
 v_mul_f32 v142, s75, v142
 v_mul_f32 v143, s75, v143
 v_mfma_f32_16x16x32_bf16 v[152:155], v[28:31], a[232:235], v[152:155]
 v_mfma_f32_16x16x32_bf16 v[152:155], v[32:35], a[248:251], v[152:155]
 buffer_load_dwordx4 v245, s[28:31], s58 offen offset:3072 nt lds
 v_cvt_pk_bf16_f32 v62, v140, v141
 v_cvt_pk_bf16_f32 v63, v142, v143
 v_mfma_f32_16x16x32_bf16 v[156:159], v[24:27], a[220:223], v[156:159]
 v_mul_f32 v144, s75, v144
 v_mul_f32 v145, s75, v145
 v_mul_f32 v146, s75, v146
 v_mfma_f32_16x16x32_bf16 v[156:159], v[28:31], a[236:239], v[156:159]
 v_mul_f32 v147, s75, v147
 v_mfma_f32_16x16x32_bf16 v[156:159], v[32:35], a[252:255], v[156:159]
 s_waitcnt lgkmcnt(4)
 v_cvt_pk_bf16_f32 v64, v144, v145
 v_mul_f32 v148, s75, v148
 v_mul_f32 v149, s75, v149
 v_mul_f32 v150, s75, v150
 v_mfma_f32_16x16x32_bf16 v[160:163], v[36:39], a[208:211], v[160:163]
 s_waitcnt lgkmcnt(2)
 ds_read_b128 a[128:131], v246 offset:0
 v_cvt_pk_bf16_f32 v65, v146, v147
 v_mul_f32 v151, s75, v151
 v_mfma_f32_16x16x32_bf16 v[160:163], v[40:43], a[224:227], v[160:163]
 s_waitcnt lgkmcnt(1)
 ds_read_b128 a[132:135], v247 offset:0
 v_cvt_pk_bf16_f32 v68, v148, v149
 v_mfma_f32_16x16x32_bf16 v[160:163], v[44:47], a[240:243], v[160:163]
 ds_read_b128 a[136:139], v248 offset:0
 v_cvt_pk_bf16_f32 v69, v150, v151
 v_mul_f32 v152, s75, v152
 v_mul_f32 v153, s75, v153
 v_mfma_f32_16x16x32_bf16 v[164:167], v[36:39], a[212:215], v[164:167]
 ds_read_b128 a[140:143], v249 offset:0
 v_mul_f32 v154, s75, v154
 v_mul_f32 v155, s75, v155
 v_mfma_f32_16x16x32_bf16 v[164:167], v[40:43], a[228:231], v[164:167]
 ds_read_b128 a[144:147], v246 offset:4096
 v_cvt_pk_bf16_f32 v72, v152, v153
 v_mfma_f32_16x16x32_bf16 v[164:167], v[44:47], a[244:247], v[164:167]
 ds_read_b128 a[148:151], v247 offset:4096
 v_cvt_pk_bf16_f32 v73, v154, v155
 v_mul_f32 v156, s75, v156
 v_mul_f32 v157, s75, v157
 v_mul_f32 v158, s75, v158
 v_mfma_f32_16x16x32_bf16 v[168:171], v[36:39], a[216:219], v[168:171]
 ds_read_b128 a[152:155], v248 offset:4096
 v_mul_f32 v159, s75, v159
 v_mfma_f32_16x16x32_bf16 v[168:171], v[40:43], a[232:235], v[168:171]
 ds_read_b128 a[156:159], v249 offset:4096
 v_cvt_pk_bf16_f32 v76, v156, v157
 v_mfma_f32_16x16x32_bf16 v[168:171], v[44:47], a[248:251], v[168:171]
 s_load_dwordx2 s[8:9], s[0:1], 0
 s_load_dwordx4 s[12:15], s[0:1], 72
 v_cvt_pk_bf16_f32 v77, v158, v159
 v_mul_f32 v160, s75, v160
 v_mul_f32 v161, s75, v161
 v_mul_f32 v162, s75, v162
 v_mfma_f32_16x16x32_bf16 v[172:175], v[36:39], a[220:223], v[172:175]
 v_mul_f32 v163, s75, v163
 v_mfma_f32_16x16x32_bf16 v[172:175], v[40:43], a[236:239], v[172:175]
 v_cvt_pk_bf16_f32 v66, v160, v161
 v_mfma_f32_16x16x32_bf16 v[172:175], v[44:47], a[252:255], v[172:175]
 v_cvt_pk_bf16_f32 v67, v162, v163
 v_mul_f32 v164, s75, v164
 v_mul_f32 v165, s75, v165
 v_mul_f32 v166, s75, v166
 v_mul_f32 v167, s75, v167
 v_cvt_pk_bf16_f32 v70, v164, v165
 v_cvt_pk_bf16_f32 v71, v166, v167
 v_mul_f32 v168, s75, v168
 v_mul_f32 v169, s75, v169
 v_mul_f32 v170, s75, v170
 v_mul_f32 v171, s75, v171
 v_cvt_pk_bf16_f32 v74, v168, v169
 v_mul_f32 v172, s75, v172
 v_cvt_pk_bf16_f32 v75, v170, v171
 v_mul_f32 v173, s75, v173
 v_mul_f32 v174, s75, v174
 v_mul_f32 v175, s75, v175
 v_cvt_pk_bf16_f32 v78, v172, v173
 v_cvt_pk_bf16_f32 v79, v174, v175
L_ab_done:
 s_mov_b32 s76, 65536
 s_sub_u32 s20, s48, 1048576
 s_subb_u32 s21, s49, 0
 s_mov_b32 s22, 9216
 s_mov_b32 s23, 0x20000
 s_and_b32 s55, s2, 1
 s_lshr_b32 s56, s2, 3
 s_lshl_b32 s55, s55, 5
 s_add_u32 s55, s55, s56
 s_lshl_b32 s55, s55, 7
 s_bfe_u32 s56, s2, 0x20001
 s_lshl2_add_u32 s55, s56, s55
 v_lshl_add_u32 v11, v1, 6, s55
 s_lshl_b32 s55, s54, 7
 s_lshl2_add_u32 s55, s53, s55
 s_add_u32 s55, s55, 8192
 v_writelane_b32 v11, s55, 2
 v_mov_b32 v10, 0
 s_mov_b64 exec, 7
 buffer_store_dword v10, v11, s[20:23], 0 offen sc1
 s_mov_b64 exec, -1
 s_nop 1
 s_waitcnt lgkmcnt(0)
 v_mfma_f32_16x16x32_bf16 v[128:131], a[128:131], v[80:83], 0
 v_mfma_f32_16x16x32_bf16 v[128:131], a[132:135], v[96:99], v[128:131]
 v_mfma_f32_16x16x32_bf16 v[128:131], a[136:139], v[48:51], v[128:131]
 v_mfma_f32_16x16x32_bf16 v[128:131], a[140:143], v[64:67], v[128:131]
 v_mfma_f32_16x16x32_bf16 v[132:135], a[128:131], v[84:87], 0
 v_mfma_f32_16x16x32_bf16 v[132:135], a[132:135], v[100:103], v[132:135]
 v_mfma_f32_16x16x32_bf16 v[132:135], a[136:139], v[52:55], v[132:135]
 v_mfma_f32_16x16x32_bf16 v[132:135], a[140:143], v[68:71], v[132:135]
 v_mfma_f32_16x16x32_bf16 v[136:139], a[128:131], v[88:91], 0
 v_mfma_f32_16x16x32_bf16 v[136:139], a[132:135], v[104:107], v[136:139]
 v_mfma_f32_16x16x32_bf16 v[136:139], a[136:139], v[56:59], v[136:139]
 v_mfma_f32_16x16x32_bf16 v[136:139], a[140:143], v[72:75], v[136:139]
 v_max3_f32 v160, v128, v129, v130
 v_mfma_f32_16x16x32_bf16 v[140:143], a[128:131], v[92:95], 0
 v_mfma_f32_16x16x32_bf16 v[140:143], a[132:135], v[108:111], v[140:143]
 v_max_f32 v160, v160, v131
 v_mfma_f32_16x16x32_bf16 v[140:143], a[136:139], v[60:63], v[140:143]
 v_mfma_f32_16x16x32_bf16 v[140:143], a[140:143], v[76:79], v[140:143]
 v_max3_f32 v164, v132, v133, v134
 v_mov_b32 v10, v160
 v_mfma_f32_16x16x32_bf16 v[144:147], a[144:147], v[80:83], 0
 ds_read_b128 a[128:131], v246 offset:8192
 v_mfma_f32_16x16x32_bf16 v[144:147], a[148:151], v[96:99], v[144:147]
 ds_read_b128 a[132:135], v247 offset:8192
 v_max_f32 v164, v164, v135
 v_permlane16_swap_b32 v10, v160
 v_mfma_f32_16x16x32_bf16 v[144:147], a[152:155], v[48:51], v[144:147]
 ds_read_b128 a[136:139], v248 offset:8192
 v_mfma_f32_16x16x32_bf16 v[144:147], a[156:159], v[64:67], v[144:147]
 ds_read_b128 a[140:143], v249 offset:8192
 v_max3_f32 v168, v136, v137, v138
 v_mov_b32 v11, v164
 v_max_f32 v160, v160, v10
 v_mfma_f32_16x16x32_bf16 v[148:151], a[144:147], v[84:87], 0
 v_mfma_f32_16x16x32_bf16 v[148:151], a[148:151], v[100:103], v[148:151]
 v_max_f32 v168, v168, v139
 v_permlane16_swap_b32 v11, v164
 v_mov_b32 v10, v160
 v_mfma_f32_16x16x32_bf16 v[148:151], a[152:155], v[52:55], v[148:151]
 v_mfma_f32_16x16x32_bf16 v[148:151], a[156:159], v[68:71], v[148:151]
 v_max3_f32 v172, v140, v141, v142
 v_mov_b32 v12, v168
 v_max_f32 v164, v164, v11
 v_permlane32_swap_b32 v10, v160
 v_mfma_f32_16x16x32_bf16 v[152:155], a[144:147], v[88:91], 0
 v_mfma_f32_16x16x32_bf16 v[152:155], a[148:151], v[104:107], v[152:155]
 v_max_f32 v172, v172, v143
 v_permlane16_swap_b32 v12, v168
 v_mov_b32 v11, v164
 v_max_f32 v160, v160, v10
 v_mfma_f32_16x16x32_bf16 v[152:155], a[152:155], v[56:59], v[152:155]
 v_mfma_f32_16x16x32_bf16 v[152:155], a[156:159], v[72:75], v[152:155]
 v_mov_b32 v13, v172
 v_max_f32 v168, v168, v12
 v_permlane32_swap_b32 v11, v164
 v_sub_f32 v160, 0, v160
 v_mfma_f32_16x16x32_bf16 v[156:159], a[144:147], v[92:95], 0
 v_mfma_f32_16x16x32_bf16 v[156:159], a[148:151], v[108:111], v[156:159]
 v_permlane16_swap_b32 v13, v172
 v_mov_b32 v12, v168
 v_max_f32 v164, v164, v11
 v_mov_b32 v161, v160
 v_mov_b32 v162, v160
 v_mfma_f32_16x16x32_bf16 v[156:159], a[152:155], v[60:63], v[156:159]
 v_mfma_f32_16x16x32_bf16 v[156:159], a[156:159], v[76:79], v[156:159]
 v_max_f32 v172, v172, v13
 v_permlane32_swap_b32 v12, v168
 v_sub_f32 v164, 0, v164
 v_mov_b32 v13, v172
 v_max_f32 v168, v168, v12
 v_mov_b32 v165, v164
 v_permlane32_swap_b32 v13, v172
 v_sub_f32 v168, 0, v168
 v_mov_b32 v166, v164
 v_max_f32 v172, v172, v13
 v_mov_b32 v169, v168
 v_mov_b32 v170, v168
 v_sub_f32 v172, 0, v172
 v_mov_b32 v163, v160
 v_mov_b32 v167, v164
 v_mov_b32 v173, v172
 v_mov_b32 v174, v172
 v_mov_b32 v171, v168
 v_mov_b32 v175, v172
 v_add_f32 v128, v160, v128
 v_add_f32 v129, v160, v129
 v_add_f32 v130, v160, v130
 v_exp_f32 v128, v128
 v_exp_f32 v129, v129
 v_exp_f32 v130, v130
 v_mov_b32 v124, v128
 v_cvt_pk_bf16_f32 v176, v128, v129
 v_add_f32 v131, v160, v131
 v_add_f32 v124, v124, v129
 v_add_f32 v132, v164, v132
 v_exp_f32 v131, v131
 v_add_f32 v124, v124, v130
 v_exp_f32 v132, v132
 v_cvt_pk_bf16_f32 v177, v130, v131
 v_add_f32 v124, v124, v131
 v_add_f32 v133, v164, v133
 v_add_f32 v134, v164, v134
 v_add_f32 v135, v164, v135
 v_exp_f32 v133, v133
 v_exp_f32 v134, v134
 v_exp_f32 v135, v135
 v_cvt_pk_bf16_f32 v180, v132, v133
 v_add_f32 v136, v168, v136
 v_cvt_pk_bf16_f32 v181, v134, v135
 v_add_f32 v137, v168, v137
 v_exp_f32 v136, v136
 v_add_f32 v138, v168, v138
 v_exp_f32 v137, v137
 v_mov_b32 v126, v136
 v_exp_f32 v138, v138
 v_cvt_pk_bf16_f32 v184, v136, v137
 v_add_f32 v126, v126, v137
 v_add_f32 v139, v168, v139
 v_add_f32 v140, v172, v140
 v_add_f32 v126, v126, v138
 v_exp_f32 v139, v139
 v_exp_f32 v140, v140
 v_add_f32 v141, v172, v141
 v_add_f32 v126, v126, v139
 v_cvt_pk_bf16_f32 v185, v138, v139
 v_exp_f32 v141, v141
 v_add_f32 v142, v172, v142
 v_add_f32 v143, v172, v143
 v_cvt_pk_bf16_f32 v188, v140, v141
 v_exp_f32 v142, v142
 v_exp_f32 v143, v143
 s_nop 0
 v_cvt_pk_bf16_f32 v189, v142, v143
 s_waitcnt lgkmcnt(3)
 v_mfma_f32_16x16x32_bf16 v[128:131], a[128:131], v[80:83], v[160:163]
 ds_read_b128 a[144:147], v246 offset:12288
 v_add_f32 v144, v160, v144
 v_add_f32 v145, v160, v145
 v_add_f32 v146, v160, v146
 s_waitcnt lgkmcnt(3)
 v_mfma_f32_16x16x32_bf16 v[128:131], a[132:135], v[96:99], v[128:131]
 ds_read_b128 a[148:151], v247 offset:12288
 v_add_f32 v147, v160, v147
 v_add_f32 v148, v164, v148
 v_add_f32 v149, v164, v149
 v_add_f32 v150, v164, v150
 s_waitcnt lgkmcnt(3)
 v_mfma_f32_16x16x32_bf16 v[128:131], a[136:139], v[48:51], v[128:131]
 ds_read_b128 a[152:155], v248 offset:12288
 v_exp_f32 v144, v144
 v_add_f32 v151, v164, v151
 s_waitcnt lgkmcnt(3)
 v_mfma_f32_16x16x32_bf16 v[128:131], a[140:143], v[64:67], v[128:131]
 ds_read_b128 a[156:159], v249 offset:12288
 v_exp_f32 v145, v145
 v_exp_f32 v146, v146
 v_mfma_f32_16x16x32_bf16 v[132:135], a[128:131], v[84:87], v[164:167]
 v_exp_f32 v147, v147
 v_add_f32 v124, v124, v144
 v_add_f32 v152, v168, v152
 v_mfma_f32_16x16x32_bf16 v[132:135], a[132:135], v[100:103], v[132:135]
 v_exp_f32 v148, v148
 v_cvt_pk_bf16_f32 v178, v144, v145
 v_exp_f32 v149, v149
 v_mfma_f32_16x16x32_bf16 v[132:135], a[136:139], v[52:55], v[132:135]
 v_exp_f32 v150, v150
 v_add_f32 v124, v124, v145
 v_cvt_pk_bf16_f32 v179, v146, v147
 v_mfma_f32_16x16x32_bf16 v[132:135], a[140:143], v[68:71], v[132:135]
 v_exp_f32 v151, v151
 v_cvt_pk_bf16_f32 v182, v148, v149
 v_exp_f32 v152, v152
 v_mfma_f32_16x16x32_bf16 v[136:139], a[128:131], v[88:91], v[168:171]
 v_add_f32 v124, v124, v146
 v_add_f32 v153, v168, v153
 v_add_f32 v154, v168, v154
 v_add_f32 v155, v168, v155
 v_add_f32 v156, v172, v156
 v_mfma_f32_16x16x32_bf16 v[136:139], a[132:135], v[104:107], v[136:139]
 v_cvt_pk_bf16_f32 v183, v150, v151
 v_add_f32 v126, v126, v152
 v_add_f32 v157, v172, v157
 v_add_f32 v158, v172, v158
 v_mfma_f32_16x16x32_bf16 v[136:139], a[136:139], v[56:59], v[136:139]
 v_exp_f32 v153, v153
 v_add_f32 v124, v124, v147
 v_exp_f32 v154, v154
 v_mfma_f32_16x16x32_bf16 v[136:139], a[140:143], v[72:75], v[136:139]
 v_exp_f32 v155, v155
 v_exp_f32 v156, v156
 v_mfma_f32_16x16x32_bf16 v[140:143], a[128:131], v[92:95], v[172:175]
 v_exp_f32 v157, v157
 v_add_f32 v126, v126, v153
 v_cvt_pk_bf16_f32 v186, v152, v153
 v_add_f32 v159, v172, v159
 v_mfma_f32_16x16x32_bf16 v[140:143], a[132:135], v[108:111], v[140:143]
 v_exp_f32 v158, v158
 v_cvt_pk_bf16_f32 v187, v154, v155
 v_mfma_f32_16x16x32_bf16 v[140:143], a[136:139], v[60:63], v[140:143]
 v_add_f32 v126, v126, v154
 v_cvt_pk_bf16_f32 v190, v156, v157
 v_exp_f32 v159, v159
 v_add_f32 v126, v126, v155
 v_cvt_pk_bf16_f32 v191, v158, v159
 v_mfma_f32_16x16x32_bf16 v[140:143], a[140:143], v[76:79], v[140:143]
 s_waitcnt vmcnt(9) lgkmcnt(0)
 s_barrier
 v_mfma_f32_16x16x32_bf16 v[144:147], a[144:147], v[80:83], v[160:163]
 ds_read_b128 a[128:131], v246 offset:16384
 v_exp_f32 v128, v128
 v_mfma_f32_16x16x32_bf16 v[144:147], a[148:151], v[96:99], v[144:147]
 ds_read_b128 a[132:135], v247 offset:16384
 v_exp_f32 v129, v129
 v_mfma_f32_16x16x32_bf16 v[144:147], a[152:155], v[48:51], v[144:147]
 ds_read_b128 a[136:139], v248 offset:16384
 v_add_f32 v124, v124, v128
 v_mfma_f32_16x16x32_bf16 v[144:147], a[156:159], v[64:67], v[144:147]
 ds_read_b128 a[140:143], v249 offset:16384
 v_cvt_pk_bf16_f32 v192, v128, v129
 v_exp_f32 v130, v130
 v_mfma_f32_16x16x32_bf16 v[148:151], a[144:147], v[84:87], v[164:167]
 ds_read_b64_tr_b16 a[160:161], v16 offset:0
 v_add_f32 v124, v124, v129
 v_mfma_f32_16x16x32_bf16 v[148:151], a[148:151], v[100:103], v[148:151]
 ds_read_b64_tr_b16 a[162:163], v16 offset:4096
 v_exp_f32 v131, v131
 v_mfma_f32_16x16x32_bf16 v[148:151], a[152:155], v[52:55], v[148:151]
 ds_read_b64_tr_b16 a[164:165], v16 offset:8192
 v_add_f32 v124, v124, v130
 v_exp_f32 v132, v132
 v_mfma_f32_16x16x32_bf16 v[148:151], a[156:159], v[68:71], v[148:151]
 ds_read_b64_tr_b16 a[166:167], v16 offset:12288
 v_cvt_pk_bf16_f32 v193, v130, v131
 v_exp_f32 v133, v133
 v_mfma_f32_16x16x32_bf16 v[152:155], a[144:147], v[88:91], v[168:171]
 v_exp_f32 v134, v134
 v_add_f32 v124, v124, v131
 v_mfma_f32_16x16x32_bf16 v[152:155], a[148:151], v[104:107], v[152:155]
 v_exp_f32 v135, v135
 v_cvt_pk_bf16_f32 v196, v132, v133
 v_mfma_f32_16x16x32_bf16 v[152:155], a[152:155], v[56:59], v[152:155]
 v_exp_f32 v136, v136
 v_exp_f32 v137, v137
 v_mfma_f32_16x16x32_bf16 v[152:155], a[156:159], v[72:75], v[152:155]
 v_exp_f32 v138, v138
 v_cvt_pk_bf16_f32 v197, v134, v135
 v_mfma_f32_16x16x32_bf16 v[156:159], a[144:147], v[92:95], v[172:175]
 v_exp_f32 v139, v139
 v_add_f32 v126, v126, v136
 v_cvt_pk_bf16_f32 v200, v136, v137
 v_mfma_f32_16x16x32_bf16 v[156:159], a[148:151], v[108:111], v[156:159]
 v_exp_f32 v140, v140
 v_exp_f32 v141, v141
 v_mfma_f32_16x16x32_bf16 v[156:159], a[152:155], v[60:63], v[156:159]
 v_exp_f32 v142, v142
 v_add_f32 v126, v126, v137
 v_cvt_pk_bf16_f32 v201, v138, v139
 v_mfma_f32_16x16x32_bf16 v[156:159], a[156:159], v[76:79], v[156:159]
 s_waitcnt lgkmcnt(4)
 v_add_f32 v126, v126, v138
 v_cvt_pk_bf16_f32 v204, v140, v141
 v_exp_f32 v143, v143
 v_add_f32 v126, v126, v139
 v_cvt_pk_bf16_f32 v205, v142, v143
 v_mfma_f32_16x16x32_bf16 v[128:131], a[128:131], v[80:83], v[160:163]
 s_add_u32 m0, s79, 0
 s_add_u32 s58, s96, 0
 buffer_load_dwordx4 v254, s[44:47], s58 offen nt lds
 v_exp_f32 v145, v145
 v_mfma_f32_16x16x32_bf16 v[128:131], a[132:135], v[96:99], v[128:131]
 ds_read_b64_tr_b16 a[168:169], v17 offset:0
 s_add_u32 m0, s79, 1024
 s_add_u32 s58, s96, 9216
 buffer_load_dwordx4 v254, s[44:47], s58 offen nt lds
 v_exp_f32 v146, v146
 v_mfma_f32_16x16x32_bf16 v[128:131], a[136:139], v[48:51], v[128:131]
 s_add_u32 m0, s79, 2048
 s_add_u32 s58, s96, 18432
 buffer_load_dwordx4 v254, s[44:47], s58 offen nt lds
 v_exp_f32 v147, v147
 v_exp_f32 v148, v148
 v_mfma_f32_16x16x32_bf16 v[128:131], a[140:143], v[64:67], v[128:131]
 ds_read_b64_tr_b16 a[170:171], v17 offset:4096
 s_add_u32 m0, s79, 3072
 s_add_u32 s58, s96, 27648
 buffer_load_dwordx4 v254, s[44:47], s58 offen nt lds
 v_exp_f32 v149, v149
 v_mfma_f32_16x16x32_bf16 v[132:135], a[128:131], v[84:87], v[164:167]
 s_add_u32 m0, s79, 4096
 s_add_u32 s58, s96, 0
 buffer_load_dwordx4 v254, s[4:7], s58 offen nt lds
 v_exp_f32 v144, v144
 v_cvt_pk_bf16_f32 v195, v146, v147
 v_mfma_f32_16x16x32_bf16 v[132:135], a[132:135], v[100:103], v[132:135]
 ds_read_b64_tr_b16 a[172:173], v17 offset:8192
 s_add_u32 m0, s79, 5120
 s_add_u32 s58, s96, 9216
 buffer_load_dwordx4 v254, s[4:7], s58 offen nt lds
 v_cvt_pk_bf16_f32 v198, v148, v149
 v_exp_f32 v150, v150
 v_mfma_f32_16x16x32_bf16 v[132:135], a[136:139], v[52:55], v[132:135]
 s_add_u32 m0, s79, 6144
 s_add_u32 s58, s96, 18432
 buffer_load_dwordx4 v254, s[4:7], s58 offen nt lds
 v_exp_f32 v151, v151
 v_add_f32 v124, v124, v144
 v_mfma_f32_16x16x32_bf16 v[132:135], a[140:143], v[68:71], v[132:135]
 ds_read_b64_tr_b16 a[174:175], v17 offset:12288
 s_add_u32 m0, s79, 7168
 s_add_u32 s58, s96, 27648
 buffer_load_dwordx4 v254, s[4:7], s58 offen nt lds
 v_cvt_pk_bf16_f32 v194, v144, v145
 v_exp_f32 v152, v152
 v_mfma_f32_16x16x32_bf16 v[136:139], a[128:131], v[88:91], v[168:171]
 s_add_u32 m0, s72, 0
 v_exp_f32 v153, v153
 v_add_f32 v124, v124, v145
 v_cvt_pk_bf16_f32 v199, v150, v151
 v_mfma_f32_16x16x32_bf16 v[136:139], a[132:135], v[104:107], v[136:139]
 buffer_load_dwordx4 v240, s[24:27], s76 offen offset:0 nt lds
 v_add_f32 v126, v126, v152
 v_mfma_f32_16x16x32_bf16 v[136:139], a[136:139], v[56:59], v[136:139]
 v_exp_f32 v154, v154
 v_add_f32 v124, v124, v146
 v_cvt_pk_bf16_f32 v202, v152, v153
 v_mfma_f32_16x16x32_bf16 v[136:139], a[140:143], v[72:75], v[136:139]
 v_exp_f32 v155, v155
 v_add_f32 v126, v126, v153
 v_mfma_f32_16x16x32_bf16 v[140:143], a[128:131], v[92:95], v[172:175]
 v_exp_f32 v156, v156
 v_add_f32 v124, v124, v147
 v_mfma_f32_16x16x32_bf16 v[140:143], a[132:135], v[108:111], v[140:143]
 v_exp_f32 v157, v157
 v_add_f32 v126, v126, v154
 v_cvt_pk_bf16_f32 v203, v154, v155
 v_mfma_f32_16x16x32_bf16 v[140:143], a[136:139], v[60:63], v[140:143]
 v_exp_f32 v158, v158
 v_exp_f32 v159, v159
 v_mfma_f32_16x16x32_bf16 v[140:143], a[140:143], v[76:79], v[140:143]
 s_waitcnt lgkmcnt(0)
 ds_read_b128 a[144:147], v246 offset:20480
 v_add_f32 v126, v126, v155
 v_cvt_pk_bf16_f32 v206, v156, v157
 v_cvt_pk_bf16_f32 v207, v158, v159
 v_mfma_f32_16x16x32_bf16 a[0:3], a[160:163], v[176:179], 0
 v_exp_f32 v128, v128
 v_mfma_f32_16x16x32_bf16 a[0:3], a[164:167], v[192:195], a[0:3]
 ds_read_b128 a[148:151], v247 offset:20480
 v_mfma_f32_16x16x32_bf16 a[4:7], a[160:163], v[180:183], 0
 v_exp_f32 v129, v129
 v_mfma_f32_16x16x32_bf16 a[4:7], a[164:167], v[196:199], a[4:7]
 ds_read_b128 a[152:155], v248 offset:20480
 v_add_f32 v124, v124, v128
 v_mfma_f32_16x16x32_bf16 a[8:11], a[160:163], v[184:187], 0
 v_exp_f32 v130, v130
 v_mfma_f32_16x16x32_bf16 a[8:11], a[164:167], v[200:203], a[8:11]
 ds_read_b128 a[156:159], v249 offset:20480
 v_add_f32 v124, v124, v129
 v_mfma_f32_16x16x32_bf16 a[12:15], a[160:163], v[188:191], 0
 v_exp_f32 v131, v131
 v_mfma_f32_16x16x32_bf16 a[12:15], a[164:167], v[204:207], a[12:15]
 buffer_load_dwordx4 v241, s[24:27], s76 offen offset:1024 nt lds
 v_mfma_f32_16x16x32_bf16 a[16:19], a[168:171], v[176:179], 0
 v_exp_f32 v132, v132
 v_mfma_f32_16x16x32_bf16 a[16:19], a[172:175], v[192:195], a[16:19]
 ds_read_b64_tr_b16 a[160:161], v18 offset:0
 v_cvt_pk_bf16_f32 v208, v128, v129
 v_mfma_f32_16x16x32_bf16 a[20:23], a[168:171], v[180:183], 0
 v_exp_f32 v133, v133
 v_mfma_f32_16x16x32_bf16 a[20:23], a[172:175], v[196:199], a[20:23]
 ds_read_b64_tr_b16 a[162:163], v18 offset:4096
 v_add_f32 v124, v124, v130
 v_mfma_f32_16x16x32_bf16 a[24:27], a[168:171], v[184:187], 0
 v_exp_f32 v134, v134
 v_mfma_f32_16x16x32_bf16 a[24:27], a[172:175], v[200:203], a[24:27]
 ds_read_b64_tr_b16 a[164:165], v18 offset:8192
 v_add_f32 v124, v124, v131
 v_mfma_f32_16x16x32_bf16 a[28:31], a[168:171], v[188:191], 0
 v_exp_f32 v135, v135
 v_mfma_f32_16x16x32_bf16 a[28:31], a[172:175], v[204:207], a[28:31]
 ds_read_b64_tr_b16 a[166:167], v18 offset:12288
 v_cvt_pk_bf16_f32 v209, v130, v131
 v_mfma_f32_16x16x32_bf16 a[196:199], a[192:195], v[180:183], 0
 v_cvt_pk_bf16_f32 v212, v132, v133
 v_cvt_pk_bf16_f32 v213, v134, v135
 v_mfma_f32_16x16x32_bf16 a[196:199], a[192:195], v[196:199], a[196:199]
 s_waitcnt lgkmcnt(4)
 v_mfma_f32_16x16x32_bf16 v[144:147], a[144:147], v[80:83], v[160:163]
 v_exp_f32 v136, v136
 v_mfma_f32_16x16x32_bf16 v[144:147], a[148:151], v[96:99], v[144:147]
 ds_read_b64_tr_b16 a[168:169], v19 offset:0
 v_mfma_f32_16x16x32_bf16 v[144:147], a[152:155], v[48:51], v[144:147]
 v_exp_f32 v137, v137
 v_mfma_f32_16x16x32_bf16 v[144:147], a[156:159], v[64:67], v[144:147]
 ds_read_b64_tr_b16 a[170:171], v19 offset:4096
 v_add_f32 v126, v126, v136
 v_mfma_f32_16x16x32_bf16 v[148:151], a[144:147], v[84:87], v[164:167]
 v_exp_f32 v138, v138
 v_mfma_f32_16x16x32_bf16 v[148:151], a[148:151], v[100:103], v[148:151]
 ds_read_b64_tr_b16 a[172:173], v19 offset:8192
 v_add_f32 v126, v126, v137
 v_mfma_f32_16x16x32_bf16 v[148:151], a[152:155], v[52:55], v[148:151]
 v_exp_f32 v139, v139
 v_mfma_f32_16x16x32_bf16 v[148:151], a[156:159], v[68:71], v[148:151]
 ds_read_b64_tr_b16 a[174:175], v19 offset:12288
 v_cvt_pk_bf16_f32 v216, v136, v137
 v_mfma_f32_16x16x32_bf16 v[152:155], a[144:147], v[88:91], v[168:171]
 v_exp_f32 v140, v140
 v_mfma_f32_16x16x32_bf16 v[152:155], a[148:151], v[104:107], v[152:155]
 buffer_load_dwordx4 v242, s[24:27], s76 offen offset:2048 nt lds
 v_mfma_f32_16x16x32_bf16 v[152:155], a[152:155], v[56:59], v[152:155]
 v_exp_f32 v141, v141
 v_mfma_f32_16x16x32_bf16 v[152:155], a[156:159], v[72:75], v[152:155]
 v_add_f32 v126, v126, v138
 v_add_f32 v126, v126, v139
 v_mfma_f32_16x16x32_bf16 v[156:159], a[144:147], v[92:95], v[172:175]
 v_exp_f32 v142, v142
 v_mfma_f32_16x16x32_bf16 v[156:159], a[148:151], v[108:111], v[156:159]
 v_cvt_pk_bf16_f32 v217, v138, v139
 v_cvt_pk_bf16_f32 v220, v140, v141
 v_mfma_f32_16x16x32_bf16 v[156:159], a[152:155], v[60:63], v[156:159]
 v_exp_f32 v143, v143
 v_mfma_f32_16x16x32_bf16 v[156:159], a[156:159], v[76:79], v[156:159]
 s_waitcnt lgkmcnt(0)
 ds_read_b128 a[128:131], v246 offset:24576
 v_mfma_f32_16x16x32_bf16 a[32:35], a[160:163], v[176:179], 0
 v_exp_f32 v144, v144
 v_mfma_f32_16x16x32_bf16 a[32:35], a[164:167], v[192:195], a[32:35]
 ds_read_b128 a[132:135], v247 offset:24576
 v_cvt_pk_bf16_f32 v221, v142, v143
 v_mfma_f32_16x16x32_bf16 a[36:39], a[160:163], v[180:183], 0
 v_exp_f32 v145, v145
 v_mfma_f32_16x16x32_bf16 a[36:39], a[164:167], v[196:199], a[36:39]
 ds_read_b128 a[136:139], v248 offset:24576
 v_add_f32 v124, v124, v144
 v_mfma_f32_16x16x32_bf16 a[40:43], a[160:163], v[184:187], 0
 v_exp_f32 v146, v146
 v_mfma_f32_16x16x32_bf16 a[40:43], a[164:167], v[200:203], a[40:43]
 ds_read_b128 a[140:143], v249 offset:24576
 v_add_f32 v124, v124, v145
 v_mfma_f32_16x16x32_bf16 a[44:47], a[160:163], v[188:191], 0
 v_exp_f32 v147, v147
 v_mfma_f32_16x16x32_bf16 a[44:47], a[164:167], v[204:207], a[44:47]
 buffer_load_dwordx4 v243, s[24:27], s76 offen offset:3072 nt lds
 v_mfma_f32_16x16x32_bf16 a[48:51], a[168:171], v[176:179], 0
 v_exp_f32 v148, v148
 v_mfma_f32_16x16x32_bf16 a[48:51], a[172:175], v[192:195], a[48:51]
 ds_read_b64_tr_b16 a[160:161], v20 offset:0
 v_cvt_pk_bf16_f32 v210, v144, v145
 v_mfma_f32_16x16x32_bf16 a[52:55], a[168:171], v[180:183], 0
 v_exp_f32 v149, v149
 v_mfma_f32_16x16x32_bf16 a[52:55], a[172:175], v[196:199], a[52:55]
 ds_read_b64_tr_b16 a[162:163], v20 offset:4096
 v_add_f32 v124, v124, v146
 v_mfma_f32_16x16x32_bf16 a[56:59], a[168:171], v[184:187], 0
 v_exp_f32 v150, v150
 v_mfma_f32_16x16x32_bf16 a[56:59], a[172:175], v[200:203], a[56:59]
 ds_read_b64_tr_b16 a[164:165], v20 offset:8192
 v_add_f32 v124, v124, v147
 v_mfma_f32_16x16x32_bf16 a[60:63], a[168:171], v[188:191], 0
 v_exp_f32 v151, v151
 v_mfma_f32_16x16x32_bf16 a[60:63], a[172:175], v[204:207], a[60:63]
 s_waitcnt lgkmcnt(3)
 ds_read_b64_tr_b16 a[166:167], v20 offset:12288
 v_cvt_pk_bf16_f32 v211, v146, v147
 v_mfma_f32_16x16x32_bf16 v[128:131], a[128:131], v[80:83], v[160:163]
 v_exp_f32 v152, v152
 v_xor_b32 v13, 0, v255
 v_mfma_f32_16x16x32_bf16 v[128:131], a[132:135], v[96:99], v[128:131]
 ds_read_b64_tr_b16 a[168:169], v21 offset:0
 v_cvt_pk_bf16_f32 v214, v148, v149
 v_mfma_f32_16x16x32_bf16 v[128:131], a[136:139], v[48:51], v[128:131]
 s_waitcnt vmcnt(8)
 ds_read_b64_tr_b16 v[24:25], v13 offset:0
 v_exp_f32 v153, v153
 v_mfma_f32_16x16x32_bf16 v[128:131], a[140:143], v[64:67], v[128:131]
 ds_read_b64_tr_b16 a[170:171], v21 offset:4096
 v_cvt_pk_bf16_f32 v215, v150, v151
 v_mfma_f32_16x16x32_bf16 v[132:135], a[128:131], v[84:87], v[164:167]
 ds_read_b64_tr_b16 v[26:27], v13 offset:2048
 v_exp_f32 v154, v154
 v_mfma_f32_16x16x32_bf16 v[132:135], a[132:135], v[100:103], v[132:135]
 ds_read_b64_tr_b16 a[172:173], v21 offset:8192
 v_add_f32 v126, v126, v152
 v_mfma_f32_16x16x32_bf16 v[132:135], a[136:139], v[52:55], v[132:135]
 v_exp_f32 v155, v155
 v_xor_b32 v14, 32, v255
 v_mfma_f32_16x16x32_bf16 v[132:135], a[140:143], v[68:71], v[132:135]
 ds_read_b64_tr_b16 a[174:175], v21 offset:12288
 v_add_f32 v126, v126, v153
 v_mfma_f32_16x16x32_bf16 v[136:139], a[128:131], v[88:91], v[168:171]
 s_add_u32 m0, s72, 114688
 ds_read_b64_tr_b16 v[28:29], v14 offset:0
 v_exp_f32 v156, v156
 v_mfma_f32_16x16x32_bf16 v[136:139], a[132:135], v[104:107], v[136:139]
 buffer_load_dwordx4 v244, s[28:31], s76 offen offset:0 nt lds
 v_mfma_f32_16x16x32_bf16 v[136:139], a[136:139], v[56:59], v[136:139]
 ds_read_b64_tr_b16 v[30:31], v14 offset:2048
 v_exp_f32 v157, v157
 v_mfma_f32_16x16x32_bf16 v[136:139], a[140:143], v[72:75], v[136:139]
 v_cvt_pk_bf16_f32 v218, v152, v153
 v_add_f32 v126, v126, v154
 v_mfma_f32_16x16x32_bf16 v[140:143], a[128:131], v[92:95], v[172:175]
 v_exp_f32 v158, v158
 v_xor_b32 v13, 64, v255
 v_mfma_f32_16x16x32_bf16 v[140:143], a[132:135], v[108:111], v[140:143]
 v_add_f32 v126, v126, v155
 v_cvt_pk_bf16_f32 v219, v154, v155
 v_mfma_f32_16x16x32_bf16 v[140:143], a[136:139], v[60:63], v[140:143]
 ds_read_b64_tr_b16 v[32:33], v13 offset:0
 v_exp_f32 v159, v159
 v_mfma_f32_16x16x32_bf16 v[140:143], a[140:143], v[76:79], v[140:143]
 s_waitcnt lgkmcnt(0)
 ds_read_b128 a[144:147], v246 offset:28672
 v_cvt_pk_bf16_f32 v222, v156, v157
 v_mfma_f32_16x16x32_bf16 a[64:67], a[160:163], v[176:179], 0
 ds_read_b64_tr_b16 v[34:35], v13 offset:2048
 v_exp_f32 v128, v128
 v_mfma_f32_16x16x32_bf16 a[64:67], a[164:167], v[192:195], a[64:67]
 ds_read_b128 a[148:151], v247 offset:28672
 v_cvt_pk_bf16_f32 v223, v158, v159
 v_mfma_f32_16x16x32_bf16 a[68:71], a[160:163], v[180:183], 0
 buffer_store_dwordx4 v[24:27], v2, s[48:51], s97 offen offset:0 sc1
 v_exp_f32 v129, v129
 v_xor_b32 v14, 96, v255
 v_mfma_f32_16x16x32_bf16 a[68:71], a[164:167], v[196:199], a[68:71]
 ds_read_b128 a[152:155], v248 offset:28672
 v_add_f32 v124, v124, v128
 v_mfma_f32_16x16x32_bf16 a[72:75], a[160:163], v[184:187], 0
 ds_read_b64_tr_b16 v[36:37], v14 offset:0
 v_exp_f32 v130, v130
 v_mfma_f32_16x16x32_bf16 a[72:75], a[164:167], v[200:203], a[72:75]
 ds_read_b128 a[156:159], v249 offset:28672
 v_add_f32 v124, v124, v129
 v_mfma_f32_16x16x32_bf16 a[76:79], a[160:163], v[188:191], 0
 ds_read_b64_tr_b16 v[38:39], v14 offset:2048
 v_exp_f32 v131, v131
 v_mfma_f32_16x16x32_bf16 a[76:79], a[164:167], v[204:207], a[76:79]
 buffer_load_dwordx4 v245, s[28:31], s76 offen offset:1024 nt lds
 v_mfma_f32_16x16x32_bf16 a[80:83], a[168:171], v[176:179], 0
 v_exp_f32 v132, v132
 v_mfma_f32_16x16x32_bf16 a[80:83], a[172:175], v[192:195], a[80:83]
 ds_read_b64_tr_b16 a[160:161], v22 offset:0
 v_cvt_pk_bf16_f32 v224, v128, v129
 v_mfma_f32_16x16x32_bf16 a[84:87], a[168:171], v[180:183], 0
 v_exp_f32 v133, v133
 v_mfma_f32_16x16x32_bf16 a[84:87], a[172:175], v[196:199], a[84:87]
 ds_read_b64_tr_b16 a[162:163], v22 offset:4096
 v_add_f32 v124, v124, v130
 v_mfma_f32_16x16x32_bf16 a[88:91], a[168:171], v[184:187], 0
 v_exp_f32 v134, v134
 v_mfma_f32_16x16x32_bf16 a[88:91], a[172:175], v[200:203], a[88:91]
 ds_read_b64_tr_b16 a[164:165], v22 offset:8192
 v_add_f32 v124, v124, v131
 v_mfma_f32_16x16x32_bf16 a[92:95], a[168:171], v[188:191], 0
 v_exp_f32 v135, v135
 v_mfma_f32_16x16x32_bf16 a[92:95], a[172:175], v[204:207], a[92:95]
 ds_read_b64_tr_b16 a[166:167], v22 offset:12288
 v_cvt_pk_bf16_f32 v225, v130, v131
 v_mfma_f32_16x16x32_bf16 a[200:203], a[192:195], v[188:191], 0
 v_cvt_pk_bf16_f32 v228, v132, v133
 v_cvt_pk_bf16_f32 v229, v134, v135
 v_mfma_f32_16x16x32_bf16 a[200:203], a[192:195], v[204:207], a[200:203]
 s_waitcnt lgkmcnt(5)
 v_mfma_f32_16x16x32_bf16 v[144:147], a[144:147], v[80:83], v[160:163]
 buffer_store_dwordx4 v[28:31], v2, s[48:51], s97 offen offset:1024 sc1
 v_exp_f32 v136, v136
 v_mfma_f32_16x16x32_bf16 v[144:147], a[148:151], v[96:99], v[144:147]
 ds_read_b64_tr_b16 a[168:169], v23 offset:0
 v_mfma_f32_16x16x32_bf16 v[144:147], a[152:155], v[48:51], v[144:147]
 v_exp_f32 v137, v137
 v_mfma_f32_16x16x32_bf16 v[144:147], a[156:159], v[64:67], v[144:147]
 ds_read_b64_tr_b16 a[170:171], v23 offset:4096
 v_add_f32 v126, v126, v136
 v_mfma_f32_16x16x32_bf16 v[148:151], a[144:147], v[84:87], v[164:167]
 v_exp_f32 v138, v138
 v_mfma_f32_16x16x32_bf16 v[148:151], a[148:151], v[100:103], v[148:151]
 ds_read_b64_tr_b16 a[172:173], v23 offset:8192
 v_add_f32 v126, v126, v137
 v_mfma_f32_16x16x32_bf16 v[148:151], a[152:155], v[52:55], v[148:151]
 v_exp_f32 v139, v139
 v_mfma_f32_16x16x32_bf16 v[148:151], a[156:159], v[68:71], v[148:151]
 ds_read_b64_tr_b16 a[174:175], v23 offset:12288
 v_cvt_pk_bf16_f32 v232, v136, v137
 v_mfma_f32_16x16x32_bf16 v[152:155], a[144:147], v[88:91], v[168:171]
 v_exp_f32 v140, v140
 v_mfma_f32_16x16x32_bf16 v[152:155], a[148:151], v[104:107], v[152:155]
 buffer_load_dwordx4 v244, s[28:31], s76 offen offset:2048 nt lds
 v_mfma_f32_16x16x32_bf16 v[152:155], a[152:155], v[56:59], v[152:155]
 v_exp_f32 v141, v141
 v_mfma_f32_16x16x32_bf16 v[152:155], a[156:159], v[72:75], v[152:155]
 v_add_f32 v126, v126, v138
 v_add_f32 v126, v126, v139
 v_mfma_f32_16x16x32_bf16 v[156:159], a[144:147], v[92:95], v[172:175]
 v_exp_f32 v142, v142
 v_mfma_f32_16x16x32_bf16 v[156:159], a[148:151], v[108:111], v[156:159]
 v_cvt_pk_bf16_f32 v233, v138, v139
 v_cvt_pk_bf16_f32 v236, v140, v141
 v_mfma_f32_16x16x32_bf16 v[156:159], a[152:155], v[60:63], v[156:159]
 v_exp_f32 v143, v143
 v_mfma_f32_16x16x32_bf16 v[156:159], a[156:159], v[76:79], v[156:159]
 s_waitcnt lgkmcnt(0)
 s_barrier
 ds_read_b128 a[128:131], v246 offset:32768
 v_mfma_f32_16x16x32_bf16 a[96:99], a[160:163], v[176:179], 0
 buffer_store_dwordx4 v[32:35], v2, s[48:51], s97 offen offset:2048 sc1
 v_exp_f32 v144, v144
 v_mfma_f32_16x16x32_bf16 a[96:99], a[164:167], v[192:195], a[96:99]
 ds_read_b128 a[132:135], v247 offset:32768
 v_cvt_pk_bf16_f32 v237, v142, v143
 v_mfma_f32_16x16x32_bf16 a[100:103], a[160:163], v[180:183], 0
 v_exp_f32 v145, v145
 v_mfma_f32_16x16x32_bf16 a[100:103], a[164:167], v[196:199], a[100:103]
 ds_read_b128 a[136:139], v248 offset:32768
 v_add_f32 v124, v124, v144
 v_mfma_f32_16x16x32_bf16 a[104:107], a[160:163], v[184:187], 0
 v_exp_f32 v146, v146
 v_mfma_f32_16x16x32_bf16 a[104:107], a[164:167], v[200:203], a[104:107]
 ds_read_b128 a[140:143], v249 offset:32768
 v_add_f32 v124, v124, v145
 v_mfma_f32_16x16x32_bf16 a[108:111], a[160:163], v[188:191], 0
 v_exp_f32 v147, v147
 v_mfma_f32_16x16x32_bf16 a[108:111], a[164:167], v[204:207], a[108:111]
 buffer_load_dwordx4 v245, s[28:31], s76 offen offset:3072 nt lds
 v_mfma_f32_16x16x32_bf16 a[112:115], a[168:171], v[176:179], 0
 s_add_u32 s76, s76, 16384
 s_add_u32 m0, s79, 0
 s_add_u32 s58, s98, 0
 buffer_load_dwordx4 v254, s[92:95], s58 offen nt lds
 v_exp_f32 v148, v148
 v_mfma_f32_16x16x32_bf16 a[112:115], a[172:175], v[192:195], a[112:115]
 ds_read_b64_tr_b16 a[160:161], v16 offset:16384
 v_cvt_pk_bf16_f32 v226, v144, v145
 v_mfma_f32_16x16x32_bf16 a[116:119], a[168:171], v[180:183], 0
 s_add_u32 m0, s79, 1024
 s_add_u32 s58, s98, 9216
 buffer_load_dwordx4 v254, s[92:95], s58 offen nt lds
 v_exp_f32 v149, v149
 v_mfma_f32_16x16x32_bf16 a[116:119], a[172:175], v[196:199], a[116:119]
 ds_read_b64_tr_b16 a[162:163], v16 offset:20480
 v_add_f32 v124, v124, v146
 v_mfma_f32_16x16x32_bf16 a[120:123], a[168:171], v[184:187], 0
 s_add_u32 m0, s79, 2048
 s_add_u32 s58, s98, 18432
 buffer_load_dwordx4 v254, s[92:95], s58 offen nt lds
 v_exp_f32 v150, v150
 v_mfma_f32_16x16x32_bf16 a[120:123], a[172:175], v[200:203], a[120:123]
 ds_read_b64_tr_b16 a[164:165], v16 offset:24576
 v_add_f32 v124, v124, v147
 v_mfma_f32_16x16x32_bf16 a[124:127], a[168:171], v[188:191], 0
 s_add_u32 m0, s79, 3072
 s_add_u32 s58, s98, 27648
 buffer_load_dwordx4 v254, s[92:95], s58 offen nt lds
 v_exp_f32 v151, v151
 v_mfma_f32_16x16x32_bf16 a[124:127], a[172:175], v[204:207], a[124:127]
 s_waitcnt lgkmcnt(3)
 ds_read_b64_tr_b16 a[166:167], v16 offset:28672
 v_cvt_pk_bf16_f32 v227, v146, v147
 v_mfma_f32_16x16x32_bf16 v[128:131], a[128:131], v[80:83], v[160:163]
 buffer_store_dwordx4 v[36:39], v2, s[48:51], s97 offen offset:3072 sc1
 v_exp_f32 v152, v152
 v_mfma_f32_16x16x32_bf16 v[128:131], a[132:135], v[96:99], v[128:131]
 ds_read_b64_tr_b16 a[168:169], v17 offset:16384
 v_cvt_pk_bf16_f32 v230, v148, v149
 v_mfma_f32_16x16x32_bf16 v[128:131], a[136:139], v[48:51], v[128:131]
 v_exp_f32 v153, v153
 v_xor_b32 v13, 0, v255
 v_mfma_f32_16x16x32_bf16 v[128:131], a[140:143], v[64:67], v[128:131]
 ds_read_b64_tr_b16 a[170:171], v17 offset:20480
 v_cvt_pk_bf16_f32 v231, v150, v151
 v_mfma_f32_16x16x32_bf16 v[132:135], a[128:131], v[84:87], v[164:167]
 s_waitcnt vmcnt(16)
 ds_read_b64_tr_b16 v[40:41], v13 offset:4096
 v_exp_f32 v154, v154
 v_mfma_f32_16x16x32_bf16 v[132:135], a[132:135], v[100:103], v[132:135]
 ds_read_b64_tr_b16 a[172:173], v17 offset:24576
 v_add_f32 v126, v126, v152
 v_mfma_f32_16x16x32_bf16 v[132:135], a[136:139], v[52:55], v[132:135]
 ds_read_b64_tr_b16 v[42:43], v13 offset:6144
 v_exp_f32 v155, v155
 v_mfma_f32_16x16x32_bf16 v[132:135], a[140:143], v[68:71], v[132:135]
 ds_read_b64_tr_b16 a[174:175], v17 offset:28672
 v_add_f32 v126, v126, v153
 v_mfma_f32_16x16x32_bf16 v[136:139], a[128:131], v[88:91], v[168:171]
 s_add_u32 m0, s72, 16384
 v_exp_f32 v156, v156
 v_mfma_f32_16x16x32_bf16 v[136:139], a[132:135], v[104:107], v[136:139]
 buffer_load_dwordx4 v240, s[24:27], s76 offen offset:0 nt lds
 v_mfma_f32_16x16x32_bf16 v[136:139], a[136:139], v[56:59], v[136:139]
 v_exp_f32 v157, v157
 v_mfma_f32_16x16x32_bf16 v[136:139], a[140:143], v[72:75], v[136:139]
 v_cvt_pk_bf16_f32 v234, v152, v153
 v_add_f32 v126, v126, v154
 v_mfma_f32_16x16x32_bf16 v[140:143], a[128:131], v[92:95], v[172:175]
 v_exp_f32 v158, v158
 v_mfma_f32_16x16x32_bf16 v[140:143], a[132:135], v[108:111], v[140:143]
 v_add_f32 v126, v126, v155
 v_cvt_pk_bf16_f32 v235, v154, v155
 v_mfma_f32_16x16x32_bf16 v[140:143], a[136:139], v[60:63], v[140:143]
 v_exp_f32 v159, v159
 v_xor_b32 v14, 32, v255
 v_mfma_f32_16x16x32_bf16 v[140:143], a[140:143], v[76:79], v[140:143]
 s_waitcnt lgkmcnt(0)
 ds_read_b128 a[144:147], v246 offset:36864
 v_cvt_pk_bf16_f32 v238, v156, v157
 v_mfma_f32_16x16x32_bf16 a[0:3], a[160:163], v[208:211], a[0:3]
 s_add_u32 s97, s97, 5308416
 buffer_store_dwordx4 v[40:43], v2, s[48:51], s97 offen offset:0 sc1
 ds_read_b64_tr_b16 v[44:45], v14 offset:4096
 v_exp_f32 v128, v128
 v_mfma_f32_16x16x32_bf16 a[0:3], a[164:167], v[224:227], a[0:3]
 ds_read_b128 a[148:151], v247 offset:36864
 v_cvt_pk_bf16_f32 v239, v158, v159
 v_mfma_f32_16x16x32_bf16 a[4:7], a[160:163], v[212:215], a[4:7]
 ds_read_b64_tr_b16 v[46:47], v14 offset:6144
 v_exp_f32 v129, v129
 v_mfma_f32_16x16x32_bf16 a[4:7], a[164:167], v[228:231], a[4:7]
 ds_read_b128 a[152:155], v248 offset:36864
 v_add_f32 v124, v124, v128
 v_mfma_f32_16x16x32_bf16 a[8:11], a[160:163], v[216:219], a[8:11]
 v_exp_f32 v130, v130
 v_mfma_f32_16x16x32_bf16 a[8:11], a[164:167], v[232:235], a[8:11]
 ds_read_b128 a[156:159], v249 offset:36864
 v_add_f32 v124, v124, v129
 v_mfma_f32_16x16x32_bf16 a[12:15], a[160:163], v[220:223], a[12:15]
 v_exp_f32 v131, v131
 v_mfma_f32_16x16x32_bf16 a[12:15], a[164:167], v[236:239], a[12:15]
 buffer_load_dwordx4 v241, s[24:27], s76 offen offset:1024 nt lds
 v_mfma_f32_16x16x32_bf16 a[16:19], a[168:171], v[208:211], a[16:19]
 v_exp_f32 v132, v132
 v_mfma_f32_16x16x32_bf16 a[16:19], a[172:175], v[224:227], a[16:19]
 ds_read_b64_tr_b16 a[160:161], v18 offset:16384
 v_cvt_pk_bf16_f32 v176, v128, v129
 v_mfma_f32_16x16x32_bf16 a[20:23], a[168:171], v[212:215], a[20:23]
 v_exp_f32 v133, v133
 v_xor_b32 v13, 64, v255
 v_mfma_f32_16x16x32_bf16 a[20:23], a[172:175], v[228:231], a[20:23]
 ds_read_b64_tr_b16 a[162:163], v18 offset:20480
 v_add_f32 v124, v124, v130
 v_mfma_f32_16x16x32_bf16 a[24:27], a[168:171], v[216:219], a[24:27]
 ds_read_b64_tr_b16 v[24:25], v13 offset:4096
 v_exp_f32 v134, v134
 v_mfma_f32_16x16x32_bf16 a[24:27], a[172:175], v[232:235], a[24:27]
 ds_read_b64_tr_b16 a[164:165], v18 offset:24576
 v_add_f32 v124, v124, v131
 v_mfma_f32_16x16x32_bf16 a[28:31], a[168:171], v[220:223], a[28:31]
 ds_read_b64_tr_b16 v[26:27], v13 offset:6144
 v_exp_f32 v135, v135
 v_mfma_f32_16x16x32_bf16 a[28:31], a[172:175], v[236:239], a[28:31]
 ds_read_b64_tr_b16 a[166:167], v18 offset:28672
 v_cvt_pk_bf16_f32 v177, v130, v131
 v_mfma_f32_16x16x32_bf16 a[196:199], a[192:195], v[212:215], a[196:199]
 s_waitcnt lgkmcnt(8)
 buffer_store_dwordx4 v[44:47], v2, s[48:51], s97 offen offset:1024 sc1
 v_cvt_pk_bf16_f32 v180, v132, v133
 v_cvt_pk_bf16_f32 v181, v134, v135
 v_mfma_f32_16x16x32_bf16 a[196:199], a[192:195], v[228:231], a[196:199]
 s_waitcnt lgkmcnt(6)
 v_mfma_f32_16x16x32_bf16 v[144:147], a[144:147], v[80:83], v[160:163]
 v_exp_f32 v136, v136
 v_mfma_f32_16x16x32_bf16 v[144:147], a[148:151], v[96:99], v[144:147]
 ds_read_b64_tr_b16 a[168:169], v19 offset:16384
 v_mfma_f32_16x16x32_bf16 v[144:147], a[152:155], v[48:51], v[144:147]
 v_exp_f32 v137, v137
 v_mfma_f32_16x16x32_bf16 v[144:147], a[156:159], v[64:67], v[144:147]
 ds_read_b64_tr_b16 a[170:171], v19 offset:20480
 v_add_f32 v126, v126, v136
 v_mfma_f32_16x16x32_bf16 v[148:151], a[144:147], v[84:87], v[164:167]
 v_exp_f32 v138, v138
 v_xor_b32 v14, 96, v255
 v_mfma_f32_16x16x32_bf16 v[148:151], a[148:151], v[100:103], v[148:151]
 ds_read_b64_tr_b16 a[172:173], v19 offset:24576
 v_add_f32 v126, v126, v137
 v_mfma_f32_16x16x32_bf16 v[148:151], a[152:155], v[52:55], v[148:151]
 ds_read_b64_tr_b16 v[28:29], v14 offset:4096
 v_exp_f32 v139, v139
 v_mfma_f32_16x16x32_bf16 v[148:151], a[156:159], v[68:71], v[148:151]
 ds_read_b64_tr_b16 a[174:175], v19 offset:28672
 v_cvt_pk_bf16_f32 v184, v136, v137
 v_mfma_f32_16x16x32_bf16 v[152:155], a[144:147], v[88:91], v[168:171]
 ds_read_b64_tr_b16 v[30:31], v14 offset:6144
 v_exp_f32 v140, v140
 v_mfma_f32_16x16x32_bf16 v[152:155], a[148:151], v[104:107], v[152:155]
 buffer_load_dwordx4 v242, s[24:27], s76 offen offset:2048 nt lds
 v_mfma_f32_16x16x32_bf16 v[152:155], a[152:155], v[56:59], v[152:155]
 v_exp_f32 v141, v141
 v_mfma_f32_16x16x32_bf16 v[152:155], a[156:159], v[72:75], v[152:155]
 v_add_f32 v126, v126, v138
 v_add_f32 v126, v126, v139
 v_mfma_f32_16x16x32_bf16 v[156:159], a[144:147], v[92:95], v[172:175]
 v_exp_f32 v142, v142
 v_mfma_f32_16x16x32_bf16 v[156:159], a[148:151], v[108:111], v[156:159]
 v_cvt_pk_bf16_f32 v185, v138, v139
 v_cvt_pk_bf16_f32 v188, v140, v141
 v_mfma_f32_16x16x32_bf16 v[156:159], a[152:155], v[60:63], v[156:159]
 s_waitcnt lgkmcnt(7)
 buffer_store_dwordx4 v[24:27], v2, s[48:51], s97 offen offset:2048 sc1
 v_exp_f32 v143, v143
 v_mfma_f32_16x16x32_bf16 v[156:159], a[156:159], v[76:79], v[156:159]
 s_waitcnt lgkmcnt(0)
 ds_read_b128 a[128:131], v246 offset:40960
 v_mfma_f32_16x16x32_bf16 a[32:35], a[160:163], v[208:211], a[32:35]
 v_exp_f32 v144, v144
 v_mfma_f32_16x16x32_bf16 a[32:35], a[164:167], v[224:227], a[32:35]
 ds_read_b128 a[132:135], v247 offset:40960
 v_cvt_pk_bf16_f32 v189, v142, v143
 v_mfma_f32_16x16x32_bf16 a[36:39], a[160:163], v[212:215], a[36:39]
 v_exp_f32 v145, v145
 v_mfma_f32_16x16x32_bf16 a[36:39], a[164:167], v[228:231], a[36:39]
 ds_read_b128 a[136:139], v248 offset:40960
 v_add_f32 v124, v124, v144
 v_mfma_f32_16x16x32_bf16 a[40:43], a[160:163], v[216:219], a[40:43]
 v_exp_f32 v146, v146
 v_mfma_f32_16x16x32_bf16 a[40:43], a[164:167], v[232:235], a[40:43]
 ds_read_b128 a[140:143], v249 offset:40960
 v_add_f32 v124, v124, v145
 v_mfma_f32_16x16x32_bf16 a[44:47], a[160:163], v[220:223], a[44:47]
 v_exp_f32 v147, v147
 v_mfma_f32_16x16x32_bf16 a[44:47], a[164:167], v[236:239], a[44:47]
 buffer_load_dwordx4 v243, s[24:27], s76 offen offset:3072 nt lds
 v_mfma_f32_16x16x32_bf16 a[48:51], a[168:171], v[208:211], a[48:51]
 v_exp_f32 v148, v148
 v_mfma_f32_16x16x32_bf16 a[48:51], a[172:175], v[224:227], a[48:51]
 ds_read_b64_tr_b16 a[160:161], v20 offset:16384
 v_cvt_pk_bf16_f32 v178, v144, v145
 v_mfma_f32_16x16x32_bf16 a[52:55], a[168:171], v[212:215], a[52:55]
 v_exp_f32 v149, v149
 v_mfma_f32_16x16x32_bf16 a[52:55], a[172:175], v[228:231], a[52:55]
 ds_read_b64_tr_b16 a[162:163], v20 offset:20480
 v_add_f32 v124, v124, v146
 v_mfma_f32_16x16x32_bf16 a[56:59], a[168:171], v[216:219], a[56:59]
 v_exp_f32 v150, v150
 v_mfma_f32_16x16x32_bf16 a[56:59], a[172:175], v[232:235], a[56:59]
 ds_read_b64_tr_b16 a[164:165], v20 offset:24576
 v_add_f32 v124, v124, v147
 v_mfma_f32_16x16x32_bf16 a[60:63], a[168:171], v[220:223], a[60:63]
 buffer_store_dwordx4 v[28:31], v2, s[48:51], s97 offen offset:3072 sc1
 v_exp_f32 v151, v151
 v_mfma_f32_16x16x32_bf16 a[60:63], a[172:175], v[236:239], a[60:63]
 s_waitcnt lgkmcnt(3)
 ds_read_b64_tr_b16 a[166:167], v20 offset:28672
 v_cvt_pk_bf16_f32 v179, v146, v147
 v_mfma_f32_16x16x32_bf16 v[128:131], a[128:131], v[80:83], v[160:163]
 v_exp_f32 v152, v152
 v_mfma_f32_16x16x32_bf16 v[128:131], a[132:135], v[96:99], v[128:131]
 ds_read_b64_tr_b16 a[168:169], v21 offset:16384
 v_cvt_pk_bf16_f32 v182, v148, v149
 v_mfma_f32_16x16x32_bf16 v[128:131], a[136:139], v[48:51], v[128:131]
 v_exp_f32 v153, v153
 v_mfma_f32_16x16x32_bf16 v[128:131], a[140:143], v[64:67], v[128:131]
 ds_read_b64_tr_b16 a[170:171], v21 offset:20480
 v_cvt_pk_bf16_f32 v183, v150, v151
 v_mfma_f32_16x16x32_bf16 v[132:135], a[128:131], v[84:87], v[164:167]
 v_exp_f32 v154, v154
 v_mfma_f32_16x16x32_bf16 v[132:135], a[132:135], v[100:103], v[132:135]
 ds_read_b64_tr_b16 a[172:173], v21 offset:24576
 v_add_f32 v126, v126, v152
 v_mfma_f32_16x16x32_bf16 v[132:135], a[136:139], v[52:55], v[132:135]
 v_exp_f32 v155, v155
 v_mfma_f32_16x16x32_bf16 v[132:135], a[140:143], v[68:71], v[132:135]
 ds_read_b64_tr_b16 a[174:175], v21 offset:28672
 v_add_f32 v126, v126, v153
 v_mfma_f32_16x16x32_bf16 v[136:139], a[128:131], v[88:91], v[168:171]
 s_add_u32 m0, s72, 65536
 v_exp_f32 v156, v156
 v_xor_b32 v13, 0, v255
 v_mfma_f32_16x16x32_bf16 v[136:139], a[132:135], v[104:107], v[136:139]
 buffer_load_dwordx4 v244, s[28:31], s76 offen offset:0 nt lds
 v_mfma_f32_16x16x32_bf16 v[136:139], a[136:139], v[56:59], v[136:139]
 s_waitcnt vmcnt(10)
 ds_read_b64_tr_b16 v[32:33], v13 offset:0
 v_exp_f32 v157, v157
 v_mfma_f32_16x16x32_bf16 v[136:139], a[140:143], v[72:75], v[136:139]
 v_cvt_pk_bf16_f32 v186, v152, v153
 v_add_f32 v126, v126, v154
 v_mfma_f32_16x16x32_bf16 v[140:143], a[128:131], v[92:95], v[172:175]
 ds_read_b64_tr_b16 v[34:35], v13 offset:2048
 v_exp_f32 v158, v158
 v_mfma_f32_16x16x32_bf16 v[140:143], a[132:135], v[108:111], v[140:143]
 v_add_f32 v126, v126, v155
 v_cvt_pk_bf16_f32 v187, v154, v155
 v_mfma_f32_16x16x32_bf16 v[140:143], a[136:139], v[60:63], v[140:143]
 v_exp_f32 v159, v159
 v_xor_b32 v14, 32, v255
 v_mfma_f32_16x16x32_bf16 v[140:143], a[140:143], v[76:79], v[140:143]
 s_waitcnt lgkmcnt(0)
 ds_read_b128 a[144:147], v246 offset:45056
 v_cvt_pk_bf16_f32 v190, v156, v157
 v_mfma_f32_16x16x32_bf16 a[64:67], a[160:163], v[208:211], a[64:67]
 ds_read_b64_tr_b16 v[36:37], v14 offset:0
 v_exp_f32 v128, v128
 v_mfma_f32_16x16x32_bf16 a[64:67], a[164:167], v[224:227], a[64:67]
 ds_read_b128 a[148:151], v247 offset:45056
 v_cvt_pk_bf16_f32 v191, v158, v159
 v_mfma_f32_16x16x32_bf16 a[68:71], a[160:163], v[212:215], a[68:71]
 ds_read_b64_tr_b16 v[38:39], v14 offset:2048
 v_exp_f32 v129, v129
 v_mfma_f32_16x16x32_bf16 a[68:71], a[164:167], v[228:231], a[68:71]
 ds_read_b128 a[152:155], v248 offset:45056
 v_add_f32 v124, v124, v128
 v_mfma_f32_16x16x32_bf16 a[72:75], a[160:163], v[216:219], a[72:75]
 buffer_store_dwordx4 v[32:35], v2, s[48:51], s99 offen offset:0 sc1
 v_exp_f32 v130, v130
 v_xor_b32 v13, 64, v255
 v_mfma_f32_16x16x32_bf16 a[72:75], a[164:167], v[232:235], a[72:75]
 ds_read_b128 a[156:159], v249 offset:45056
 v_add_f32 v124, v124, v129
 v_mfma_f32_16x16x32_bf16 a[76:79], a[160:163], v[220:223], a[76:79]
 ds_read_b64_tr_b16 v[40:41], v13 offset:0
 v_exp_f32 v131, v131
 v_mfma_f32_16x16x32_bf16 a[76:79], a[164:167], v[236:239], a[76:79]
 buffer_load_dwordx4 v245, s[28:31], s76 offen offset:1024 nt lds
 v_mfma_f32_16x16x32_bf16 a[80:83], a[168:171], v[208:211], a[80:83]
 ds_read_b64_tr_b16 v[42:43], v13 offset:2048
 v_exp_f32 v132, v132
 v_mfma_f32_16x16x32_bf16 a[80:83], a[172:175], v[224:227], a[80:83]
 ds_read_b64_tr_b16 a[160:161], v22 offset:16384
 v_cvt_pk_bf16_f32 v192, v128, v129
 v_mfma_f32_16x16x32_bf16 a[84:87], a[168:171], v[212:215], a[84:87]
 v_exp_f32 v133, v133
 v_xor_b32 v14, 96, v255
 v_mfma_f32_16x16x32_bf16 a[84:87], a[172:175], v[228:231], a[84:87]
 ds_read_b64_tr_b16 a[162:163], v22 offset:20480
 v_add_f32 v124, v124, v130
 v_mfma_f32_16x16x32_bf16 a[88:91], a[168:171], v[216:219], a[88:91]
 ds_read_b64_tr_b16 v[44:45], v14 offset:0
 v_exp_f32 v134, v134
 v_mfma_f32_16x16x32_bf16 a[88:91], a[172:175], v[232:235], a[88:91]
 ds_read_b64_tr_b16 a[164:165], v22 offset:24576
 v_add_f32 v124, v124, v131
 v_mfma_f32_16x16x32_bf16 a[92:95], a[168:171], v[220:223], a[92:95]
 ds_read_b64_tr_b16 v[46:47], v14 offset:2048
 v_exp_f32 v135, v135
 v_mfma_f32_16x16x32_bf16 a[92:95], a[172:175], v[236:239], a[92:95]
 ds_read_b64_tr_b16 a[166:167], v22 offset:28672
 v_cvt_pk_bf16_f32 v193, v130, v131
 v_mfma_f32_16x16x32_bf16 a[200:203], a[192:195], v[220:223], a[200:203]
 v_cvt_pk_bf16_f32 v196, v132, v133
 v_cvt_pk_bf16_f32 v197, v134, v135
 v_mfma_f32_16x16x32_bf16 a[200:203], a[192:195], v[236:239], a[200:203]
 s_waitcnt lgkmcnt(8)
 v_mfma_f32_16x16x32_bf16 v[144:147], a[144:147], v[80:83], v[160:163]
 buffer_store_dwordx4 v[36:39], v2, s[48:51], s99 offen offset:1024 sc1
 v_exp_f32 v136, v136
 v_mfma_f32_16x16x32_bf16 v[144:147], a[148:151], v[96:99], v[144:147]
 ds_read_b64_tr_b16 a[168:169], v23 offset:16384
 v_mfma_f32_16x16x32_bf16 v[144:147], a[152:155], v[48:51], v[144:147]
 v_exp_f32 v137, v137
 v_mfma_f32_16x16x32_bf16 v[144:147], a[156:159], v[64:67], v[144:147]
 ds_read_b64_tr_b16 a[170:171], v23 offset:20480
 v_add_f32 v126, v126, v136
 v_mfma_f32_16x16x32_bf16 v[148:151], a[144:147], v[84:87], v[164:167]
 v_exp_f32 v138, v138
 v_mfma_f32_16x16x32_bf16 v[148:151], a[148:151], v[100:103], v[148:151]
 ds_read_b64_tr_b16 a[172:173], v23 offset:24576
 v_add_f32 v126, v126, v137
 v_mfma_f32_16x16x32_bf16 v[148:151], a[152:155], v[52:55], v[148:151]
 v_exp_f32 v139, v139
 v_mfma_f32_16x16x32_bf16 v[148:151], a[156:159], v[68:71], v[148:151]
 ds_read_b64_tr_b16 a[174:175], v23 offset:28672
 v_cvt_pk_bf16_f32 v200, v136, v137
 v_mfma_f32_16x16x32_bf16 v[152:155], a[144:147], v[88:91], v[168:171]
 v_exp_f32 v140, v140
 v_mfma_f32_16x16x32_bf16 v[152:155], a[148:151], v[104:107], v[152:155]
 buffer_load_dwordx4 v244, s[28:31], s76 offen offset:2048 nt lds
 v_mfma_f32_16x16x32_bf16 v[152:155], a[152:155], v[56:59], v[152:155]
 v_exp_f32 v141, v141
 v_mfma_f32_16x16x32_bf16 v[152:155], a[156:159], v[72:75], v[152:155]
 v_add_f32 v126, v126, v138
 v_add_f32 v126, v126, v139
 v_mfma_f32_16x16x32_bf16 v[156:159], a[144:147], v[92:95], v[172:175]
 v_exp_f32 v142, v142
 v_mfma_f32_16x16x32_bf16 v[156:159], a[148:151], v[108:111], v[156:159]
 v_cvt_pk_bf16_f32 v201, v138, v139
 v_cvt_pk_bf16_f32 v204, v140, v141
 v_mfma_f32_16x16x32_bf16 v[156:159], a[152:155], v[60:63], v[156:159]
 s_waitcnt lgkmcnt(10)
 buffer_store_dwordx4 v[40:43], v2, s[48:51], s99 offen offset:2048 sc1
 v_exp_f32 v143, v143
 v_mfma_f32_16x16x32_bf16 v[156:159], a[156:159], v[76:79], v[156:159]
 s_waitcnt lgkmcnt(0)
 s_barrier
 ds_read_b128 a[128:131], v246 offset:49152
 v_mfma_f32_16x16x32_bf16 a[96:99], a[160:163], v[208:211], a[96:99]
 v_exp_f32 v144, v144
 v_mfma_f32_16x16x32_bf16 a[96:99], a[164:167], v[224:227], a[96:99]
 ds_read_b128 a[132:135], v247 offset:49152
 v_cvt_pk_bf16_f32 v205, v142, v143
 v_mfma_f32_16x16x32_bf16 a[100:103], a[160:163], v[212:215], a[100:103]
 v_exp_f32 v145, v145
 v_mfma_f32_16x16x32_bf16 a[100:103], a[164:167], v[228:231], a[100:103]
 ds_read_b128 a[136:139], v248 offset:49152
 v_add_f32 v124, v124, v144
 v_mfma_f32_16x16x32_bf16 a[104:107], a[160:163], v[216:219], a[104:107]
 v_exp_f32 v146, v146
 v_mfma_f32_16x16x32_bf16 a[104:107], a[164:167], v[232:235], a[104:107]
 ds_read_b128 a[140:143], v249 offset:49152
 v_add_f32 v124, v124, v145
 v_mfma_f32_16x16x32_bf16 a[108:111], a[160:163], v[220:223], a[108:111]
 v_exp_f32 v147, v147
 v_mfma_f32_16x16x32_bf16 a[108:111], a[164:167], v[236:239], a[108:111]
 buffer_load_dwordx4 v245, s[28:31], s76 offen offset:3072 nt lds
 v_mfma_f32_16x16x32_bf16 a[112:115], a[168:171], v[208:211], a[112:115]
 s_add_u32 s76, s76, 16384
 v_exp_f32 v148, v148
 v_mfma_f32_16x16x32_bf16 a[112:115], a[172:175], v[224:227], a[112:115]
 ds_read_b64_tr_b16 a[160:161], v16 offset:32768
 v_cvt_pk_bf16_f32 v194, v144, v145
 v_mfma_f32_16x16x32_bf16 a[116:119], a[168:171], v[212:215], a[116:119]
 v_exp_f32 v149, v149
 v_mfma_f32_16x16x32_bf16 a[116:119], a[172:175], v[228:231], a[116:119]
 ds_read_b64_tr_b16 a[162:163], v16 offset:36864
 v_add_f32 v124, v124, v146
 v_mfma_f32_16x16x32_bf16 a[120:123], a[168:171], v[216:219], a[120:123]
 buffer_store_dwordx4 v[44:47], v2, s[48:51], s99 offen offset:3072 sc1
 v_exp_f32 v150, v150
 v_mfma_f32_16x16x32_bf16 a[120:123], a[172:175], v[232:235], a[120:123]
 ds_read_b64_tr_b16 a[164:165], v16 offset:40960
 v_add_f32 v124, v124, v147
 v_mfma_f32_16x16x32_bf16 a[124:127], a[168:171], v[220:223], a[124:127]
 v_exp_f32 v151, v151
 v_mfma_f32_16x16x32_bf16 a[124:127], a[172:175], v[236:239], a[124:127]
 s_waitcnt lgkmcnt(3)
 ds_read_b64_tr_b16 a[166:167], v16 offset:45056
 v_cvt_pk_bf16_f32 v195, v146, v147
 s_mov_b32 s77, 7
 s_branch L_att_p2
.p2align 6
L_att_p0:
 v_mfma_f32_16x16x32_bf16 v[128:131], a[128:131], v[80:83], v[160:163]
 v_exp_f32 v152, v152
 v_mfma_f32_16x16x32_bf16 v[128:131], a[132:135], v[96:99], v[128:131]
 ds_read_b64_tr_b16 a[168:169], v17 offset:0
 v_cvt_pk_bf16_f32 v198, v148, v149
 v_mfma_f32_16x16x32_bf16 v[128:131], a[136:139], v[48:51], v[128:131]
 v_exp_f32 v153, v153
 v_mfma_f32_16x16x32_bf16 v[128:131], a[140:143], v[64:67], v[128:131]
 ds_read_b64_tr_b16 a[170:171], v17 offset:4096
 v_cvt_pk_bf16_f32 v199, v150, v151
 v_mfma_f32_16x16x32_bf16 v[132:135], a[128:131], v[84:87], v[164:167]
 v_exp_f32 v154, v154
 v_mfma_f32_16x16x32_bf16 v[132:135], a[132:135], v[100:103], v[132:135]
 ds_read_b64_tr_b16 a[172:173], v17 offset:8192
 v_add_f32 v126, v126, v152
 v_mfma_f32_16x16x32_bf16 v[132:135], a[136:139], v[52:55], v[132:135]
 v_exp_f32 v155, v155
 v_mfma_f32_16x16x32_bf16 v[132:135], a[140:143], v[68:71], v[132:135]
 ds_read_b64_tr_b16 a[174:175], v17 offset:12288
 v_add_f32 v126, v126, v153
 v_mfma_f32_16x16x32_bf16 v[136:139], a[128:131], v[88:91], v[168:171]
 s_add_u32 m0, s72, 0
 v_exp_f32 v156, v156
 v_mfma_f32_16x16x32_bf16 v[136:139], a[132:135], v[104:107], v[136:139]
 buffer_load_dwordx4 v240, s[24:27], s76 offen offset:0 nt lds
 v_mfma_f32_16x16x32_bf16 v[136:139], a[136:139], v[56:59], v[136:139]
 v_exp_f32 v157, v157
 v_mfma_f32_16x16x32_bf16 v[136:139], a[140:143], v[72:75], v[136:139]
 v_cvt_pk_bf16_f32 v202, v152, v153
 v_add_f32 v126, v126, v154
 v_mfma_f32_16x16x32_bf16 v[140:143], a[128:131], v[92:95], v[172:175]
 v_exp_f32 v158, v158
 v_mfma_f32_16x16x32_bf16 v[140:143], a[132:135], v[108:111], v[140:143]
 v_add_f32 v126, v126, v155
 v_cvt_pk_bf16_f32 v203, v154, v155
 v_mfma_f32_16x16x32_bf16 v[140:143], a[136:139], v[60:63], v[140:143]
 v_exp_f32 v159, v159
 v_mfma_f32_16x16x32_bf16 v[140:143], a[140:143], v[76:79], v[140:143]
 s_waitcnt lgkmcnt(0)
 ds_read_b128 a[144:147], v246 offset:20480
 v_cvt_pk_bf16_f32 v206, v156, v157
 v_mfma_f32_16x16x32_bf16 a[0:3], a[160:163], v[176:179], a[0:3]
 v_exp_f32 v128, v128
 v_mfma_f32_16x16x32_bf16 a[0:3], a[164:167], v[192:195], a[0:3]
 ds_read_b128 a[148:151], v247 offset:20480
 v_cvt_pk_bf16_f32 v207, v158, v159
 v_mfma_f32_16x16x32_bf16 a[4:7], a[160:163], v[180:183], a[4:7]
 v_exp_f32 v129, v129
 v_mfma_f32_16x16x32_bf16 a[4:7], a[164:167], v[196:199], a[4:7]
 ds_read_b128 a[152:155], v248 offset:20480
 v_add_f32 v124, v124, v128
 v_mfma_f32_16x16x32_bf16 a[8:11], a[160:163], v[184:187], a[8:11]
 v_exp_f32 v130, v130
 v_mfma_f32_16x16x32_bf16 a[8:11], a[164:167], v[200:203], a[8:11]
 ds_read_b128 a[156:159], v249 offset:20480
 v_add_f32 v124, v124, v129
 v_mfma_f32_16x16x32_bf16 a[12:15], a[160:163], v[188:191], a[12:15]
 v_exp_f32 v131, v131
 v_mfma_f32_16x16x32_bf16 a[12:15], a[164:167], v[204:207], a[12:15]
 buffer_load_dwordx4 v241, s[24:27], s76 offen offset:1024 nt lds
 v_mfma_f32_16x16x32_bf16 a[16:19], a[168:171], v[176:179], a[16:19]
 v_exp_f32 v132, v132
 v_mfma_f32_16x16x32_bf16 a[16:19], a[172:175], v[192:195], a[16:19]
 ds_read_b64_tr_b16 a[160:161], v18 offset:0
 v_cvt_pk_bf16_f32 v208, v128, v129
 v_mfma_f32_16x16x32_bf16 a[20:23], a[168:171], v[180:183], a[20:23]
 v_exp_f32 v133, v133
 v_mfma_f32_16x16x32_bf16 a[20:23], a[172:175], v[196:199], a[20:23]
 ds_read_b64_tr_b16 a[162:163], v18 offset:4096
 v_add_f32 v124, v124, v130
 v_mfma_f32_16x16x32_bf16 a[24:27], a[168:171], v[184:187], a[24:27]
 v_exp_f32 v134, v134
 v_mfma_f32_16x16x32_bf16 a[24:27], a[172:175], v[200:203], a[24:27]
 ds_read_b64_tr_b16 a[164:165], v18 offset:8192
 v_add_f32 v124, v124, v131
 v_mfma_f32_16x16x32_bf16 a[28:31], a[168:171], v[188:191], a[28:31]
 v_exp_f32 v135, v135
 v_mfma_f32_16x16x32_bf16 a[28:31], a[172:175], v[204:207], a[28:31]
 ds_read_b64_tr_b16 a[166:167], v18 offset:12288
 v_cvt_pk_bf16_f32 v209, v130, v131
 v_mfma_f32_16x16x32_bf16 a[196:199], a[192:195], v[180:183], a[196:199]
 v_cvt_pk_bf16_f32 v212, v132, v133
 v_cvt_pk_bf16_f32 v213, v134, v135
 v_mfma_f32_16x16x32_bf16 a[196:199], a[192:195], v[196:199], a[196:199]
 s_waitcnt lgkmcnt(4)
 v_mfma_f32_16x16x32_bf16 v[144:147], a[144:147], v[80:83], v[160:163]
 v_exp_f32 v136, v136
 v_mfma_f32_16x16x32_bf16 v[144:147], a[148:151], v[96:99], v[144:147]
 ds_read_b64_tr_b16 a[168:169], v19 offset:0
 v_mfma_f32_16x16x32_bf16 v[144:147], a[152:155], v[48:51], v[144:147]
 v_exp_f32 v137, v137
 v_mfma_f32_16x16x32_bf16 v[144:147], a[156:159], v[64:67], v[144:147]
 ds_read_b64_tr_b16 a[170:171], v19 offset:4096
 v_add_f32 v126, v126, v136
 v_mfma_f32_16x16x32_bf16 v[148:151], a[144:147], v[84:87], v[164:167]
 v_exp_f32 v138, v138
 v_mfma_f32_16x16x32_bf16 v[148:151], a[148:151], v[100:103], v[148:151]
 ds_read_b64_tr_b16 a[172:173], v19 offset:8192
 v_add_f32 v126, v126, v137
 v_mfma_f32_16x16x32_bf16 v[148:151], a[152:155], v[52:55], v[148:151]
 v_exp_f32 v139, v139
 v_mfma_f32_16x16x32_bf16 v[148:151], a[156:159], v[68:71], v[148:151]
 ds_read_b64_tr_b16 a[174:175], v19 offset:12288
 v_cvt_pk_bf16_f32 v216, v136, v137
 v_mfma_f32_16x16x32_bf16 v[152:155], a[144:147], v[88:91], v[168:171]
 v_exp_f32 v140, v140
 v_mfma_f32_16x16x32_bf16 v[152:155], a[148:151], v[104:107], v[152:155]
 buffer_load_dwordx4 v242, s[24:27], s76 offen offset:2048 nt lds
 v_mfma_f32_16x16x32_bf16 v[152:155], a[152:155], v[56:59], v[152:155]
 v_exp_f32 v141, v141
 v_mfma_f32_16x16x32_bf16 v[152:155], a[156:159], v[72:75], v[152:155]
 v_add_f32 v126, v126, v138
 v_add_f32 v126, v126, v139
 v_mfma_f32_16x16x32_bf16 v[156:159], a[144:147], v[92:95], v[172:175]
 v_exp_f32 v142, v142
 v_mfma_f32_16x16x32_bf16 v[156:159], a[148:151], v[108:111], v[156:159]
 v_cvt_pk_bf16_f32 v217, v138, v139
 v_cvt_pk_bf16_f32 v220, v140, v141
 v_mfma_f32_16x16x32_bf16 v[156:159], a[152:155], v[60:63], v[156:159]
 v_exp_f32 v143, v143
 v_mfma_f32_16x16x32_bf16 v[156:159], a[156:159], v[76:79], v[156:159]
 s_waitcnt lgkmcnt(0)
 ds_read_b128 a[128:131], v246 offset:24576
 v_mfma_f32_16x16x32_bf16 a[32:35], a[160:163], v[176:179], a[32:35]
 v_exp_f32 v144, v144
 v_mfma_f32_16x16x32_bf16 a[32:35], a[164:167], v[192:195], a[32:35]
 ds_read_b128 a[132:135], v247 offset:24576
 v_cvt_pk_bf16_f32 v221, v142, v143
 v_mfma_f32_16x16x32_bf16 a[36:39], a[160:163], v[180:183], a[36:39]
 v_exp_f32 v145, v145
 v_mfma_f32_16x16x32_bf16 a[36:39], a[164:167], v[196:199], a[36:39]
 ds_read_b128 a[136:139], v248 offset:24576
 v_add_f32 v124, v124, v144
 v_mfma_f32_16x16x32_bf16 a[40:43], a[160:163], v[184:187], a[40:43]
 v_exp_f32 v146, v146
 v_mfma_f32_16x16x32_bf16 a[40:43], a[164:167], v[200:203], a[40:43]
 ds_read_b128 a[140:143], v249 offset:24576
 v_add_f32 v124, v124, v145
 v_mfma_f32_16x16x32_bf16 a[44:47], a[160:163], v[188:191], a[44:47]
 v_exp_f32 v147, v147
 v_mfma_f32_16x16x32_bf16 a[44:47], a[164:167], v[204:207], a[44:47]
 buffer_load_dwordx4 v243, s[24:27], s76 offen offset:3072 nt lds
 v_mfma_f32_16x16x32_bf16 a[48:51], a[168:171], v[176:179], a[48:51]
 v_exp_f32 v148, v148
 v_mfma_f32_16x16x32_bf16 a[48:51], a[172:175], v[192:195], a[48:51]
 ds_read_b64_tr_b16 a[160:161], v20 offset:0
 v_cvt_pk_bf16_f32 v210, v144, v145
 v_mfma_f32_16x16x32_bf16 a[52:55], a[168:171], v[180:183], a[52:55]
 v_exp_f32 v149, v149
 v_mfma_f32_16x16x32_bf16 a[52:55], a[172:175], v[196:199], a[52:55]
 ds_read_b64_tr_b16 a[162:163], v20 offset:4096
 v_add_f32 v124, v124, v146
 v_mfma_f32_16x16x32_bf16 a[56:59], a[168:171], v[184:187], a[56:59]
 v_exp_f32 v150, v150
 v_mfma_f32_16x16x32_bf16 a[56:59], a[172:175], v[200:203], a[56:59]
 ds_read_b64_tr_b16 a[164:165], v20 offset:8192
 v_add_f32 v124, v124, v147
 v_mfma_f32_16x16x32_bf16 a[60:63], a[168:171], v[188:191], a[60:63]
 v_exp_f32 v151, v151
 v_mfma_f32_16x16x32_bf16 a[60:63], a[172:175], v[204:207], a[60:63]
 s_waitcnt lgkmcnt(3)
 ds_read_b64_tr_b16 a[166:167], v20 offset:12288
 v_cvt_pk_bf16_f32 v211, v146, v147
 v_mfma_f32_16x16x32_bf16 v[128:131], a[128:131], v[80:83], v[160:163]
 v_exp_f32 v152, v152
 v_mfma_f32_16x16x32_bf16 v[128:131], a[132:135], v[96:99], v[128:131]
 ds_read_b64_tr_b16 a[168:169], v21 offset:0
 v_cvt_pk_bf16_f32 v214, v148, v149
 v_mfma_f32_16x16x32_bf16 v[128:131], a[136:139], v[48:51], v[128:131]
 v_exp_f32 v153, v153
 v_mfma_f32_16x16x32_bf16 v[128:131], a[140:143], v[64:67], v[128:131]
 ds_read_b64_tr_b16 a[170:171], v21 offset:4096
 v_cvt_pk_bf16_f32 v215, v150, v151
 v_mfma_f32_16x16x32_bf16 v[132:135], a[128:131], v[84:87], v[164:167]
 v_exp_f32 v154, v154
 v_mfma_f32_16x16x32_bf16 v[132:135], a[132:135], v[100:103], v[132:135]
 ds_read_b64_tr_b16 a[172:173], v21 offset:8192
 v_add_f32 v126, v126, v152
 v_mfma_f32_16x16x32_bf16 v[132:135], a[136:139], v[52:55], v[132:135]
 v_exp_f32 v155, v155
 v_mfma_f32_16x16x32_bf16 v[132:135], a[140:143], v[68:71], v[132:135]
 ds_read_b64_tr_b16 a[174:175], v21 offset:12288
 v_add_f32 v126, v126, v153
 v_mfma_f32_16x16x32_bf16 v[136:139], a[128:131], v[88:91], v[168:171]
 s_add_u32 m0, s72, 114688
 v_exp_f32 v156, v156
 v_mfma_f32_16x16x32_bf16 v[136:139], a[132:135], v[104:107], v[136:139]
 buffer_load_dwordx4 v244, s[28:31], s76 offen offset:0 nt lds
 v_mfma_f32_16x16x32_bf16 v[136:139], a[136:139], v[56:59], v[136:139]
 v_exp_f32 v157, v157
 v_mfma_f32_16x16x32_bf16 v[136:139], a[140:143], v[72:75], v[136:139]
 v_cvt_pk_bf16_f32 v218, v152, v153
 v_add_f32 v126, v126, v154
 v_mfma_f32_16x16x32_bf16 v[140:143], a[128:131], v[92:95], v[172:175]
 v_exp_f32 v158, v158
 v_mfma_f32_16x16x32_bf16 v[140:143], a[132:135], v[108:111], v[140:143]
 v_add_f32 v126, v126, v155
 v_cvt_pk_bf16_f32 v219, v154, v155
 v_mfma_f32_16x16x32_bf16 v[140:143], a[136:139], v[60:63], v[140:143]
 v_exp_f32 v159, v159
 v_mfma_f32_16x16x32_bf16 v[140:143], a[140:143], v[76:79], v[140:143]
 s_waitcnt lgkmcnt(0)
 ds_read_b128 a[144:147], v246 offset:28672
 v_cvt_pk_bf16_f32 v222, v156, v157
 v_mfma_f32_16x16x32_bf16 a[64:67], a[160:163], v[176:179], a[64:67]
 v_exp_f32 v128, v128
 v_mfma_f32_16x16x32_bf16 a[64:67], a[164:167], v[192:195], a[64:67]
 ds_read_b128 a[148:151], v247 offset:28672
 v_cvt_pk_bf16_f32 v223, v158, v159
 v_mfma_f32_16x16x32_bf16 a[68:71], a[160:163], v[180:183], a[68:71]
 v_exp_f32 v129, v129
 v_mfma_f32_16x16x32_bf16 a[68:71], a[164:167], v[196:199], a[68:71]
 ds_read_b128 a[152:155], v248 offset:28672
 v_add_f32 v124, v124, v128
 v_mfma_f32_16x16x32_bf16 a[72:75], a[160:163], v[184:187], a[72:75]
 v_exp_f32 v130, v130
 v_mfma_f32_16x16x32_bf16 a[72:75], a[164:167], v[200:203], a[72:75]
 ds_read_b128 a[156:159], v249 offset:28672
 v_add_f32 v124, v124, v129
 v_mfma_f32_16x16x32_bf16 a[76:79], a[160:163], v[188:191], a[76:79]
 v_exp_f32 v131, v131
 v_mfma_f32_16x16x32_bf16 a[76:79], a[164:167], v[204:207], a[76:79]
 buffer_load_dwordx4 v245, s[28:31], s76 offen offset:1024 nt lds
 v_mfma_f32_16x16x32_bf16 a[80:83], a[168:171], v[176:179], a[80:83]
 v_exp_f32 v132, v132
 v_mfma_f32_16x16x32_bf16 a[80:83], a[172:175], v[192:195], a[80:83]
 ds_read_b64_tr_b16 a[160:161], v22 offset:0
 v_cvt_pk_bf16_f32 v224, v128, v129
 v_mfma_f32_16x16x32_bf16 a[84:87], a[168:171], v[180:183], a[84:87]
 v_exp_f32 v133, v133
 v_mfma_f32_16x16x32_bf16 a[84:87], a[172:175], v[196:199], a[84:87]
 ds_read_b64_tr_b16 a[162:163], v22 offset:4096
 v_add_f32 v124, v124, v130
 v_mfma_f32_16x16x32_bf16 a[88:91], a[168:171], v[184:187], a[88:91]
 v_exp_f32 v134, v134
 v_mfma_f32_16x16x32_bf16 a[88:91], a[172:175], v[200:203], a[88:91]
 ds_read_b64_tr_b16 a[164:165], v22 offset:8192
 v_add_f32 v124, v124, v131
 v_mfma_f32_16x16x32_bf16 a[92:95], a[168:171], v[188:191], a[92:95]
 v_exp_f32 v135, v135
 v_mfma_f32_16x16x32_bf16 a[92:95], a[172:175], v[204:207], a[92:95]
 ds_read_b64_tr_b16 a[166:167], v22 offset:12288
 v_cvt_pk_bf16_f32 v225, v130, v131
 v_mfma_f32_16x16x32_bf16 a[200:203], a[192:195], v[188:191], a[200:203]
 v_cvt_pk_bf16_f32 v228, v132, v133
 v_cvt_pk_bf16_f32 v229, v134, v135
 v_mfma_f32_16x16x32_bf16 a[200:203], a[192:195], v[204:207], a[200:203]
 s_waitcnt lgkmcnt(4)
 v_mfma_f32_16x16x32_bf16 v[144:147], a[144:147], v[80:83], v[160:163]
 v_exp_f32 v136, v136
 v_mfma_f32_16x16x32_bf16 v[144:147], a[148:151], v[96:99], v[144:147]
 ds_read_b64_tr_b16 a[168:169], v23 offset:0
 v_mfma_f32_16x16x32_bf16 v[144:147], a[152:155], v[48:51], v[144:147]
 v_exp_f32 v137, v137
 v_mfma_f32_16x16x32_bf16 v[144:147], a[156:159], v[64:67], v[144:147]
 ds_read_b64_tr_b16 a[170:171], v23 offset:4096
 v_add_f32 v126, v126, v136
 v_mfma_f32_16x16x32_bf16 v[148:151], a[144:147], v[84:87], v[164:167]
 v_exp_f32 v138, v138
 v_mfma_f32_16x16x32_bf16 v[148:151], a[148:151], v[100:103], v[148:151]
 ds_read_b64_tr_b16 a[172:173], v23 offset:8192
 v_add_f32 v126, v126, v137
 v_mfma_f32_16x16x32_bf16 v[148:151], a[152:155], v[52:55], v[148:151]
 v_exp_f32 v139, v139
 v_mfma_f32_16x16x32_bf16 v[148:151], a[156:159], v[68:71], v[148:151]
 ds_read_b64_tr_b16 a[174:175], v23 offset:12288
 v_cvt_pk_bf16_f32 v232, v136, v137
 v_mfma_f32_16x16x32_bf16 v[152:155], a[144:147], v[88:91], v[168:171]
 v_exp_f32 v140, v140
 v_mfma_f32_16x16x32_bf16 v[152:155], a[148:151], v[104:107], v[152:155]
 buffer_load_dwordx4 v244, s[28:31], s76 offen offset:2048 nt lds
 v_mfma_f32_16x16x32_bf16 v[152:155], a[152:155], v[56:59], v[152:155]
 v_exp_f32 v141, v141
 v_mfma_f32_16x16x32_bf16 v[152:155], a[156:159], v[72:75], v[152:155]
 v_add_f32 v126, v126, v138
 v_add_f32 v126, v126, v139
 v_mfma_f32_16x16x32_bf16 v[156:159], a[144:147], v[92:95], v[172:175]
 v_exp_f32 v142, v142
 v_mfma_f32_16x16x32_bf16 v[156:159], a[148:151], v[108:111], v[156:159]
 v_cvt_pk_bf16_f32 v233, v138, v139
 v_cvt_pk_bf16_f32 v236, v140, v141
 v_mfma_f32_16x16x32_bf16 v[156:159], a[152:155], v[60:63], v[156:159]
 v_exp_f32 v143, v143
 v_mfma_f32_16x16x32_bf16 v[156:159], a[156:159], v[76:79], v[156:159]
 s_waitcnt vmcnt(15) lgkmcnt(0)
 s_barrier
 ds_read_b128 a[128:131], v246 offset:32768
 v_mfma_f32_16x16x32_bf16 a[96:99], a[160:163], v[176:179], a[96:99]
 v_exp_f32 v144, v144
 v_mfma_f32_16x16x32_bf16 a[96:99], a[164:167], v[192:195], a[96:99]
 ds_read_b128 a[132:135], v247 offset:32768
 v_cvt_pk_bf16_f32 v237, v142, v143
 v_mfma_f32_16x16x32_bf16 a[100:103], a[160:163], v[180:183], a[100:103]
 v_exp_f32 v145, v145
 v_mfma_f32_16x16x32_bf16 a[100:103], a[164:167], v[196:199], a[100:103]
 ds_read_b128 a[136:139], v248 offset:32768
 v_add_f32 v124, v124, v144
 v_mfma_f32_16x16x32_bf16 a[104:107], a[160:163], v[184:187], a[104:107]
 v_exp_f32 v146, v146
 v_mfma_f32_16x16x32_bf16 a[104:107], a[164:167], v[200:203], a[104:107]
 ds_read_b128 a[140:143], v249 offset:32768
 v_add_f32 v124, v124, v145
 v_mfma_f32_16x16x32_bf16 a[108:111], a[160:163], v[188:191], a[108:111]
 v_exp_f32 v147, v147
 v_mfma_f32_16x16x32_bf16 a[108:111], a[164:167], v[204:207], a[108:111]
 buffer_load_dwordx4 v245, s[28:31], s76 offen offset:3072 nt lds
 v_mfma_f32_16x16x32_bf16 a[112:115], a[168:171], v[176:179], a[112:115]
 s_add_u32 s76, s76, 16384
 v_exp_f32 v148, v148
 v_mfma_f32_16x16x32_bf16 a[112:115], a[172:175], v[192:195], a[112:115]
 ds_read_b64_tr_b16 a[160:161], v16 offset:16384
 v_cvt_pk_bf16_f32 v226, v144, v145
 v_mfma_f32_16x16x32_bf16 a[116:119], a[168:171], v[180:183], a[116:119]
 s_cmp_eq_u32 s77, 6
 v_exp_f32 v149, v149
 s_cbranch_scc1 L_job0
L_job_b:
 v_mfma_f32_16x16x32_bf16 a[116:119], a[172:175], v[196:199], a[116:119]
 ds_read_b64_tr_b16 a[162:163], v16 offset:20480
 v_add_f32 v124, v124, v146
 v_mfma_f32_16x16x32_bf16 a[120:123], a[168:171], v[184:187], a[120:123]
 s_sub_u32 s77, s77, 1
 v_exp_f32 v150, v150
 v_mfma_f32_16x16x32_bf16 a[120:123], a[172:175], v[200:203], a[120:123]
 ds_read_b64_tr_b16 a[164:165], v16 offset:24576
 v_add_f32 v124, v124, v147
 v_mfma_f32_16x16x32_bf16 a[124:127], a[168:171], v[188:191], a[124:127]
 s_cmp_eq_u32 s77, 0
 v_exp_f32 v151, v151
 v_mfma_f32_16x16x32_bf16 a[124:127], a[172:175], v[204:207], a[124:127]
 s_waitcnt lgkmcnt(3)
 ds_read_b64_tr_b16 a[166:167], v16 offset:28672
 v_cvt_pk_bf16_f32 v227, v146, v147
 s_cbranch_scc1 L_att_last
L_att_p1:
 v_mfma_f32_16x16x32_bf16 v[128:131], a[128:131], v[80:83], v[160:163]
 v_exp_f32 v152, v152
 v_mfma_f32_16x16x32_bf16 v[128:131], a[132:135], v[96:99], v[128:131]
 ds_read_b64_tr_b16 a[168:169], v17 offset:16384
 v_cvt_pk_bf16_f32 v230, v148, v149
 v_mfma_f32_16x16x32_bf16 v[128:131], a[136:139], v[48:51], v[128:131]
 v_exp_f32 v153, v153
 v_mfma_f32_16x16x32_bf16 v[128:131], a[140:143], v[64:67], v[128:131]
 ds_read_b64_tr_b16 a[170:171], v17 offset:20480
 v_cvt_pk_bf16_f32 v231, v150, v151
 v_mfma_f32_16x16x32_bf16 v[132:135], a[128:131], v[84:87], v[164:167]
 v_exp_f32 v154, v154
 v_mfma_f32_16x16x32_bf16 v[132:135], a[132:135], v[100:103], v[132:135]
 ds_read_b64_tr_b16 a[172:173], v17 offset:24576
 v_add_f32 v126, v126, v152
 v_mfma_f32_16x16x32_bf16 v[132:135], a[136:139], v[52:55], v[132:135]
 v_exp_f32 v155, v155
 v_mfma_f32_16x16x32_bf16 v[132:135], a[140:143], v[68:71], v[132:135]
 ds_read_b64_tr_b16 a[174:175], v17 offset:28672
 v_add_f32 v126, v126, v153
 v_mfma_f32_16x16x32_bf16 v[136:139], a[128:131], v[88:91], v[168:171]
 s_add_u32 m0, s72, 16384
 v_exp_f32 v156, v156
 v_mfma_f32_16x16x32_bf16 v[136:139], a[132:135], v[104:107], v[136:139]
 buffer_load_dwordx4 v240, s[24:27], s76 offen offset:0 nt lds
 v_mfma_f32_16x16x32_bf16 v[136:139], a[136:139], v[56:59], v[136:139]
 v_exp_f32 v157, v157
 v_mfma_f32_16x16x32_bf16 v[136:139], a[140:143], v[72:75], v[136:139]
 v_cvt_pk_bf16_f32 v234, v152, v153
 v_add_f32 v126, v126, v154
 v_mfma_f32_16x16x32_bf16 v[140:143], a[128:131], v[92:95], v[172:175]
 v_exp_f32 v158, v158
 v_mfma_f32_16x16x32_bf16 v[140:143], a[132:135], v[108:111], v[140:143]
 v_add_f32 v126, v126, v155
 v_cvt_pk_bf16_f32 v235, v154, v155
 v_mfma_f32_16x16x32_bf16 v[140:143], a[136:139], v[60:63], v[140:143]
 v_exp_f32 v159, v159
 v_mfma_f32_16x16x32_bf16 v[140:143], a[140:143], v[76:79], v[140:143]
 s_waitcnt lgkmcnt(0)
 ds_read_b128 a[144:147], v246 offset:36864
 v_cvt_pk_bf16_f32 v238, v156, v157
 v_mfma_f32_16x16x32_bf16 a[0:3], a[160:163], v[208:211], a[0:3]
 v_exp_f32 v128, v128
 v_mfma_f32_16x16x32_bf16 a[0:3], a[164:167], v[224:227], a[0:3]
 ds_read_b128 a[148:151], v247 offset:36864
 v_cvt_pk_bf16_f32 v239, v158, v159
 v_mfma_f32_16x16x32_bf16 a[4:7], a[160:163], v[212:215], a[4:7]
 v_exp_f32 v129, v129
 v_mfma_f32_16x16x32_bf16 a[4:7], a[164:167], v[228:231], a[4:7]
 ds_read_b128 a[152:155], v248 offset:36864
 v_add_f32 v124, v124, v128
 v_mfma_f32_16x16x32_bf16 a[8:11], a[160:163], v[216:219], a[8:11]
 v_exp_f32 v130, v130
 v_mfma_f32_16x16x32_bf16 a[8:11], a[164:167], v[232:235], a[8:11]
 ds_read_b128 a[156:159], v249 offset:36864
 v_add_f32 v124, v124, v129
 v_mfma_f32_16x16x32_bf16 a[12:15], a[160:163], v[220:223], a[12:15]
 v_exp_f32 v131, v131
 v_mfma_f32_16x16x32_bf16 a[12:15], a[164:167], v[236:239], a[12:15]
 buffer_load_dwordx4 v241, s[24:27], s76 offen offset:1024 nt lds
 v_mfma_f32_16x16x32_bf16 a[16:19], a[168:171], v[208:211], a[16:19]
 v_exp_f32 v132, v132
 v_mfma_f32_16x16x32_bf16 a[16:19], a[172:175], v[224:227], a[16:19]
 ds_read_b64_tr_b16 a[160:161], v18 offset:16384
 v_cvt_pk_bf16_f32 v176, v128, v129
 v_mfma_f32_16x16x32_bf16 a[20:23], a[168:171], v[212:215], a[20:23]
 v_exp_f32 v133, v133
 v_mfma_f32_16x16x32_bf16 a[20:23], a[172:175], v[228:231], a[20:23]
 ds_read_b64_tr_b16 a[162:163], v18 offset:20480
 v_add_f32 v124, v124, v130
 v_mfma_f32_16x16x32_bf16 a[24:27], a[168:171], v[216:219], a[24:27]
 v_exp_f32 v134, v134
 v_mfma_f32_16x16x32_bf16 a[24:27], a[172:175], v[232:235], a[24:27]
 ds_read_b64_tr_b16 a[164:165], v18 offset:24576
 v_add_f32 v124, v124, v131
 v_mfma_f32_16x16x32_bf16 a[28:31], a[168:171], v[220:223], a[28:31]
 v_exp_f32 v135, v135
 v_mfma_f32_16x16x32_bf16 a[28:31], a[172:175], v[236:239], a[28:31]
 ds_read_b64_tr_b16 a[166:167], v18 offset:28672
 v_cvt_pk_bf16_f32 v177, v130, v131
 v_mfma_f32_16x16x32_bf16 a[196:199], a[192:195], v[212:215], a[196:199]
 v_cvt_pk_bf16_f32 v180, v132, v133
 v_cvt_pk_bf16_f32 v181, v134, v135
 v_mfma_f32_16x16x32_bf16 a[196:199], a[192:195], v[228:231], a[196:199]
 s_waitcnt lgkmcnt(4)
 v_mfma_f32_16x16x32_bf16 v[144:147], a[144:147], v[80:83], v[160:163]
 v_exp_f32 v136, v136
 v_mfma_f32_16x16x32_bf16 v[144:147], a[148:151], v[96:99], v[144:147]
 ds_read_b64_tr_b16 a[168:169], v19 offset:16384
 v_mfma_f32_16x16x32_bf16 v[144:147], a[152:155], v[48:51], v[144:147]
 v_exp_f32 v137, v137
 v_mfma_f32_16x16x32_bf16 v[144:147], a[156:159], v[64:67], v[144:147]
 ds_read_b64_tr_b16 a[170:171], v19 offset:20480
 v_add_f32 v126, v126, v136
 v_mfma_f32_16x16x32_bf16 v[148:151], a[144:147], v[84:87], v[164:167]
 v_exp_f32 v138, v138
 v_mfma_f32_16x16x32_bf16 v[148:151], a[148:151], v[100:103], v[148:151]
 ds_read_b64_tr_b16 a[172:173], v19 offset:24576
 v_add_f32 v126, v126, v137
 v_mfma_f32_16x16x32_bf16 v[148:151], a[152:155], v[52:55], v[148:151]
 v_exp_f32 v139, v139
 v_mfma_f32_16x16x32_bf16 v[148:151], a[156:159], v[68:71], v[148:151]
 ds_read_b64_tr_b16 a[174:175], v19 offset:28672
 v_cvt_pk_bf16_f32 v184, v136, v137
 v_mfma_f32_16x16x32_bf16 v[152:155], a[144:147], v[88:91], v[168:171]
 v_exp_f32 v140, v140
 v_mfma_f32_16x16x32_bf16 v[152:155], a[148:151], v[104:107], v[152:155]
 buffer_load_dwordx4 v242, s[24:27], s76 offen offset:2048 nt lds
 v_mfma_f32_16x16x32_bf16 v[152:155], a[152:155], v[56:59], v[152:155]
 v_exp_f32 v141, v141
 v_mfma_f32_16x16x32_bf16 v[152:155], a[156:159], v[72:75], v[152:155]
 v_add_f32 v126, v126, v138
 v_add_f32 v126, v126, v139
 v_mfma_f32_16x16x32_bf16 v[156:159], a[144:147], v[92:95], v[172:175]
 v_exp_f32 v142, v142
 v_mfma_f32_16x16x32_bf16 v[156:159], a[148:151], v[108:111], v[156:159]
 v_cvt_pk_bf16_f32 v185, v138, v139
 v_cvt_pk_bf16_f32 v188, v140, v141
 v_mfma_f32_16x16x32_bf16 v[156:159], a[152:155], v[60:63], v[156:159]
 v_exp_f32 v143, v143
 v_mfma_f32_16x16x32_bf16 v[156:159], a[156:159], v[76:79], v[156:159]
 s_waitcnt lgkmcnt(0)
 ds_read_b128 a[128:131], v246 offset:40960
 v_mfma_f32_16x16x32_bf16 a[32:35], a[160:163], v[208:211], a[32:35]
 v_exp_f32 v144, v144
 v_mfma_f32_16x16x32_bf16 a[32:35], a[164:167], v[224:227], a[32:35]
 ds_read_b128 a[132:135], v247 offset:40960
 v_cvt_pk_bf16_f32 v189, v142, v143
 v_mfma_f32_16x16x32_bf16 a[36:39], a[160:163], v[212:215], a[36:39]
 v_exp_f32 v145, v145
 v_mfma_f32_16x16x32_bf16 a[36:39], a[164:167], v[228:231], a[36:39]
 ds_read_b128 a[136:139], v248 offset:40960
 v_add_f32 v124, v124, v144
 v_mfma_f32_16x16x32_bf16 a[40:43], a[160:163], v[216:219], a[40:43]
 v_exp_f32 v146, v146
 v_mfma_f32_16x16x32_bf16 a[40:43], a[164:167], v[232:235], a[40:43]
 ds_read_b128 a[140:143], v249 offset:40960
 v_add_f32 v124, v124, v145
 v_mfma_f32_16x16x32_bf16 a[44:47], a[160:163], v[220:223], a[44:47]
 v_exp_f32 v147, v147
 v_mfma_f32_16x16x32_bf16 a[44:47], a[164:167], v[236:239], a[44:47]
 buffer_load_dwordx4 v243, s[24:27], s76 offen offset:3072 nt lds
 v_mfma_f32_16x16x32_bf16 a[48:51], a[168:171], v[208:211], a[48:51]
 v_exp_f32 v148, v148
 v_mfma_f32_16x16x32_bf16 a[48:51], a[172:175], v[224:227], a[48:51]
 ds_read_b64_tr_b16 a[160:161], v20 offset:16384
 v_cvt_pk_bf16_f32 v178, v144, v145
 v_mfma_f32_16x16x32_bf16 a[52:55], a[168:171], v[212:215], a[52:55]
 v_exp_f32 v149, v149
 v_mfma_f32_16x16x32_bf16 a[52:55], a[172:175], v[228:231], a[52:55]
 ds_read_b64_tr_b16 a[162:163], v20 offset:20480
 v_add_f32 v124, v124, v146
 v_mfma_f32_16x16x32_bf16 a[56:59], a[168:171], v[216:219], a[56:59]
 v_exp_f32 v150, v150
 v_mfma_f32_16x16x32_bf16 a[56:59], a[172:175], v[232:235], a[56:59]
 ds_read_b64_tr_b16 a[164:165], v20 offset:24576
 v_add_f32 v124, v124, v147
 v_mfma_f32_16x16x32_bf16 a[60:63], a[168:171], v[220:223], a[60:63]
 v_exp_f32 v151, v151
 v_mfma_f32_16x16x32_bf16 a[60:63], a[172:175], v[236:239], a[60:63]
 s_waitcnt lgkmcnt(3)
 ds_read_b64_tr_b16 a[166:167], v20 offset:28672
 v_cvt_pk_bf16_f32 v179, v146, v147
 v_mfma_f32_16x16x32_bf16 v[128:131], a[128:131], v[80:83], v[160:163]
 v_exp_f32 v152, v152
 v_mfma_f32_16x16x32_bf16 v[128:131], a[132:135], v[96:99], v[128:131]
 ds_read_b64_tr_b16 a[168:169], v21 offset:16384
 v_cvt_pk_bf16_f32 v182, v148, v149
 v_mfma_f32_16x16x32_bf16 v[128:131], a[136:139], v[48:51], v[128:131]
 v_exp_f32 v153, v153
 v_mfma_f32_16x16x32_bf16 v[128:131], a[140:143], v[64:67], v[128:131]
 ds_read_b64_tr_b16 a[170:171], v21 offset:20480
 v_cvt_pk_bf16_f32 v183, v150, v151
 v_mfma_f32_16x16x32_bf16 v[132:135], a[128:131], v[84:87], v[164:167]
 v_exp_f32 v154, v154
 v_mfma_f32_16x16x32_bf16 v[132:135], a[132:135], v[100:103], v[132:135]
 ds_read_b64_tr_b16 a[172:173], v21 offset:24576
 v_add_f32 v126, v126, v152
 v_mfma_f32_16x16x32_bf16 v[132:135], a[136:139], v[52:55], v[132:135]
 v_exp_f32 v155, v155
 v_mfma_f32_16x16x32_bf16 v[132:135], a[140:143], v[68:71], v[132:135]
 ds_read_b64_tr_b16 a[174:175], v21 offset:28672
 v_add_f32 v126, v126, v153
 v_mfma_f32_16x16x32_bf16 v[136:139], a[128:131], v[88:91], v[168:171]
 s_add_u32 m0, s72, 65536
 v_exp_f32 v156, v156
 v_mfma_f32_16x16x32_bf16 v[136:139], a[132:135], v[104:107], v[136:139]
 buffer_load_dwordx4 v244, s[28:31], s76 offen offset:0 nt lds
 v_mfma_f32_16x16x32_bf16 v[136:139], a[136:139], v[56:59], v[136:139]
 v_exp_f32 v157, v157
 v_mfma_f32_16x16x32_bf16 v[136:139], a[140:143], v[72:75], v[136:139]
 v_cvt_pk_bf16_f32 v186, v152, v153
 v_add_f32 v126, v126, v154
 v_mfma_f32_16x16x32_bf16 v[140:143], a[128:131], v[92:95], v[172:175]
 v_exp_f32 v158, v158
 v_mfma_f32_16x16x32_bf16 v[140:143], a[132:135], v[108:111], v[140:143]
 v_add_f32 v126, v126, v155
 v_cvt_pk_bf16_f32 v187, v154, v155
 v_mfma_f32_16x16x32_bf16 v[140:143], a[136:139], v[60:63], v[140:143]
 v_exp_f32 v159, v159
 v_mfma_f32_16x16x32_bf16 v[140:143], a[140:143], v[76:79], v[140:143]
 s_waitcnt lgkmcnt(0)
 ds_read_b128 a[144:147], v246 offset:45056
 v_cvt_pk_bf16_f32 v190, v156, v157
 v_mfma_f32_16x16x32_bf16 a[64:67], a[160:163], v[208:211], a[64:67]
 v_exp_f32 v128, v128
 v_mfma_f32_16x16x32_bf16 a[64:67], a[164:167], v[224:227], a[64:67]
 ds_read_b128 a[148:151], v247 offset:45056
 v_cvt_pk_bf16_f32 v191, v158, v159
 v_mfma_f32_16x16x32_bf16 a[68:71], a[160:163], v[212:215], a[68:71]
 v_exp_f32 v129, v129
 v_mfma_f32_16x16x32_bf16 a[68:71], a[164:167], v[228:231], a[68:71]
 ds_read_b128 a[152:155], v248 offset:45056
 v_add_f32 v124, v124, v128
 v_mfma_f32_16x16x32_bf16 a[72:75], a[160:163], v[216:219], a[72:75]
 v_exp_f32 v130, v130
 v_mfma_f32_16x16x32_bf16 a[72:75], a[164:167], v[232:235], a[72:75]
 ds_read_b128 a[156:159], v249 offset:45056
 v_add_f32 v124, v124, v129
 v_mfma_f32_16x16x32_bf16 a[76:79], a[160:163], v[220:223], a[76:79]
 v_exp_f32 v131, v131
 v_mfma_f32_16x16x32_bf16 a[76:79], a[164:167], v[236:239], a[76:79]
 buffer_load_dwordx4 v245, s[28:31], s76 offen offset:1024 nt lds
 v_mfma_f32_16x16x32_bf16 a[80:83], a[168:171], v[208:211], a[80:83]
 v_exp_f32 v132, v132
 v_mfma_f32_16x16x32_bf16 a[80:83], a[172:175], v[224:227], a[80:83]
 ds_read_b64_tr_b16 a[160:161], v22 offset:16384
 v_cvt_pk_bf16_f32 v192, v128, v129
 v_mfma_f32_16x16x32_bf16 a[84:87], a[168:171], v[212:215], a[84:87]
 v_exp_f32 v133, v133
 v_mfma_f32_16x16x32_bf16 a[84:87], a[172:175], v[228:231], a[84:87]
 ds_read_b64_tr_b16 a[162:163], v22 offset:20480
 v_add_f32 v124, v124, v130
 v_mfma_f32_16x16x32_bf16 a[88:91], a[168:171], v[216:219], a[88:91]
 v_exp_f32 v134, v134
 v_mfma_f32_16x16x32_bf16 a[88:91], a[172:175], v[232:235], a[88:91]
 ds_read_b64_tr_b16 a[164:165], v22 offset:24576
 v_add_f32 v124, v124, v131
 v_mfma_f32_16x16x32_bf16 a[92:95], a[168:171], v[220:223], a[92:95]
 v_exp_f32 v135, v135
 v_mfma_f32_16x16x32_bf16 a[92:95], a[172:175], v[236:239], a[92:95]
 ds_read_b64_tr_b16 a[166:167], v22 offset:28672
 v_cvt_pk_bf16_f32 v193, v130, v131
 v_mfma_f32_16x16x32_bf16 a[200:203], a[192:195], v[220:223], a[200:203]
 v_cvt_pk_bf16_f32 v196, v132, v133
 v_cvt_pk_bf16_f32 v197, v134, v135
 v_mfma_f32_16x16x32_bf16 a[200:203], a[192:195], v[236:239], a[200:203]
 s_waitcnt lgkmcnt(4)
 v_mfma_f32_16x16x32_bf16 v[144:147], a[144:147], v[80:83], v[160:163]
 v_exp_f32 v136, v136
 v_mfma_f32_16x16x32_bf16 v[144:147], a[148:151], v[96:99], v[144:147]
 ds_read_b64_tr_b16 a[168:169], v23 offset:16384
 v_mfma_f32_16x16x32_bf16 v[144:147], a[152:155], v[48:51], v[144:147]
 v_exp_f32 v137, v137
 v_mfma_f32_16x16x32_bf16 v[144:147], a[156:159], v[64:67], v[144:147]
 ds_read_b64_tr_b16 a[170:171], v23 offset:20480
 v_add_f32 v126, v126, v136
 v_mfma_f32_16x16x32_bf16 v[148:151], a[144:147], v[84:87], v[164:167]
 v_exp_f32 v138, v138
 v_mfma_f32_16x16x32_bf16 v[148:151], a[148:151], v[100:103], v[148:151]
 ds_read_b64_tr_b16 a[172:173], v23 offset:24576
 v_add_f32 v126, v126, v137
 v_mfma_f32_16x16x32_bf16 v[148:151], a[152:155], v[52:55], v[148:151]
 v_exp_f32 v139, v139
 v_mfma_f32_16x16x32_bf16 v[148:151], a[156:159], v[68:71], v[148:151]
 ds_read_b64_tr_b16 a[174:175], v23 offset:28672
 v_cvt_pk_bf16_f32 v200, v136, v137
 v_mfma_f32_16x16x32_bf16 v[152:155], a[144:147], v[88:91], v[168:171]
 v_exp_f32 v140, v140
 v_mfma_f32_16x16x32_bf16 v[152:155], a[148:151], v[104:107], v[152:155]
 buffer_load_dwordx4 v244, s[28:31], s76 offen offset:2048 nt lds
 v_mfma_f32_16x16x32_bf16 v[152:155], a[152:155], v[56:59], v[152:155]
 v_exp_f32 v141, v141
 v_mfma_f32_16x16x32_bf16 v[152:155], a[156:159], v[72:75], v[152:155]
 v_add_f32 v126, v126, v138
 v_add_f32 v126, v126, v139
 v_mfma_f32_16x16x32_bf16 v[156:159], a[144:147], v[92:95], v[172:175]
 v_exp_f32 v142, v142
 v_mfma_f32_16x16x32_bf16 v[156:159], a[148:151], v[108:111], v[156:159]
 v_cvt_pk_bf16_f32 v201, v138, v139
 v_cvt_pk_bf16_f32 v204, v140, v141
 v_mfma_f32_16x16x32_bf16 v[156:159], a[152:155], v[60:63], v[156:159]
 v_exp_f32 v143, v143
 v_mfma_f32_16x16x32_bf16 v[156:159], a[156:159], v[76:79], v[156:159]
 s_waitcnt vmcnt(15) lgkmcnt(0)
 s_barrier
 ds_read_b128 a[128:131], v246 offset:49152
 v_mfma_f32_16x16x32_bf16 a[96:99], a[160:163], v[208:211], a[96:99]
 v_exp_f32 v144, v144
 v_mfma_f32_16x16x32_bf16 a[96:99], a[164:167], v[224:227], a[96:99]
 ds_read_b128 a[132:135], v247 offset:49152
 v_cvt_pk_bf16_f32 v205, v142, v143
 v_mfma_f32_16x16x32_bf16 a[100:103], a[160:163], v[212:215], a[100:103]
 v_exp_f32 v145, v145
 v_mfma_f32_16x16x32_bf16 a[100:103], a[164:167], v[228:231], a[100:103]
 ds_read_b128 a[136:139], v248 offset:49152
 v_add_f32 v124, v124, v144
 v_mfma_f32_16x16x32_bf16 a[104:107], a[160:163], v[216:219], a[104:107]
 v_exp_f32 v146, v146
 v_mfma_f32_16x16x32_bf16 a[104:107], a[164:167], v[232:235], a[104:107]
 ds_read_b128 a[140:143], v249 offset:49152
 v_add_f32 v124, v124, v145
 v_mfma_f32_16x16x32_bf16 a[108:111], a[160:163], v[220:223], a[108:111]
 v_exp_f32 v147, v147
 v_mfma_f32_16x16x32_bf16 a[108:111], a[164:167], v[236:239], a[108:111]
 buffer_load_dwordx4 v245, s[28:31], s76 offen offset:3072 nt lds
 v_mfma_f32_16x16x32_bf16 a[112:115], a[168:171], v[208:211], a[112:115]
 s_add_u32 s76, s76, 16384
 v_exp_f32 v148, v148
 v_mfma_f32_16x16x32_bf16 a[112:115], a[172:175], v[224:227], a[112:115]
 ds_read_b64_tr_b16 a[160:161], v16 offset:32768
 v_cvt_pk_bf16_f32 v194, v144, v145
 v_mfma_f32_16x16x32_bf16 a[116:119], a[168:171], v[212:215], a[116:119]
 v_exp_f32 v149, v149
 v_mfma_f32_16x16x32_bf16 a[116:119], a[172:175], v[228:231], a[116:119]
 ds_read_b64_tr_b16 a[162:163], v16 offset:36864
 v_add_f32 v124, v124, v146
 v_mfma_f32_16x16x32_bf16 a[120:123], a[168:171], v[216:219], a[120:123]
 v_exp_f32 v150, v150
 v_mfma_f32_16x16x32_bf16 a[120:123], a[172:175], v[232:235], a[120:123]
 ds_read_b64_tr_b16 a[164:165], v16 offset:40960
 v_add_f32 v124, v124, v147
 v_mfma_f32_16x16x32_bf16 a[124:127], a[168:171], v[220:223], a[124:127]
 v_exp_f32 v151, v151
 v_mfma_f32_16x16x32_bf16 a[124:127], a[172:175], v[236:239], a[124:127]
 s_waitcnt lgkmcnt(3)
 ds_read_b64_tr_b16 a[166:167], v16 offset:45056
 v_cvt_pk_bf16_f32 v195, v146, v147
L_att_p2:
 v_mfma_f32_16x16x32_bf16 v[128:131], a[128:131], v[80:83], v[160:163]
 v_exp_f32 v152, v152
 v_mfma_f32_16x16x32_bf16 v[128:131], a[132:135], v[96:99], v[128:131]
 ds_read_b64_tr_b16 a[168:169], v17 offset:32768
 v_cvt_pk_bf16_f32 v198, v148, v149
 v_mfma_f32_16x16x32_bf16 v[128:131], a[136:139], v[48:51], v[128:131]
 v_exp_f32 v153, v153
 v_mfma_f32_16x16x32_bf16 v[128:131], a[140:143], v[64:67], v[128:131]
 ds_read_b64_tr_b16 a[170:171], v17 offset:36864
 v_cvt_pk_bf16_f32 v199, v150, v151
 v_mfma_f32_16x16x32_bf16 v[132:135], a[128:131], v[84:87], v[164:167]
 v_exp_f32 v154, v154
 v_mfma_f32_16x16x32_bf16 v[132:135], a[132:135], v[100:103], v[132:135]
 ds_read_b64_tr_b16 a[172:173], v17 offset:40960
 v_add_f32 v126, v126, v152
 v_mfma_f32_16x16x32_bf16 v[132:135], a[136:139], v[52:55], v[132:135]
 v_exp_f32 v155, v155
 v_mfma_f32_16x16x32_bf16 v[132:135], a[140:143], v[68:71], v[132:135]
 ds_read_b64_tr_b16 a[174:175], v17 offset:45056
 v_add_f32 v126, v126, v153
 v_mfma_f32_16x16x32_bf16 v[136:139], a[128:131], v[88:91], v[168:171]
 s_add_u32 m0, s72, 32768
 v_exp_f32 v156, v156
 v_mfma_f32_16x16x32_bf16 v[136:139], a[132:135], v[104:107], v[136:139]
 buffer_load_dwordx4 v240, s[24:27], s76 offen offset:0 nt lds
 v_mfma_f32_16x16x32_bf16 v[136:139], a[136:139], v[56:59], v[136:139]
 v_exp_f32 v157, v157
 v_mfma_f32_16x16x32_bf16 v[136:139], a[140:143], v[72:75], v[136:139]
 v_cvt_pk_bf16_f32 v202, v152, v153
 v_add_f32 v126, v126, v154
 v_mfma_f32_16x16x32_bf16 v[140:143], a[128:131], v[92:95], v[172:175]
 v_exp_f32 v158, v158
 v_mfma_f32_16x16x32_bf16 v[140:143], a[132:135], v[108:111], v[140:143]
 v_add_f32 v126, v126, v155
 v_cvt_pk_bf16_f32 v203, v154, v155
 v_mfma_f32_16x16x32_bf16 v[140:143], a[136:139], v[60:63], v[140:143]
 v_exp_f32 v159, v159
 v_mfma_f32_16x16x32_bf16 v[140:143], a[140:143], v[76:79], v[140:143]
 s_waitcnt lgkmcnt(0)
 ds_read_b128 a[144:147], v246 offset:53248
 v_cvt_pk_bf16_f32 v206, v156, v157
 v_mfma_f32_16x16x32_bf16 a[0:3], a[160:163], v[176:179], a[0:3]
 v_exp_f32 v128, v128
 v_mfma_f32_16x16x32_bf16 a[0:3], a[164:167], v[192:195], a[0:3]
 ds_read_b128 a[148:151], v247 offset:53248
 v_cvt_pk_bf16_f32 v207, v158, v159
 v_mfma_f32_16x16x32_bf16 a[4:7], a[160:163], v[180:183], a[4:7]
 v_exp_f32 v129, v129
 v_mfma_f32_16x16x32_bf16 a[4:7], a[164:167], v[196:199], a[4:7]
 ds_read_b128 a[152:155], v248 offset:53248
 v_add_f32 v124, v124, v128
 v_mfma_f32_16x16x32_bf16 a[8:11], a[160:163], v[184:187], a[8:11]
 v_exp_f32 v130, v130
 v_mfma_f32_16x16x32_bf16 a[8:11], a[164:167], v[200:203], a[8:11]
 ds_read_b128 a[156:159], v249 offset:53248
 v_add_f32 v124, v124, v129
 v_mfma_f32_16x16x32_bf16 a[12:15], a[160:163], v[188:191], a[12:15]
 v_exp_f32 v131, v131
 v_mfma_f32_16x16x32_bf16 a[12:15], a[164:167], v[204:207], a[12:15]
 buffer_load_dwordx4 v241, s[24:27], s76 offen offset:1024 nt lds
 v_mfma_f32_16x16x32_bf16 a[16:19], a[168:171], v[176:179], a[16:19]
 v_exp_f32 v132, v132
 v_mfma_f32_16x16x32_bf16 a[16:19], a[172:175], v[192:195], a[16:19]
 ds_read_b64_tr_b16 a[160:161], v18 offset:32768
 v_cvt_pk_bf16_f32 v208, v128, v129
 v_mfma_f32_16x16x32_bf16 a[20:23], a[168:171], v[180:183], a[20:23]
 v_exp_f32 v133, v133
 v_mfma_f32_16x16x32_bf16 a[20:23], a[172:175], v[196:199], a[20:23]
 ds_read_b64_tr_b16 a[162:163], v18 offset:36864
 v_add_f32 v124, v124, v130
 v_mfma_f32_16x16x32_bf16 a[24:27], a[168:171], v[184:187], a[24:27]
 v_exp_f32 v134, v134
 v_mfma_f32_16x16x32_bf16 a[24:27], a[172:175], v[200:203], a[24:27]
 ds_read_b64_tr_b16 a[164:165], v18 offset:40960
 v_add_f32 v124, v124, v131
 v_mfma_f32_16x16x32_bf16 a[28:31], a[168:171], v[188:191], a[28:31]
 v_exp_f32 v135, v135
 v_mfma_f32_16x16x32_bf16 a[28:31], a[172:175], v[204:207], a[28:31]
 ds_read_b64_tr_b16 a[166:167], v18 offset:45056
 v_cvt_pk_bf16_f32 v209, v130, v131
 v_mfma_f32_16x16x32_bf16 a[196:199], a[192:195], v[180:183], a[196:199]
 v_cvt_pk_bf16_f32 v212, v132, v133
 v_cvt_pk_bf16_f32 v213, v134, v135
 v_mfma_f32_16x16x32_bf16 a[196:199], a[192:195], v[196:199], a[196:199]
 s_waitcnt lgkmcnt(4)
 v_mfma_f32_16x16x32_bf16 v[144:147], a[144:147], v[80:83], v[160:163]
 v_exp_f32 v136, v136
 v_mfma_f32_16x16x32_bf16 v[144:147], a[148:151], v[96:99], v[144:147]
 ds_read_b64_tr_b16 a[168:169], v19 offset:32768
 v_mfma_f32_16x16x32_bf16 v[144:147], a[152:155], v[48:51], v[144:147]
 v_exp_f32 v137, v137
 v_mfma_f32_16x16x32_bf16 v[144:147], a[156:159], v[64:67], v[144:147]
 ds_read_b64_tr_b16 a[170:171], v19 offset:36864
 v_add_f32 v126, v126, v136
 v_mfma_f32_16x16x32_bf16 v[148:151], a[144:147], v[84:87], v[164:167]
 v_exp_f32 v138, v138
 v_mfma_f32_16x16x32_bf16 v[148:151], a[148:151], v[100:103], v[148:151]
 ds_read_b64_tr_b16 a[172:173], v19 offset:40960
 v_add_f32 v126, v126, v137
 v_mfma_f32_16x16x32_bf16 v[148:151], a[152:155], v[52:55], v[148:151]
 v_exp_f32 v139, v139
 v_mfma_f32_16x16x32_bf16 v[148:151], a[156:159], v[68:71], v[148:151]
 ds_read_b64_tr_b16 a[174:175], v19 offset:45056
 v_cvt_pk_bf16_f32 v216, v136, v137
 v_mfma_f32_16x16x32_bf16 v[152:155], a[144:147], v[88:91], v[168:171]
 v_exp_f32 v140, v140
 v_mfma_f32_16x16x32_bf16 v[152:155], a[148:151], v[104:107], v[152:155]
 buffer_load_dwordx4 v242, s[24:27], s76 offen offset:2048 nt lds
 v_mfma_f32_16x16x32_bf16 v[152:155], a[152:155], v[56:59], v[152:155]
 v_exp_f32 v141, v141
 v_mfma_f32_16x16x32_bf16 v[152:155], a[156:159], v[72:75], v[152:155]
 v_add_f32 v126, v126, v138
 v_add_f32 v126, v126, v139
 v_mfma_f32_16x16x32_bf16 v[156:159], a[144:147], v[92:95], v[172:175]
 v_exp_f32 v142, v142
 v_mfma_f32_16x16x32_bf16 v[156:159], a[148:151], v[108:111], v[156:159]
 v_cvt_pk_bf16_f32 v217, v138, v139
 v_cvt_pk_bf16_f32 v220, v140, v141
 v_mfma_f32_16x16x32_bf16 v[156:159], a[152:155], v[60:63], v[156:159]
 v_exp_f32 v143, v143
 v_mfma_f32_16x16x32_bf16 v[156:159], a[156:159], v[76:79], v[156:159]
 s_waitcnt lgkmcnt(0)
 ds_read_b128 a[128:131], v246 offset:57344
 v_mfma_f32_16x16x32_bf16 a[32:35], a[160:163], v[176:179], a[32:35]
 v_exp_f32 v144, v144
 v_mfma_f32_16x16x32_bf16 a[32:35], a[164:167], v[192:195], a[32:35]
 ds_read_b128 a[132:135], v247 offset:57344
 v_cvt_pk_bf16_f32 v221, v142, v143
 v_mfma_f32_16x16x32_bf16 a[36:39], a[160:163], v[180:183], a[36:39]
 v_exp_f32 v145, v145
 v_mfma_f32_16x16x32_bf16 a[36:39], a[164:167], v[196:199], a[36:39]
 ds_read_b128 a[136:139], v248 offset:57344
 v_add_f32 v124, v124, v144
 v_mfma_f32_16x16x32_bf16 a[40:43], a[160:163], v[184:187], a[40:43]
 v_exp_f32 v146, v146
 v_mfma_f32_16x16x32_bf16 a[40:43], a[164:167], v[200:203], a[40:43]
 ds_read_b128 a[140:143], v249 offset:57344
 v_add_f32 v124, v124, v145
 v_mfma_f32_16x16x32_bf16 a[44:47], a[160:163], v[188:191], a[44:47]
 v_exp_f32 v147, v147
 v_mfma_f32_16x16x32_bf16 a[44:47], a[164:167], v[204:207], a[44:47]
 buffer_load_dwordx4 v243, s[24:27], s76 offen offset:3072 nt lds
 v_mfma_f32_16x16x32_bf16 a[48:51], a[168:171], v[176:179], a[48:51]
 v_exp_f32 v148, v148
 v_mfma_f32_16x16x32_bf16 a[48:51], a[172:175], v[192:195], a[48:51]
 ds_read_b64_tr_b16 a[160:161], v20 offset:32768
 v_cvt_pk_bf16_f32 v210, v144, v145
 v_mfma_f32_16x16x32_bf16 a[52:55], a[168:171], v[180:183], a[52:55]
 v_exp_f32 v149, v149
 v_mfma_f32_16x16x32_bf16 a[52:55], a[172:175], v[196:199], a[52:55]
 ds_read_b64_tr_b16 a[162:163], v20 offset:36864
 v_add_f32 v124, v124, v146
 v_mfma_f32_16x16x32_bf16 a[56:59], a[168:171], v[184:187], a[56:59]
 v_exp_f32 v150, v150
 v_mfma_f32_16x16x32_bf16 a[56:59], a[172:175], v[200:203], a[56:59]
 ds_read_b64_tr_b16 a[164:165], v20 offset:40960
 v_add_f32 v124, v124, v147
 v_mfma_f32_16x16x32_bf16 a[60:63], a[168:171], v[188:191], a[60:63]
 v_exp_f32 v151, v151
 v_mfma_f32_16x16x32_bf16 a[60:63], a[172:175], v[204:207], a[60:63]
 s_waitcnt lgkmcnt(3)
 ds_read_b64_tr_b16 a[166:167], v20 offset:45056
 v_cvt_pk_bf16_f32 v211, v146, v147
 v_mfma_f32_16x16x32_bf16 v[128:131], a[128:131], v[80:83], v[160:163]
 v_exp_f32 v152, v152
 v_mfma_f32_16x16x32_bf16 v[128:131], a[132:135], v[96:99], v[128:131]
 ds_read_b64_tr_b16 a[168:169], v21 offset:32768
 v_cvt_pk_bf16_f32 v214, v148, v149
 v_mfma_f32_16x16x32_bf16 v[128:131], a[136:139], v[48:51], v[128:131]
 v_exp_f32 v153, v153
 v_mfma_f32_16x16x32_bf16 v[128:131], a[140:143], v[64:67], v[128:131]
 ds_read_b64_tr_b16 a[170:171], v21 offset:36864
 v_cvt_pk_bf16_f32 v215, v150, v151
 v_mfma_f32_16x16x32_bf16 v[132:135], a[128:131], v[84:87], v[164:167]
 v_exp_f32 v154, v154
 v_mfma_f32_16x16x32_bf16 v[132:135], a[132:135], v[100:103], v[132:135]
 ds_read_b64_tr_b16 a[172:173], v21 offset:40960
 v_add_f32 v126, v126, v152
 v_mfma_f32_16x16x32_bf16 v[132:135], a[136:139], v[52:55], v[132:135]
 v_exp_f32 v155, v155
 v_mfma_f32_16x16x32_bf16 v[132:135], a[140:143], v[68:71], v[132:135]
 ds_read_b64_tr_b16 a[174:175], v21 offset:45056
 v_add_f32 v126, v126, v153
 v_mfma_f32_16x16x32_bf16 v[136:139], a[128:131], v[88:91], v[168:171]
 s_add_u32 m0, s72, 81920
 v_exp_f32 v156, v156
 v_mfma_f32_16x16x32_bf16 v[136:139], a[132:135], v[104:107], v[136:139]
 buffer_load_dwordx4 v244, s[28:31], s76 offen offset:0 nt lds
 v_mfma_f32_16x16x32_bf16 v[136:139], a[136:139], v[56:59], v[136:139]
 v_exp_f32 v157, v157
 v_mfma_f32_16x16x32_bf16 v[136:139], a[140:143], v[72:75], v[136:139]
 v_cvt_pk_bf16_f32 v218, v152, v153
 v_add_f32 v126, v126, v154
 v_mfma_f32_16x16x32_bf16 v[140:143], a[128:131], v[92:95], v[172:175]
 v_exp_f32 v158, v158
 v_mfma_f32_16x16x32_bf16 v[140:143], a[132:135], v[108:111], v[140:143]
 v_add_f32 v126, v126, v155
 v_cvt_pk_bf16_f32 v219, v154, v155
 v_mfma_f32_16x16x32_bf16 v[140:143], a[136:139], v[60:63], v[140:143]
 v_exp_f32 v159, v159
 v_mfma_f32_16x16x32_bf16 v[140:143], a[140:143], v[76:79], v[140:143]
 s_waitcnt lgkmcnt(0)
 ds_read_b128 a[144:147], v246 offset:61440
 v_cvt_pk_bf16_f32 v222, v156, v157
 v_mfma_f32_16x16x32_bf16 a[64:67], a[160:163], v[176:179], a[64:67]
 v_exp_f32 v128, v128
 v_mfma_f32_16x16x32_bf16 a[64:67], a[164:167], v[192:195], a[64:67]
 ds_read_b128 a[148:151], v247 offset:61440
 v_cvt_pk_bf16_f32 v223, v158, v159
 v_mfma_f32_16x16x32_bf16 a[68:71], a[160:163], v[180:183], a[68:71]
 v_exp_f32 v129, v129
 v_mfma_f32_16x16x32_bf16 a[68:71], a[164:167], v[196:199], a[68:71]
 ds_read_b128 a[152:155], v248 offset:61440
 v_add_f32 v124, v124, v128
 v_mfma_f32_16x16x32_bf16 a[72:75], a[160:163], v[184:187], a[72:75]
 v_exp_f32 v130, v130
 v_mfma_f32_16x16x32_bf16 a[72:75], a[164:167], v[200:203], a[72:75]
 ds_read_b128 a[156:159], v249 offset:61440
 v_add_f32 v124, v124, v129
 v_mfma_f32_16x16x32_bf16 a[76:79], a[160:163], v[188:191], a[76:79]
 v_exp_f32 v131, v131
 v_mfma_f32_16x16x32_bf16 a[76:79], a[164:167], v[204:207], a[76:79]
 buffer_load_dwordx4 v245, s[28:31], s76 offen offset:1024 nt lds
 v_mfma_f32_16x16x32_bf16 a[80:83], a[168:171], v[176:179], a[80:83]
 v_exp_f32 v132, v132
 v_mfma_f32_16x16x32_bf16 a[80:83], a[172:175], v[192:195], a[80:83]
 ds_read_b64_tr_b16 a[160:161], v22 offset:32768
 v_cvt_pk_bf16_f32 v224, v128, v129
 v_mfma_f32_16x16x32_bf16 a[84:87], a[168:171], v[180:183], a[84:87]
 v_exp_f32 v133, v133
 v_mfma_f32_16x16x32_bf16 a[84:87], a[172:175], v[196:199], a[84:87]
 ds_read_b64_tr_b16 a[162:163], v22 offset:36864
 v_add_f32 v124, v124, v130
 v_mfma_f32_16x16x32_bf16 a[88:91], a[168:171], v[184:187], a[88:91]
 v_exp_f32 v134, v134
 v_mfma_f32_16x16x32_bf16 a[88:91], a[172:175], v[200:203], a[88:91]
 ds_read_b64_tr_b16 a[164:165], v22 offset:40960
 v_add_f32 v124, v124, v131
 v_mfma_f32_16x16x32_bf16 a[92:95], a[168:171], v[188:191], a[92:95]
 v_exp_f32 v135, v135
 v_mfma_f32_16x16x32_bf16 a[92:95], a[172:175], v[204:207], a[92:95]
 ds_read_b64_tr_b16 a[166:167], v22 offset:45056
 v_cvt_pk_bf16_f32 v225, v130, v131
 v_mfma_f32_16x16x32_bf16 a[200:203], a[192:195], v[188:191], a[200:203]
 v_cvt_pk_bf16_f32 v228, v132, v133
 v_cvt_pk_bf16_f32 v229, v134, v135
 v_mfma_f32_16x16x32_bf16 a[200:203], a[192:195], v[204:207], a[200:203]
 s_waitcnt lgkmcnt(4)
 v_mfma_f32_16x16x32_bf16 v[144:147], a[144:147], v[80:83], v[160:163]
 v_exp_f32 v136, v136
 v_mfma_f32_16x16x32_bf16 v[144:147], a[148:151], v[96:99], v[144:147]
 ds_read_b64_tr_b16 a[168:169], v23 offset:32768
 v_mfma_f32_16x16x32_bf16 v[144:147], a[152:155], v[48:51], v[144:147]
 v_exp_f32 v137, v137
 v_mfma_f32_16x16x32_bf16 v[144:147], a[156:159], v[64:67], v[144:147]
 ds_read_b64_tr_b16 a[170:171], v23 offset:36864
 v_add_f32 v126, v126, v136
 v_mfma_f32_16x16x32_bf16 v[148:151], a[144:147], v[84:87], v[164:167]
 v_exp_f32 v138, v138
 v_mfma_f32_16x16x32_bf16 v[148:151], a[148:151], v[100:103], v[148:151]
 ds_read_b64_tr_b16 a[172:173], v23 offset:40960
 v_add_f32 v126, v126, v137
 v_mfma_f32_16x16x32_bf16 v[148:151], a[152:155], v[52:55], v[148:151]
 v_exp_f32 v139, v139
 v_mfma_f32_16x16x32_bf16 v[148:151], a[156:159], v[68:71], v[148:151]
 ds_read_b64_tr_b16 a[174:175], v23 offset:45056
 v_cvt_pk_bf16_f32 v232, v136, v137
 v_mfma_f32_16x16x32_bf16 v[152:155], a[144:147], v[88:91], v[168:171]
 v_exp_f32 v140, v140
 v_mfma_f32_16x16x32_bf16 v[152:155], a[148:151], v[104:107], v[152:155]
 buffer_load_dwordx4 v244, s[28:31], s76 offen offset:2048 nt lds
 v_mfma_f32_16x16x32_bf16 v[152:155], a[152:155], v[56:59], v[152:155]
 v_exp_f32 v141, v141
 v_mfma_f32_16x16x32_bf16 v[152:155], a[156:159], v[72:75], v[152:155]
 v_add_f32 v126, v126, v138
 v_add_f32 v126, v126, v139
 v_mfma_f32_16x16x32_bf16 v[156:159], a[144:147], v[92:95], v[172:175]
 v_exp_f32 v142, v142
 v_mfma_f32_16x16x32_bf16 v[156:159], a[148:151], v[108:111], v[156:159]
 v_cvt_pk_bf16_f32 v233, v138, v139
 v_cvt_pk_bf16_f32 v236, v140, v141
 v_mfma_f32_16x16x32_bf16 v[156:159], a[152:155], v[60:63], v[156:159]
 v_exp_f32 v143, v143
 v_mfma_f32_16x16x32_bf16 v[156:159], a[156:159], v[76:79], v[156:159]
 s_waitcnt vmcnt(15) lgkmcnt(0)
 s_barrier
 ds_read_b128 a[128:131], v246 offset:0
 v_mfma_f32_16x16x32_bf16 a[96:99], a[160:163], v[176:179], a[96:99]
 v_exp_f32 v144, v144
 v_mfma_f32_16x16x32_bf16 a[96:99], a[164:167], v[192:195], a[96:99]
 ds_read_b128 a[132:135], v247 offset:0
 v_cvt_pk_bf16_f32 v237, v142, v143
 v_mfma_f32_16x16x32_bf16 a[100:103], a[160:163], v[180:183], a[100:103]
 v_exp_f32 v145, v145
 v_mfma_f32_16x16x32_bf16 a[100:103], a[164:167], v[196:199], a[100:103]
 ds_read_b128 a[136:139], v248 offset:0
 v_add_f32 v124, v124, v144
 v_mfma_f32_16x16x32_bf16 a[104:107], a[160:163], v[184:187], a[104:107]
 v_exp_f32 v146, v146
 v_mfma_f32_16x16x32_bf16 a[104:107], a[164:167], v[200:203], a[104:107]
 ds_read_b128 a[140:143], v249 offset:0
 v_add_f32 v124, v124, v145
 v_mfma_f32_16x16x32_bf16 a[108:111], a[160:163], v[188:191], a[108:111]
 v_exp_f32 v147, v147
 v_mfma_f32_16x16x32_bf16 a[108:111], a[164:167], v[204:207], a[108:111]
 buffer_load_dwordx4 v245, s[28:31], s76 offen offset:3072 nt lds
 v_mfma_f32_16x16x32_bf16 a[112:115], a[168:171], v[176:179], a[112:115]
 s_add_u32 s76, s76, 16384
 v_exp_f32 v148, v148
 v_mfma_f32_16x16x32_bf16 a[112:115], a[172:175], v[192:195], a[112:115]
 ds_read_b64_tr_b16 a[160:161], v16 offset:49152
 v_cvt_pk_bf16_f32 v226, v144, v145
 v_mfma_f32_16x16x32_bf16 a[116:119], a[168:171], v[180:183], a[116:119]
 v_exp_f32 v149, v149
 v_mfma_f32_16x16x32_bf16 a[116:119], a[172:175], v[196:199], a[116:119]
 ds_read_b64_tr_b16 a[162:163], v16 offset:53248
 v_add_f32 v124, v124, v146
 v_mfma_f32_16x16x32_bf16 a[120:123], a[168:171], v[184:187], a[120:123]
 v_exp_f32 v150, v150
 v_mfma_f32_16x16x32_bf16 a[120:123], a[172:175], v[200:203], a[120:123]
 ds_read_b64_tr_b16 a[164:165], v16 offset:57344
 v_add_f32 v124, v124, v147
 v_mfma_f32_16x16x32_bf16 a[124:127], a[168:171], v[188:191], a[124:127]
 v_exp_f32 v151, v151
 v_mfma_f32_16x16x32_bf16 a[124:127], a[172:175], v[204:207], a[124:127]
 s_waitcnt lgkmcnt(3)
 ds_read_b64_tr_b16 a[166:167], v16 offset:61440
 v_cvt_pk_bf16_f32 v227, v146, v147
 v_mfma_f32_16x16x32_bf16 v[128:131], a[128:131], v[80:83], v[160:163]
 v_exp_f32 v152, v152
 v_mfma_f32_16x16x32_bf16 v[128:131], a[132:135], v[96:99], v[128:131]
 ds_read_b64_tr_b16 a[168:169], v17 offset:49152
 v_cvt_pk_bf16_f32 v230, v148, v149
 v_mfma_f32_16x16x32_bf16 v[128:131], a[136:139], v[48:51], v[128:131]
 v_exp_f32 v153, v153
 v_mfma_f32_16x16x32_bf16 v[128:131], a[140:143], v[64:67], v[128:131]
 ds_read_b64_tr_b16 a[170:171], v17 offset:53248
 v_cvt_pk_bf16_f32 v231, v150, v151
 v_mfma_f32_16x16x32_bf16 v[132:135], a[128:131], v[84:87], v[164:167]
 v_exp_f32 v154, v154
 v_mfma_f32_16x16x32_bf16 v[132:135], a[132:135], v[100:103], v[132:135]
 ds_read_b64_tr_b16 a[172:173], v17 offset:57344
 v_add_f32 v126, v126, v152
 v_mfma_f32_16x16x32_bf16 v[132:135], a[136:139], v[52:55], v[132:135]
 v_exp_f32 v155, v155
 v_mfma_f32_16x16x32_bf16 v[132:135], a[140:143], v[68:71], v[132:135]
 ds_read_b64_tr_b16 a[174:175], v17 offset:61440
 v_add_f32 v126, v126, v153
 v_mfma_f32_16x16x32_bf16 v[136:139], a[128:131], v[88:91], v[168:171]
 s_add_u32 m0, s72, 49152
 v_exp_f32 v156, v156
 v_mfma_f32_16x16x32_bf16 v[136:139], a[132:135], v[104:107], v[136:139]
 buffer_load_dwordx4 v240, s[24:27], s76 offen offset:0 nt lds
 v_mfma_f32_16x16x32_bf16 v[136:139], a[136:139], v[56:59], v[136:139]
 v_exp_f32 v157, v157
 v_mfma_f32_16x16x32_bf16 v[136:139], a[140:143], v[72:75], v[136:139]
 v_cvt_pk_bf16_f32 v234, v152, v153
 v_add_f32 v126, v126, v154
 v_mfma_f32_16x16x32_bf16 v[140:143], a[128:131], v[92:95], v[172:175]
 v_exp_f32 v158, v158
 v_mfma_f32_16x16x32_bf16 v[140:143], a[132:135], v[108:111], v[140:143]
 v_add_f32 v126, v126, v155
 v_cvt_pk_bf16_f32 v235, v154, v155
 v_mfma_f32_16x16x32_bf16 v[140:143], a[136:139], v[60:63], v[140:143]
 v_exp_f32 v159, v159
 v_mfma_f32_16x16x32_bf16 v[140:143], a[140:143], v[76:79], v[140:143]
 s_waitcnt lgkmcnt(0)
 ds_read_b128 a[144:147], v246 offset:4096
 v_cvt_pk_bf16_f32 v238, v156, v157
 v_mfma_f32_16x16x32_bf16 a[0:3], a[160:163], v[208:211], a[0:3]
 v_exp_f32 v128, v128
 v_mfma_f32_16x16x32_bf16 a[0:3], a[164:167], v[224:227], a[0:3]
 ds_read_b128 a[148:151], v247 offset:4096
 v_cvt_pk_bf16_f32 v239, v158, v159
 v_mfma_f32_16x16x32_bf16 a[4:7], a[160:163], v[212:215], a[4:7]
 v_exp_f32 v129, v129
 v_mfma_f32_16x16x32_bf16 a[4:7], a[164:167], v[228:231], a[4:7]
 ds_read_b128 a[152:155], v248 offset:4096
 v_add_f32 v124, v124, v128
 v_mfma_f32_16x16x32_bf16 a[8:11], a[160:163], v[216:219], a[8:11]
 v_exp_f32 v130, v130
 v_mfma_f32_16x16x32_bf16 a[8:11], a[164:167], v[232:235], a[8:11]
 ds_read_b128 a[156:159], v249 offset:4096
 v_add_f32 v124, v124, v129
 v_mfma_f32_16x16x32_bf16 a[12:15], a[160:163], v[220:223], a[12:15]
 v_exp_f32 v131, v131
 v_mfma_f32_16x16x32_bf16 a[12:15], a[164:167], v[236:239], a[12:15]
 buffer_load_dwordx4 v241, s[24:27], s76 offen offset:1024 nt lds
 v_mfma_f32_16x16x32_bf16 a[16:19], a[168:171], v[208:211], a[16:19]
 v_exp_f32 v132, v132
 v_mfma_f32_16x16x32_bf16 a[16:19], a[172:175], v[224:227], a[16:19]
 ds_read_b64_tr_b16 a[160:161], v18 offset:49152
 v_cvt_pk_bf16_f32 v176, v128, v129
 v_mfma_f32_16x16x32_bf16 a[20:23], a[168:171], v[212:215], a[20:23]
 v_exp_f32 v133, v133
 v_mfma_f32_16x16x32_bf16 a[20:23], a[172:175], v[228:231], a[20:23]
 ds_read_b64_tr_b16 a[162:163], v18 offset:53248
 v_add_f32 v124, v124, v130
 v_mfma_f32_16x16x32_bf16 a[24:27], a[168:171], v[216:219], a[24:27]
 v_exp_f32 v134, v134
 v_mfma_f32_16x16x32_bf16 a[24:27], a[172:175], v[232:235], a[24:27]
 ds_read_b64_tr_b16 a[164:165], v18 offset:57344
 v_add_f32 v124, v124, v131
 v_mfma_f32_16x16x32_bf16 a[28:31], a[168:171], v[220:223], a[28:31]
 v_exp_f32 v135, v135
 v_mfma_f32_16x16x32_bf16 a[28:31], a[172:175], v[236:239], a[28:31]
 ds_read_b64_tr_b16 a[166:167], v18 offset:61440
 v_cvt_pk_bf16_f32 v177, v130, v131
 v_mfma_f32_16x16x32_bf16 a[196:199], a[192:195], v[212:215], a[196:199]
 v_cvt_pk_bf16_f32 v180, v132, v133
 v_cvt_pk_bf16_f32 v181, v134, v135
 v_mfma_f32_16x16x32_bf16 a[196:199], a[192:195], v[228:231], a[196:199]
 s_waitcnt lgkmcnt(4)
 v_mfma_f32_16x16x32_bf16 v[144:147], a[144:147], v[80:83], v[160:163]
 v_exp_f32 v136, v136
 v_mfma_f32_16x16x32_bf16 v[144:147], a[148:151], v[96:99], v[144:147]
 ds_read_b64_tr_b16 a[168:169], v19 offset:49152
 v_mfma_f32_16x16x32_bf16 v[144:147], a[152:155], v[48:51], v[144:147]
 v_exp_f32 v137, v137
 v_mfma_f32_16x16x32_bf16 v[144:147], a[156:159], v[64:67], v[144:147]
 ds_read_b64_tr_b16 a[170:171], v19 offset:53248
 v_add_f32 v126, v126, v136
 v_mfma_f32_16x16x32_bf16 v[148:151], a[144:147], v[84:87], v[164:167]
 v_exp_f32 v138, v138
 v_mfma_f32_16x16x32_bf16 v[148:151], a[148:151], v[100:103], v[148:151]
 ds_read_b64_tr_b16 a[172:173], v19 offset:57344
 v_add_f32 v126, v126, v137
 v_mfma_f32_16x16x32_bf16 v[148:151], a[152:155], v[52:55], v[148:151]
 v_exp_f32 v139, v139
 v_mfma_f32_16x16x32_bf16 v[148:151], a[156:159], v[68:71], v[148:151]
 ds_read_b64_tr_b16 a[174:175], v19 offset:61440
 v_cvt_pk_bf16_f32 v184, v136, v137
 v_mfma_f32_16x16x32_bf16 v[152:155], a[144:147], v[88:91], v[168:171]
 v_exp_f32 v140, v140
 v_mfma_f32_16x16x32_bf16 v[152:155], a[148:151], v[104:107], v[152:155]
 buffer_load_dwordx4 v242, s[24:27], s76 offen offset:2048 nt lds
 v_mfma_f32_16x16x32_bf16 v[152:155], a[152:155], v[56:59], v[152:155]
 v_exp_f32 v141, v141
 v_mfma_f32_16x16x32_bf16 v[152:155], a[156:159], v[72:75], v[152:155]
 v_add_f32 v126, v126, v138
 v_add_f32 v126, v126, v139
 v_mfma_f32_16x16x32_bf16 v[156:159], a[144:147], v[92:95], v[172:175]
 v_exp_f32 v142, v142
 v_mfma_f32_16x16x32_bf16 v[156:159], a[148:151], v[108:111], v[156:159]
 v_cvt_pk_bf16_f32 v185, v138, v139
 v_cvt_pk_bf16_f32 v188, v140, v141
 v_mfma_f32_16x16x32_bf16 v[156:159], a[152:155], v[60:63], v[156:159]
 v_exp_f32 v143, v143
 v_mfma_f32_16x16x32_bf16 v[156:159], a[156:159], v[76:79], v[156:159]
 s_waitcnt lgkmcnt(0)
 ds_read_b128 a[128:131], v246 offset:8192
 v_mfma_f32_16x16x32_bf16 a[32:35], a[160:163], v[208:211], a[32:35]
 v_exp_f32 v144, v144
 v_mfma_f32_16x16x32_bf16 a[32:35], a[164:167], v[224:227], a[32:35]
 ds_read_b128 a[132:135], v247 offset:8192
 v_cvt_pk_bf16_f32 v189, v142, v143
 v_mfma_f32_16x16x32_bf16 a[36:39], a[160:163], v[212:215], a[36:39]
 v_exp_f32 v145, v145
 v_mfma_f32_16x16x32_bf16 a[36:39], a[164:167], v[228:231], a[36:39]
 ds_read_b128 a[136:139], v248 offset:8192
 v_add_f32 v124, v124, v144
 v_mfma_f32_16x16x32_bf16 a[40:43], a[160:163], v[216:219], a[40:43]
 v_exp_f32 v146, v146
 v_mfma_f32_16x16x32_bf16 a[40:43], a[164:167], v[232:235], a[40:43]
 ds_read_b128 a[140:143], v249 offset:8192
 v_add_f32 v124, v124, v145
 v_mfma_f32_16x16x32_bf16 a[44:47], a[160:163], v[220:223], a[44:47]
 v_exp_f32 v147, v147
 v_mfma_f32_16x16x32_bf16 a[44:47], a[164:167], v[236:239], a[44:47]
 buffer_load_dwordx4 v243, s[24:27], s76 offen offset:3072 nt lds
 v_mfma_f32_16x16x32_bf16 a[48:51], a[168:171], v[208:211], a[48:51]
 v_exp_f32 v148, v148
 v_mfma_f32_16x16x32_bf16 a[48:51], a[172:175], v[224:227], a[48:51]
 ds_read_b64_tr_b16 a[160:161], v20 offset:49152
 v_cvt_pk_bf16_f32 v178, v144, v145
 v_mfma_f32_16x16x32_bf16 a[52:55], a[168:171], v[212:215], a[52:55]
 v_exp_f32 v149, v149
 v_mfma_f32_16x16x32_bf16 a[52:55], a[172:175], v[228:231], a[52:55]
 ds_read_b64_tr_b16 a[162:163], v20 offset:53248
 v_add_f32 v124, v124, v146
 v_mfma_f32_16x16x32_bf16 a[56:59], a[168:171], v[216:219], a[56:59]
 v_exp_f32 v150, v150
 v_mfma_f32_16x16x32_bf16 a[56:59], a[172:175], v[232:235], a[56:59]
 ds_read_b64_tr_b16 a[164:165], v20 offset:57344
 v_add_f32 v124, v124, v147
 v_mfma_f32_16x16x32_bf16 a[60:63], a[168:171], v[220:223], a[60:63]
 v_exp_f32 v151, v151
 v_mfma_f32_16x16x32_bf16 a[60:63], a[172:175], v[236:239], a[60:63]
 s_waitcnt lgkmcnt(3)
 ds_read_b64_tr_b16 a[166:167], v20 offset:61440
 v_cvt_pk_bf16_f32 v179, v146, v147
 v_mfma_f32_16x16x32_bf16 v[128:131], a[128:131], v[80:83], v[160:163]
 v_exp_f32 v152, v152
 v_mfma_f32_16x16x32_bf16 v[128:131], a[132:135], v[96:99], v[128:131]
 ds_read_b64_tr_b16 a[168:169], v21 offset:49152
 v_cvt_pk_bf16_f32 v182, v148, v149
 v_mfma_f32_16x16x32_bf16 v[128:131], a[136:139], v[48:51], v[128:131]
 v_exp_f32 v153, v153
 v_mfma_f32_16x16x32_bf16 v[128:131], a[140:143], v[64:67], v[128:131]
 ds_read_b64_tr_b16 a[170:171], v21 offset:53248
 v_cvt_pk_bf16_f32 v183, v150, v151
 v_mfma_f32_16x16x32_bf16 v[132:135], a[128:131], v[84:87], v[164:167]
 v_exp_f32 v154, v154
 v_mfma_f32_16x16x32_bf16 v[132:135], a[132:135], v[100:103], v[132:135]
 ds_read_b64_tr_b16 a[172:173], v21 offset:57344
 v_add_f32 v126, v126, v152
 v_mfma_f32_16x16x32_bf16 v[132:135], a[136:139], v[52:55], v[132:135]
 v_exp_f32 v155, v155
 v_mfma_f32_16x16x32_bf16 v[132:135], a[140:143], v[68:71], v[132:135]
 ds_read_b64_tr_b16 a[174:175], v21 offset:61440
 v_add_f32 v126, v126, v153
 v_mfma_f32_16x16x32_bf16 v[136:139], a[128:131], v[88:91], v[168:171]
 s_add_u32 m0, s72, 98304
 v_exp_f32 v156, v156
 v_mfma_f32_16x16x32_bf16 v[136:139], a[132:135], v[104:107], v[136:139]
 buffer_load_dwordx4 v244, s[28:31], s76 offen offset:0 nt lds
 v_mfma_f32_16x16x32_bf16 v[136:139], a[136:139], v[56:59], v[136:139]
 v_exp_f32 v157, v157
 v_mfma_f32_16x16x32_bf16 v[136:139], a[140:143], v[72:75], v[136:139]
 v_cvt_pk_bf16_f32 v186, v152, v153
 v_add_f32 v126, v126, v154
 v_mfma_f32_16x16x32_bf16 v[140:143], a[128:131], v[92:95], v[172:175]
 v_exp_f32 v158, v158
 v_mfma_f32_16x16x32_bf16 v[140:143], a[132:135], v[108:111], v[140:143]
 v_add_f32 v126, v126, v155
 v_cvt_pk_bf16_f32 v187, v154, v155
 v_mfma_f32_16x16x32_bf16 v[140:143], a[136:139], v[60:63], v[140:143]
 v_exp_f32 v159, v159
 v_mfma_f32_16x16x32_bf16 v[140:143], a[140:143], v[76:79], v[140:143]
 s_waitcnt lgkmcnt(0)
 ds_read_b128 a[144:147], v246 offset:12288
 v_cvt_pk_bf16_f32 v190, v156, v157
 v_mfma_f32_16x16x32_bf16 a[64:67], a[160:163], v[208:211], a[64:67]
 v_exp_f32 v128, v128
 v_mfma_f32_16x16x32_bf16 a[64:67], a[164:167], v[224:227], a[64:67]
 ds_read_b128 a[148:151], v247 offset:12288
 v_cvt_pk_bf16_f32 v191, v158, v159
 v_mfma_f32_16x16x32_bf16 a[68:71], a[160:163], v[212:215], a[68:71]
 v_exp_f32 v129, v129
 v_mfma_f32_16x16x32_bf16 a[68:71], a[164:167], v[228:231], a[68:71]
 ds_read_b128 a[152:155], v248 offset:12288
 v_add_f32 v124, v124, v128
 v_mfma_f32_16x16x32_bf16 a[72:75], a[160:163], v[216:219], a[72:75]
 v_exp_f32 v130, v130
 v_mfma_f32_16x16x32_bf16 a[72:75], a[164:167], v[232:235], a[72:75]
 ds_read_b128 a[156:159], v249 offset:12288
 v_add_f32 v124, v124, v129
 v_mfma_f32_16x16x32_bf16 a[76:79], a[160:163], v[220:223], a[76:79]
 v_exp_f32 v131, v131
 v_mfma_f32_16x16x32_bf16 a[76:79], a[164:167], v[236:239], a[76:79]
 buffer_load_dwordx4 v245, s[28:31], s76 offen offset:1024 nt lds
 v_mfma_f32_16x16x32_bf16 a[80:83], a[168:171], v[208:211], a[80:83]
 v_exp_f32 v132, v132
 v_mfma_f32_16x16x32_bf16 a[80:83], a[172:175], v[224:227], a[80:83]
 ds_read_b64_tr_b16 a[160:161], v22 offset:49152
 v_cvt_pk_bf16_f32 v192, v128, v129
 v_mfma_f32_16x16x32_bf16 a[84:87], a[168:171], v[212:215], a[84:87]
 v_exp_f32 v133, v133
 v_mfma_f32_16x16x32_bf16 a[84:87], a[172:175], v[228:231], a[84:87]
 ds_read_b64_tr_b16 a[162:163], v22 offset:53248
 v_add_f32 v124, v124, v130
 v_mfma_f32_16x16x32_bf16 a[88:91], a[168:171], v[216:219], a[88:91]
 v_exp_f32 v134, v134
 v_mfma_f32_16x16x32_bf16 a[88:91], a[172:175], v[232:235], a[88:91]
 ds_read_b64_tr_b16 a[164:165], v22 offset:57344
 v_add_f32 v124, v124, v131
 v_mfma_f32_16x16x32_bf16 a[92:95], a[168:171], v[220:223], a[92:95]
 v_exp_f32 v135, v135
 v_mfma_f32_16x16x32_bf16 a[92:95], a[172:175], v[236:239], a[92:95]
 ds_read_b64_tr_b16 a[166:167], v22 offset:61440
 v_cvt_pk_bf16_f32 v193, v130, v131
 v_mfma_f32_16x16x32_bf16 a[200:203], a[192:195], v[220:223], a[200:203]
 v_cvt_pk_bf16_f32 v196, v132, v133
 v_cvt_pk_bf16_f32 v197, v134, v135
 v_mfma_f32_16x16x32_bf16 a[200:203], a[192:195], v[236:239], a[200:203]
 s_waitcnt lgkmcnt(4)
 v_mfma_f32_16x16x32_bf16 v[144:147], a[144:147], v[80:83], v[160:163]
 v_exp_f32 v136, v136
 v_mfma_f32_16x16x32_bf16 v[144:147], a[148:151], v[96:99], v[144:147]
 ds_read_b64_tr_b16 a[168:169], v23 offset:49152
 v_mfma_f32_16x16x32_bf16 v[144:147], a[152:155], v[48:51], v[144:147]
 v_exp_f32 v137, v137
 v_mfma_f32_16x16x32_bf16 v[144:147], a[156:159], v[64:67], v[144:147]
 ds_read_b64_tr_b16 a[170:171], v23 offset:53248
 v_add_f32 v126, v126, v136
 v_mfma_f32_16x16x32_bf16 v[148:151], a[144:147], v[84:87], v[164:167]
 v_exp_f32 v138, v138
 v_mfma_f32_16x16x32_bf16 v[148:151], a[148:151], v[100:103], v[148:151]
 ds_read_b64_tr_b16 a[172:173], v23 offset:57344
 v_add_f32 v126, v126, v137
 v_mfma_f32_16x16x32_bf16 v[148:151], a[152:155], v[52:55], v[148:151]
 v_exp_f32 v139, v139
 v_mfma_f32_16x16x32_bf16 v[148:151], a[156:159], v[68:71], v[148:151]
 ds_read_b64_tr_b16 a[174:175], v23 offset:61440
 v_cvt_pk_bf16_f32 v200, v136, v137
 v_mfma_f32_16x16x32_bf16 v[152:155], a[144:147], v[88:91], v[168:171]
 v_exp_f32 v140, v140
 v_mfma_f32_16x16x32_bf16 v[152:155], a[148:151], v[104:107], v[152:155]
 buffer_load_dwordx4 v244, s[28:31], s76 offen offset:2048 nt lds
 v_mfma_f32_16x16x32_bf16 v[152:155], a[152:155], v[56:59], v[152:155]
 v_exp_f32 v141, v141
 v_mfma_f32_16x16x32_bf16 v[152:155], a[156:159], v[72:75], v[152:155]
 v_add_f32 v126, v126, v138
 v_add_f32 v126, v126, v139
 v_mfma_f32_16x16x32_bf16 v[156:159], a[144:147], v[92:95], v[172:175]
 v_exp_f32 v142, v142
 v_mfma_f32_16x16x32_bf16 v[156:159], a[148:151], v[108:111], v[156:159]
 v_cvt_pk_bf16_f32 v201, v138, v139
 v_cvt_pk_bf16_f32 v204, v140, v141
 v_mfma_f32_16x16x32_bf16 v[156:159], a[152:155], v[60:63], v[156:159]
 v_exp_f32 v143, v143
 v_mfma_f32_16x16x32_bf16 v[156:159], a[156:159], v[76:79], v[156:159]
 s_waitcnt vmcnt(15) lgkmcnt(0)
 s_barrier
 ds_read_b128 a[128:131], v246 offset:16384
 v_mfma_f32_16x16x32_bf16 a[96:99], a[160:163], v[208:211], a[96:99]
 v_exp_f32 v144, v144
 v_mfma_f32_16x16x32_bf16 a[96:99], a[164:167], v[224:227], a[96:99]
 ds_read_b128 a[132:135], v247 offset:16384
 v_cvt_pk_bf16_f32 v205, v142, v143
 v_mfma_f32_16x16x32_bf16 a[100:103], a[160:163], v[212:215], a[100:103]
 v_exp_f32 v145, v145
 v_mfma_f32_16x16x32_bf16 a[100:103], a[164:167], v[228:231], a[100:103]
 ds_read_b128 a[136:139], v248 offset:16384
 v_add_f32 v124, v124, v144
 v_mfma_f32_16x16x32_bf16 a[104:107], a[160:163], v[216:219], a[104:107]
 v_exp_f32 v146, v146
 v_mfma_f32_16x16x32_bf16 a[104:107], a[164:167], v[232:235], a[104:107]
 ds_read_b128 a[140:143], v249 offset:16384
 v_add_f32 v124, v124, v145
 v_mfma_f32_16x16x32_bf16 a[108:111], a[160:163], v[220:223], a[108:111]
 v_exp_f32 v147, v147
 v_mfma_f32_16x16x32_bf16 a[108:111], a[164:167], v[236:239], a[108:111]
 buffer_load_dwordx4 v245, s[28:31], s76 offen offset:3072 nt lds
 v_mfma_f32_16x16x32_bf16 a[112:115], a[168:171], v[208:211], a[112:115]
 s_add_u32 s76, s76, 16384
 v_exp_f32 v148, v148
 v_mfma_f32_16x16x32_bf16 a[112:115], a[172:175], v[224:227], a[112:115]
 ds_read_b64_tr_b16 a[160:161], v16 offset:0
 v_cvt_pk_bf16_f32 v194, v144, v145
 v_mfma_f32_16x16x32_bf16 a[116:119], a[168:171], v[212:215], a[116:119]
 v_exp_f32 v149, v149
 v_mfma_f32_16x16x32_bf16 a[116:119], a[172:175], v[228:231], a[116:119]
 ds_read_b64_tr_b16 a[162:163], v16 offset:4096
 v_add_f32 v124, v124, v146
 v_mfma_f32_16x16x32_bf16 a[120:123], a[168:171], v[216:219], a[120:123]
 v_exp_f32 v150, v150
 v_mfma_f32_16x16x32_bf16 a[120:123], a[172:175], v[232:235], a[120:123]
 ds_read_b64_tr_b16 a[164:165], v16 offset:8192
 v_add_f32 v124, v124, v147
 v_mfma_f32_16x16x32_bf16 a[124:127], a[168:171], v[220:223], a[124:127]
 v_exp_f32 v151, v151
 v_mfma_f32_16x16x32_bf16 a[124:127], a[172:175], v[236:239], a[124:127]
 s_waitcnt lgkmcnt(3)
 ds_read_b64_tr_b16 a[166:167], v16 offset:12288
 v_cvt_pk_bf16_f32 v195, v146, v147
 s_branch L_att_p0
L_att_last:
 v_mfma_f32_16x16x32_bf16 v[128:131], a[128:131], v[80:83], v[160:163]
 s_mov_b32 s44, s14
 v_exp_f32 v152, v152
 v_mfma_f32_16x16x32_bf16 v[128:131], a[132:135], v[96:99], v[128:131]
 s_mov_b32 s45, s15
 ds_read_b64_tr_b16 a[168:169], v17 offset:16384
 v_cvt_pk_bf16_f32 v230, v148, v149
 v_mfma_f32_16x16x32_bf16 v[128:131], a[136:139], v[48:51], v[128:131]
 s_mov_b32 s46, 256
 v_exp_f32 v153, v153
 v_and_b32 v30, 7, v1
 s_getpc_b64 s[4:5]
L_cpb:
 s_add_u32 s4, s4, L_att_t31-L_cpb
 s_addc_u32 s5, s5, 0
 s_mov_b32 s6, L_slow-L_att_t31
 s_mov_b32 s7, 0x20000
 s_lshr_b32 s56, s2, 3
 s_lshl2_add_u32 s56, s56, s52
 s_mul_i32 s56, s56, 384
 v_min_u32 v8, 2, v1
 v_lshlrev_b32 v8, 7, v8
 buffer_load_dword v8, v8, s[4:7], s56 offen
 v_mfma_f32_16x16x32_bf16 v[128:131], a[140:143], v[64:67], v[128:131]
 s_mov_b32 s47, 0x20000
 ds_read_b64_tr_b16 a[170:171], v17 offset:20480
 v_cvt_pk_bf16_f32 v231, v150, v151
 v_mfma_f32_16x16x32_bf16 v[132:135], a[128:131], v[84:87], v[164:167]
 v_exp_f32 v154, v154
 v_mfma_f32_16x16x32_bf16 v[132:135], a[132:135], v[100:103], v[132:135]
 ds_read_b64_tr_b16 a[172:173], v17 offset:24576
 v_add_f32 v126, v126, v152
 v_lshlrev_b32 v31, 5, v30
 v_mfma_f32_16x16x32_bf16 v[132:135], a[136:139], v[52:55], v[132:135]
 v_exp_f32 v155, v155
 v_mfma_f32_16x16x32_bf16 v[132:135], a[140:143], v[68:71], v[132:135]
 ds_read_b64_tr_b16 a[174:175], v17 offset:28672
 v_add_f32 v126, v126, v153
 v_lshlrev_b32 v30, 2, v30
 v_mfma_f32_16x16x32_bf16 v[136:139], a[128:131], v[88:91], v[168:171]
 v_exp_f32 v156, v156
 v_mfma_f32_16x16x32_bf16 v[136:139], a[132:135], v[104:107], v[136:139]
 buffer_load_dword v28, v31, s[44:47], 0 offen sc1
 v_mfma_f32_16x16x32_bf16 v[136:139], a[136:139], v[56:59], v[136:139]
 s_and_b32 s55, s2, 1
 v_exp_f32 v157, v157
 v_mfma_f32_16x16x32_bf16 v[136:139], a[140:143], v[72:75], v[136:139]
 s_lshl_b32 s55, s55, 5
 v_cvt_pk_bf16_f32 v234, v152, v153
 v_add_f32 v126, v126, v154
 v_mfma_f32_16x16x32_bf16 v[140:143], a[128:131], v[92:95], v[172:175]
 s_lshr_b32 s56, s2, 3
 v_exp_f32 v158, v158
 v_mfma_f32_16x16x32_bf16 v[140:143], a[132:135], v[108:111], v[140:143]
 s_add_u32 s55, s55, s56
 v_add_f32 v126, v126, v155
 v_cvt_pk_bf16_f32 v235, v154, v155
 v_mfma_f32_16x16x32_bf16 v[140:143], a[136:139], v[60:63], v[140:143]
 s_bfe_u32 s56, s2, 0x20001
 v_exp_f32 v159, v159
 v_mfma_f32_16x16x32_bf16 v[140:143], a[140:143], v[76:79], v[140:143]
 s_waitcnt lgkmcnt(0)
 ds_read_b128 a[144:147], v246 offset:36864
 v_cvt_pk_bf16_f32 v238, v156, v157
 v_mfma_f32_16x16x32_bf16 a[0:3], a[160:163], v[208:211], a[0:3]
 s_lshl2_add_u32 s55, s55, s56
 v_exp_f32 v128, v128
 v_mfma_f32_16x16x32_bf16 a[0:3], a[164:167], v[224:227], a[0:3]
 s_lshl2_add_u32 s55, s55, s52
 ds_read_b128 a[148:151], v247 offset:36864
 v_cvt_pk_bf16_f32 v239, v158, v159
 v_mfma_f32_16x16x32_bf16 a[4:7], a[160:163], v[212:215], a[4:7]
 s_mul_i32 s55, s55, 16384
 v_exp_f32 v129, v129
 v_mfma_f32_16x16x32_bf16 a[4:7], a[164:167], v[228:231], a[4:7]
 s_add_u32 s55, s55, 10485760
 ds_read_b128 a[152:155], v248 offset:36864
 v_add_f32 v124, v124, v128
 v_mfma_f32_16x16x32_bf16 a[8:11], a[160:163], v[216:219], a[8:11]
 s_mov_b32 s40, s48
 v_exp_f32 v130, v130
 v_mfma_f32_16x16x32_bf16 a[8:11], a[164:167], v[232:235], a[8:11]
 s_mov_b32 s41, s49
 ds_read_b128 a[156:159], v249 offset:36864
 v_add_f32 v124, v124, v129
 v_mov_b32 v24, -1
 v_mfma_f32_16x16x32_bf16 a[12:15], a[160:163], v[220:223], a[12:15]
 s_mov_b32 s42, 27262976
 v_exp_f32 v131, v131
 v_mov_b32 v25, -1
 v_mfma_f32_16x16x32_bf16 a[12:15], a[164:167], v[236:239], a[12:15]
 s_mov_b32 s43, 0x20000
 v_mov_b32 v26, -1
 v_mov_b32 v27, -1
 v_mfma_f32_16x16x32_bf16 a[16:19], a[168:171], v[208:211], a[16:19]
 s_add_u32 s55, s55, 8192
 buffer_store_dwordx4 v[24:27], v2, s[40:43], s55 offen offset:0 sc1
 v_exp_f32 v132, v132
 v_mfma_f32_16x16x32_bf16 a[16:19], a[172:175], v[224:227], a[16:19]
 ds_read_b64_tr_b16 a[160:161], v18 offset:16384
 v_cvt_pk_bf16_f32 v176, v128, v129
 v_mfma_f32_16x16x32_bf16 a[20:23], a[168:171], v[212:215], a[20:23]
 v_exp_f32 v133, v133
 v_mfma_f32_16x16x32_bf16 a[20:23], a[172:175], v[228:231], a[20:23]
 ds_read_b64_tr_b16 a[162:163], v18 offset:20480
 v_add_f32 v124, v124, v130
 v_mfma_f32_16x16x32_bf16 a[24:27], a[168:171], v[216:219], a[24:27]
 v_exp_f32 v134, v134
 v_mfma_f32_16x16x32_bf16 a[24:27], a[172:175], v[232:235], a[24:27]
 ds_read_b64_tr_b16 a[164:165], v18 offset:24576
 v_add_f32 v124, v124, v131
 v_mfma_f32_16x16x32_bf16 a[28:31], a[168:171], v[220:223], a[28:31]
 v_exp_f32 v135, v135
 v_mfma_f32_16x16x32_bf16 a[28:31], a[172:175], v[236:239], a[28:31]
 ds_read_b64_tr_b16 a[166:167], v18 offset:28672
 v_cvt_pk_bf16_f32 v177, v130, v131
 v_mfma_f32_16x16x32_bf16 a[196:199], a[192:195], v[212:215], a[196:199]
 v_cvt_pk_bf16_f32 v180, v132, v133
 v_cvt_pk_bf16_f32 v181, v134, v135
 v_mfma_f32_16x16x32_bf16 a[196:199], a[192:195], v[228:231], a[196:199]
 s_waitcnt lgkmcnt(4)
 v_mfma_f32_16x16x32_bf16 v[144:147], a[144:147], v[80:83], v[160:163]
 v_exp_f32 v136, v136
 v_mfma_f32_16x16x32_bf16 v[144:147], a[148:151], v[96:99], v[144:147]
 ds_read_b64_tr_b16 a[168:169], v19 offset:16384
 v_mfma_f32_16x16x32_bf16 v[144:147], a[152:155], v[48:51], v[144:147]
 v_exp_f32 v137, v137
 v_mfma_f32_16x16x32_bf16 v[144:147], a[156:159], v[64:67], v[144:147]
 ds_read_b64_tr_b16 a[170:171], v19 offset:20480
 v_add_f32 v126, v126, v136
 v_mfma_f32_16x16x32_bf16 v[148:151], a[144:147], v[84:87], v[164:167]
 v_exp_f32 v138, v138
 v_mfma_f32_16x16x32_bf16 v[148:151], a[148:151], v[100:103], v[148:151]
 ds_read_b64_tr_b16 a[172:173], v19 offset:24576
 v_add_f32 v126, v126, v137
 v_mfma_f32_16x16x32_bf16 v[148:151], a[152:155], v[52:55], v[148:151]
 v_exp_f32 v139, v139
 v_mfma_f32_16x16x32_bf16 v[148:151], a[156:159], v[68:71], v[148:151]
 ds_read_b64_tr_b16 a[174:175], v19 offset:28672
 v_cvt_pk_bf16_f32 v184, v136, v137
 v_mfma_f32_16x16x32_bf16 v[152:155], a[144:147], v[88:91], v[168:171]
 v_exp_f32 v140, v140
 v_mfma_f32_16x16x32_bf16 v[152:155], a[148:151], v[104:107], v[152:155]
 buffer_store_dwordx4 v[24:27], v2, s[40:43], s55 offen offset:1024 sc1
 v_mfma_f32_16x16x32_bf16 v[152:155], a[152:155], v[56:59], v[152:155]
 s_bfe_u32 s80, s2, 0x20001
 v_exp_f32 v141, v141
 v_mfma_f32_16x16x32_bf16 v[152:155], a[156:159], v[72:75], v[152:155]
 s_and_b32 s83, s2, 1
 v_add_f32 v126, v126, v138
 v_add_f32 v126, v126, v139
 v_mfma_f32_16x16x32_bf16 v[156:159], a[144:147], v[92:95], v[172:175]
 s_lshr_b32 s84, s2, 5
 v_exp_f32 v142, v142
 v_mfma_f32_16x16x32_bf16 v[156:159], a[148:151], v[108:111], v[156:159]
 s_lshl3_add_u32 s81, s83, s84
 v_cvt_pk_bf16_f32 v185, v138, v139
 v_cvt_pk_bf16_f32 v188, v140, v141
 v_mfma_f32_16x16x32_bf16 v[156:159], a[152:155], v[60:63], v[156:159]
 s_bfe_u32 s82, s2, 0x20003
 v_exp_f32 v143, v143
 v_mfma_f32_16x16x32_bf16 v[156:159], a[156:159], v[76:79], v[156:159]
 s_waitcnt lgkmcnt(0)
 ds_read_b128 a[128:131], v246 offset:40960
 v_mfma_f32_16x16x32_bf16 a[32:35], a[160:163], v[208:211], a[32:35]
 s_lshr_b32 s83, s80, 1
 v_exp_f32 v144, v144
 v_mfma_f32_16x16x32_bf16 a[32:35], a[164:167], v[224:227], a[32:35]
 s_lshl_b32 s84, s83, 10
 ds_read_b128 a[132:135], v247 offset:40960
 v_cvt_pk_bf16_f32 v189, v142, v143
 v_mfma_f32_16x16x32_bf16 a[36:39], a[160:163], v[212:215], a[36:39]
 s_mul_i32 s87, s80, 4718592
 v_exp_f32 v145, v145
 v_mfma_f32_16x16x32_bf16 a[36:39], a[164:167], v[228:231], a[36:39]
 s_mul_i32 s88, s80, 4194304
 ds_read_b128 a[136:139], v248 offset:40960
 v_add_f32 v124, v124, v144
 v_mfma_f32_16x16x32_bf16 a[40:43], a[160:163], v[216:219], a[40:43]
 s_add_u32 s88, s88, 20971520
 v_exp_f32 v146, v146
 v_mfma_f32_16x16x32_bf16 a[40:43], a[164:167], v[232:235], a[40:43]
 s_mul_i32 s91, s52, 9216
 ds_read_b128 a[140:143], v249 offset:40960
 v_add_f32 v124, v124, v145
 v_mfma_f32_16x16x32_bf16 a[44:47], a[160:163], v[220:223], a[44:47]
 s_mul_i32 s83, s82, 9216
 v_exp_f32 v147, v147
 v_mfma_f32_16x16x32_bf16 a[44:47], a[164:167], v[236:239], a[44:47]
 buffer_store_dwordx4 v[24:27], v2, s[40:43], s55 offen offset:2048 sc1
 v_mfma_f32_16x16x32_bf16 a[48:51], a[168:171], v[208:211], a[48:51]
 v_exp_f32 v148, v148
 v_mfma_f32_16x16x32_bf16 a[48:51], a[172:175], v[224:227], a[48:51]
 ds_read_b64_tr_b16 a[160:161], v20 offset:16384
 v_cvt_pk_bf16_f32 v178, v144, v145
 v_mfma_f32_16x16x32_bf16 a[52:55], a[168:171], v[212:215], a[52:55]
 v_exp_f32 v149, v149
 v_mfma_f32_16x16x32_bf16 a[52:55], a[172:175], v[228:231], a[52:55]
 ds_read_b64_tr_b16 a[162:163], v20 offset:20480
 v_add_f32 v124, v124, v146
 v_mfma_f32_16x16x32_bf16 a[56:59], a[168:171], v[216:219], a[56:59]
 v_exp_f32 v150, v150
 v_mfma_f32_16x16x32_bf16 a[56:59], a[172:175], v[232:235], a[56:59]
 ds_read_b64_tr_b16 a[164:165], v20 offset:24576
 v_add_f32 v124, v124, v147
 v_mfma_f32_16x16x32_bf16 a[60:63], a[168:171], v[220:223], a[60:63]
 s_mul_i32 s89, s80, 1327104
 v_exp_f32 v151, v151
 v_add_u32 v6, s84, v2
 v_mfma_f32_16x16x32_bf16 a[60:63], a[172:175], v[236:239], a[60:63]
 s_waitcnt lgkmcnt(3)
 ds_read_b64_tr_b16 a[166:167], v20 offset:28672
 v_cvt_pk_bf16_f32 v179, v146, v147
 v_mfma_f32_16x16x32_bf16 v[128:131], a[128:131], v[80:83], v[160:163]
 s_mul_i32 s84, s52, 36864
 v_exp_f32 v152, v152
 v_mfma_f32_16x16x32_bf16 v[128:131], a[132:135], v[96:99], v[128:131]
 s_add_u32 s83, s83, s84
 ds_read_b64_tr_b16 a[168:169], v21 offset:16384
 v_cvt_pk_bf16_f32 v182, v148, v149
 v_mfma_f32_16x16x32_bf16 v[128:131], a[136:139], v[48:51], v[128:131]
 s_add_u32 s89, s89, s83
 v_exp_f32 v153, v153
 v_mfma_f32_16x16x32_bf16 v[128:131], a[140:143], v[64:67], v[128:131]
 s_mul_i32 s90, s80, 1179648
 ds_read_b64_tr_b16 a[170:171], v21 offset:20480
 v_cvt_pk_bf16_f32 v183, v150, v151
 v_mfma_f32_16x16x32_bf16 v[132:135], a[128:131], v[84:87], v[164:167]
 s_add_u32 s90, s90, s83
 v_exp_f32 v154, v154
 v_mfma_f32_16x16x32_bf16 v[132:135], a[132:135], v[100:103], v[132:135]
 s_add_u32 s90, s90, 5308416
 ds_read_b64_tr_b16 a[172:173], v21 offset:24576
 v_add_f32 v126, v126, v152
 v_mfma_f32_16x16x32_bf16 v[132:135], a[136:139], v[52:55], v[132:135]
 s_lshl_b32 s83, s81, 3
 v_exp_f32 v155, v155
 v_mfma_f32_16x16x32_bf16 v[132:135], a[140:143], v[68:71], v[132:135]
 s_lshl1_add_u32 s83, s52, s83
 ds_read_b64_tr_b16 a[174:175], v21 offset:28672
 v_add_f32 v126, v126, v153
 v_mfma_f32_16x16x32_bf16 v[136:139], a[128:131], v[88:91], v[168:171]
 s_lshl_b32 s84, s83, 10
 v_exp_f32 v156, v156
 v_mfma_f32_16x16x32_bf16 v[136:139], a[132:135], v[104:107], v[136:139]
 s_sub_u32 s18, 37748736, s84
 buffer_store_dwordx4 v[24:27], v2, s[40:43], s55 offen offset:3072 sc1
 v_mfma_f32_16x16x32_bf16 v[136:139], a[136:139], v[56:59], v[136:139]
 s_mov_b32 s19, 0x20000
 v_exp_f32 v157, v157
 v_mfma_f32_16x16x32_bf16 v[136:139], a[140:143], v[72:75], v[136:139]
 s_sub_u32 s84, 39845888, s84
 v_cvt_pk_bf16_f32 v186, v152, v153
 v_add_f32 v126, v126, v154
 s_waitcnt vmcnt(4)
 v_cmp_gt_u32 vcc, 32, v28
 s_cbranch_vccnz L_spin_a
L_spin_a_b:
 v_mfma_f32_16x16x32_bf16 v[140:143], a[128:131], v[92:95], v[172:175]
 v_exp_f32 v158, v158
 v_mfma_f32_16x16x32_bf16 v[140:143], a[132:135], v[108:111], v[140:143]
 v_add_f32 v126, v126, v155
 v_cvt_pk_bf16_f32 v187, v154, v155
 v_mfma_f32_16x16x32_bf16 v[140:143], a[136:139], v[60:63], v[140:143]
 v_exp_f32 v159, v159
 v_xor_b32 v7, 1024, v6
 v_mfma_f32_16x16x32_bf16 v[140:143], a[140:143], v[76:79], v[140:143]
 s_waitcnt lgkmcnt(0)
 ds_read_b128 a[144:147], v246 offset:45056
 v_cvt_pk_bf16_f32 v190, v156, v157
 v_mfma_f32_16x16x32_bf16 a[64:67], a[160:163], v[208:211], a[64:67]
 v_exp_f32 v128, v128
 v_mfma_f32_16x16x32_bf16 a[64:67], a[164:167], v[224:227], a[64:67]
 ds_read_b128 a[148:151], v247 offset:45056
 v_cvt_pk_bf16_f32 v191, v158, v159
 v_mfma_f32_16x16x32_bf16 a[68:71], a[160:163], v[212:215], a[68:71]
 v_exp_f32 v129, v129
 v_mfma_f32_16x16x32_bf16 a[68:71], a[164:167], v[228:231], a[68:71]
 ds_read_b128 a[152:155], v248 offset:45056
 v_add_f32 v124, v124, v128
 v_mfma_f32_16x16x32_bf16 a[72:75], a[160:163], v[216:219], a[72:75]
 v_exp_f32 v130, v130
 v_mfma_f32_16x16x32_bf16 a[72:75], a[164:167], v[232:235], a[72:75]
 ds_read_b128 a[156:159], v249 offset:45056
 v_add_f32 v124, v124, v129
 v_mfma_f32_16x16x32_bf16 a[76:79], a[160:163], v[220:223], a[76:79]
 v_exp_f32 v131, v131
 v_mfma_f32_16x16x32_bf16 a[76:79], a[164:167], v[236:239], a[76:79]
 s_add_u32 s55, s55, 4096
 buffer_store_dwordx4 v[24:27], v2, s[40:43], s55 offen offset:0 sc1
 v_mfma_f32_16x16x32_bf16 a[80:83], a[168:171], v[208:211], a[80:83]
 v_exp_f32 v132, v132
 v_mfma_f32_16x16x32_bf16 a[80:83], a[172:175], v[224:227], a[80:83]
 ds_read_b64_tr_b16 a[160:161], v22 offset:16384
 v_cvt_pk_bf16_f32 v192, v128, v129
 v_mfma_f32_16x16x32_bf16 a[84:87], a[168:171], v[212:215], a[84:87]
 v_exp_f32 v133, v133
 v_mfma_f32_16x16x32_bf16 a[84:87], a[172:175], v[228:231], a[84:87]
 ds_read_b64_tr_b16 a[162:163], v22 offset:20480
 v_add_f32 v124, v124, v130
 v_mfma_f32_16x16x32_bf16 a[88:91], a[168:171], v[216:219], a[88:91]
 v_exp_f32 v134, v134
 v_mfma_f32_16x16x32_bf16 a[88:91], a[172:175], v[232:235], a[88:91]
 ds_read_b64_tr_b16 a[164:165], v22 offset:24576
 v_add_f32 v124, v124, v131
 v_mfma_f32_16x16x32_bf16 a[92:95], a[168:171], v[220:223], a[92:95]
 v_exp_f32 v135, v135
 v_mfma_f32_16x16x32_bf16 a[92:95], a[172:175], v[236:239], a[92:95]
 ds_read_b64_tr_b16 a[166:167], v22 offset:28672
 v_cvt_pk_bf16_f32 v193, v130, v131
 v_mfma_f32_16x16x32_bf16 a[200:203], a[192:195], v[220:223], a[200:203]
 v_cvt_pk_bf16_f32 v196, v132, v133
 v_cvt_pk_bf16_f32 v197, v134, v135
 v_mfma_f32_16x16x32_bf16 a[200:203], a[192:195], v[236:239], a[200:203]
 s_waitcnt lgkmcnt(4)
 v_mfma_f32_16x16x32_bf16 v[144:147], a[144:147], v[80:83], v[160:163]
 v_exp_f32 v136, v136
 v_mfma_f32_16x16x32_bf16 v[144:147], a[148:151], v[96:99], v[144:147]
 ds_read_b64_tr_b16 a[168:169], v23 offset:16384
 v_mfma_f32_16x16x32_bf16 v[144:147], a[152:155], v[48:51], v[144:147]
 v_exp_f32 v137, v137
 v_mfma_f32_16x16x32_bf16 v[144:147], a[156:159], v[64:67], v[144:147]
 ds_read_b64_tr_b16 a[170:171], v23 offset:20480
 v_add_f32 v126, v126, v136
 v_mfma_f32_16x16x32_bf16 v[148:151], a[144:147], v[84:87], v[164:167]
 v_exp_f32 v138, v138
 v_mfma_f32_16x16x32_bf16 v[148:151], a[148:151], v[100:103], v[148:151]
 ds_read_b64_tr_b16 a[172:173], v23 offset:24576
 v_add_f32 v126, v126, v137
 v_mfma_f32_16x16x32_bf16 v[148:151], a[152:155], v[52:55], v[148:151]
 v_exp_f32 v139, v139
 v_mfma_f32_16x16x32_bf16 v[148:151], a[156:159], v[68:71], v[148:151]
 ds_read_b64_tr_b16 a[174:175], v23 offset:28672
 v_cvt_pk_bf16_f32 v200, v136, v137
 v_mfma_f32_16x16x32_bf16 v[152:155], a[144:147], v[88:91], v[168:171]
 v_exp_f32 v140, v140
 v_mfma_f32_16x16x32_bf16 v[152:155], a[148:151], v[104:107], v[152:155]
 buffer_store_dwordx4 v[24:27], v2, s[40:43], s55 offen offset:1024 sc1
 v_mfma_f32_16x16x32_bf16 v[152:155], a[152:155], v[56:59], v[152:155]
 v_exp_f32 v141, v141
 v_mfma_f32_16x16x32_bf16 v[152:155], a[156:159], v[72:75], v[152:155]
 v_add_f32 v126, v126, v138
 v_add_f32 v126, v126, v139
 s_sub_u32 s16, s48, s84
 s_subb_u32 s17, s49, 0
 v_mfma_f32_16x16x32_bf16 v[156:159], a[144:147], v[92:95], v[172:175]
 v_exp_f32 v142, v142
 v_mfma_f32_16x16x32_bf16 v[156:159], a[148:151], v[108:111], v[156:159]
 v_cvt_pk_bf16_f32 v201, v138, v139
 v_cvt_pk_bf16_f32 v204, v140, v141
 v_mfma_f32_16x16x32_bf16 v[156:159], a[152:155], v[60:63], v[156:159]
 v_exp_f32 v143, v143
 v_mfma_f32_16x16x32_bf16 v[156:159], a[156:159], v[76:79], v[156:159]
 s_waitcnt lgkmcnt(0)
 s_barrier
 ds_read_b128 a[128:131], v246 offset:49152
 v_mfma_f32_16x16x32_bf16 a[96:99], a[160:163], v[208:211], a[96:99]
 v_exp_f32 v144, v144
 v_mfma_f32_16x16x32_bf16 a[96:99], a[164:167], v[224:227], a[96:99]
 ds_read_b128 a[132:135], v247 offset:49152
 v_cvt_pk_bf16_f32 v205, v142, v143
 v_mfma_f32_16x16x32_bf16 a[100:103], a[160:163], v[212:215], a[100:103]
 v_exp_f32 v145, v145
 v_mfma_f32_16x16x32_bf16 a[100:103], a[164:167], v[228:231], a[100:103]
 ds_read_b128 a[136:139], v248 offset:49152
 v_add_f32 v124, v124, v144
 v_mfma_f32_16x16x32_bf16 a[104:107], a[160:163], v[216:219], a[104:107]
 v_exp_f32 v146, v146
 v_mfma_f32_16x16x32_bf16 a[104:107], a[164:167], v[232:235], a[104:107]
 ds_read_b128 a[140:143], v249 offset:49152
 v_add_f32 v124, v124, v145
 v_mfma_f32_16x16x32_bf16 a[108:111], a[160:163], v[220:223], a[108:111]
 v_exp_f32 v147, v147
 v_mfma_f32_16x16x32_bf16 a[108:111], a[164:167], v[236:239], a[108:111]
 buffer_store_dwordx4 v[24:27], v2, s[40:43], s55 offen offset:2048 sc1
 v_mfma_f32_16x16x32_bf16 a[112:115], a[168:171], v[208:211], a[112:115]
 s_add_u32 s76, s76, 16384
 v_exp_f32 v148, v148
 v_mfma_f32_16x16x32_bf16 a[112:115], a[172:175], v[224:227], a[112:115]
 ds_read_b64_tr_b16 a[160:161], v16 offset:32768
 v_cvt_pk_bf16_f32 v194, v144, v145
 v_mfma_f32_16x16x32_bf16 a[116:119], a[168:171], v[212:215], a[116:119]
 v_exp_f32 v149, v149
 v_mfma_f32_16x16x32_bf16 a[116:119], a[172:175], v[228:231], a[116:119]
 ds_read_b64_tr_b16 a[162:163], v16 offset:36864
 v_add_f32 v124, v124, v146
 v_mfma_f32_16x16x32_bf16 a[120:123], a[168:171], v[216:219], a[120:123]
 v_exp_f32 v150, v150
 v_mfma_f32_16x16x32_bf16 a[120:123], a[172:175], v[232:235], a[120:123]
 ds_read_b64_tr_b16 a[164:165], v16 offset:40960
 v_add_f32 v124, v124, v147
 v_mfma_f32_16x16x32_bf16 a[124:127], a[168:171], v[220:223], a[124:127]
 v_exp_f32 v151, v151
 v_mfma_f32_16x16x32_bf16 a[124:127], a[172:175], v[236:239], a[124:127]
 s_waitcnt lgkmcnt(3)
 ds_read_b64_tr_b16 a[166:167], v16 offset:45056
 v_cvt_pk_bf16_f32 v195, v146, v147
 v_mfma_f32_16x16x32_bf16 v[128:131], a[128:131], v[80:83], v[160:163]
 s_add_u32 s83, s87, 0
 buffer_load_dwordx4 a[204:207], v6, s[16:19], s83 offen sc1
 v_exp_f32 v152, v152
 v_mfma_f32_16x16x32_bf16 v[128:131], a[132:135], v[96:99], v[128:131]
 ds_read_b64_tr_b16 a[168:169], v17 offset:32768
 v_cvt_pk_bf16_f32 v198, v148, v149
 v_mfma_f32_16x16x32_bf16 v[128:131], a[136:139], v[48:51], v[128:131]
 v_exp_f32 v153, v153
 v_mfma_f32_16x16x32_bf16 v[128:131], a[140:143], v[64:67], v[128:131]
 ds_read_b64_tr_b16 a[170:171], v17 offset:36864
 v_cvt_pk_bf16_f32 v199, v150, v151
 v_mfma_f32_16x16x32_bf16 v[132:135], a[128:131], v[84:87], v[164:167]
 v_exp_f32 v154, v154
 v_mfma_f32_16x16x32_bf16 v[132:135], a[132:135], v[100:103], v[132:135]
 ds_read_b64_tr_b16 a[172:173], v17 offset:40960
 v_add_f32 v126, v126, v152
 v_mfma_f32_16x16x32_bf16 v[132:135], a[136:139], v[52:55], v[132:135]
 v_exp_f32 v155, v155
 v_mfma_f32_16x16x32_bf16 v[132:135], a[140:143], v[68:71], v[132:135]
 ds_read_b64_tr_b16 a[174:175], v17 offset:45056
 v_add_f32 v126, v126, v153
 v_mfma_f32_16x16x32_bf16 v[136:139], a[128:131], v[88:91], v[168:171]
 v_exp_f32 v156, v156
 v_mfma_f32_16x16x32_bf16 v[136:139], a[132:135], v[104:107], v[136:139]
 buffer_load_dwordx4 a[208:211], v7, s[16:19], s83 offen sc1
 v_mfma_f32_16x16x32_bf16 v[136:139], a[136:139], v[56:59], v[136:139]
 v_exp_f32 v157, v157
 v_mfma_f32_16x16x32_bf16 v[136:139], a[140:143], v[72:75], v[136:139]
 s_add_u32 s83, s87, 131072
 buffer_load_dwordx4 a[212:215], v6, s[16:19], s83 offen sc1
 v_cvt_pk_bf16_f32 v202, v152, v153
 v_add_f32 v126, v126, v154
 v_mfma_f32_16x16x32_bf16 v[140:143], a[128:131], v[92:95], v[172:175]
 v_exp_f32 v158, v158
 v_mfma_f32_16x16x32_bf16 v[140:143], a[132:135], v[108:111], v[140:143]
 v_add_f32 v126, v126, v155
 v_cvt_pk_bf16_f32 v203, v154, v155
 v_mfma_f32_16x16x32_bf16 v[140:143], a[136:139], v[60:63], v[140:143]
 v_exp_f32 v159, v159
 v_mfma_f32_16x16x32_bf16 v[140:143], a[140:143], v[76:79], v[140:143]
 s_waitcnt lgkmcnt(0)
 ds_read_b128 a[144:147], v246 offset:53248
 buffer_load_dwordx4 a[216:219], v7, s[16:19], s83 offen sc1
 v_cvt_pk_bf16_f32 v206, v156, v157
 v_mfma_f32_16x16x32_bf16 a[0:3], a[160:163], v[176:179], a[0:3]
 v_exp_f32 v128, v128
 v_mfma_f32_16x16x32_bf16 a[0:3], a[164:167], v[192:195], a[0:3]
 ds_read_b128 a[148:151], v247 offset:53248
 v_cvt_pk_bf16_f32 v207, v158, v159
 v_mfma_f32_16x16x32_bf16 a[4:7], a[160:163], v[180:183], a[4:7]
 v_exp_f32 v129, v129
 v_mfma_f32_16x16x32_bf16 a[4:7], a[164:167], v[196:199], a[4:7]
 ds_read_b128 a[152:155], v248 offset:53248
 v_add_f32 v124, v124, v128
 v_mfma_f32_16x16x32_bf16 a[8:11], a[160:163], v[184:187], a[8:11]
 v_exp_f32 v130, v130
 v_mfma_f32_16x16x32_bf16 a[8:11], a[164:167], v[200:203], a[8:11]
 ds_read_b128 a[156:159], v249 offset:53248
 v_add_f32 v124, v124, v129
 v_mfma_f32_16x16x32_bf16 a[12:15], a[160:163], v[188:191], a[12:15]
 v_exp_f32 v131, v131
 v_mfma_f32_16x16x32_bf16 a[12:15], a[164:167], v[204:207], a[12:15]
 s_add_u32 s83, s87, 262144
 buffer_load_dwordx4 a[220:223], v6, s[16:19], s83 offen sc1
 v_mfma_f32_16x16x32_bf16 a[16:19], a[168:171], v[176:179], a[16:19]
 v_exp_f32 v132, v132
 v_mfma_f32_16x16x32_bf16 a[16:19], a[172:175], v[192:195], a[16:19]
 ds_read_b64_tr_b16 a[160:161], v18 offset:32768
 buffer_load_dwordx4 a[224:227], v7, s[16:19], s83 offen sc1
 v_cvt_pk_bf16_f32 v208, v128, v129
 v_mfma_f32_16x16x32_bf16 a[20:23], a[168:171], v[180:183], a[20:23]
 v_exp_f32 v133, v133
 v_mfma_f32_16x16x32_bf16 a[20:23], a[172:175], v[196:199], a[20:23]
 ds_read_b64_tr_b16 a[162:163], v18 offset:36864
 v_add_f32 v124, v124, v130
 v_mfma_f32_16x16x32_bf16 a[24:27], a[168:171], v[184:187], a[24:27]
 v_exp_f32 v134, v134
 v_mfma_f32_16x16x32_bf16 a[24:27], a[172:175], v[200:203], a[24:27]
 ds_read_b64_tr_b16 a[164:165], v18 offset:40960
 v_add_f32 v124, v124, v131
 v_mfma_f32_16x16x32_bf16 a[28:31], a[168:171], v[188:191], a[28:31]
 v_exp_f32 v135, v135
 v_mfma_f32_16x16x32_bf16 a[28:31], a[172:175], v[204:207], a[28:31]
 ds_read_b64_tr_b16 a[166:167], v18 offset:45056
 v_cvt_pk_bf16_f32 v209, v130, v131
 v_mfma_f32_16x16x32_bf16 a[196:199], a[192:195], v[180:183], a[196:199]
 v_cvt_pk_bf16_f32 v212, v132, v133
 v_cvt_pk_bf16_f32 v213, v134, v135
 v_mfma_f32_16x16x32_bf16 a[196:199], a[192:195], v[196:199], a[196:199]
 s_waitcnt lgkmcnt(4)
 s_add_u32 s83, s87, 393216
 buffer_load_dwordx4 a[228:231], v6, s[16:19], s83 offen sc1
 v_mfma_f32_16x16x32_bf16 v[144:147], a[144:147], v[80:83], v[160:163]
 v_exp_f32 v136, v136
 v_mfma_f32_16x16x32_bf16 v[144:147], a[148:151], v[96:99], v[144:147]
 ds_read_b64_tr_b16 a[168:169], v19 offset:32768
 buffer_load_dwordx4 a[232:235], v7, s[16:19], s83 offen sc1
 v_mfma_f32_16x16x32_bf16 v[144:147], a[152:155], v[48:51], v[144:147]
 v_exp_f32 v137, v137
 v_mfma_f32_16x16x32_bf16 v[144:147], a[156:159], v[64:67], v[144:147]
 ds_read_b64_tr_b16 a[170:171], v19 offset:36864
 v_add_f32 v126, v126, v136
 v_mfma_f32_16x16x32_bf16 v[148:151], a[144:147], v[84:87], v[164:167]
 v_exp_f32 v138, v138
 v_mfma_f32_16x16x32_bf16 v[148:151], a[148:151], v[100:103], v[148:151]
 ds_read_b64_tr_b16 a[172:173], v19 offset:40960
 v_add_f32 v126, v126, v137
 v_mfma_f32_16x16x32_bf16 v[148:151], a[152:155], v[52:55], v[148:151]
 v_exp_f32 v139, v139
 v_mfma_f32_16x16x32_bf16 v[148:151], a[156:159], v[68:71], v[148:151]
 ds_read_b64_tr_b16 a[174:175], v19 offset:45056
 v_cvt_pk_bf16_f32 v216, v136, v137
 v_mfma_f32_16x16x32_bf16 v[152:155], a[144:147], v[88:91], v[168:171]
 v_exp_f32 v140, v140
 v_mfma_f32_16x16x32_bf16 v[152:155], a[148:151], v[104:107], v[152:155]
 s_add_u32 s83, s87, 524288
 buffer_load_dwordx4 a[236:239], v6, s[16:19], s83 offen sc1
 v_mfma_f32_16x16x32_bf16 v[152:155], a[152:155], v[56:59], v[152:155]
 v_exp_f32 v141, v141
 v_mfma_f32_16x16x32_bf16 v[152:155], a[156:159], v[72:75], v[152:155]
 buffer_load_dwordx4 a[240:243], v7, s[16:19], s83 offen sc1
 v_add_f32 v126, v126, v138
 v_add_f32 v126, v126, v139
 v_mfma_f32_16x16x32_bf16 v[156:159], a[144:147], v[92:95], v[172:175]
 v_exp_f32 v142, v142
 v_mfma_f32_16x16x32_bf16 v[156:159], a[148:151], v[108:111], v[156:159]
 v_cvt_pk_bf16_f32 v217, v138, v139
 v_cvt_pk_bf16_f32 v220, v140, v141
 v_mfma_f32_16x16x32_bf16 v[156:159], a[152:155], v[60:63], v[156:159]
 v_exp_f32 v143, v143
 v_mfma_f32_16x16x32_bf16 v[156:159], a[156:159], v[76:79], v[156:159]
 s_waitcnt lgkmcnt(0)
 ds_read_b128 a[128:131], v246 offset:57344
 v_mfma_f32_16x16x32_bf16 a[32:35], a[160:163], v[176:179], a[32:35]
 s_add_u32 s83, s87, 655360
 buffer_load_dwordx4 a[244:247], v6, s[16:19], s83 offen sc1
 v_exp_f32 v144, v144
 v_mfma_f32_16x16x32_bf16 a[32:35], a[164:167], v[192:195], a[32:35]
 ds_read_b128 a[132:135], v247 offset:57344
 v_cvt_pk_bf16_f32 v221, v142, v143
 v_mfma_f32_16x16x32_bf16 a[36:39], a[160:163], v[180:183], a[36:39]
 v_exp_f32 v145, v145
 v_mfma_f32_16x16x32_bf16 a[36:39], a[164:167], v[196:199], a[36:39]
 ds_read_b128 a[136:139], v248 offset:57344
 v_add_f32 v124, v124, v144
 v_mfma_f32_16x16x32_bf16 a[40:43], a[160:163], v[184:187], a[40:43]
 v_exp_f32 v146, v146
 v_mfma_f32_16x16x32_bf16 a[40:43], a[164:167], v[200:203], a[40:43]
 ds_read_b128 a[140:143], v249 offset:57344
 v_add_f32 v124, v124, v145
 v_mfma_f32_16x16x32_bf16 a[44:47], a[160:163], v[188:191], a[44:47]
 v_exp_f32 v147, v147
 v_mfma_f32_16x16x32_bf16 a[44:47], a[164:167], v[204:207], a[44:47]
 buffer_load_dwordx4 a[248:251], v7, s[16:19], s83 offen sc1
 v_mfma_f32_16x16x32_bf16 a[48:51], a[168:171], v[176:179], a[48:51]
 v_exp_f32 v148, v148
 v_mfma_f32_16x16x32_bf16 a[48:51], a[172:175], v[192:195], a[48:51]
 ds_read_b64_tr_b16 a[160:161], v20 offset:32768
 v_cvt_pk_bf16_f32 v210, v144, v145
 v_mfma_f32_16x16x32_bf16 a[52:55], a[168:171], v[180:183], a[52:55]
 s_add_u32 s83, s87, 786432
 buffer_load_dwordx4 a[176:179], v6, s[16:19], s83 offen sc1
 v_exp_f32 v149, v149
 v_mfma_f32_16x16x32_bf16 a[52:55], a[172:175], v[196:199], a[52:55]
 ds_read_b64_tr_b16 a[162:163], v20 offset:36864
 v_add_f32 v124, v124, v146
 v_mfma_f32_16x16x32_bf16 a[56:59], a[168:171], v[184:187], a[56:59]
 v_exp_f32 v150, v150
 v_mfma_f32_16x16x32_bf16 a[56:59], a[172:175], v[200:203], a[56:59]
 ds_read_b64_tr_b16 a[164:165], v20 offset:40960
 v_add_f32 v124, v124, v147
 v_mfma_f32_16x16x32_bf16 a[60:63], a[168:171], v[188:191], a[60:63]
 v_exp_f32 v151, v151
 v_mfma_f32_16x16x32_bf16 a[60:63], a[172:175], v[204:207], a[60:63]
 s_waitcnt lgkmcnt(3)
 ds_read_b64_tr_b16 a[166:167], v20 offset:45056
 buffer_load_dwordx4 a[180:183], v7, s[16:19], s83 offen sc1
 v_cvt_pk_bf16_f32 v211, v146, v147
 v_mfma_f32_16x16x32_bf16 v[128:131], a[128:131], v[80:83], v[160:163]
 v_exp_f32 v152, v152
 v_mfma_f32_16x16x32_bf16 v[128:131], a[132:135], v[96:99], v[128:131]
 ds_read_b64_tr_b16 a[168:169], v21 offset:32768
 v_cvt_pk_bf16_f32 v214, v148, v149
 v_mfma_f32_16x16x32_bf16 v[128:131], a[136:139], v[48:51], v[128:131]
 v_exp_f32 v153, v153
 v_mfma_f32_16x16x32_bf16 v[128:131], a[140:143], v[64:67], v[128:131]
 ds_read_b64_tr_b16 a[170:171], v21 offset:36864
 v_cvt_pk_bf16_f32 v215, v150, v151
 v_mfma_f32_16x16x32_bf16 v[132:135], a[128:131], v[84:87], v[164:167]
 s_add_u32 s83, s87, 917504
 buffer_load_dwordx4 a[184:187], v6, s[16:19], s83 offen sc1
 v_exp_f32 v154, v154
 v_mfma_f32_16x16x32_bf16 v[132:135], a[132:135], v[100:103], v[132:135]
 ds_read_b64_tr_b16 a[172:173], v21 offset:40960
 v_add_f32 v126, v126, v152
 v_mfma_f32_16x16x32_bf16 v[132:135], a[136:139], v[52:55], v[132:135]
 v_exp_f32 v155, v155
 v_mfma_f32_16x16x32_bf16 v[132:135], a[140:143], v[68:71], v[132:135]
 ds_read_b64_tr_b16 a[174:175], v21 offset:45056
 v_add_f32 v126, v126, v153
 v_mfma_f32_16x16x32_bf16 v[136:139], a[128:131], v[88:91], v[168:171]
 v_exp_f32 v156, v156
 v_mfma_f32_16x16x32_bf16 v[136:139], a[132:135], v[104:107], v[136:139]
 buffer_load_dwordx4 a[188:191], v7, s[16:19], s83 offen sc1
 v_mfma_f32_16x16x32_bf16 v[136:139], a[136:139], v[56:59], v[136:139]
 v_exp_f32 v157, v157
 v_mfma_f32_16x16x32_bf16 v[136:139], a[140:143], v[72:75], v[136:139]
 v_cvt_pk_bf16_f32 v218, v152, v153
 v_add_f32 v126, v126, v154
 v_mfma_f32_16x16x32_bf16 v[140:143], a[128:131], v[92:95], v[172:175]
 v_exp_f32 v158, v158
 v_mfma_f32_16x16x32_bf16 v[140:143], a[132:135], v[108:111], v[140:143]
 v_add_f32 v126, v126, v155
 v_cvt_pk_bf16_f32 v219, v154, v155
 v_mfma_f32_16x16x32_bf16 v[140:143], a[136:139], v[60:63], v[140:143]
 s_add_u32 m0, s91, 0
 s_add_u32 s86, s89, 0
 buffer_load_dwordx4 v2, s[48:51], s86 offen offset:0 sc1 lds
 v_exp_f32 v159, v159
 v_mfma_f32_16x16x32_bf16 v[140:143], a[140:143], v[76:79], v[140:143]
 s_waitcnt lgkmcnt(0)
 ds_read_b128 a[144:147], v246 offset:61440
 v_cvt_pk_bf16_f32 v222, v156, v157
 v_mfma_f32_16x16x32_bf16 a[64:67], a[160:163], v[176:179], a[64:67]
 v_exp_f32 v128, v128
 v_mfma_f32_16x16x32_bf16 a[64:67], a[164:167], v[192:195], a[64:67]
 ds_read_b128 a[148:151], v247 offset:61440
 v_cvt_pk_bf16_f32 v223, v158, v159
 v_mfma_f32_16x16x32_bf16 a[68:71], a[160:163], v[180:183], a[68:71]
 v_exp_f32 v129, v129
 v_mfma_f32_16x16x32_bf16 a[68:71], a[164:167], v[196:199], a[68:71]
 ds_read_b128 a[152:155], v248 offset:61440
 v_add_f32 v124, v124, v128
 v_mfma_f32_16x16x32_bf16 a[72:75], a[160:163], v[184:187], a[72:75]
 v_exp_f32 v130, v130
 v_mfma_f32_16x16x32_bf16 a[72:75], a[164:167], v[200:203], a[72:75]
 ds_read_b128 a[156:159], v249 offset:61440
 v_add_f32 v124, v124, v129
 v_mfma_f32_16x16x32_bf16 a[76:79], a[160:163], v[188:191], a[76:79]
 v_exp_f32 v131, v131
 v_mfma_f32_16x16x32_bf16 a[76:79], a[164:167], v[204:207], a[76:79]
 buffer_load_dwordx4 v2, s[48:51], s86 offen offset:1024 sc1 lds
 v_mfma_f32_16x16x32_bf16 a[80:83], a[168:171], v[176:179], a[80:83]
 v_exp_f32 v132, v132
 v_mfma_f32_16x16x32_bf16 a[80:83], a[172:175], v[192:195], a[80:83]
 ds_read_b64_tr_b16 a[160:161], v22 offset:32768
 buffer_load_dwordx4 v2, s[48:51], s86 offen offset:2048 sc1 lds
 v_cvt_pk_bf16_f32 v224, v128, v129
 v_mfma_f32_16x16x32_bf16 a[84:87], a[168:171], v[180:183], a[84:87]
 v_exp_f32 v133, v133
 v_mfma_f32_16x16x32_bf16 a[84:87], a[172:175], v[196:199], a[84:87]
 ds_read_b64_tr_b16 a[162:163], v22 offset:36864
 v_add_f32 v124, v124, v130
 v_mfma_f32_16x16x32_bf16 a[88:91], a[168:171], v[184:187], a[88:91]
 v_exp_f32 v134, v134
 v_mfma_f32_16x16x32_bf16 a[88:91], a[172:175], v[200:203], a[88:91]
 ds_read_b64_tr_b16 a[164:165], v22 offset:40960
 v_add_f32 v124, v124, v131
 v_mfma_f32_16x16x32_bf16 a[92:95], a[168:171], v[188:191], a[92:95]
 v_exp_f32 v135, v135
 v_mfma_f32_16x16x32_bf16 a[92:95], a[172:175], v[204:207], a[92:95]
 ds_read_b64_tr_b16 a[166:167], v22 offset:45056
 v_cvt_pk_bf16_f32 v225, v130, v131
 v_mfma_f32_16x16x32_bf16 a[200:203], a[192:195], v[188:191], a[200:203]
 v_cvt_pk_bf16_f32 v228, v132, v133
 v_cvt_pk_bf16_f32 v229, v134, v135
 v_mfma_f32_16x16x32_bf16 a[200:203], a[192:195], v[204:207], a[200:203]
 s_waitcnt lgkmcnt(4)
 buffer_load_dwordx4 v2, s[48:51], s86 offen offset:3072 sc1 lds
 v_mfma_f32_16x16x32_bf16 v[144:147], a[144:147], v[80:83], v[160:163]
 v_exp_f32 v136, v136
 v_mfma_f32_16x16x32_bf16 v[144:147], a[148:151], v[96:99], v[144:147]
 ds_read_b64_tr_b16 a[168:169], v23 offset:32768
 s_add_u32 m0, s91, 4096
 s_add_u32 s86, s89, 4096
 buffer_load_dwordx4 v2, s[48:51], s86 offen offset:0 sc1 lds
 v_mfma_f32_16x16x32_bf16 v[144:147], a[152:155], v[48:51], v[144:147]
 v_exp_f32 v137, v137
 v_mfma_f32_16x16x32_bf16 v[144:147], a[156:159], v[64:67], v[144:147]
 ds_read_b64_tr_b16 a[170:171], v23 offset:36864
 v_add_f32 v126, v126, v136
 v_mfma_f32_16x16x32_bf16 v[148:151], a[144:147], v[84:87], v[164:167]
 v_exp_f32 v138, v138
 v_mfma_f32_16x16x32_bf16 v[148:151], a[148:151], v[100:103], v[148:151]
 ds_read_b64_tr_b16 a[172:173], v23 offset:40960
 v_add_f32 v126, v126, v137
 v_mfma_f32_16x16x32_bf16 v[148:151], a[152:155], v[52:55], v[148:151]
 v_exp_f32 v139, v139
 v_mfma_f32_16x16x32_bf16 v[148:151], a[156:159], v[68:71], v[148:151]
 ds_read_b64_tr_b16 a[174:175], v23 offset:45056
 v_cvt_pk_bf16_f32 v232, v136, v137
 v_mfma_f32_16x16x32_bf16 v[152:155], a[144:147], v[88:91], v[168:171]
 v_exp_f32 v140, v140
 v_mfma_f32_16x16x32_bf16 v[152:155], a[148:151], v[104:107], v[152:155]
 buffer_load_dwordx4 v2, s[48:51], s86 offen offset:1024 sc1 lds
 v_mfma_f32_16x16x32_bf16 v[152:155], a[152:155], v[56:59], v[152:155]
 v_exp_f32 v141, v141
 v_mfma_f32_16x16x32_bf16 v[152:155], a[156:159], v[72:75], v[152:155]
 buffer_load_dwordx4 v2, s[48:51], s86 offen offset:2048 sc1 lds
 v_add_f32 v126, v126, v138
 v_add_f32 v126, v126, v139
 v_mfma_f32_16x16x32_bf16 v[156:159], a[144:147], v[92:95], v[172:175]
 v_exp_f32 v142, v142
 v_mfma_f32_16x16x32_bf16 v[156:159], a[148:151], v[108:111], v[156:159]
 v_cvt_pk_bf16_f32 v233, v138, v139
 v_cvt_pk_bf16_f32 v236, v140, v141
 v_mfma_f32_16x16x32_bf16 v[156:159], a[152:155], v[60:63], v[156:159]
 v_exp_f32 v143, v143
 v_mfma_f32_16x16x32_bf16 v[156:159], a[156:159], v[76:79], v[156:159]
 s_waitcnt lgkmcnt(0)
 s_barrier
 ds_read_b64_tr_b16 a[128:129], v17 offset:49152
 v_mfma_f32_16x16x32_bf16 a[96:99], a[160:163], v[176:179], a[96:99]
 buffer_load_dwordx4 v2, s[48:51], s86 offen offset:3072 sc1 lds
 v_exp_f32 v144, v144
 v_mfma_f32_16x16x32_bf16 a[96:99], a[164:167], v[192:195], a[96:99]
 ds_read_b64_tr_b16 a[130:131], v17 offset:53248
 v_cvt_pk_bf16_f32 v237, v142, v143
 v_mfma_f32_16x16x32_bf16 a[100:103], a[160:163], v[180:183], a[100:103]
 v_exp_f32 v145, v145
 v_mfma_f32_16x16x32_bf16 a[100:103], a[164:167], v[196:199], a[100:103]
 ds_read_b64_tr_b16 a[132:133], v18 offset:49152
 v_add_f32 v124, v124, v144
 v_mfma_f32_16x16x32_bf16 a[104:107], a[160:163], v[184:187], a[104:107]
 v_exp_f32 v146, v146
 v_mfma_f32_16x16x32_bf16 a[104:107], a[164:167], v[200:203], a[104:107]
 ds_read_b64_tr_b16 a[134:135], v18 offset:53248
 v_add_f32 v124, v124, v145
 v_mfma_f32_16x16x32_bf16 a[108:111], a[160:163], v[188:191], a[108:111]
 v_exp_f32 v147, v147
 v_mfma_f32_16x16x32_bf16 a[108:111], a[164:167], v[204:207], a[108:111]
 s_add_u32 m0, s91, 8192
 s_add_u32 s86, s89, 8192
 buffer_load_dwordx4 v2, s[48:51], s86 offen offset:0 sc1 lds
 v_mfma_f32_16x16x32_bf16 a[112:115], a[168:171], v[176:179], a[112:115]
 s_add_u32 s76, s76, 16384
 v_exp_f32 v148, v148
 v_mfma_f32_16x16x32_bf16 a[112:115], a[172:175], v[192:195], a[112:115]
 ds_read_b64_tr_b16 a[160:161], v16 offset:49152
 v_cvt_pk_bf16_f32 v226, v144, v145
 v_mfma_f32_16x16x32_bf16 a[116:119], a[168:171], v[180:183], a[116:119]
 v_exp_f32 v149, v149
 v_mfma_f32_16x16x32_bf16 a[116:119], a[172:175], v[196:199], a[116:119]
 ds_read_b64_tr_b16 a[162:163], v16 offset:53248
 v_add_f32 v124, v124, v146
 v_mfma_f32_16x16x32_bf16 a[120:123], a[168:171], v[184:187], a[120:123]
 v_exp_f32 v150, v150
 v_mfma_f32_16x16x32_bf16 a[120:123], a[172:175], v[200:203], a[120:123]
 ds_read_b64_tr_b16 a[164:165], v16 offset:57344
 v_add_f32 v124, v124, v147
 v_mfma_f32_16x16x32_bf16 a[124:127], a[168:171], v[188:191], a[124:127]
 v_exp_f32 v151, v151
 v_mfma_f32_16x16x32_bf16 a[124:127], a[172:175], v[204:207], a[124:127]
 s_waitcnt lgkmcnt(3)
 ds_read_b64_tr_b16 a[166:167], v16 offset:61440
 v_cvt_pk_bf16_f32 v227, v146, v147
L_att_t31:
 v_mfma_f32_16x16x32_bf16 a[196:199], a[192:195], v[212:215], a[196:199]
 s_add_u32 m0, s91, 36864
 ds_read_b64_tr_b16 a[136:137], v19 offset:49152
 v_cvt_pk_bf16_f32 v230, v148, v149
 v_mfma_f32_16x16x32_bf16 a[200:203], a[192:195], v[220:223], a[200:203]
 s_add_u32 s86, s89, 147456
 buffer_load_dwordx4 v2, s[48:51], s86 offen offset:0 sc1 lds
 s_waitcnt lgkmcnt(3)
 v_mfma_f32_16x16x32_bf16 a[0:3], a[160:163], v[208:211], a[0:3]
 ds_read_b64_tr_b16 a[138:139], v19 offset:53248
 v_cvt_pk_bf16_f32 v231, v150, v151
 v_mfma_f32_16x16x32_bf16 a[4:7], a[160:163], v[212:215], a[4:7]
 v_exp_f32 v152, v152
 v_mfma_f32_16x16x32_bf16 a[8:11], a[160:163], v[216:219], a[8:11]
 ds_read_b64_tr_b16 a[140:141], v20 offset:49152
 v_exp_f32 v153, v153
 v_mfma_f32_16x16x32_bf16 a[12:15], a[160:163], v[220:223], a[12:15]
 buffer_load_dwordx4 v2, s[48:51], s86 offen offset:1024 sc1 lds
 v_mfma_f32_16x16x32_bf16 a[16:19], a[128:131], v[208:211], a[16:19]
 ds_read_b64_tr_b16 a[142:143], v20 offset:53248
 v_add_f32 v126, v126, v152
 v_mfma_f32_16x16x32_bf16 a[20:23], a[128:131], v[212:215], a[20:23]
 v_exp_f32 v154, v154
 v_mfma_f32_16x16x32_bf16 a[24:27], a[128:131], v[216:219], a[24:27]
 ds_read_b64_tr_b16 a[144:145], v21 offset:49152
 v_add_f32 v126, v126, v153
 v_mfma_f32_16x16x32_bf16 a[28:31], a[128:131], v[220:223], a[28:31]
 buffer_load_dwordx4 v2, s[48:51], s86 offen offset:2048 sc1 lds
 v_cvt_pk_bf16_f32 v234, v152, v153
 v_mfma_f32_16x16x32_bf16 a[32:35], a[132:135], v[208:211], a[32:35]
 ds_read_b64_tr_b16 a[146:147], v21 offset:53248
 v_add_f32 v126, v126, v154
 v_mfma_f32_16x16x32_bf16 a[36:39], a[132:135], v[212:215], a[36:39]
 v_exp_f32 v155, v155
 v_mfma_f32_16x16x32_bf16 a[40:43], a[132:135], v[216:219], a[40:43]
 ds_read_b64_tr_b16 a[148:149], v22 offset:49152
 v_mov_b32 v10, v124
 v_mfma_f32_16x16x32_bf16 a[44:47], a[132:135], v[220:223], a[44:47]
 buffer_load_dwordx4 v2, s[48:51], s86 offen offset:3072 sc1 lds
 s_waitcnt lgkmcnt(5)
 v_mfma_f32_16x16x32_bf16 a[48:51], a[136:139], v[208:211], a[48:51]
 ds_read_b64_tr_b16 a[150:151], v22 offset:53248
 v_exp_f32 v156, v156
 v_mfma_f32_16x16x32_bf16 a[52:55], a[136:139], v[212:215], a[52:55]
 v_exp_f32 v157, v157
 v_mfma_f32_16x16x32_bf16 a[56:59], a[136:139], v[216:219], a[56:59]
 s_add_u32 m0, s91, 40960
 ds_read_b64_tr_b16 a[152:153], v23 offset:49152
 v_add_f32 v126, v126, v155
 v_mfma_f32_16x16x32_bf16 a[60:63], a[136:139], v[220:223], a[60:63]
 s_add_u32 s86, s89, 151552
 buffer_load_dwordx4 v2, s[48:51], s86 offen offset:0 sc1 lds
 s_waitcnt lgkmcnt(5)
 v_mfma_f32_16x16x32_bf16 a[64:67], a[140:143], v[208:211], a[64:67]
 ds_read_b64_tr_b16 a[154:155], v23 offset:53248
 v_cvt_pk_bf16_f32 v235, v154, v155
 v_mfma_f32_16x16x32_bf16 a[68:71], a[140:143], v[212:215], a[68:71]
 v_exp_f32 v158, v158
 v_cvt_pk_bf16_f32 v238, v156, v157
 v_mfma_f32_16x16x32_bf16 a[72:75], a[140:143], v[216:219], a[72:75]
 ds_read_b64_tr_b16 a[156:157], v17 offset:57344
 v_mov_b32 v12, v126
 v_mfma_f32_16x16x32_bf16 a[76:79], a[140:143], v[220:223], a[76:79]
 buffer_load_dwordx4 v2, s[48:51], s86 offen offset:1024 sc1 lds
 s_waitcnt lgkmcnt(5)
 v_mfma_f32_16x16x32_bf16 a[80:83], a[144:147], v[208:211], a[80:83]
 ds_read_b64_tr_b16 a[158:159], v17 offset:61440
 v_permlane16_swap_b32 v10, v124
 v_mfma_f32_16x16x32_bf16 a[84:87], a[144:147], v[212:215], a[84:87]
 v_exp_f32 v159, v159
 v_mfma_f32_16x16x32_bf16 a[88:91], a[144:147], v[216:219], a[88:91]
 ds_read_b64_tr_b16 a[128:129], v18 offset:57344
 v_permlane16_swap_b32 v12, v126
 v_add_f32 v124, v124, v10
 v_mfma_f32_16x16x32_bf16 a[92:95], a[144:147], v[220:223], a[92:95]
 buffer_load_dwordx4 v2, s[48:51], s86 offen offset:2048 sc1 lds
 s_waitcnt lgkmcnt(5)
 v_mfma_f32_16x16x32_bf16 a[96:99], a[148:151], v[208:211], a[96:99]
 s_and_b32 s92, s80, 1
 ds_read_b64_tr_b16 a[130:131], v18 offset:61440
 v_cvt_pk_bf16_f32 v239, v158, v159
 v_mfma_f32_16x16x32_bf16 a[100:103], a[148:151], v[212:215], a[100:103]
 s_lshl2_add_u32 s83, s81, s82
 v_add_f32 v126, v126, v12
 v_mov_b32 v10, v124
 v_mfma_f32_16x16x32_bf16 a[104:107], a[148:151], v[216:219], a[104:107]
 s_lshl_b32 s99, s83, 7
 ds_read_b64_tr_b16 a[132:133], v19 offset:57344
 v_mfma_f32_16x16x32_bf16 a[108:111], a[148:151], v[220:223], a[108:111]
 s_lshl2_add_u32 s83, s83, s80
 buffer_load_dwordx4 v2, s[48:51], s86 offen offset:3072 sc1 lds
 v_mov_b32 v12, v126
 s_waitcnt lgkmcnt(5)
 v_mfma_f32_16x16x32_bf16 a[112:115], a[152:155], v[208:211], a[112:115]
 s_lshl2_add_u32 s83, s83, s52
 ds_read_b64_tr_b16 a[134:135], v19 offset:61440
 v_permlane32_swap_b32 v10, v124
 v_mfma_f32_16x16x32_bf16 a[116:119], a[152:155], v[212:215], a[116:119]
 s_mul_i32 s95, s83, 16384
 v_permlane32_swap_b32 v12, v126
 v_add_f32 v124, v124, v10
 v_add_f32 v126, v126, v12
 v_mfma_f32_16x16x32_bf16 a[120:123], a[152:155], v[216:219], a[120:123]
 s_add_u32 m0, s91, 45056
 ds_read_b64_tr_b16 a[136:137], v20 offset:57344
 v_mfma_f32_16x16x32_bf16 a[124:127], a[152:155], v[220:223], a[124:127]
 s_add_u32 s86, s89, 155648
 buffer_load_dwordx4 v2, s[48:51], s86 offen offset:0 sc1 lds
 v_mfma_f32_16x16x32_bf16 a[196:199], a[192:195], v[228:231], a[196:199]
 s_lshr_b32 s83, s81, 1
 ds_read_b64_tr_b16 a[138:139], v20 offset:61440
 v_mfma_f32_16x16x32_bf16 a[200:203], a[192:195], v[236:239], a[200:203]
 s_lshl_b32 s83, s83, 7
 v_rcp_f32 v240, v124
 v_mfma_f32_16x16x32_bf16 a[0:3], a[164:167], v[224:227], a[0:3]
 s_lshl_b32 s84, s80, 5
 ds_read_b64_tr_b16 a[140:141], v21 offset:57344
 v_mfma_f32_16x16x32_bf16 a[4:7], a[164:167], v[228:231], a[4:7]
 s_add_u32 s98, s83, s84
 v_rcp_f32 v242, v126
 v_mfma_f32_16x16x32_bf16 a[8:11], a[164:167], v[232:235], a[8:11]
 s_add_u32 s98, s98, 8192
 ds_read_b64_tr_b16 a[142:143], v21 offset:61440
 v_mfma_f32_16x16x32_bf16 a[12:15], a[164:167], v[236:239], a[12:15]
 s_lshl_b32 s83, s81, 7
 s_waitcnt lgkmcnt(8)
 v_mfma_f32_16x16x32_bf16 a[16:19], a[156:159], v[224:227], a[16:19]
 s_lshl_b32 s84, s52, 5
 ds_read_b64_tr_b16 a[144:145], v22 offset:57344
 v_and_b32 v24, 15, v1
 v_mfma_f32_16x16x32_bf16 a[20:23], a[156:159], v[228:231], a[20:23]
 s_add_u32 s83, s83, s84
 v_accvgpr_read_b32 v125, a196
 v_accvgpr_read_b32 v127, a200
 v_mfma_f32_16x16x32_bf16 a[24:27], a[156:159], v[232:235], a[24:27]
 s_lshr_b32 s84, s80, 1
 ds_read_b64_tr_b16 a[146:147], v22 offset:61440
 v_lshrrev_b32 v25, 4, v1
 v_mfma_f32_16x16x32_bf16 a[28:31], a[156:159], v[236:239], a[28:31]
 s_lshl4_add_u32 s83, s84, s83
 v_rcp_f32 v241, v125
 s_waitcnt lgkmcnt(8)
 v_mfma_f32_16x16x32_bf16 a[32:35], a[128:131], v[224:227], a[32:35]
 s_mul_i32 s84, s92, 160
 ds_read_b64_tr_b16 a[148:149], v23 offset:57344
 v_add_u32 v24, s83, v24
 v_mfma_f32_16x16x32_bf16 a[36:39], a[128:131], v[228:231], a[36:39]
 s_mul_i32 s83, s82, 288
 v_rcp_f32 v243, v127
 v_mfma_f32_16x16x32_bf16 a[40:43], a[128:131], v[232:235], a[40:43]
 s_add_u32 s83, s83, s84
 ds_read_b64_tr_b16 a[150:151], v23 offset:61440
 v_mul_u32_u24 v24, 1152, v24
 v_mfma_f32_16x16x32_bf16 a[44:47], a[128:131], v[236:239], a[44:47]
 v_cmp_nge_f32 vcc, s78, v124
 s_cbranch_vccnz L_slow
 s_waitcnt lgkmcnt(8)
 v_mfma_f32_16x16x32_bf16 a[48:51], a[132:135], v[224:227], a[48:51]
 v_cmp_nge_f32 vcc, s78, v125
 s_cbranch_vccnz L_slow
 v_mfma_f32_16x16x32_bf16 a[52:55], a[132:135], v[228:231], a[52:55]
 v_cmp_nge_f32 vcc, s78, v126
 s_cbranch_vccnz L_slow
 v_mfma_f32_16x16x32_bf16 a[56:59], a[132:135], v[232:235], a[56:59]
 v_cmp_nge_f32 vcc, s78, v127
 s_cbranch_vccnz L_slow
 v_mfma_f32_16x16x32_bf16 a[60:63], a[132:135], v[236:239], a[60:63]
 s_mul_i32 s84, s92, 5120
 v_lshl_add_u32 v24, v25, 3, v24
 v_lshlrev_b32 v9, 3, v1
 s_waitcnt lgkmcnt(6)
 v_mfma_f32_16x16x32_bf16 a[64:67], a[136:139], v[224:227], a[64:67]
 v_add_u32 v8, s83, v24
 v_and_b32 v29, 3, v1
 v_mfma_f32_16x16x32_bf16 a[68:71], a[136:139], v[228:231], a[68:71]
 v_lshlrev_b32 v29, 2, v29
 v_add_u32 v3, s84, v2
 v_mfma_f32_16x16x32_bf16 a[72:75], a[136:139], v[232:235], a[72:75]
 s_sub_u32 s84, 5120, s84
 v_mov_b32 v4, v2
 v_add_u32 v5, s84, v2
 v_mfma_f32_16x16x32_bf16 a[76:79], a[136:139], v[236:239], a[76:79]
 s_waitcnt lgkmcnt(4)
 v_mfma_f32_16x16x32_bf16 a[80:83], a[140:143], v[224:227], a[80:83]
 v_mfma_f32_16x16x32_bf16 a[84:87], a[140:143], v[228:231], a[84:87]
 s_waitcnt vmcnt(9)
 s_barrier
 v_mfma_f32_16x16x32_bf16 a[88:91], a[140:143], v[232:235], a[88:91]
 ds_read_b128 v[32:35], v3 offset:0
 v_mfma_f32_16x16x32_bf16 a[92:95], a[140:143], v[236:239], a[92:95]
 ds_read_b128 v[36:39], v3 offset:9216
 s_waitcnt lgkmcnt(4)
 v_mfma_f32_16x16x32_bf16 a[96:99], a[144:147], v[224:227], a[96:99]
 ds_read_b128 v[40:43], v3 offset:18432
 v_mfma_f32_16x16x32_bf16 a[100:103], a[144:147], v[228:231], a[100:103]
 ds_read_b128 v[44:47], v3 offset:27648
 v_mfma_f32_16x16x32_bf16 a[104:107], a[144:147], v[232:235], a[104:107]
 ds_read_b128 v[48:51], v3 offset:1024
 v_mfma_f32_16x16x32_bf16 a[108:111], a[144:147], v[236:239], a[108:111]
 ds_read_b128 v[52:55], v3 offset:10240
 s_waitcnt lgkmcnt(6)
 v_mfma_f32_16x16x32_bf16 a[112:115], a[148:151], v[224:227], a[112:115]
 ds_read_b128 v[56:59], v3 offset:19456
 v_mfma_f32_16x16x32_bf16 a[116:119], a[148:151], v[228:231], a[116:119]
 ds_read_b128 v[60:63], v3 offset:28672
 v_mfma_f32_16x16x32_bf16 a[120:123], a[148:151], v[232:235], a[120:123]
 v_mfma_f32_16x16x32_bf16 a[124:127], a[148:151], v[236:239], a[124:127]
L_fin_join:
 s_waitcnt lgkmcnt(7)
 v_mfma_f32_16x16x32_bf16 v[80:83], v[32:35], a[204:207], 0
 s_add_u32 m0, s91, 73728
 ds_read_b128 v[64:67], v3 offset:2048
 s_waitcnt lgkmcnt(7)
 v_mfma_f32_16x16x32_bf16 v[80:83], v[36:39], a[212:215], v[80:83]
 s_add_u32 s86, s89, 294912
 buffer_load_dwordx4 v2, s[48:51], s86 offen offset:0 sc1 lds
 s_waitcnt lgkmcnt(6)
 v_mfma_f32_16x16x32_bf16 v[80:83], v[40:43], a[220:223], v[80:83]
 ds_read_b128 v[68:71], v3 offset:11264
 s_waitcnt lgkmcnt(6)
 v_mfma_f32_16x16x32_bf16 v[80:83], v[44:47], a[228:231], v[80:83]
 v_mfma_f32_16x16x32_bf16 v[116:119], v[32:35], a[208:211], 0
 s_add_u32 s59, s64, 0
 ds_read_b128 v[72:75], v3 offset:20480
 v_accvgpr_read_b32 v152, a0
 v_mfma_f32_16x16x32_bf16 v[116:119], v[36:39], a[216:219], v[116:119]
 buffer_load_dwordx4 v2, s[48:51], s86 offen offset:1024 sc1 lds
 v_accvgpr_read_b32 v153, a1
 v_mfma_f32_16x16x32_bf16 v[116:119], v[40:43], a[224:227], v[116:119]
 ds_read_b128 v[76:79], v3 offset:29696
 v_accvgpr_read_b32 v154, a2
 v_accvgpr_read_b32 v155, a3
 v_mfma_f32_16x16x32_bf16 v[116:119], v[44:47], a[232:235], v[116:119]
 s_add_u32 s40, s48, 10485760
 s_addc_u32 s41, s49, 0
 s_mov_b32 s42, 16777216
 s_mov_b32 s43, 0x20000
 s_waitcnt lgkmcnt(7)
 v_mfma_f32_16x16x32_bf16 v[84:87], v[48:51], a[204:207], 0
 s_mov_b32 s24, s8
 ds_read_b128 v[32:35], v3 offset:3072
 v_accvgpr_read_b32 v156, a16
 v_accvgpr_read_b32 v157, a17
 s_waitcnt lgkmcnt(7)
 v_mfma_f32_16x16x32_bf16 v[84:87], v[52:55], a[212:215], v[84:87]
 s_mov_b32 s25, s9
 buffer_load_dwordx4 v2, s[48:51], s86 offen offset:2048 sc1 lds
 v_accvgpr_read_b32 v158, a18
 s_waitcnt lgkmcnt(6)
 v_mfma_f32_16x16x32_bf16 v[84:87], v[56:59], a[220:223], v[84:87]
 s_mov_b32 s26, 2359296
 ds_read_b128 v[36:39], v3 offset:12288
 v_accvgpr_read_b32 v159, a19
 s_waitcnt lgkmcnt(6)
 v_mfma_f32_16x16x32_bf16 v[84:87], v[60:63], a[228:231], v[84:87]
 s_mov_b32 s27, 0x20000
 v_mul_f32 v152, v152, v240
 v_mul_f32 v153, v153, v240
 v_mul_f32 v154, v154, v240
 v_mfma_f32_16x16x32_bf16 v[120:123], v[48:51], a[208:211], 0
 s_mov_b32 s28, s12
 ds_read_b128 v[40:43], v3 offset:21504
 v_mul_f32 v155, v155, v240
 v_mul_f32 v156, v156, v240
 v_mfma_f32_16x16x32_bf16 v[120:123], v[52:55], a[216:219], v[120:123]
 s_mov_b32 s29, s13
 buffer_load_dwordx4 v2, s[48:51], s86 offen offset:3072 sc1 lds
 v_mul_f32 v157, v157, v240
 v_mfma_f32_16x16x32_bf16 v[120:123], v[56:59], a[224:227], v[120:123]
 s_mov_b32 s30, 2359296
 ds_read_b128 v[44:47], v3 offset:30720
 v_mul_f32 v158, v158, v240
 v_mfma_f32_16x16x32_bf16 v[120:123], v[60:63], a[232:235], v[120:123]
 s_waitcnt lgkmcnt(4)
 v_mul_f32 v159, v159, v240
 v_cvt_pk_bf16_f32 v160, v152, v153
 v_cvt_pk_bf16_f32 v161, v154, v155
 v_mfma_f32_16x16x32_bf16 v[88:91], v[64:67], a[204:207], 0
 s_add_u32 m0, s91, 77824
 ds_read_b128 v[48:51], v4 offset:4096
 v_cvt_pk_bf16_f32 v162, v156, v157
 v_accvgpr_read_b32 v164, a4
 v_mfma_f32_16x16x32_bf16 v[88:91], v[68:71], a[212:215], v[88:91]
 s_add_u32 s86, s89, 299008
 buffer_load_dwordx4 v2, s[48:51], s86 offen offset:0 sc1 lds
 v_mfma_f32_16x16x32_bf16 v[88:91], v[72:75], a[220:223], v[88:91]
 s_mov_b32 s31, 0x20000
 ds_read_b128 v[52:55], v4 offset:13312
 v_cvt_pk_bf16_f32 v163, v158, v159
 v_accvgpr_read_b32 v165, a5
 v_mfma_f32_16x16x32_bf16 v[88:91], v[76:79], a[228:231], v[88:91]
 v_accvgpr_read_b32 v166, a6
 v_accvgpr_read_b32 v167, a7
 v_accvgpr_read_b32 v168, a20
 v_mfma_f32_16x16x32_bf16 v[124:127], v[64:67], a[208:211], 0
 ds_read_b128 v[56:59], v4 offset:22528
 v_accvgpr_read_b32 v169, a21
 v_mfma_f32_16x16x32_bf16 v[124:127], v[68:71], a[216:219], v[124:127]
 buffer_load_dwordx4 v2, s[48:51], s86 offen offset:1024 sc1 lds
 v_accvgpr_read_b32 v170, a22
 v_mfma_f32_16x16x32_bf16 v[124:127], v[72:75], a[224:227], v[124:127]
 ds_read_b128 v[60:63], v4 offset:31744
 v_accvgpr_read_b32 v171, a23
 v_mul_f32 v164, v164, v241
 v_mfma_f32_16x16x32_bf16 v[124:127], v[76:79], a[232:235], v[124:127]
 s_waitcnt lgkmcnt(4)
 buffer_store_dwordx4 v[160:163], v2, s[36:39], s59 offen sc1
 v_mfma_f32_16x16x32_bf16 v[92:95], v[32:35], a[204:207], 0
 s_add_u32 s59, s65, 0
 ds_read_b128 v[64:67], v5 offset:0
 v_mul_f32 v165, v165, v241
 v_mfma_f32_16x16x32_bf16 v[92:95], v[36:39], a[212:215], v[92:95]
 buffer_load_dwordx4 v2, s[48:51], s86 offen offset:2048 sc1 lds
 v_mul_f32 v166, v166, v241
 v_mfma_f32_16x16x32_bf16 v[92:95], v[40:43], a[220:223], v[92:95]
 ds_read_b128 v[68:71], v5 offset:9216
 v_mul_f32 v167, v167, v241
 v_mul_f32 v168, v168, v241
 v_mfma_f32_16x16x32_bf16 v[92:95], v[44:47], a[228:231], v[92:95]
 v_mul_f32 v169, v169, v241
 v_mul_f32 v170, v170, v241
 v_mfma_f32_16x16x32_bf16 v[128:131], v[32:35], a[208:211], 0
 ds_read_b128 v[72:75], v5 offset:18432
 v_mul_f32 v171, v171, v241
 v_cvt_pk_bf16_f32 v172, v164, v165
 v_mfma_f32_16x16x32_bf16 v[128:131], v[36:39], a[216:219], v[128:131]
 buffer_load_dwordx4 v2, s[48:51], s86 offen offset:3072 sc1 lds
 v_cvt_pk_bf16_f32 v173, v166, v167
 v_mfma_f32_16x16x32_bf16 v[128:131], v[40:43], a[224:227], v[128:131]
 ds_read_b128 v[76:79], v5 offset:27648
 v_cvt_pk_bf16_f32 v174, v168, v169
 v_mfma_f32_16x16x32_bf16 v[128:131], v[44:47], a[232:235], v[128:131]
 s_waitcnt lgkmcnt(4)
 v_cvt_pk_bf16_f32 v175, v170, v171
 v_accvgpr_read_b32 v176, a8
 v_accvgpr_read_b32 v177, a9
 v_mfma_f32_16x16x32_bf16 v[96:99], v[48:51], a[204:207], 0
 s_add_u32 m0, s91, 81920
 ds_read_b128 v[32:35], v5 offset:1024
 v_accvgpr_read_b32 v178, a10
 v_accvgpr_read_b32 v179, a11
 v_mfma_f32_16x16x32_bf16 v[96:99], v[52:55], a[212:215], v[96:99]
 s_add_u32 s86, s89, 303104
 buffer_load_dwordx4 v2, s[48:51], s86 offen offset:0 sc1 lds
 v_accvgpr_read_b32 v180, a24
 v_mfma_f32_16x16x32_bf16 v[96:99], v[56:59], a[220:223], v[96:99]
 ds_read_b128 v[36:39], v5 offset:10240
 v_accvgpr_read_b32 v181, a25
 v_mfma_f32_16x16x32_bf16 v[96:99], v[60:63], a[228:231], v[96:99]
 buffer_store_dwordx4 v[172:175], v2, s[36:39], s59 offen sc1
 v_mfma_f32_16x16x32_bf16 v[132:135], v[48:51], a[208:211], 0
 s_add_u32 s59, s66, 0
 ds_read_b128 v[40:43], v5 offset:19456
 v_accvgpr_read_b32 v182, a26
 v_accvgpr_read_b32 v183, a27
 v_mfma_f32_16x16x32_bf16 v[132:135], v[52:55], a[216:219], v[132:135]
 s_add_u32 s83, s87, 1048576
 buffer_load_dwordx4 a[128:131], v6, s[16:19], s83 offen sc1
 v_mfma_f32_16x16x32_bf16 v[132:135], v[56:59], a[224:227], v[132:135]
 ds_read_b128 v[44:47], v5 offset:28672
 v_mul_f32 v176, v176, v242
 v_mul_f32 v177, v177, v242
 v_mfma_f32_16x16x32_bf16 v[132:135], v[60:63], a[232:235], v[132:135]
 s_waitcnt lgkmcnt(4)
 v_mul_f32 v178, v178, v242
 v_mul_f32 v179, v179, v242
 v_mul_f32 v180, v180, v242
 v_mfma_f32_16x16x32_bf16 v[100:103], v[64:67], a[204:207], 0
 ds_read_b128 v[48:51], v5 offset:2048
 v_mul_f32 v181, v181, v242
 v_mul_f32 v182, v182, v242
 v_mfma_f32_16x16x32_bf16 v[100:103], v[68:71], a[212:215], v[100:103]
 buffer_load_dwordx4 a[132:135], v7, s[16:19], s83 offen sc1
 v_mfma_f32_16x16x32_bf16 v[100:103], v[72:75], a[220:223], v[100:103]
 ds_read_b128 v[52:55], v5 offset:11264
 v_mul_f32 v183, v183, v242
 v_cvt_pk_bf16_f32 v184, v176, v177
 v_mfma_f32_16x16x32_bf16 v[100:103], v[76:79], a[228:231], v[100:103]
 v_cvt_pk_bf16_f32 v185, v178, v179
 v_cvt_pk_bf16_f32 v186, v180, v181
 v_accvgpr_read_b32 v188, a12
 v_mfma_f32_16x16x32_bf16 v[136:139], v[64:67], a[208:211], 0
 ds_read_b128 v[56:59], v5 offset:20480
 v_cvt_pk_bf16_f32 v187, v182, v183
 v_mfma_f32_16x16x32_bf16 v[136:139], v[68:71], a[216:219], v[136:139]
 s_add_u32 s83, s87, 1179648
 buffer_load_dwordx4 a[136:139], v6, s[16:19], s83 offen sc1
 v_accvgpr_read_b32 v189, a13
 v_mfma_f32_16x16x32_bf16 v[136:139], v[72:75], a[224:227], v[136:139]
 ds_read_b128 v[60:63], v5 offset:29696
 v_accvgpr_read_b32 v190, a14
 v_accvgpr_read_b32 v191, a15
 v_mfma_f32_16x16x32_bf16 v[136:139], v[76:79], a[232:235], v[136:139]
 s_waitcnt lgkmcnt(4)
 buffer_store_dwordx4 v[184:187], v2, s[36:39], s59 offen sc1
 v_mfma_f32_16x16x32_bf16 v[104:107], v[32:35], a[204:207], 0
 s_add_u32 s59, s67, 0
 ds_read_b128 v[64:67], v5 offset:3072
 v_accvgpr_read_b32 v192, a28
 v_mfma_f32_16x16x32_bf16 v[104:107], v[36:39], a[212:215], v[104:107]
 buffer_load_dwordx4 a[140:143], v7, s[16:19], s83 offen sc1
 v_accvgpr_read_b32 v193, a29
 v_mfma_f32_16x16x32_bf16 v[104:107], v[40:43], a[220:223], v[104:107]
 ds_read_b128 v[68:71], v5 offset:12288
 v_accvgpr_read_b32 v194, a30
 v_accvgpr_read_b32 v195, a31
 v_mfma_f32_16x16x32_bf16 v[104:107], v[44:47], a[228:231], v[104:107]
 v_mul_f32 v188, v188, v243
 v_mul_f32 v189, v189, v243
 v_mfma_f32_16x16x32_bf16 v[140:143], v[32:35], a[208:211], 0
 ds_read_b128 v[72:75], v5 offset:21504
 v_mul_f32 v190, v190, v243
 v_mul_f32 v191, v191, v243
 v_mfma_f32_16x16x32_bf16 v[140:143], v[36:39], a[216:219], v[140:143]
 s_add_u32 s83, s87, 1310720
 buffer_load_dwordx4 a[144:147], v6, s[16:19], s83 offen sc1
 v_mul_f32 v192, v192, v243
 v_mfma_f32_16x16x32_bf16 v[140:143], v[40:43], a[224:227], v[140:143]
 ds_read_b128 v[76:79], v5 offset:30720
 v_mul_f32 v193, v193, v243
 v_mul_f32 v194, v194, v243
 v_mfma_f32_16x16x32_bf16 v[140:143], v[44:47], a[232:235], v[140:143]
 s_waitcnt vmcnt(17) lgkmcnt(4)
 s_barrier
 v_add_u32 v3, 0x9000, v3
 v_mfma_f32_16x16x32_bf16 v[108:111], v[48:51], a[204:207], 0
 ds_read_b128 v[32:35], v3 offset:0
 v_add_u32 v4, 0x9000, v4
 v_mul_f32 v195, v195, v243
 v_mfma_f32_16x16x32_bf16 v[108:111], v[52:55], a[212:215], v[108:111]
 buffer_load_dwordx4 a[148:151], v7, s[16:19], s83 offen sc1
 v_cvt_pk_bf16_f32 v196, v188, v189
 v_mfma_f32_16x16x32_bf16 v[108:111], v[56:59], a[220:223], v[108:111]
 ds_read_b128 v[36:39], v3 offset:9216
 v_add_u32 v5, 0x9000, v5
 v_mfma_f32_16x16x32_bf16 v[108:111], v[60:63], a[228:231], v[108:111]
 v_cvt_pk_bf16_f32 v197, v190, v191
 v_cvt_pk_bf16_f32 v198, v192, v193
 v_cvt_pk_bf16_f32 v199, v194, v195
 v_mfma_f32_16x16x32_bf16 v[144:147], v[48:51], a[208:211], 0
 ds_read_b128 v[40:43], v3 offset:18432
 v_accvgpr_read_b32 v152, a32
 v_accvgpr_read_b32 v153, a33
 v_mfma_f32_16x16x32_bf16 v[144:147], v[52:55], a[216:219], v[144:147]
 s_add_u32 s83, s87, 1441792
 buffer_load_dwordx4 a[152:155], v6, s[16:19], s83 offen sc1
 v_accvgpr_read_b32 v154, a34
 v_mfma_f32_16x16x32_bf16 v[144:147], v[56:59], a[224:227], v[144:147]
 ds_read_b128 v[44:47], v3 offset:27648
 v_accvgpr_read_b32 v155, a35
 v_mfma_f32_16x16x32_bf16 v[144:147], v[60:63], a[232:235], v[144:147]
 s_waitcnt lgkmcnt(4)
 buffer_store_dwordx4 v[196:199], v2, s[36:39], s59 offen sc1
 v_mfma_f32_16x16x32_bf16 v[112:115], v[64:67], a[204:207], 0
 s_add_u32 s59, s64, 131072
 ds_read_b128 v[48:51], v3 offset:1024
 v_accvgpr_read_b32 v156, a48
 v_accvgpr_read_b32 v157, a49
 v_mfma_f32_16x16x32_bf16 v[112:115], v[68:71], a[212:215], v[112:115]
 buffer_load_dwordx4 a[156:159], v7, s[16:19], s83 offen sc1
 v_mfma_f32_16x16x32_bf16 v[112:115], v[72:75], a[220:223], v[112:115]
 ds_read_b128 v[52:55], v3 offset:10240
 v_accvgpr_read_b32 v158, a50
 v_accvgpr_read_b32 v159, a51
 v_mfma_f32_16x16x32_bf16 v[112:115], v[76:79], a[228:231], v[112:115]
 v_mul_f32 v152, v152, v240
 v_mul_f32 v153, v153, v240
 v_mul_f32 v154, v154, v240
 v_mfma_f32_16x16x32_bf16 v[148:151], v[64:67], a[208:211], 0
 ds_read_b128 v[56:59], v3 offset:19456
 v_mul_f32 v155, v155, v240
 v_mul_f32 v156, v156, v240
 v_mfma_f32_16x16x32_bf16 v[148:151], v[68:71], a[216:219], v[148:151]
 v_mul_f32 v157, v157, v240
 v_mul_f32 v158, v158, v240
 v_mfma_f32_16x16x32_bf16 v[148:151], v[72:75], a[224:227], v[148:151]
 ds_read_b128 v[60:63], v3 offset:28672
 v_mul_f32 v159, v159, v240
 v_cvt_pk_bf16_f32 v160, v152, v153
 v_mfma_f32_16x16x32_bf16 v[148:151], v[76:79], a[232:235], v[148:151]
 s_waitcnt lgkmcnt(4)
 v_cvt_pk_bf16_f32 v161, v154, v155
 v_cvt_pk_bf16_f32 v162, v156, v157
 v_accvgpr_read_b32 v164, a36
 v_mfma_f32_16x16x32_bf16 v[80:83], v[32:35], a[236:239], v[80:83]
 s_add_u32 m0, s91, 110592
 ds_read_b128 v[64:67], v3 offset:2048
 v_cvt_pk_bf16_f32 v163, v158, v159
 v_mfma_f32_16x16x32_bf16 v[80:83], v[36:39], a[244:247], v[80:83]
 s_add_u32 s86, s89, 442368
 buffer_load_dwordx4 v2, s[48:51], s86 offen offset:0 sc1 lds
 v_accvgpr_read_b32 v165, a37
 v_mfma_f32_16x16x32_bf16 v[80:83], v[40:43], a[176:179], v[80:83]
 ds_read_b128 v[68:71], v3 offset:11264
 v_accvgpr_read_b32 v166, a38
 v_accvgpr_read_b32 v167, a39
 v_mfma_f32_16x16x32_bf16 v[80:83], v[44:47], a[184:187], v[80:83]
 buffer_store_dwordx4 v[160:163], v2, s[36:39], s59 offen sc1
 v_mfma_f32_16x16x32_bf16 v[116:119], v[32:35], a[240:243], v[116:119]
 s_add_u32 s59, s65, 131072
 ds_read_b128 v[72:75], v3 offset:20480
 v_accvgpr_read_b32 v168, a52
 v_mfma_f32_16x16x32_bf16 v[116:119], v[36:39], a[248:251], v[116:119]
 buffer_load_dwordx4 v2, s[48:51], s86 offen offset:1024 sc1 lds
 v_accvgpr_read_b32 v169, a53
 v_mfma_f32_16x16x32_bf16 v[116:119], v[40:43], a[180:183], v[116:119]
 ds_read_b128 v[76:79], v3 offset:29696
 v_accvgpr_read_b32 v170, a54
 v_accvgpr_read_b32 v171, a55
 v_mfma_f32_16x16x32_bf16 v[116:119], v[44:47], a[188:191], v[116:119]
 s_waitcnt lgkmcnt(4)
 v_mul_f32 v164, v164, v241
 v_mul_f32 v165, v165, v241
 v_mul_f32 v166, v166, v241
 v_mfma_f32_16x16x32_bf16 v[84:87], v[48:51], a[236:239], v[84:87]
 ds_read_b128 v[32:35], v3 offset:3072
 v_mul_f32 v167, v167, v241
 v_mfma_f32_16x16x32_bf16 v[84:87], v[52:55], a[244:247], v[84:87]
 buffer_load_dwordx4 v2, s[48:51], s86 offen offset:2048 sc1 lds
 v_mul_f32 v168, v168, v241
 v_mfma_f32_16x16x32_bf16 v[84:87], v[56:59], a[176:179], v[84:87]
 ds_read_b128 v[36:39], v3 offset:12288
 v_mul_f32 v169, v169, v241
 v_mul_f32 v170, v170, v241
 v_mfma_f32_16x16x32_bf16 v[84:87], v[60:63], a[184:187], v[84:87]
 v_mul_f32 v171, v171, v241
 v_cvt_pk_bf16_f32 v172, v164, v165
 v_cvt_pk_bf16_f32 v173, v166, v167
 v_mfma_f32_16x16x32_bf16 v[120:123], v[48:51], a[240:243], v[120:123]
 ds_read_b128 v[40:43], v3 offset:21504
 v_cvt_pk_bf16_f32 v174, v168, v169
 v_mfma_f32_16x16x32_bf16 v[120:123], v[52:55], a[248:251], v[120:123]
 buffer_load_dwordx4 v2, s[48:51], s86 offen offset:3072 sc1 lds
 v_cvt_pk_bf16_f32 v175, v170, v171
 v_mfma_f32_16x16x32_bf16 v[120:123], v[56:59], a[180:183], v[120:123]
 ds_read_b128 v[44:47], v3 offset:30720
 v_accvgpr_read_b32 v176, a40
 v_accvgpr_read_b32 v177, a41
 v_mfma_f32_16x16x32_bf16 v[120:123], v[60:63], a[188:191], v[120:123]
 s_waitcnt lgkmcnt(4)
 buffer_store_dwordx4 v[172:175], v2, s[36:39], s59 offen sc1
 v_mfma_f32_16x16x32_bf16 v[88:91], v[64:67], a[236:239], v[88:91]
 s_add_u32 m0, s91, 114688
 ds_read_b128 v[48:51], v4 offset:4096
 v_accvgpr_read_b32 v178, a42
 v_accvgpr_read_b32 v179, a43
 v_mfma_f32_16x16x32_bf16 v[88:91], v[68:71], a[244:247], v[88:91]
 s_add_u32 s86, s89, 446464
 buffer_load_dwordx4 v2, s[48:51], s86 offen offset:0 sc1 lds
 v_accvgpr_read_b32 v180, a56
 v_mfma_f32_16x16x32_bf16 v[88:91], v[72:75], a[176:179], v[88:91]
 s_add_u32 s59, s66, 131072
 ds_read_b128 v[52:55], v4 offset:13312
 v_accvgpr_read_b32 v181, a57
 v_accvgpr_read_b32 v182, a58
 v_mfma_f32_16x16x32_bf16 v[88:91], v[76:79], a[184:187], v[88:91]
 v_accvgpr_read_b32 v183, a59
 v_mul_f32 v176, v176, v242
 v_mfma_f32_16x16x32_bf16 v[124:127], v[64:67], a[240:243], v[124:127]
 ds_read_b128 v[56:59], v4 offset:22528
 v_mul_f32 v177, v177, v242
 v_mul_f32 v178, v178, v242
 v_mfma_f32_16x16x32_bf16 v[124:127], v[68:71], a[248:251], v[124:127]
 buffer_load_dwordx4 v2, s[48:51], s86 offen offset:1024 sc1 lds
 v_mul_f32 v179, v179, v242
 v_mfma_f32_16x16x32_bf16 v[124:127], v[72:75], a[180:183], v[124:127]
 ds_read_b128 v[60:63], v4 offset:31744
 v_mul_f32 v180, v180, v242
 v_mul_f32 v181, v181, v242
 v_mfma_f32_16x16x32_bf16 v[124:127], v[76:79], a[188:191], v[124:127]
 s_waitcnt lgkmcnt(4)
 v_mul_f32 v182, v182, v242
 v_mul_f32 v183, v183, v242
 v_mfma_f32_16x16x32_bf16 v[92:95], v[32:35], a[236:239], v[92:95]
 ds_read_b128 v[64:67], v5 offset:0
 v_cvt_pk_bf16_f32 v184, v176, v177
 v_cvt_pk_bf16_f32 v185, v178, v179
 v_mfma_f32_16x16x32_bf16 v[92:95], v[36:39], a[244:247], v[92:95]
 buffer_load_dwordx4 v2, s[48:51], s86 offen offset:2048 sc1 lds
 v_cvt_pk_bf16_f32 v186, v180, v181
 v_mfma_f32_16x16x32_bf16 v[92:95], v[40:43], a[176:179], v[92:95]
 ds_read_b128 v[68:71], v5 offset:9216
 v_cvt_pk_bf16_f32 v187, v182, v183
 v_mfma_f32_16x16x32_bf16 v[92:95], v[44:47], a[184:187], v[92:95]
 v_accvgpr_read_b32 v188, a44
 v_accvgpr_read_b32 v189, a45
 v_accvgpr_read_b32 v190, a46
 v_mfma_f32_16x16x32_bf16 v[128:131], v[32:35], a[240:243], v[128:131]
 ds_read_b128 v[72:75], v5 offset:18432
 v_accvgpr_read_b32 v191, a47
 v_accvgpr_read_b32 v192, a60
 v_mfma_f32_16x16x32_bf16 v[128:131], v[36:39], a[248:251], v[128:131]
 buffer_load_dwordx4 v2, s[48:51], s86 offen offset:3072 sc1 lds
 v_accvgpr_read_b32 v193, a61
 v_mfma_f32_16x16x32_bf16 v[128:131], v[40:43], a[180:183], v[128:131]
 ds_read_b128 v[76:79], v5 offset:27648
 v_accvgpr_read_b32 v194, a62
 v_mfma_f32_16x16x32_bf16 v[128:131], v[44:47], a[188:191], v[128:131]
 s_waitcnt lgkmcnt(4)
 buffer_store_dwordx4 v[184:187], v2, s[36:39], s59 offen sc1
 v_mfma_f32_16x16x32_bf16 v[96:99], v[48:51], a[236:239], v[96:99]
 s_add_u32 m0, s91, 118784
 ds_read_b128 v[32:35], v5 offset:1024
 v_accvgpr_read_b32 v195, a63
 v_mul_f32 v188, v188, v243
 v_mfma_f32_16x16x32_bf16 v[96:99], v[52:55], a[244:247], v[96:99]
 s_add_u32 s86, s89, 450560
 buffer_load_dwordx4 v2, s[48:51], s86 offen offset:0 sc1 lds
 v_mul_f32 v189, v189, v243
 v_mfma_f32_16x16x32_bf16 v[96:99], v[56:59], a[176:179], v[96:99]
 s_add_u32 s59, s67, 131072
 ds_read_b128 v[36:39], v5 offset:10240
 v_mul_f32 v190, v190, v243
 v_mfma_f32_16x16x32_bf16 v[96:99], v[60:63], a[184:187], v[96:99]
 v_mul_f32 v191, v191, v243
 v_mul_f32 v192, v192, v243
 v_mul_f32 v193, v193, v243
 v_mfma_f32_16x16x32_bf16 v[132:135], v[48:51], a[240:243], v[132:135]
 ds_read_b128 v[40:43], v5 offset:19456
 v_mul_f32 v194, v194, v243
 v_mul_f32 v195, v195, v243
 v_mfma_f32_16x16x32_bf16 v[132:135], v[52:55], a[248:251], v[132:135]
 s_add_u32 s83, s87, 1572864
 buffer_load_dwordx4 a[204:207], v6, s[16:19], s83 offen sc1
 v_cvt_pk_bf16_f32 v196, v188, v189
 v_mfma_f32_16x16x32_bf16 v[132:135], v[56:59], a[180:183], v[132:135]
 ds_read_b128 v[44:47], v5 offset:28672
 v_cvt_pk_bf16_f32 v197, v190, v191
 v_mfma_f32_16x16x32_bf16 v[132:135], v[60:63], a[188:191], v[132:135]
 s_waitcnt lgkmcnt(4)
 v_cvt_pk_bf16_f32 v198, v192, v193
 v_cvt_pk_bf16_f32 v199, v194, v195
 v_accvgpr_read_b32 v152, a64
 v_mfma_f32_16x16x32_bf16 v[100:103], v[64:67], a[236:239], v[100:103]
 ds_read_b128 v[48:51], v5 offset:2048
 v_accvgpr_read_b32 v153, a65
 v_accvgpr_read_b32 v154, a66
 v_mfma_f32_16x16x32_bf16 v[100:103], v[68:71], a[244:247], v[100:103]
 buffer_load_dwordx4 a[208:211], v7, s[16:19], s83 offen sc1
 v_accvgpr_read_b32 v155, a67
 v_mfma_f32_16x16x32_bf16 v[100:103], v[72:75], a[176:179], v[100:103]
 ds_read_b128 v[52:55], v5 offset:11264
 v_accvgpr_read_b32 v156, a80
 v_mfma_f32_16x16x32_bf16 v[100:103], v[76:79], a[184:187], v[100:103]
 buffer_store_dwordx4 v[196:199], v2, s[36:39], s59 offen sc1
 v_mfma_f32_16x16x32_bf16 v[136:139], v[64:67], a[240:243], v[136:139]
 s_add_u32 s59, s64, 262144
 ds_read_b128 v[56:59], v5 offset:20480
 v_accvgpr_read_b32 v157, a81
 v_accvgpr_read_b32 v158, a82
 v_mfma_f32_16x16x32_bf16 v[136:139], v[68:71], a[248:251], v[136:139]
 s_add_u32 s83, s87, 1703936
 buffer_load_dwordx4 a[212:215], v6, s[16:19], s83 offen sc1
 v_accvgpr_read_b32 v159, a83
 v_mfma_f32_16x16x32_bf16 v[136:139], v[72:75], a[180:183], v[136:139]
 ds_read_b128 v[60:63], v5 offset:29696
 v_mul_f32 v152, v152, v240
 v_mfma_f32_16x16x32_bf16 v[136:139], v[76:79], a[188:191], v[136:139]
 s_waitcnt lgkmcnt(4)
 v_mul_f32 v153, v153, v240
 v_mul_f32 v154, v154, v240
 v_mul_f32 v155, v155, v240
 v_mfma_f32_16x16x32_bf16 v[104:107], v[32:35], a[236:239], v[104:107]
 ds_read_b128 v[64:67], v5 offset:3072
 v_mul_f32 v156, v156, v240
 v_mul_f32 v157, v157, v240
 v_mfma_f32_16x16x32_bf16 v[104:107], v[36:39], a[244:247], v[104:107]
 buffer_load_dwordx4 a[216:219], v7, s[16:19], s83 offen sc1
 v_mfma_f32_16x16x32_bf16 v[104:107], v[40:43], a[176:179], v[104:107]
 ds_read_b128 v[68:71], v5 offset:12288
 v_mul_f32 v158, v158, v240
 v_mul_f32 v159, v159, v240
 v_mfma_f32_16x16x32_bf16 v[104:107], v[44:47], a[184:187], v[104:107]
 v_cvt_pk_bf16_f32 v160, v152, v153
 v_cvt_pk_bf16_f32 v161, v154, v155
 v_cvt_pk_bf16_f32 v162, v156, v157
 v_mfma_f32_16x16x32_bf16 v[140:143], v[32:35], a[240:243], v[140:143]
 ds_read_b128 v[72:75], v5 offset:21504
 v_cvt_pk_bf16_f32 v163, v158, v159
 v_accvgpr_read_b32 v164, a68
 v_mfma_f32_16x16x32_bf16 v[140:143], v[36:39], a[248:251], v[140:143]
 s_add_u32 s83, s87, 1835008
 buffer_load_dwordx4 a[220:223], v6, s[16:19], s83 offen sc1
 v_accvgpr_read_b32 v165, a69
 v_mfma_f32_16x16x32_bf16 v[140:143], v[40:43], a[180:183], v[140:143]
 ds_read_b128 v[76:79], v5 offset:30720
 v_accvgpr_read_b32 v166, a70
 v_mfma_f32_16x16x32_bf16 v[140:143], v[44:47], a[188:191], v[140:143]
 s_waitcnt vmcnt(29) lgkmcnt(4)
 s_barrier
 v_add_u32 v3, 0x9000, v3
 v_accvgpr_read_b32 v167, a71
 v_mfma_f32_16x16x32_bf16 v[108:111], v[48:51], a[236:239], v[108:111]
 ds_read_b128 v[32:35], v3 offset:0
 v_add_u32 v4, 0x9000, v4
 v_accvgpr_read_b32 v168, a84
 v_mfma_f32_16x16x32_bf16 v[108:111], v[52:55], a[244:247], v[108:111]
 buffer_load_dwordx4 a[224:227], v7, s[16:19], s83 offen sc1
 v_mfma_f32_16x16x32_bf16 v[108:111], v[56:59], a[176:179], v[108:111]
 ds_read_b128 v[36:39], v3 offset:9216
 v_add_u32 v5, 0x9000, v5
 v_accvgpr_read_b32 v169, a85
 v_mfma_f32_16x16x32_bf16 v[108:111], v[60:63], a[184:187], v[108:111]
 buffer_store_dwordx4 v[160:163], v2, s[36:39], s59 offen sc1
 v_mfma_f32_16x16x32_bf16 v[144:147], v[48:51], a[240:243], v[144:147]
 s_add_u32 s59, s65, 262144
 ds_read_b128 v[40:43], v3 offset:18432
 v_accvgpr_read_b32 v170, a86
 v_accvgpr_read_b32 v171, a87
 v_mfma_f32_16x16x32_bf16 v[144:147], v[52:55], a[248:251], v[144:147]
 s_add_u32 s83, s87, 1966080
 buffer_load_dwordx4 a[228:231], v6, s[16:19], s83 offen sc1
 v_mul_f32 v164, v164, v241
 v_mfma_f32_16x16x32_bf16 v[144:147], v[56:59], a[180:183], v[144:147]
 ds_read_b128 v[44:47], v3 offset:27648
 v_mul_f32 v165, v165, v241
 v_mfma_f32_16x16x32_bf16 v[144:147], v[60:63], a[188:191], v[144:147]
 s_waitcnt lgkmcnt(4)
 v_mul_f32 v166, v166, v241
 v_mul_f32 v167, v167, v241
 v_mul_f32 v168, v168, v241
 v_mfma_f32_16x16x32_bf16 v[112:115], v[64:67], a[236:239], v[112:115]
 ds_read_b128 v[48:51], v3 offset:1024
 v_mul_f32 v169, v169, v241
 v_mul_f32 v170, v170, v241
 v_mfma_f32_16x16x32_bf16 v[112:115], v[68:71], a[244:247], v[112:115]
 buffer_load_dwordx4 a[232:235], v7, s[16:19], s83 offen sc1
 v_mul_f32 v171, v171, v241
 v_mfma_f32_16x16x32_bf16 v[112:115], v[72:75], a[176:179], v[112:115]
 ds_read_b128 v[52:55], v3 offset:10240
 v_cvt_pk_bf16_f32 v172, v164, v165
 v_mfma_f32_16x16x32_bf16 v[112:115], v[76:79], a[184:187], v[112:115]
 v_cvt_pk_bf16_f32 v173, v166, v167
 v_cvt_pk_bf16_f32 v174, v168, v169
 v_cvt_pk_bf16_f32 v175, v170, v171
 v_mfma_f32_16x16x32_bf16 v[148:151], v[64:67], a[240:243], v[148:151]
 ds_read_b128 v[56:59], v3 offset:19456
 v_accvgpr_read_b32 v176, a72
 v_accvgpr_read_b32 v177, a73
 v_mfma_f32_16x16x32_bf16 v[148:151], v[68:71], a[248:251], v[148:151]
 buffer_store_dwordx4 v[172:175], v2, s[36:39], s59 offen sc1
 v_mfma_f32_16x16x32_bf16 v[148:151], v[72:75], a[180:183], v[148:151]
 s_add_u32 s59, s66, 262144
 ds_read_b128 v[60:63], v3 offset:28672
 v_accvgpr_read_b32 v178, a74
 v_mfma_f32_16x16x32_bf16 v[148:151], v[76:79], a[188:191], v[148:151]
 s_waitcnt vmcnt(23) lgkmcnt(4)
 v_accvgpr_read_b32 v179, a75
 v_accvgpr_read_b32 v180, a88
 v_accvgpr_read_b32 v181, a89
 v_mfma_f32_16x16x32_bf16 v[80:83], v[32:35], a[128:131], v[80:83]
 s_add_u32 m0, s91, 0
 ds_read_b128 v[64:67], v3 offset:2048
 v_accvgpr_read_b32 v182, a90
 v_accvgpr_read_b32 v183, a91
 v_mfma_f32_16x16x32_bf16 v[80:83], v[36:39], a[136:139], v[80:83]
 s_add_u32 s86, s89, 589824
 buffer_load_dwordx4 v2, s[48:51], s86 offen offset:0 sc1 lds
 v_mul_f32 v176, v176, v242
 v_mfma_f32_16x16x32_bf16 v[80:83], v[40:43], a[144:147], v[80:83]
 ds_read_b128 v[68:71], v3 offset:11264
 v_mul_f32 v177, v177, v242
 v_mfma_f32_16x16x32_bf16 v[80:83], v[44:47], a[152:155], v[80:83]
 v_mul_f32 v178, v178, v242
 v_mul_f32 v179, v179, v242
 v_mul_f32 v180, v180, v242
 v_mfma_f32_16x16x32_bf16 v[116:119], v[32:35], a[132:135], v[116:119]
 ds_read_b128 v[72:75], v3 offset:20480
 v_mul_f32 v181, v181, v242
 v_mul_f32 v182, v182, v242
 v_mfma_f32_16x16x32_bf16 v[116:119], v[36:39], a[140:143], v[116:119]
 buffer_load_dwordx4 v2, s[48:51], s86 offen offset:1024 sc1 lds
 v_mul_f32 v183, v183, v242
 v_mfma_f32_16x16x32_bf16 v[116:119], v[40:43], a[148:151], v[116:119]
 ds_read_b128 v[76:79], v3 offset:29696
 v_cvt_pk_bf16_f32 v184, v176, v177
 v_cvt_pk_bf16_f32 v185, v178, v179
 v_mfma_f32_16x16x32_bf16 v[116:119], v[44:47], a[156:159], v[116:119]
 s_waitcnt lgkmcnt(4)
 v_cvt_pk_bf16_f32 v186, v180, v181
 v_cvt_pk_bf16_f32 v187, v182, v183
 v_mfma_f32_16x16x32_bf16 v[84:87], v[48:51], a[128:131], v[84:87]
 ds_read_b128 v[32:35], v3 offset:3072
 v_accvgpr_read_b32 v188, a76
 v_accvgpr_read_b32 v189, a77
 v_mfma_f32_16x16x32_bf16 v[84:87], v[52:55], a[136:139], v[84:87]
 buffer_load_dwordx4 v2, s[48:51], s86 offen offset:2048 sc1 lds
 v_accvgpr_read_b32 v190, a78
 v_mfma_f32_16x16x32_bf16 v[84:87], v[56:59], a[144:147], v[84:87]
 ds_read_b128 v[36:39], v3 offset:12288
 v_accvgpr_read_b32 v191, a79
 v_accvgpr_read_b32 v192, a92
 v_mfma_f32_16x16x32_bf16 v[84:87], v[60:63], a[152:155], v[84:87]
 buffer_store_dwordx4 v[184:187], v2, s[36:39], s59 offen sc1
 v_mfma_f32_16x16x32_bf16 v[120:123], v[48:51], a[132:135], v[120:123]
 s_add_u32 s59, s67, 262144
 ds_read_b128 v[40:43], v3 offset:21504
 v_accvgpr_read_b32 v193, a93
 v_accvgpr_read_b32 v194, a94
 v_mfma_f32_16x16x32_bf16 v[120:123], v[52:55], a[140:143], v[120:123]
 buffer_load_dwordx4 v2, s[48:51], s86 offen offset:3072 sc1 lds
 v_accvgpr_read_b32 v195, a95
 v_mfma_f32_16x16x32_bf16 v[120:123], v[56:59], a[148:151], v[120:123]
 ds_read_b128 v[44:47], v3 offset:30720
 v_mul_f32 v188, v188, v243
 v_mul_f32 v189, v189, v243
 v_mfma_f32_16x16x32_bf16 v[120:123], v[60:63], a[156:159], v[120:123]
 s_waitcnt lgkmcnt(4)
 v_mul_f32 v190, v190, v243
 v_mul_f32 v191, v191, v243
 v_mul_f32 v192, v192, v243
 v_mfma_f32_16x16x32_bf16 v[88:91], v[64:67], a[128:131], v[88:91]
 s_add_u32 m0, s91, 4096
 ds_read_b128 v[48:51], v4 offset:4096
 v_mul_f32 v193, v193, v243
 v_mfma_f32_16x16x32_bf16 v[88:91], v[68:71], a[136:139], v[88:91]
 s_add_u32 s86, s89, 593920
 buffer_load_dwordx4 v2, s[48:51], s86 offen offset:0 sc1 lds
 v_mul_f32 v194, v194, v243
 v_mfma_f32_16x16x32_bf16 v[88:91], v[72:75], a[144:147], v[88:91]
 ds_read_b128 v[52:55], v4 offset:13312
 v_mul_f32 v195, v195, v243
 v_cvt_pk_bf16_f32 v196, v188, v189
 v_mfma_f32_16x16x32_bf16 v[88:91], v[76:79], a[152:155], v[88:91]
 v_cvt_pk_bf16_f32 v197, v190, v191
 v_cvt_pk_bf16_f32 v198, v192, v193
 v_accvgpr_read_b32 v152, a96
 v_mfma_f32_16x16x32_bf16 v[124:127], v[64:67], a[132:135], v[124:127]
 ds_read_b128 v[56:59], v4 offset:22528
 v_cvt_pk_bf16_f32 v199, v194, v195
 v_mfma_f32_16x16x32_bf16 v[124:127], v[68:71], a[140:143], v[124:127]
 buffer_load_dwordx4 v2, s[48:51], s86 offen offset:1024 sc1 lds
 v_accvgpr_read_b32 v153, a97
 v_mfma_f32_16x16x32_bf16 v[124:127], v[72:75], a[148:151], v[124:127]
 ds_read_b128 v[60:63], v4 offset:31744
 v_accvgpr_read_b32 v154, a98
 v_accvgpr_read_b32 v155, a99
 v_mfma_f32_16x16x32_bf16 v[124:127], v[76:79], a[156:159], v[124:127]
 s_waitcnt lgkmcnt(4)
 buffer_store_dwordx4 v[196:199], v2, s[36:39], s59 offen sc1
 v_mfma_f32_16x16x32_bf16 v[92:95], v[32:35], a[128:131], v[92:95]
 s_add_u32 s59, s64, 393216
 ds_read_b128 v[64:67], v5 offset:0
 v_accvgpr_read_b32 v156, a112
 v_accvgpr_read_b32 v157, a113
 v_mfma_f32_16x16x32_bf16 v[92:95], v[36:39], a[136:139], v[92:95]
 buffer_load_dwordx4 v2, s[48:51], s86 offen offset:2048 sc1 lds
 v_mfma_f32_16x16x32_bf16 v[92:95], v[40:43], a[144:147], v[92:95]
 ds_read_b128 v[68:71], v5 offset:9216
 v_accvgpr_read_b32 v158, a114
 v_accvgpr_read_b32 v159, a115
 v_mfma_f32_16x16x32_bf16 v[92:95], v[44:47], a[152:155], v[92:95]
 v_mul_f32 v152, v152, v240
 v_mul_f32 v153, v153, v240
 v_mul_f32 v154, v154, v240
 v_mfma_f32_16x16x32_bf16 v[128:131], v[32:35], a[132:135], v[128:131]
 ds_read_b128 v[72:75], v5 offset:18432
 v_mul_f32 v155, v155, v240
 v_mul_f32 v156, v156, v240
 v_mfma_f32_16x16x32_bf16 v[128:131], v[36:39], a[140:143], v[128:131]
 buffer_load_dwordx4 v2, s[48:51], s86 offen offset:3072 sc1 lds
 v_mul_f32 v157, v157, v240
 v_mfma_f32_16x16x32_bf16 v[128:131], v[40:43], a[148:151], v[128:131]
 ds_read_b128 v[76:79], v5 offset:27648
 v_mul_f32 v158, v158, v240
 v_mfma_f32_16x16x32_bf16 v[128:131], v[44:47], a[156:159], v[128:131]
 s_waitcnt lgkmcnt(4)
 v_mul_f32 v159, v159, v240
 v_cvt_pk_bf16_f32 v160, v152, v153
 v_cvt_pk_bf16_f32 v161, v154, v155
 v_mfma_f32_16x16x32_bf16 v[96:99], v[48:51], a[128:131], v[96:99]
 s_add_u32 m0, s91, 8192
 ds_read_b128 v[32:35], v5 offset:1024
 v_cvt_pk_bf16_f32 v162, v156, v157
 v_accvgpr_read_b32 v164, a100
 v_mfma_f32_16x16x32_bf16 v[96:99], v[52:55], a[136:139], v[96:99]
 s_add_u32 s86, s89, 598016
 buffer_load_dwordx4 v2, s[48:51], s86 offen offset:0 sc1 lds
 v_cvt_pk_bf16_f32 v163, v158, v159
 v_mfma_f32_16x16x32_bf16 v[96:99], v[56:59], a[144:147], v[96:99]
 ds_read_b128 v[36:39], v5 offset:10240
 v_accvgpr_read_b32 v165, a101
 v_accvgpr_read_b32 v166, a102
 v_mfma_f32_16x16x32_bf16 v[96:99], v[60:63], a[152:155], v[96:99]
 buffer_store_dwordx4 v[160:163], v2, s[36:39], s59 offen sc1
 v_mfma_f32_16x16x32_bf16 v[132:135], v[48:51], a[132:135], v[132:135]
 s_add_u32 s59, s65, 393216
 ds_read_b128 v[40:43], v5 offset:19456
 v_accvgpr_read_b32 v167, a103
 v_accvgpr_read_b32 v168, a116
 v_mfma_f32_16x16x32_bf16 v[132:135], v[52:55], a[140:143], v[132:135]
 s_add_u32 s83, s87, 2097152
 buffer_load_dwordx4 a[236:239], v6, s[16:19], s83 offen sc1
 v_accvgpr_read_b32 v169, a117
 v_mfma_f32_16x16x32_bf16 v[132:135], v[56:59], a[148:151], v[132:135]
 ds_read_b128 v[44:47], v5 offset:28672
 v_accvgpr_read_b32 v170, a118
 v_accvgpr_read_b32 v171, a119
 v_mfma_f32_16x16x32_bf16 v[132:135], v[60:63], a[156:159], v[132:135]
 s_waitcnt lgkmcnt(4)
 v_mul_f32 v164, v164, v241
 v_mul_f32 v165, v165, v241
 v_mul_f32 v166, v166, v241
 v_mfma_f32_16x16x32_bf16 v[100:103], v[64:67], a[128:131], v[100:103]
 ds_read_b128 v[48:51], v5 offset:2048
 v_mul_f32 v167, v167, v241
 v_mfma_f32_16x16x32_bf16 v[100:103], v[68:71], a[136:139], v[100:103]
 buffer_load_dwordx4 a[240:243], v7, s[16:19], s83 offen sc1
 v_mul_f32 v168, v168, v241
 v_mfma_f32_16x16x32_bf16 v[100:103], v[72:75], a[144:147], v[100:103]
 ds_read_b128 v[52:55], v5 offset:11264
 v_mul_f32 v169, v169, v241
 v_mul_f32 v170, v170, v241
 v_mfma_f32_16x16x32_bf16 v[100:103], v[76:79], a[152:155], v[100:103]
 v_mul_f32 v171, v171, v241
 v_cvt_pk_bf16_f32 v172, v164, v165
 v_cvt_pk_bf16_f32 v173, v166, v167
 v_mfma_f32_16x16x32_bf16 v[136:139], v[64:67], a[132:135], v[136:139]
 ds_read_b128 v[56:59], v5 offset:20480
 v_cvt_pk_bf16_f32 v174, v168, v169
 v_mfma_f32_16x16x32_bf16 v[136:139], v[68:71], a[140:143], v[136:139]
 s_add_u32 s83, s87, 2228224
 buffer_load_dwordx4 a[244:247], v6, s[16:19], s83 offen sc1
 v_cvt_pk_bf16_f32 v175, v170, v171
 v_mfma_f32_16x16x32_bf16 v[136:139], v[72:75], a[148:151], v[136:139]
 ds_read_b128 v[60:63], v5 offset:29696
 v_accvgpr_read_b32 v176, a104
 v_accvgpr_read_b32 v177, a105
 v_mfma_f32_16x16x32_bf16 v[136:139], v[76:79], a[156:159], v[136:139]
 s_waitcnt lgkmcnt(4)
 buffer_store_dwordx4 v[172:175], v2, s[36:39], s59 offen sc1
 v_mfma_f32_16x16x32_bf16 v[104:107], v[32:35], a[128:131], v[104:107]
 s_add_u32 s59, s66, 393216
 ds_read_b128 v[64:67], v5 offset:3072
 v_accvgpr_read_b32 v178, a106
 v_accvgpr_read_b32 v179, a107
 v_mfma_f32_16x16x32_bf16 v[104:107], v[36:39], a[136:139], v[104:107]
 buffer_load_dwordx4 a[248:251], v7, s[16:19], s83 offen sc1
 v_accvgpr_read_b32 v180, a120
 v_mfma_f32_16x16x32_bf16 v[104:107], v[40:43], a[144:147], v[104:107]
 ds_read_b128 v[68:71], v5 offset:12288
 v_accvgpr_read_b32 v181, a121
 v_mfma_f32_16x16x32_bf16 v[104:107], v[44:47], a[152:155], v[104:107]
 v_accvgpr_read_b32 v182, a122
 v_accvgpr_read_b32 v183, a123
 v_mul_f32 v176, v176, v242
 v_mfma_f32_16x16x32_bf16 v[140:143], v[32:35], a[132:135], v[140:143]
 ds_read_b128 v[72:75], v5 offset:21504
 v_mul_f32 v177, v177, v242
 v_mul_f32 v178, v178, v242
 v_mfma_f32_16x16x32_bf16 v[140:143], v[36:39], a[140:143], v[140:143]
 s_add_u32 s83, s87, 2359296
 buffer_load_dwordx4 a[176:179], v6, s[16:19], s83 offen sc1
 v_mul_f32 v179, v179, v242
 v_mfma_f32_16x16x32_bf16 v[140:143], v[40:43], a[148:151], v[140:143]
 ds_read_b128 v[76:79], v5 offset:30720
 v_mul_f32 v180, v180, v242
 v_mul_f32 v181, v181, v242
 v_mfma_f32_16x16x32_bf16 v[140:143], v[44:47], a[156:159], v[140:143]
 s_waitcnt vmcnt(29) lgkmcnt(4)
 s_barrier
 v_add_u32 v3, 0x9000, v3
 v_mul_f32 v182, v182, v242
 v_mfma_f32_16x16x32_bf16 v[108:111], v[48:51], a[128:131], v[108:111]
 ds_read_b128 v[32:35], v3 offset:0
 v_add_u32 v4, 0x9000, v4
 v_mfma_f32_16x16x32_bf16 v[108:111], v[52:55], a[136:139], v[108:111]
 buffer_load_dwordx4 a[180:183], v7, s[16:19], s83 offen sc1
 v_mul_f32 v183, v183, v242
 v_mfma_f32_16x16x32_bf16 v[108:111], v[56:59], a[144:147], v[108:111]
 ds_read_b128 v[36:39], v3 offset:9216
 v_add_u32 v5, 0x9000, v5
 v_cvt_pk_bf16_f32 v184, v176, v177
 v_mfma_f32_16x16x32_bf16 v[108:111], v[60:63], a[152:155], v[108:111]
 v_cvt_pk_bf16_f32 v185, v178, v179
 v_cvt_pk_bf16_f32 v186, v180, v181
 v_cvt_pk_bf16_f32 v187, v182, v183
 v_mfma_f32_16x16x32_bf16 v[144:147], v[48:51], a[132:135], v[144:147]
 ds_read_b128 v[40:43], v3 offset:18432
 v_accvgpr_read_b32 v188, a108
 v_accvgpr_read_b32 v189, a109
 v_mfma_f32_16x16x32_bf16 v[144:147], v[52:55], a[140:143], v[144:147]
 s_add_u32 s83, s87, 2490368
 buffer_load_dwordx4 a[184:187], v6, s[16:19], s83 offen sc1
 v_accvgpr_read_b32 v190, a110
 v_mfma_f32_16x16x32_bf16 v[144:147], v[56:59], a[148:151], v[144:147]
 ds_read_b128 v[44:47], v3 offset:27648
 v_accvgpr_read_b32 v191, a111
 v_mfma_f32_16x16x32_bf16 v[144:147], v[60:63], a[156:159], v[144:147]
 s_waitcnt lgkmcnt(4)
 buffer_store_dwordx4 v[184:187], v2, s[36:39], s59 offen sc1
 v_mfma_f32_16x16x32_bf16 v[112:115], v[64:67], a[128:131], v[112:115]
 s_add_u32 s59, s67, 393216
 ds_read_b128 v[48:51], v3 offset:1024
 v_accvgpr_read_b32 v192, a124
 v_accvgpr_read_b32 v193, a125
 v_mfma_f32_16x16x32_bf16 v[112:115], v[68:71], a[136:139], v[112:115]
 buffer_load_dwordx4 a[188:191], v7, s[16:19], s83 offen sc1
 v_accvgpr_read_b32 v194, a126
 v_mfma_f32_16x16x32_bf16 v[112:115], v[72:75], a[144:147], v[112:115]
 ds_read_b128 v[52:55], v3 offset:10240
 v_accvgpr_read_b32 v195, a127
 v_mul_f32 v188, v188, v243
 v_mfma_f32_16x16x32_bf16 v[112:115], v[76:79], a[152:155], v[112:115]
 v_mul_f32 v189, v189, v243
 v_mul_f32 v190, v190, v243
 v_mul_f32 v191, v191, v243
 v_mfma_f32_16x16x32_bf16 v[148:151], v[64:67], a[132:135], v[148:151]
 ds_read_b128 v[56:59], v3 offset:19456
 v_mul_f32 v192, v192, v243
 v_mul_f32 v193, v193, v243
 v_mfma_f32_16x16x32_bf16 v[148:151], v[68:71], a[140:143], v[148:151]
 v_mul_f32 v194, v194, v243
 v_mul_f32 v195, v195, v243
 v_cvt_pk_bf16_f32 v196, v188, v189
 v_mfma_f32_16x16x32_bf16 v[148:151], v[72:75], a[148:151], v[148:151]
 ds_read_b128 v[60:63], v3 offset:28672
 v_cvt_pk_bf16_f32 v197, v190, v191
 v_cvt_pk_bf16_f32 v198, v192, v193
 v_mfma_f32_16x16x32_bf16 v[148:151], v[76:79], a[156:159], v[148:151]
 s_waitcnt vmcnt(23) lgkmcnt(4)
 v_cvt_pk_bf16_f32 v199, v194, v195
 buffer_store_dwordx4 v[196:199], v2, s[36:39], s59 offen sc1
 v_mfma_f32_16x16x32_bf16 v[80:83], v[32:35], a[204:207], v[80:83]
 s_add_u32 m0, s91, 36864
 ds_read_b128 v[64:67], v3 offset:2048
 v_mfma_f32_16x16x32_bf16 v[80:83], v[36:39], a[212:215], v[80:83]
 s_add_u32 s86, s89, 737280
 buffer_load_dwordx4 v2, s[48:51], s86 offen offset:0 sc1 lds
 v_mfma_f32_16x16x32_bf16 v[80:83], v[40:43], a[220:223], v[80:83]
 ds_read_b128 v[68:71], v3 offset:11264
 v_mfma_f32_16x16x32_bf16 v[80:83], v[44:47], a[228:231], v[80:83]
 v_mfma_f32_16x16x32_bf16 v[116:119], v[32:35], a[208:211], v[116:119]
 ds_read_b128 v[72:75], v3 offset:20480
 v_mfma_f32_16x16x32_bf16 v[116:119], v[36:39], a[216:219], v[116:119]
 buffer_load_dwordx4 v2, s[48:51], s86 offen offset:1024 sc1 lds
 v_mfma_f32_16x16x32_bf16 v[116:119], v[40:43], a[224:227], v[116:119]
 ds_read_b128 v[76:79], v3 offset:29696
 v_mfma_f32_16x16x32_bf16 v[116:119], v[44:47], a[232:235], v[116:119]
 s_waitcnt lgkmcnt(4)
 v_mfma_f32_16x16x32_bf16 v[84:87], v[48:51], a[204:207], v[84:87]
 ds_read_b128 v[32:35], v3 offset:3072
 v_mfma_f32_16x16x32_bf16 v[84:87], v[52:55], a[212:215], v[84:87]
 buffer_load_dwordx4 v2, s[48:51], s86 offen offset:2048 sc1 lds
 v_mfma_f32_16x16x32_bf16 v[84:87], v[56:59], a[220:223], v[84:87]
 ds_read_b128 v[36:39], v3 offset:12288
 v_mfma_f32_16x16x32_bf16 v[84:87], v[60:63], a[228:231], v[84:87]
 v_mfma_f32_16x16x32_bf16 v[120:123], v[48:51], a[208:211], v[120:123]
 ds_read_b128 v[40:43], v3 offset:21504
 v_mfma_f32_16x16x32_bf16 v[120:123], v[52:55], a[216:219], v[120:123]
 buffer_load_dwordx4 v2, s[48:51], s86 offen offset:3072 sc1 lds
 v_mfma_f32_16x16x32_bf16 v[120:123], v[56:59], a[224:227], v[120:123]
 ds_read_b128 v[44:47], v3 offset:30720
 v_mfma_f32_16x16x32_bf16 v[120:123], v[60:63], a[232:235], v[120:123]
 s_waitcnt lgkmcnt(4)
 v_mfma_f32_16x16x32_bf16 v[88:91], v[64:67], a[204:207], v[88:91]
 s_add_u32 m0, s91, 40960
 ds_read_b128 v[48:51], v4 offset:4096
 v_mfma_f32_16x16x32_bf16 v[88:91], v[68:71], a[212:215], v[88:91]
 s_add_u32 s86, s89, 741376
 buffer_load_dwordx4 v2, s[48:51], s86 offen offset:0 sc1 lds
 v_mfma_f32_16x16x32_bf16 v[88:91], v[72:75], a[220:223], v[88:91]
 ds_read_b128 v[52:55], v4 offset:13312
 v_mfma_f32_16x16x32_bf16 v[88:91], v[76:79], a[228:231], v[88:91]
 v_mfma_f32_16x16x32_bf16 v[124:127], v[64:67], a[208:211], v[124:127]
 ds_read_b128 v[56:59], v4 offset:22528
 v_mfma_f32_16x16x32_bf16 v[124:127], v[68:71], a[216:219], v[124:127]
 buffer_load_dwordx4 v2, s[48:51], s86 offen offset:1024 sc1 lds
 v_mfma_f32_16x16x32_bf16 v[124:127], v[72:75], a[224:227], v[124:127]
 ds_read_b128 v[60:63], v4 offset:31744
 v_mfma_f32_16x16x32_bf16 v[124:127], v[76:79], a[232:235], v[124:127]
 s_waitcnt lgkmcnt(4)
 v_mfma_f32_16x16x32_bf16 v[92:95], v[32:35], a[204:207], v[92:95]
 ds_read_b128 v[64:67], v5 offset:0
 v_mfma_f32_16x16x32_bf16 v[92:95], v[36:39], a[212:215], v[92:95]
 buffer_load_dwordx4 v2, s[48:51], s86 offen offset:2048 sc1 lds
 v_mfma_f32_16x16x32_bf16 v[92:95], v[40:43], a[220:223], v[92:95]
 ds_read_b128 v[68:71], v5 offset:9216
 v_mfma_f32_16x16x32_bf16 v[92:95], v[44:47], a[228:231], v[92:95]
 v_mfma_f32_16x16x32_bf16 v[128:131], v[32:35], a[208:211], v[128:131]
 ds_read_b128 v[72:75], v5 offset:18432
 v_mfma_f32_16x16x32_bf16 v[128:131], v[36:39], a[216:219], v[128:131]
 buffer_load_dwordx4 v2, s[48:51], s86 offen offset:3072 sc1 lds
 v_mfma_f32_16x16x32_bf16 v[128:131], v[40:43], a[224:227], v[128:131]
 ds_read_b128 v[76:79], v5 offset:27648
 v_mfma_f32_16x16x32_bf16 v[128:131], v[44:47], a[232:235], v[128:131]
 s_waitcnt lgkmcnt(4)
 v_mfma_f32_16x16x32_bf16 v[96:99], v[48:51], a[204:207], v[96:99]
 s_add_u32 m0, s91, 45056
 ds_read_b128 v[32:35], v5 offset:1024
 v_mfma_f32_16x16x32_bf16 v[96:99], v[52:55], a[212:215], v[96:99]
 s_add_u32 s86, s89, 745472
 buffer_load_dwordx4 v2, s[48:51], s86 offen offset:0 sc1 lds
 v_mfma_f32_16x16x32_bf16 v[96:99], v[56:59], a[220:223], v[96:99]
 ds_read_b128 v[36:39], v5 offset:10240
 v_mfma_f32_16x16x32_bf16 v[96:99], v[60:63], a[228:231], v[96:99]
 v_mfma_f32_16x16x32_bf16 v[132:135], v[48:51], a[208:211], v[132:135]
 ds_read_b128 v[40:43], v5 offset:19456
 v_mfma_f32_16x16x32_bf16 v[132:135], v[52:55], a[216:219], v[132:135]
 s_add_u32 s83, s87, 2621440
 buffer_load_dwordx4 a[128:131], v6, s[16:19], s83 offen sc1
 v_mfma_f32_16x16x32_bf16 v[132:135], v[56:59], a[224:227], v[132:135]
 ds_read_b128 v[44:47], v5 offset:28672
 v_mfma_f32_16x16x32_bf16 v[132:135], v[60:63], a[232:235], v[132:135]
 s_waitcnt lgkmcnt(4)
 v_mfma_f32_16x16x32_bf16 v[100:103], v[64:67], a[204:207], v[100:103]
 ds_read_b128 v[48:51], v5 offset:2048
 v_mfma_f32_16x16x32_bf16 v[100:103], v[68:71], a[212:215], v[100:103]
 buffer_load_dwordx4 a[132:135], v7, s[16:19], s83 offen sc1
 v_mfma_f32_16x16x32_bf16 v[100:103], v[72:75], a[220:223], v[100:103]
 ds_read_b128 v[52:55], v5 offset:11264
 v_mfma_f32_16x16x32_bf16 v[100:103], v[76:79], a[228:231], v[100:103]
 v_mfma_f32_16x16x32_bf16 v[136:139], v[64:67], a[208:211], v[136:139]
 ds_read_b128 v[56:59], v5 offset:20480
 v_mfma_f32_16x16x32_bf16 v[136:139], v[68:71], a[216:219], v[136:139]
 s_add_u32 s83, s87, 2752512
 buffer_load_dwordx4 a[136:139], v6, s[16:19], s83 offen sc1
 v_mfma_f32_16x16x32_bf16 v[136:139], v[72:75], a[224:227], v[136:139]
 ds_read_b128 v[60:63], v5 offset:29696
 v_mfma_f32_16x16x32_bf16 v[136:139], v[76:79], a[232:235], v[136:139]
 s_waitcnt lgkmcnt(4)
 v_mfma_f32_16x16x32_bf16 v[104:107], v[32:35], a[204:207], v[104:107]
 ds_read_b128 v[64:67], v5 offset:3072
 v_mfma_f32_16x16x32_bf16 v[104:107], v[36:39], a[212:215], v[104:107]
 buffer_load_dwordx4 a[140:143], v7, s[16:19], s83 offen sc1
 v_mfma_f32_16x16x32_bf16 v[104:107], v[40:43], a[220:223], v[104:107]
 ds_read_b128 v[68:71], v5 offset:12288
 v_mfma_f32_16x16x32_bf16 v[104:107], v[44:47], a[228:231], v[104:107]
 v_mfma_f32_16x16x32_bf16 v[140:143], v[32:35], a[208:211], v[140:143]
 ds_read_b128 v[72:75], v5 offset:21504
 v_mfma_f32_16x16x32_bf16 v[140:143], v[36:39], a[216:219], v[140:143]
 s_add_u32 s83, s87, 2883584
 buffer_load_dwordx4 a[144:147], v6, s[16:19], s83 offen sc1
 v_mfma_f32_16x16x32_bf16 v[140:143], v[40:43], a[224:227], v[140:143]
 ds_read_b128 v[76:79], v5 offset:30720
 v_mfma_f32_16x16x32_bf16 v[140:143], v[44:47], a[232:235], v[140:143]
 s_waitcnt vmcnt(26) lgkmcnt(4)
 s_barrier
 v_add_u32 v3, 0xfffe5000, v3
 v_mfma_f32_16x16x32_bf16 v[108:111], v[48:51], a[204:207], v[108:111]
 ds_read_b128 v[32:35], v3 offset:0
 v_add_u32 v4, 0xfffe5000, v4
 v_mfma_f32_16x16x32_bf16 v[108:111], v[52:55], a[212:215], v[108:111]
 buffer_load_dwordx4 a[148:151], v7, s[16:19], s83 offen sc1
 v_mfma_f32_16x16x32_bf16 v[108:111], v[56:59], a[220:223], v[108:111]
 ds_read_b128 v[36:39], v3 offset:9216
 v_add_u32 v5, 0xfffe5000, v5
 v_mfma_f32_16x16x32_bf16 v[108:111], v[60:63], a[228:231], v[108:111]
 v_mfma_f32_16x16x32_bf16 v[144:147], v[48:51], a[208:211], v[144:147]
 ds_read_b128 v[40:43], v3 offset:18432
 v_mfma_f32_16x16x32_bf16 v[144:147], v[52:55], a[216:219], v[144:147]
 s_add_u32 s83, s87, 3014656
 buffer_load_dwordx4 a[152:155], v6, s[16:19], s83 offen sc1
 v_mfma_f32_16x16x32_bf16 v[144:147], v[56:59], a[224:227], v[144:147]
 ds_read_b128 v[44:47], v3 offset:27648
 v_mfma_f32_16x16x32_bf16 v[144:147], v[60:63], a[232:235], v[144:147]
 s_waitcnt lgkmcnt(4)
 v_mfma_f32_16x16x32_bf16 v[112:115], v[64:67], a[204:207], v[112:115]
 ds_read_b128 v[48:51], v3 offset:1024
 v_mfma_f32_16x16x32_bf16 v[112:115], v[68:71], a[212:215], v[112:115]
 buffer_load_dwordx4 a[156:159], v7, s[16:19], s83 offen sc1
 v_mfma_f32_16x16x32_bf16 v[112:115], v[72:75], a[220:223], v[112:115]
 ds_read_b128 v[52:55], v3 offset:10240
 v_mfma_f32_16x16x32_bf16 v[112:115], v[76:79], a[228:231], v[112:115]
 v_mfma_f32_16x16x32_bf16 v[148:151], v[64:67], a[208:211], v[148:151]
 ds_read_b128 v[56:59], v3 offset:19456
 v_mfma_f32_16x16x32_bf16 v[148:151], v[68:71], a[216:219], v[148:151]
 v_mfma_f32_16x16x32_bf16 v[148:151], v[72:75], a[224:227], v[148:151]
 ds_read_b128 v[60:63], v3 offset:28672
 v_mfma_f32_16x16x32_bf16 v[148:151], v[76:79], a[232:235], v[148:151]
 s_waitcnt vmcnt(18) lgkmcnt(4)
 v_mfma_f32_16x16x32_bf16 v[80:83], v[32:35], a[236:239], v[80:83]
 s_add_u32 m0, s91, 73728
 ds_read_b128 v[64:67], v3 offset:2048
 v_mfma_f32_16x16x32_bf16 v[80:83], v[36:39], a[244:247], v[80:83]
 s_add_u32 s86, s89, 884736
 buffer_load_dwordx4 v2, s[48:51], s86 offen offset:0 sc1 lds
 v_mfma_f32_16x16x32_bf16 v[80:83], v[40:43], a[176:179], v[80:83]
 ds_read_b128 v[68:71], v3 offset:11264
 v_mfma_f32_16x16x32_bf16 v[80:83], v[44:47], a[184:187], v[80:83]
 v_mfma_f32_16x16x32_bf16 v[116:119], v[32:35], a[240:243], v[116:119]
 ds_read_b128 v[72:75], v3 offset:20480
 v_mfma_f32_16x16x32_bf16 v[116:119], v[36:39], a[248:251], v[116:119]
 buffer_load_dwordx4 v2, s[48:51], s86 offen offset:1024 sc1 lds
 v_mfma_f32_16x16x32_bf16 v[116:119], v[40:43], a[180:183], v[116:119]
 ds_read_b128 v[76:79], v3 offset:29696
 v_mfma_f32_16x16x32_bf16 v[116:119], v[44:47], a[188:191], v[116:119]
 s_waitcnt lgkmcnt(4)
 v_mfma_f32_16x16x32_bf16 v[84:87], v[48:51], a[236:239], v[84:87]
 ds_read_b128 v[32:35], v3 offset:3072
 v_mfma_f32_16x16x32_bf16 v[84:87], v[52:55], a[244:247], v[84:87]
 buffer_load_dwordx4 v2, s[48:51], s86 offen offset:2048 sc1 lds
 v_mfma_f32_16x16x32_bf16 v[84:87], v[56:59], a[176:179], v[84:87]
 ds_read_b128 v[36:39], v3 offset:12288
 v_mfma_f32_16x16x32_bf16 v[84:87], v[60:63], a[184:187], v[84:87]
 v_mfma_f32_16x16x32_bf16 v[120:123], v[48:51], a[240:243], v[120:123]
 ds_read_b128 v[40:43], v3 offset:21504
 v_mfma_f32_16x16x32_bf16 v[120:123], v[52:55], a[248:251], v[120:123]
 buffer_load_dwordx4 v2, s[48:51], s86 offen offset:3072 sc1 lds
 v_mfma_f32_16x16x32_bf16 v[120:123], v[56:59], a[180:183], v[120:123]
 ds_read_b128 v[44:47], v3 offset:30720
 v_mfma_f32_16x16x32_bf16 v[120:123], v[60:63], a[188:191], v[120:123]
 s_waitcnt lgkmcnt(4)
 v_mfma_f32_16x16x32_bf16 v[88:91], v[64:67], a[236:239], v[88:91]
 s_add_u32 m0, s91, 77824
 ds_read_b128 v[48:51], v4 offset:4096
 v_mfma_f32_16x16x32_bf16 v[88:91], v[68:71], a[244:247], v[88:91]
 s_add_u32 s86, s89, 888832
 buffer_load_dwordx4 v2, s[48:51], s86 offen offset:0 sc1 lds
 v_mfma_f32_16x16x32_bf16 v[88:91], v[72:75], a[176:179], v[88:91]
 ds_read_b128 v[52:55], v4 offset:13312
 v_mfma_f32_16x16x32_bf16 v[88:91], v[76:79], a[184:187], v[88:91]
 v_mfma_f32_16x16x32_bf16 v[124:127], v[64:67], a[240:243], v[124:127]
 ds_read_b128 v[56:59], v4 offset:22528
 v_mfma_f32_16x16x32_bf16 v[124:127], v[68:71], a[248:251], v[124:127]
 buffer_load_dwordx4 v2, s[48:51], s86 offen offset:1024 sc1 lds
 v_mfma_f32_16x16x32_bf16 v[124:127], v[72:75], a[180:183], v[124:127]
 ds_read_b128 v[60:63], v4 offset:31744
 v_mfma_f32_16x16x32_bf16 v[124:127], v[76:79], a[188:191], v[124:127]
 s_waitcnt lgkmcnt(4)
 v_mfma_f32_16x16x32_bf16 v[92:95], v[32:35], a[236:239], v[92:95]
 ds_read_b128 v[64:67], v5 offset:0
 v_mfma_f32_16x16x32_bf16 v[92:95], v[36:39], a[244:247], v[92:95]
 buffer_load_dwordx4 v2, s[48:51], s86 offen offset:2048 sc1 lds
 v_mfma_f32_16x16x32_bf16 v[92:95], v[40:43], a[176:179], v[92:95]
 ds_read_b128 v[68:71], v5 offset:9216
 v_mfma_f32_16x16x32_bf16 v[92:95], v[44:47], a[184:187], v[92:95]
 v_mfma_f32_16x16x32_bf16 v[128:131], v[32:35], a[240:243], v[128:131]
 ds_read_b128 v[72:75], v5 offset:18432
 v_mfma_f32_16x16x32_bf16 v[128:131], v[36:39], a[248:251], v[128:131]
 buffer_load_dwordx4 v2, s[48:51], s86 offen offset:3072 sc1 lds
 v_mfma_f32_16x16x32_bf16 v[128:131], v[40:43], a[180:183], v[128:131]
 ds_read_b128 v[76:79], v5 offset:27648
 v_mfma_f32_16x16x32_bf16 v[128:131], v[44:47], a[188:191], v[128:131]
 s_waitcnt lgkmcnt(4)
 v_mfma_f32_16x16x32_bf16 v[96:99], v[48:51], a[236:239], v[96:99]
 s_add_u32 m0, s91, 81920
 ds_read_b128 v[32:35], v5 offset:1024
 v_mfma_f32_16x16x32_bf16 v[96:99], v[52:55], a[244:247], v[96:99]
 s_add_u32 s86, s89, 892928
 buffer_load_dwordx4 v2, s[48:51], s86 offen offset:0 sc1 lds
 v_mfma_f32_16x16x32_bf16 v[96:99], v[56:59], a[176:179], v[96:99]
 ds_read_b128 v[36:39], v5 offset:10240
 v_mfma_f32_16x16x32_bf16 v[96:99], v[60:63], a[184:187], v[96:99]
 v_mfma_f32_16x16x32_bf16 v[132:135], v[48:51], a[240:243], v[132:135]
 ds_read_b128 v[40:43], v5 offset:19456
 v_mfma_f32_16x16x32_bf16 v[132:135], v[52:55], a[248:251], v[132:135]
 s_add_u32 s83, s87, 3145728
 buffer_load_dwordx4 a[204:207], v6, s[16:19], s83 offen sc1
 v_mfma_f32_16x16x32_bf16 v[132:135], v[56:59], a[180:183], v[132:135]
 ds_read_b128 v[44:47], v5 offset:28672
 v_mfma_f32_16x16x32_bf16 v[132:135], v[60:63], a[188:191], v[132:135]
 s_waitcnt lgkmcnt(4)
 v_mfma_f32_16x16x32_bf16 v[100:103], v[64:67], a[236:239], v[100:103]
 ds_read_b128 v[48:51], v5 offset:2048
 v_mfma_f32_16x16x32_bf16 v[100:103], v[68:71], a[244:247], v[100:103]
 buffer_load_dwordx4 a[208:211], v7, s[16:19], s83 offen sc1
 v_mfma_f32_16x16x32_bf16 v[100:103], v[72:75], a[176:179], v[100:103]
 ds_read_b128 v[52:55], v5 offset:11264
 v_mfma_f32_16x16x32_bf16 v[100:103], v[76:79], a[184:187], v[100:103]
 v_mfma_f32_16x16x32_bf16 v[136:139], v[64:67], a[240:243], v[136:139]
 ds_read_b128 v[56:59], v5 offset:20480
 v_mfma_f32_16x16x32_bf16 v[136:139], v[68:71], a[248:251], v[136:139]
 s_add_u32 s83, s87, 3276800
 buffer_load_dwordx4 a[212:215], v6, s[16:19], s83 offen sc1
 v_mfma_f32_16x16x32_bf16 v[136:139], v[72:75], a[180:183], v[136:139]
 ds_read_b128 v[60:63], v5 offset:29696
 v_mfma_f32_16x16x32_bf16 v[136:139], v[76:79], a[188:191], v[136:139]
 s_waitcnt lgkmcnt(4)
 v_mfma_f32_16x16x32_bf16 v[104:107], v[32:35], a[236:239], v[104:107]
 ds_read_b128 v[64:67], v5 offset:3072
 v_mfma_f32_16x16x32_bf16 v[104:107], v[36:39], a[244:247], v[104:107]
 buffer_load_dwordx4 a[216:219], v7, s[16:19], s83 offen sc1
 v_mfma_f32_16x16x32_bf16 v[104:107], v[40:43], a[176:179], v[104:107]
 ds_read_b128 v[68:71], v5 offset:12288
 v_mfma_f32_16x16x32_bf16 v[104:107], v[44:47], a[184:187], v[104:107]
 v_mfma_f32_16x16x32_bf16 v[140:143], v[32:35], a[240:243], v[140:143]
 ds_read_b128 v[72:75], v5 offset:21504
 v_mfma_f32_16x16x32_bf16 v[140:143], v[36:39], a[248:251], v[140:143]
 s_add_u32 s83, s87, 3407872
 buffer_load_dwordx4 a[220:223], v6, s[16:19], s83 offen sc1
 v_mfma_f32_16x16x32_bf16 v[140:143], v[40:43], a[180:183], v[140:143]
 ds_read_b128 v[76:79], v5 offset:30720
 v_mfma_f32_16x16x32_bf16 v[140:143], v[44:47], a[188:191], v[140:143]
 s_waitcnt vmcnt(22) lgkmcnt(4)
 s_barrier
 v_add_u32 v3, 0x9000, v3
 v_mfma_f32_16x16x32_bf16 v[108:111], v[48:51], a[236:239], v[108:111]
 ds_read_b128 v[32:35], v3 offset:0
 v_add_u32 v4, 0x9000, v4
 v_mfma_f32_16x16x32_bf16 v[108:111], v[52:55], a[244:247], v[108:111]
 buffer_load_dwordx4 a[224:227], v7, s[16:19], s83 offen sc1
 s_cmp_eq_u32 s52, 0
 s_cbranch_scc1 L_flag_o
L_flag_o_b:
 v_mfma_f32_16x16x32_bf16 v[108:111], v[56:59], a[176:179], v[108:111]
 ds_read_b128 v[36:39], v3 offset:9216
 v_add_u32 v5, 0x9000, v5
 v_mfma_f32_16x16x32_bf16 v[108:111], v[60:63], a[184:187], v[108:111]
 v_mfma_f32_16x16x32_bf16 v[144:147], v[48:51], a[240:243], v[144:147]
 ds_read_b128 v[40:43], v3 offset:18432
 v_mfma_f32_16x16x32_bf16 v[144:147], v[52:55], a[248:251], v[144:147]
 s_add_u32 s83, s87, 3538944
 buffer_load_dwordx4 a[228:231], v6, s[16:19], s83 offen sc1
 v_mfma_f32_16x16x32_bf16 v[144:147], v[56:59], a[180:183], v[144:147]
 ds_read_b128 v[44:47], v3 offset:27648
 v_mfma_f32_16x16x32_bf16 v[144:147], v[60:63], a[188:191], v[144:147]
 s_waitcnt lgkmcnt(4)
 v_mfma_f32_16x16x32_bf16 v[112:115], v[64:67], a[236:239], v[112:115]
 ds_read_b128 v[48:51], v3 offset:1024
 v_mfma_f32_16x16x32_bf16 v[112:115], v[68:71], a[244:247], v[112:115]
 buffer_load_dwordx4 a[232:235], v7, s[16:19], s83 offen sc1
 v_mfma_f32_16x16x32_bf16 v[112:115], v[72:75], a[176:179], v[112:115]
 ds_read_b128 v[52:55], v3 offset:10240
 v_mfma_f32_16x16x32_bf16 v[112:115], v[76:79], a[184:187], v[112:115]
 v_mfma_f32_16x16x32_bf16 v[148:151], v[64:67], a[240:243], v[148:151]
 ds_read_b128 v[56:59], v3 offset:19456
 v_mfma_f32_16x16x32_bf16 v[148:151], v[68:71], a[248:251], v[148:151]
 v_mfma_f32_16x16x32_bf16 v[148:151], v[72:75], a[180:183], v[148:151]
 ds_read_b128 v[60:63], v3 offset:28672
 v_mfma_f32_16x16x32_bf16 v[148:151], v[76:79], a[188:191], v[148:151]
 s_waitcnt vmcnt(17) lgkmcnt(4)
 v_mfma_f32_16x16x32_bf16 v[80:83], v[32:35], a[128:131], v[80:83]
 s_add_u32 m0, s91, 110592
 ds_read_b128 v[64:67], v3 offset:2048
 v_mfma_f32_16x16x32_bf16 v[80:83], v[36:39], a[136:139], v[80:83]
 s_add_u32 s86, s89, 1032192
 buffer_load_dwordx4 v2, s[48:51], s86 offen offset:0 sc1 lds
 v_mfma_f32_16x16x32_bf16 v[80:83], v[40:43], a[144:147], v[80:83]
 ds_read_b128 v[68:71], v3 offset:11264
 v_mfma_f32_16x16x32_bf16 v[80:83], v[44:47], a[152:155], v[80:83]
 v_mfma_f32_16x16x32_bf16 v[116:119], v[32:35], a[132:135], v[116:119]
 ds_read_b128 v[72:75], v3 offset:20480
 v_mfma_f32_16x16x32_bf16 v[116:119], v[36:39], a[140:143], v[116:119]
 buffer_load_dwordx4 v2, s[48:51], s86 offen offset:1024 sc1 lds
 v_mfma_f32_16x16x32_bf16 v[116:119], v[40:43], a[148:151], v[116:119]
 ds_read_b128 v[76:79], v3 offset:29696
 v_mfma_f32_16x16x32_bf16 v[116:119], v[44:47], a[156:159], v[116:119]
 s_waitcnt lgkmcnt(4)
 v_mfma_f32_16x16x32_bf16 v[84:87], v[48:51], a[128:131], v[84:87]
 ds_read_b128 v[32:35], v3 offset:3072
 v_mfma_f32_16x16x32_bf16 v[84:87], v[52:55], a[136:139], v[84:87]
 buffer_load_dwordx4 v2, s[48:51], s86 offen offset:2048 sc1 lds
 v_mfma_f32_16x16x32_bf16 v[84:87], v[56:59], a[144:147], v[84:87]
 ds_read_b128 v[36:39], v3 offset:12288
 v_mfma_f32_16x16x32_bf16 v[84:87], v[60:63], a[152:155], v[84:87]
 v_mfma_f32_16x16x32_bf16 v[120:123], v[48:51], a[132:135], v[120:123]
 ds_read_b128 v[40:43], v3 offset:21504
 v_mfma_f32_16x16x32_bf16 v[120:123], v[52:55], a[140:143], v[120:123]
 buffer_load_dwordx4 v2, s[48:51], s86 offen offset:3072 sc1 lds
 v_mfma_f32_16x16x32_bf16 v[120:123], v[56:59], a[148:151], v[120:123]
 ds_read_b128 v[44:47], v3 offset:30720
 v_mfma_f32_16x16x32_bf16 v[120:123], v[60:63], a[156:159], v[120:123]
 s_waitcnt lgkmcnt(4)
 v_mfma_f32_16x16x32_bf16 v[88:91], v[64:67], a[128:131], v[88:91]
 s_add_u32 m0, s91, 114688
 ds_read_b128 v[48:51], v4 offset:4096
 v_mfma_f32_16x16x32_bf16 v[88:91], v[68:71], a[136:139], v[88:91]
 s_add_u32 s86, s89, 1036288
 buffer_load_dwordx4 v2, s[48:51], s86 offen offset:0 sc1 lds
 v_mfma_f32_16x16x32_bf16 v[88:91], v[72:75], a[144:147], v[88:91]
 ds_read_b128 v[52:55], v4 offset:13312
 v_mfma_f32_16x16x32_bf16 v[88:91], v[76:79], a[152:155], v[88:91]
 v_mfma_f32_16x16x32_bf16 v[124:127], v[64:67], a[132:135], v[124:127]
 ds_read_b128 v[56:59], v4 offset:22528
 v_mfma_f32_16x16x32_bf16 v[124:127], v[68:71], a[140:143], v[124:127]
 buffer_load_dwordx4 v2, s[48:51], s86 offen offset:1024 sc1 lds
 v_mfma_f32_16x16x32_bf16 v[124:127], v[72:75], a[148:151], v[124:127]
 ds_read_b128 v[60:63], v4 offset:31744
 v_mfma_f32_16x16x32_bf16 v[124:127], v[76:79], a[156:159], v[124:127]
 s_waitcnt lgkmcnt(4)
 v_mfma_f32_16x16x32_bf16 v[92:95], v[32:35], a[128:131], v[92:95]
 ds_read_b128 v[64:67], v5 offset:0
 v_mfma_f32_16x16x32_bf16 v[92:95], v[36:39], a[136:139], v[92:95]
 buffer_load_dwordx4 v2, s[48:51], s86 offen offset:2048 sc1 lds
 v_mfma_f32_16x16x32_bf16 v[92:95], v[40:43], a[144:147], v[92:95]
 ds_read_b128 v[68:71], v5 offset:9216
 v_mfma_f32_16x16x32_bf16 v[92:95], v[44:47], a[152:155], v[92:95]
 v_mfma_f32_16x16x32_bf16 v[128:131], v[32:35], a[132:135], v[128:131]
 ds_read_b128 v[72:75], v5 offset:18432
 v_mfma_f32_16x16x32_bf16 v[128:131], v[36:39], a[140:143], v[128:131]
 buffer_load_dwordx4 v2, s[48:51], s86 offen offset:3072 sc1 lds
 v_mfma_f32_16x16x32_bf16 v[128:131], v[40:43], a[148:151], v[128:131]
 ds_read_b128 v[76:79], v5 offset:27648
 v_mfma_f32_16x16x32_bf16 v[128:131], v[44:47], a[156:159], v[128:131]
 s_waitcnt lgkmcnt(4)
 v_mfma_f32_16x16x32_bf16 v[96:99], v[48:51], a[128:131], v[96:99]
 s_add_u32 m0, s91, 118784
 ds_read_b128 v[32:35], v5 offset:1024
 v_mfma_f32_16x16x32_bf16 v[96:99], v[52:55], a[136:139], v[96:99]
 s_add_u32 s86, s89, 1040384
 buffer_load_dwordx4 v2, s[48:51], s86 offen offset:0 sc1 lds
 v_mfma_f32_16x16x32_bf16 v[96:99], v[56:59], a[144:147], v[96:99]
 ds_read_b128 v[36:39], v5 offset:10240
 v_mfma_f32_16x16x32_bf16 v[96:99], v[60:63], a[152:155], v[96:99]
 v_mfma_f32_16x16x32_bf16 v[132:135], v[48:51], a[132:135], v[132:135]
 ds_read_b128 v[40:43], v5 offset:19456
 v_mfma_f32_16x16x32_bf16 v[132:135], v[52:55], a[140:143], v[132:135]
 s_add_u32 s83, s87, 3670016
 buffer_load_dwordx4 a[236:239], v6, s[16:19], s83 offen sc1
 v_mfma_f32_16x16x32_bf16 v[132:135], v[56:59], a[148:151], v[132:135]
 ds_read_b128 v[44:47], v5 offset:28672
 v_mfma_f32_16x16x32_bf16 v[132:135], v[60:63], a[156:159], v[132:135]
 s_waitcnt lgkmcnt(4)
 v_mfma_f32_16x16x32_bf16 v[100:103], v[64:67], a[128:131], v[100:103]
 ds_read_b128 v[48:51], v5 offset:2048
 v_mfma_f32_16x16x32_bf16 v[100:103], v[68:71], a[136:139], v[100:103]
 buffer_load_dwordx4 a[240:243], v7, s[16:19], s83 offen sc1
 v_mfma_f32_16x16x32_bf16 v[100:103], v[72:75], a[144:147], v[100:103]
 ds_read_b128 v[52:55], v5 offset:11264
 v_mfma_f32_16x16x32_bf16 v[100:103], v[76:79], a[152:155], v[100:103]
 v_mfma_f32_16x16x32_bf16 v[136:139], v[64:67], a[132:135], v[136:139]
 ds_read_b128 v[56:59], v5 offset:20480
 v_mfma_f32_16x16x32_bf16 v[136:139], v[68:71], a[140:143], v[136:139]
 s_add_u32 s83, s87, 3801088
 buffer_load_dwordx4 a[244:247], v6, s[16:19], s83 offen sc1
 v_mfma_f32_16x16x32_bf16 v[136:139], v[72:75], a[148:151], v[136:139]
 ds_read_b128 v[60:63], v5 offset:29696
 v_mfma_f32_16x16x32_bf16 v[136:139], v[76:79], a[156:159], v[136:139]
 s_waitcnt lgkmcnt(4)
 v_mfma_f32_16x16x32_bf16 v[104:107], v[32:35], a[128:131], v[104:107]
 ds_read_b128 v[64:67], v5 offset:3072
 v_mfma_f32_16x16x32_bf16 v[104:107], v[36:39], a[136:139], v[104:107]
 buffer_load_dwordx4 a[248:251], v7, s[16:19], s83 offen sc1
 v_mfma_f32_16x16x32_bf16 v[104:107], v[40:43], a[144:147], v[104:107]
 ds_read_b128 v[68:71], v5 offset:12288
 v_mfma_f32_16x16x32_bf16 v[104:107], v[44:47], a[152:155], v[104:107]
 v_mfma_f32_16x16x32_bf16 v[140:143], v[32:35], a[132:135], v[140:143]
 ds_read_b128 v[72:75], v5 offset:21504
 v_mfma_f32_16x16x32_bf16 v[140:143], v[36:39], a[140:143], v[140:143]
 s_add_u32 s83, s87, 3932160
 buffer_load_dwordx4 a[176:179], v6, s[16:19], s83 offen sc1
 v_mfma_f32_16x16x32_bf16 v[140:143], v[40:43], a[148:151], v[140:143]
 ds_read_b128 v[76:79], v5 offset:30720
 v_mfma_f32_16x16x32_bf16 v[140:143], v[44:47], a[156:159], v[140:143]
 s_waitcnt vmcnt(22) lgkmcnt(4)
 s_barrier
 v_add_u32 v3, 0x9000, v3
 v_mfma_f32_16x16x32_bf16 v[108:111], v[48:51], a[128:131], v[108:111]
 ds_read_b128 v[32:35], v3 offset:0
 v_add_u32 v4, 0x9000, v4
 v_mfma_f32_16x16x32_bf16 v[108:111], v[52:55], a[136:139], v[108:111]
 buffer_load_dwordx4 a[180:183], v7, s[16:19], s83 offen sc1
 v_mfma_f32_16x16x32_bf16 v[108:111], v[56:59], a[144:147], v[108:111]
 ds_read_b128 v[36:39], v3 offset:9216
 v_add_u32 v5, 0x9000, v5
 v_mfma_f32_16x16x32_bf16 v[108:111], v[60:63], a[152:155], v[108:111]
 v_mfma_f32_16x16x32_bf16 v[144:147], v[48:51], a[132:135], v[144:147]
 ds_read_b128 v[40:43], v3 offset:18432
 v_mfma_f32_16x16x32_bf16 v[144:147], v[52:55], a[140:143], v[144:147]
 s_add_u32 s83, s87, 4063232
 buffer_load_dwordx4 a[184:187], v6, s[16:19], s83 offen sc1
 v_mfma_f32_16x16x32_bf16 v[144:147], v[56:59], a[148:151], v[144:147]
 ds_read_b128 v[44:47], v3 offset:27648
 v_mfma_f32_16x16x32_bf16 v[144:147], v[60:63], a[156:159], v[144:147]
 s_waitcnt lgkmcnt(4)
 v_mfma_f32_16x16x32_bf16 v[112:115], v[64:67], a[128:131], v[112:115]
 ds_read_b128 v[48:51], v3 offset:1024
 v_mfma_f32_16x16x32_bf16 v[112:115], v[68:71], a[136:139], v[112:115]
 buffer_load_dwordx4 a[188:191], v7, s[16:19], s83 offen sc1
 v_mfma_f32_16x16x32_bf16 v[112:115], v[72:75], a[144:147], v[112:115]
 ds_read_b128 v[52:55], v3 offset:10240
 v_mfma_f32_16x16x32_bf16 v[112:115], v[76:79], a[152:155], v[112:115]
 v_mfma_f32_16x16x32_bf16 v[148:151], v[64:67], a[132:135], v[148:151]
 ds_read_b128 v[56:59], v3 offset:19456
 v_mfma_f32_16x16x32_bf16 v[148:151], v[68:71], a[140:143], v[148:151]
 v_mfma_f32_16x16x32_bf16 v[148:151], v[72:75], a[148:151], v[148:151]
 ds_read_b128 v[60:63], v3 offset:28672
 v_mfma_f32_16x16x32_bf16 v[148:151], v[76:79], a[156:159], v[148:151]
 s_waitcnt vmcnt(17) lgkmcnt(4)
L_fin_e6:
 v_mfma_f32_16x16x32_bf16 v[80:83], v[32:35], a[204:207], v[80:83]
 s_add_u32 m0, s91, 0
 ds_read_b128 v[64:67], v3 offset:2048
 v_mfma_f32_16x16x32_bf16 v[80:83], v[36:39], a[212:215], v[80:83]
 s_add_u32 s86, s89, 1179648
 buffer_load_dwordx4 v2, s[48:51], s86 offen offset:0 sc1 lds
 v_mfma_f32_16x16x32_bf16 v[80:83], v[40:43], a[220:223], v[80:83]
 ds_read_b128 v[68:71], v3 offset:11264
 v_mfma_f32_16x16x32_bf16 v[80:83], v[44:47], a[228:231], v[80:83]
 v_mfma_f32_16x16x32_bf16 v[116:119], v[32:35], a[208:211], v[116:119]
 ds_read_b128 v[72:75], v3 offset:20480
 v_mfma_f32_16x16x32_bf16 v[116:119], v[36:39], a[216:219], v[116:119]
 buffer_load_dwordx4 v2, s[48:51], s86 offen offset:1024 sc1 lds
 v_mfma_f32_16x16x32_bf16 v[116:119], v[40:43], a[224:227], v[116:119]
 ds_read_b128 v[76:79], v3 offset:29696
 v_mfma_f32_16x16x32_bf16 v[116:119], v[44:47], a[232:235], v[116:119]
 s_waitcnt lgkmcnt(4)
 v_mfma_f32_16x16x32_bf16 v[84:87], v[48:51], a[204:207], v[84:87]
 ds_read_b128 v[32:35], v3 offset:3072
 v_mfma_f32_16x16x32_bf16 v[84:87], v[52:55], a[212:215], v[84:87]
 buffer_load_dwordx4 v2, s[48:51], s86 offen offset:2048 sc1 lds
 v_mfma_f32_16x16x32_bf16 v[84:87], v[56:59], a[220:223], v[84:87]
 ds_read_b128 v[36:39], v3 offset:12288
 v_mfma_f32_16x16x32_bf16 v[84:87], v[60:63], a[228:231], v[84:87]
 v_mfma_f32_16x16x32_bf16 v[120:123], v[48:51], a[208:211], v[120:123]
 ds_read_b128 v[40:43], v3 offset:21504
 v_mfma_f32_16x16x32_bf16 v[120:123], v[52:55], a[216:219], v[120:123]
 buffer_load_dwordx4 v2, s[48:51], s86 offen offset:3072 sc1 lds
 v_mfma_f32_16x16x32_bf16 v[120:123], v[56:59], a[224:227], v[120:123]
 ds_read_b128 v[44:47], v3 offset:30720
 v_mfma_f32_16x16x32_bf16 v[120:123], v[60:63], a[232:235], v[120:123]
 s_waitcnt lgkmcnt(4)
 v_mfma_f32_16x16x32_bf16 v[88:91], v[64:67], a[204:207], v[88:91]
 s_add_u32 m0, s91, 4096
 ds_read_b128 v[48:51], v4 offset:4096
 v_mfma_f32_16x16x32_bf16 v[88:91], v[68:71], a[212:215], v[88:91]
 s_add_u32 s86, s89, 1183744
 buffer_load_dwordx4 v2, s[48:51], s86 offen offset:0 sc1 lds
 v_mfma_f32_16x16x32_bf16 v[88:91], v[72:75], a[220:223], v[88:91]
 ds_read_b128 v[52:55], v4 offset:13312
 v_mfma_f32_16x16x32_bf16 v[88:91], v[76:79], a[228:231], v[88:91]
 v_mfma_f32_16x16x32_bf16 v[124:127], v[64:67], a[208:211], v[124:127]
 ds_read_b128 v[56:59], v4 offset:22528
 v_mfma_f32_16x16x32_bf16 v[124:127], v[68:71], a[216:219], v[124:127]
 buffer_load_dwordx4 v2, s[48:51], s86 offen offset:1024 sc1 lds
 v_mfma_f32_16x16x32_bf16 v[124:127], v[72:75], a[224:227], v[124:127]
 ds_read_b128 v[60:63], v4 offset:31744
 v_mfma_f32_16x16x32_bf16 v[124:127], v[76:79], a[232:235], v[124:127]
 s_waitcnt lgkmcnt(4)
 v_mfma_f32_16x16x32_bf16 v[92:95], v[32:35], a[204:207], v[92:95]
 ds_read_b128 v[64:67], v5 offset:0
 v_mfma_f32_16x16x32_bf16 v[92:95], v[36:39], a[212:215], v[92:95]
 buffer_load_dwordx4 v2, s[48:51], s86 offen offset:2048 sc1 lds
 v_mfma_f32_16x16x32_bf16 v[92:95], v[40:43], a[220:223], v[92:95]
 ds_read_b128 v[68:71], v5 offset:9216
 v_mfma_f32_16x16x32_bf16 v[92:95], v[44:47], a[228:231], v[92:95]
 v_mfma_f32_16x16x32_bf16 v[128:131], v[32:35], a[208:211], v[128:131]
 ds_read_b128 v[72:75], v5 offset:18432
 v_mfma_f32_16x16x32_bf16 v[128:131], v[36:39], a[216:219], v[128:131]
 buffer_load_dwordx4 v2, s[48:51], s86 offen offset:3072 sc1 lds
 v_mfma_f32_16x16x32_bf16 v[128:131], v[40:43], a[224:227], v[128:131]
 ds_read_b128 v[76:79], v5 offset:27648
 v_mfma_f32_16x16x32_bf16 v[128:131], v[44:47], a[232:235], v[128:131]
 s_waitcnt lgkmcnt(4)
 v_mfma_f32_16x16x32_bf16 v[96:99], v[48:51], a[204:207], v[96:99]
 s_add_u32 m0, s91, 8192
 ds_read_b128 v[32:35], v5 offset:1024
 v_mfma_f32_16x16x32_bf16 v[96:99], v[52:55], a[212:215], v[96:99]
 s_add_u32 s86, s89, 1187840
 buffer_load_dwordx4 v2, s[48:51], s86 offen offset:0 sc1 lds
 v_mfma_f32_16x16x32_bf16 v[96:99], v[56:59], a[220:223], v[96:99]
 ds_read_b128 v[36:39], v5 offset:10240
 v_mfma_f32_16x16x32_bf16 v[96:99], v[60:63], a[228:231], v[96:99]
 v_mfma_f32_16x16x32_bf16 v[132:135], v[48:51], a[208:211], v[132:135]
 ds_read_b128 v[40:43], v5 offset:19456
 v_mfma_f32_16x16x32_bf16 v[132:135], v[52:55], a[216:219], v[132:135]
 s_add_u32 s83, s87, 4194304
 buffer_load_dwordx4 a[128:131], v6, s[16:19], s83 offen sc1
 v_mfma_f32_16x16x32_bf16 v[132:135], v[56:59], a[224:227], v[132:135]
 ds_read_b128 v[44:47], v5 offset:28672
 v_mfma_f32_16x16x32_bf16 v[132:135], v[60:63], a[232:235], v[132:135]
 s_waitcnt lgkmcnt(4)
 v_mfma_f32_16x16x32_bf16 v[100:103], v[64:67], a[204:207], v[100:103]
 ds_read_b128 v[48:51], v5 offset:2048
 v_mfma_f32_16x16x32_bf16 v[100:103], v[68:71], a[212:215], v[100:103]
 buffer_load_dwordx4 a[132:135], v7, s[16:19], s83 offen sc1
 v_mfma_f32_16x16x32_bf16 v[100:103], v[72:75], a[220:223], v[100:103]
 ds_read_b128 v[52:55], v5 offset:11264
 v_mfma_f32_16x16x32_bf16 v[100:103], v[76:79], a[228:231], v[100:103]
 v_mfma_f32_16x16x32_bf16 v[136:139], v[64:67], a[208:211], v[136:139]
 ds_read_b128 v[56:59], v5 offset:20480
 v_mfma_f32_16x16x32_bf16 v[136:139], v[68:71], a[216:219], v[136:139]
 s_add_u32 s83, s87, 4325376
 buffer_load_dwordx4 a[136:139], v6, s[16:19], s83 offen sc1
 v_mfma_f32_16x16x32_bf16 v[136:139], v[72:75], a[224:227], v[136:139]
 ds_read_b128 v[60:63], v5 offset:29696
 v_mfma_f32_16x16x32_bf16 v[136:139], v[76:79], a[232:235], v[136:139]
 s_waitcnt lgkmcnt(4)
 v_mfma_f32_16x16x32_bf16 v[104:107], v[32:35], a[204:207], v[104:107]
 ds_read_b128 v[64:67], v5 offset:3072
 v_mfma_f32_16x16x32_bf16 v[104:107], v[36:39], a[212:215], v[104:107]
 buffer_load_dwordx4 a[140:143], v7, s[16:19], s83 offen sc1
 v_mfma_f32_16x16x32_bf16 v[104:107], v[40:43], a[220:223], v[104:107]
 ds_read_b128 v[68:71], v5 offset:12288
 v_mfma_f32_16x16x32_bf16 v[104:107], v[44:47], a[228:231], v[104:107]
 v_mfma_f32_16x16x32_bf16 v[140:143], v[32:35], a[208:211], v[140:143]
 ds_read_b128 v[72:75], v5 offset:21504
 v_mfma_f32_16x16x32_bf16 v[140:143], v[36:39], a[216:219], v[140:143]
 s_add_u32 s83, s87, 4456448
 buffer_load_dwordx4 a[144:147], v6, s[16:19], s83 offen sc1
 v_mfma_f32_16x16x32_bf16 v[140:143], v[40:43], a[224:227], v[140:143]
 ds_read_b128 v[76:79], v5 offset:30720
 v_mfma_f32_16x16x32_bf16 v[140:143], v[44:47], a[232:235], v[140:143]
 s_waitcnt vmcnt(22) lgkmcnt(4)
 s_barrier
 v_add_u32 v3, 0x9000, v3
 v_mfma_f32_16x16x32_bf16 v[108:111], v[48:51], a[204:207], v[108:111]
 ds_read_b128 v[32:35], v3 offset:0
 v_add_u32 v4, 0x9000, v4
 v_mfma_f32_16x16x32_bf16 v[108:111], v[52:55], a[212:215], v[108:111]
 buffer_load_dwordx4 a[148:151], v7, s[16:19], s83 offen sc1
 v_mfma_f32_16x16x32_bf16 v[108:111], v[56:59], a[220:223], v[108:111]
 ds_read_b128 v[36:39], v3 offset:9216
 v_add_u32 v5, 0x9000, v5
 v_mfma_f32_16x16x32_bf16 v[108:111], v[60:63], a[228:231], v[108:111]
 v_mfma_f32_16x16x32_bf16 v[144:147], v[48:51], a[208:211], v[144:147]
 ds_read_b128 v[40:43], v3 offset:18432
 v_mfma_f32_16x16x32_bf16 v[144:147], v[52:55], a[216:219], v[144:147]
 s_add_u32 s83, s87, 4587520
 buffer_load_dwordx4 a[152:155], v6, s[16:19], s83 offen sc1
 v_mfma_f32_16x16x32_bf16 v[144:147], v[56:59], a[224:227], v[144:147]
 ds_read_b128 v[44:47], v3 offset:27648
 v_mfma_f32_16x16x32_bf16 v[144:147], v[60:63], a[232:235], v[144:147]
 s_waitcnt lgkmcnt(4)
 v_mfma_f32_16x16x32_bf16 v[112:115], v[64:67], a[204:207], v[112:115]
 ds_read_b128 v[48:51], v3 offset:1024
 v_mfma_f32_16x16x32_bf16 v[112:115], v[68:71], a[212:215], v[112:115]
 buffer_load_dwordx4 a[156:159], v7, s[16:19], s83 offen sc1
 v_mfma_f32_16x16x32_bf16 v[112:115], v[72:75], a[220:223], v[112:115]
 ds_read_b128 v[52:55], v3 offset:10240
 v_mfma_f32_16x16x32_bf16 v[112:115], v[76:79], a[228:231], v[112:115]
 buffer_load_dword v28, v30, s[20:23], s98 offen sc1
 v_mfma_f32_16x16x32_bf16 v[148:151], v[64:67], a[208:211], v[148:151]
 ds_read_b128 v[56:59], v3 offset:19456
 v_mfma_f32_16x16x32_bf16 v[148:151], v[68:71], a[216:219], v[148:151]
 v_mfma_f32_16x16x32_bf16 v[148:151], v[72:75], a[224:227], v[148:151]
 ds_read_b128 v[60:63], v3 offset:28672
 v_mfma_f32_16x16x32_bf16 v[148:151], v[76:79], a[232:235], v[148:151]
 s_waitcnt vmcnt(18) lgkmcnt(4)
 v_mfma_f32_16x16x32_bf16 v[80:83], v[32:35], a[236:239], v[80:83]
 s_add_u32 m0, s91, 36864
 ds_read_b128 v[64:67], v3 offset:2048
 v_mfma_f32_16x16x32_bf16 v[80:83], v[36:39], a[244:247], v[80:83]
 s_add_u32 s86, s90, 0
 buffer_load_dwordx4 v2, s[48:51], s86 offen offset:0 sc1 lds
 v_mfma_f32_16x16x32_bf16 v[80:83], v[40:43], a[176:179], v[80:83]
 ds_read_b128 v[68:71], v3 offset:11264
 v_mfma_f32_16x16x32_bf16 v[80:83], v[44:47], a[184:187], v[80:83]
 v_mfma_f32_16x16x32_bf16 v[116:119], v[32:35], a[240:243], v[116:119]
 ds_read_b128 v[72:75], v3 offset:20480
 v_mfma_f32_16x16x32_bf16 v[116:119], v[36:39], a[248:251], v[116:119]
 buffer_load_dwordx4 v2, s[48:51], s86 offen offset:1024 sc1 lds
 v_mfma_f32_16x16x32_bf16 v[116:119], v[40:43], a[180:183], v[116:119]
 ds_read_b128 v[76:79], v3 offset:29696
 v_mfma_f32_16x16x32_bf16 v[116:119], v[44:47], a[188:191], v[116:119]
 s_waitcnt lgkmcnt(4)
 v_mfma_f32_16x16x32_bf16 v[84:87], v[48:51], a[236:239], v[84:87]
 ds_read_b128 v[32:35], v3 offset:3072
 v_mfma_f32_16x16x32_bf16 v[84:87], v[52:55], a[244:247], v[84:87]
 buffer_load_dwordx4 v2, s[48:51], s86 offen offset:2048 sc1 lds
 v_mfma_f32_16x16x32_bf16 v[84:87], v[56:59], a[176:179], v[84:87]
 ds_read_b128 v[36:39], v3 offset:12288
 v_mfma_f32_16x16x32_bf16 v[84:87], v[60:63], a[184:187], v[84:87]
 v_mfma_f32_16x16x32_bf16 v[120:123], v[48:51], a[240:243], v[120:123]
 ds_read_b128 v[40:43], v3 offset:21504
 v_mfma_f32_16x16x32_bf16 v[120:123], v[52:55], a[248:251], v[120:123]
 buffer_load_dwordx4 v2, s[48:51], s86 offen offset:3072 sc1 lds
 v_mfma_f32_16x16x32_bf16 v[120:123], v[56:59], a[180:183], v[120:123]
 ds_read_b128 v[44:47], v3 offset:30720
 v_mfma_f32_16x16x32_bf16 v[120:123], v[60:63], a[188:191], v[120:123]
 s_waitcnt lgkmcnt(4)
 v_mfma_f32_16x16x32_bf16 v[88:91], v[64:67], a[236:239], v[88:91]
 s_add_u32 m0, s91, 40960
 ds_read_b128 v[48:51], v4 offset:4096
 v_mfma_f32_16x16x32_bf16 v[88:91], v[68:71], a[244:247], v[88:91]
 s_add_u32 s86, s90, 4096
 buffer_load_dwordx4 v2, s[48:51], s86 offen offset:0 sc1 lds
 v_mfma_f32_16x16x32_bf16 v[88:91], v[72:75], a[176:179], v[88:91]
 ds_read_b128 v[52:55], v4 offset:13312
 v_mfma_f32_16x16x32_bf16 v[88:91], v[76:79], a[184:187], v[88:91]
 v_mfma_f32_16x16x32_bf16 v[124:127], v[64:67], a[240:243], v[124:127]
 ds_read_b128 v[56:59], v4 offset:22528
 v_mfma_f32_16x16x32_bf16 v[124:127], v[68:71], a[248:251], v[124:127]
 buffer_load_dwordx4 v2, s[48:51], s86 offen offset:1024 sc1 lds
 v_mfma_f32_16x16x32_bf16 v[124:127], v[72:75], a[180:183], v[124:127]
 ds_read_b128 v[60:63], v4 offset:31744
 v_mfma_f32_16x16x32_bf16 v[124:127], v[76:79], a[188:191], v[124:127]
 s_waitcnt lgkmcnt(4)
 v_mfma_f32_16x16x32_bf16 v[92:95], v[32:35], a[236:239], v[92:95]
 ds_read_b128 v[64:67], v5 offset:0
 v_mfma_f32_16x16x32_bf16 v[92:95], v[36:39], a[244:247], v[92:95]
 buffer_load_dwordx4 v2, s[48:51], s86 offen offset:2048 sc1 lds
 v_mfma_f32_16x16x32_bf16 v[92:95], v[40:43], a[176:179], v[92:95]
 ds_read_b128 v[68:71], v5 offset:9216
 v_mfma_f32_16x16x32_bf16 v[92:95], v[44:47], a[184:187], v[92:95]
 v_mfma_f32_16x16x32_bf16 v[128:131], v[32:35], a[240:243], v[128:131]
 ds_read_b128 v[72:75], v5 offset:18432
 v_mfma_f32_16x16x32_bf16 v[128:131], v[36:39], a[248:251], v[128:131]
 buffer_load_dwordx4 v2, s[48:51], s86 offen offset:3072 sc1 lds
 v_mfma_f32_16x16x32_bf16 v[128:131], v[40:43], a[180:183], v[128:131]
 ds_read_b128 v[76:79], v5 offset:27648
 v_mfma_f32_16x16x32_bf16 v[128:131], v[44:47], a[188:191], v[128:131]
 s_waitcnt lgkmcnt(4)
 v_mfma_f32_16x16x32_bf16 v[96:99], v[48:51], a[236:239], v[96:99]
 s_add_u32 m0, s91, 45056
 ds_read_b128 v[32:35], v5 offset:1024
 v_mfma_f32_16x16x32_bf16 v[96:99], v[52:55], a[244:247], v[96:99]
 s_add_u32 s86, s90, 8192
 buffer_load_dwordx4 v2, s[48:51], s86 offen offset:0 sc1 lds
 v_mfma_f32_16x16x32_bf16 v[96:99], v[56:59], a[176:179], v[96:99]
 ds_read_b128 v[36:39], v5 offset:10240
 v_mfma_f32_16x16x32_bf16 v[96:99], v[60:63], a[184:187], v[96:99]
 s_waitcnt vmcnt(9)
 v_cmp_eq_u32 vcc, 0, v28
 s_cbranch_vccnz L_spin_o
L_spin_o_b:
 v_mfma_f32_16x16x32_bf16 v[132:135], v[48:51], a[240:243], v[132:135]
 ds_read_b128 v[40:43], v5 offset:19456
 v_mfma_f32_16x16x32_bf16 v[132:135], v[52:55], a[248:251], v[132:135]
 s_add_u32 s83, s88, 0
 buffer_load_dwordx4 a[204:207], v6, s[16:19], s83 offen sc1
 v_mfma_f32_16x16x32_bf16 v[132:135], v[56:59], a[180:183], v[132:135]
 ds_read_b128 v[44:47], v5 offset:28672
 v_mfma_f32_16x16x32_bf16 v[132:135], v[60:63], a[188:191], v[132:135]
 s_waitcnt lgkmcnt(4)
 v_mfma_f32_16x16x32_bf16 v[100:103], v[64:67], a[236:239], v[100:103]
 ds_read_b128 v[48:51], v5 offset:2048
 v_mfma_f32_16x16x32_bf16 v[100:103], v[68:71], a[244:247], v[100:103]
 buffer_load_dwordx4 a[208:211], v7, s[16:19], s83 offen sc1
 v_mfma_f32_16x16x32_bf16 v[100:103], v[72:75], a[176:179], v[100:103]
 ds_read_b128 v[52:55], v5 offset:11264
 v_mfma_f32_16x16x32_bf16 v[100:103], v[76:79], a[184:187], v[100:103]
 v_mfma_f32_16x16x32_bf16 v[136:139], v[64:67], a[240:243], v[136:139]
 ds_read_b128 v[56:59], v5 offset:20480
 v_mfma_f32_16x16x32_bf16 v[136:139], v[68:71], a[248:251], v[136:139]
 s_add_u32 s83, s88, 131072
 buffer_load_dwordx4 a[212:215], v6, s[16:19], s83 offen sc1
 v_mfma_f32_16x16x32_bf16 v[136:139], v[72:75], a[180:183], v[136:139]
 ds_read_b128 v[60:63], v5 offset:29696
 v_mfma_f32_16x16x32_bf16 v[136:139], v[76:79], a[188:191], v[136:139]
 s_waitcnt lgkmcnt(4)
 v_mfma_f32_16x16x32_bf16 v[104:107], v[32:35], a[236:239], v[104:107]
 ds_read_b128 v[64:67], v5 offset:3072
 v_mfma_f32_16x16x32_bf16 v[104:107], v[36:39], a[244:247], v[104:107]
 buffer_load_dwordx4 a[216:219], v7, s[16:19], s83 offen sc1
 v_mfma_f32_16x16x32_bf16 v[104:107], v[40:43], a[176:179], v[104:107]
 ds_read_b128 v[68:71], v5 offset:12288
 v_mfma_f32_16x16x32_bf16 v[104:107], v[44:47], a[184:187], v[104:107]
 v_mfma_f32_16x16x32_bf16 v[140:143], v[32:35], a[240:243], v[140:143]
 ds_read_b128 v[72:75], v5 offset:21504
 v_mfma_f32_16x16x32_bf16 v[140:143], v[36:39], a[248:251], v[140:143]
 s_add_u32 s83, s88, 262144
 buffer_load_dwordx4 a[220:223], v6, s[16:19], s83 offen sc1
 v_mfma_f32_16x16x32_bf16 v[140:143], v[40:43], a[180:183], v[140:143]
 ds_read_b128 v[76:79], v5 offset:30720
 v_mfma_f32_16x16x32_bf16 v[140:143], v[44:47], a[188:191], v[140:143]
 s_waitcnt lgkmcnt(4)
 s_barrier
 v_add_u32 v3, 0xfffe5000, v3
 v_mfma_f32_16x16x32_bf16 v[108:111], v[48:51], a[236:239], v[108:111]
 ds_read_b128 v[32:35], v3 offset:0
 v_add_u32 v4, 0xfffe5000, v4
 v_mfma_f32_16x16x32_bf16 v[108:111], v[52:55], a[244:247], v[108:111]
 buffer_load_dwordx4 a[224:227], v7, s[16:19], s83 offen sc1
 v_mfma_f32_16x16x32_bf16 v[108:111], v[56:59], a[176:179], v[108:111]
 ds_read_b128 v[36:39], v3 offset:9216
 v_add_u32 v5, 0xfffe5000, v5
 v_mfma_f32_16x16x32_bf16 v[108:111], v[60:63], a[184:187], v[108:111]
 v_mfma_f32_16x16x32_bf16 v[144:147], v[48:51], a[240:243], v[144:147]
 ds_read_b128 v[40:43], v3 offset:18432
 v_mfma_f32_16x16x32_bf16 v[144:147], v[52:55], a[248:251], v[144:147]
 s_add_u32 s83, s88, 393216
 buffer_load_dwordx4 a[228:231], v6, s[16:19], s83 offen sc1
 v_mfma_f32_16x16x32_bf16 v[144:147], v[56:59], a[180:183], v[144:147]
 ds_read_b128 v[44:47], v3 offset:27648
 v_mfma_f32_16x16x32_bf16 v[144:147], v[60:63], a[188:191], v[144:147]
 s_waitcnt lgkmcnt(4)
 v_mfma_f32_16x16x32_bf16 v[112:115], v[64:67], a[236:239], v[112:115]
 ds_read_b128 v[48:51], v3 offset:1024
 v_mfma_f32_16x16x32_bf16 v[112:115], v[68:71], a[244:247], v[112:115]
 buffer_load_dwordx4 a[232:235], v7, s[16:19], s83 offen sc1
 v_mfma_f32_16x16x32_bf16 v[112:115], v[72:75], a[176:179], v[112:115]
 ds_read_b128 v[52:55], v3 offset:10240
 v_mfma_f32_16x16x32_bf16 v[112:115], v[76:79], a[184:187], v[112:115]
 v_mfma_f32_16x16x32_bf16 v[148:151], v[64:67], a[240:243], v[148:151]
 ds_read_b128 v[56:59], v3 offset:19456
 v_mfma_f32_16x16x32_bf16 v[148:151], v[68:71], a[248:251], v[148:151]
 v_mfma_f32_16x16x32_bf16 v[148:151], v[72:75], a[180:183], v[148:151]
 ds_read_b128 v[60:63], v3 offset:28672
 v_mfma_f32_16x16x32_bf16 v[148:151], v[76:79], a[188:191], v[148:151]
 s_waitcnt lgkmcnt(4)
 v_mfma_f32_16x16x32_bf16 v[80:83], v[32:35], a[128:131], v[80:83]
 s_add_u32 m0, s91, 73728
 ds_read_b128 v[64:67], v3 offset:2048
 v_mfma_f32_16x16x32_bf16 v[80:83], v[36:39], a[136:139], v[80:83]
 s_add_u32 s86, s90, 147456
 buffer_load_dwordx4 v2, s[48:51], s86 offen offset:0 sc1 lds
 v_mfma_f32_16x16x32_bf16 v[80:83], v[40:43], a[144:147], v[80:83]
 ds_read_b128 v[68:71], v3 offset:11264
 v_mfma_f32_16x16x32_bf16 v[80:83], v[44:47], a[152:155], v[80:83]
 v_mfma_f32_16x16x32_bf16 v[116:119], v[32:35], a[132:135], v[116:119]
 ds_read_b128 v[72:75], v3 offset:20480
 v_mfma_f32_16x16x32_bf16 v[116:119], v[36:39], a[140:143], v[116:119]
 buffer_load_dwordx4 v2, s[48:51], s86 offen offset:1024 sc1 lds
 v_mfma_f32_16x16x32_bf16 v[116:119], v[40:43], a[148:151], v[116:119]
 ds_read_b128 v[76:79], v3 offset:29696
 v_mfma_f32_16x16x32_bf16 v[116:119], v[44:47], a[156:159], v[116:119]
 s_waitcnt lgkmcnt(4)
 v_mfma_f32_16x16x32_bf16 v[84:87], v[48:51], a[128:131], v[84:87]
 ds_read_b128 v[32:35], v3 offset:3072
 v_mfma_f32_16x16x32_bf16 v[84:87], v[52:55], a[136:139], v[84:87]
 buffer_load_dwordx4 v2, s[48:51], s86 offen offset:2048 sc1 lds
 v_mfma_f32_16x16x32_bf16 v[84:87], v[56:59], a[144:147], v[84:87]
 ds_read_b128 v[36:39], v3 offset:12288
 v_mfma_f32_16x16x32_bf16 v[84:87], v[60:63], a[152:155], v[84:87]
 v_mfma_f32_16x16x32_bf16 v[120:123], v[48:51], a[132:135], v[120:123]
 ds_read_b128 v[40:43], v3 offset:21504
 v_mfma_f32_16x16x32_bf16 v[120:123], v[52:55], a[140:143], v[120:123]
 buffer_load_dwordx4 v2, s[48:51], s86 offen offset:3072 sc1 lds
 v_mfma_f32_16x16x32_bf16 v[120:123], v[56:59], a[148:151], v[120:123]
 ds_read_b128 v[44:47], v3 offset:30720
 v_mfma_f32_16x16x32_bf16 v[120:123], v[60:63], a[156:159], v[120:123]
 s_waitcnt lgkmcnt(4)
 v_mfma_f32_16x16x32_bf16 v[88:91], v[64:67], a[128:131], v[88:91]
 s_add_u32 m0, s91, 77824
 ds_read_b128 v[48:51], v4 offset:4096
 v_mfma_f32_16x16x32_bf16 v[88:91], v[68:71], a[136:139], v[88:91]
 s_add_u32 s86, s90, 151552
 buffer_load_dwordx4 v2, s[48:51], s86 offen offset:0 sc1 lds
 v_mfma_f32_16x16x32_bf16 v[88:91], v[72:75], a[144:147], v[88:91]
 ds_read_b128 v[52:55], v4 offset:13312
 v_mfma_f32_16x16x32_bf16 v[88:91], v[76:79], a[152:155], v[88:91]
 v_mfma_f32_16x16x32_bf16 v[124:127], v[64:67], a[132:135], v[124:127]
 ds_read_b128 v[56:59], v4 offset:22528
 v_mfma_f32_16x16x32_bf16 v[124:127], v[68:71], a[140:143], v[124:127]
 buffer_load_dwordx4 v2, s[48:51], s86 offen offset:1024 sc1 lds
 v_mfma_f32_16x16x32_bf16 v[124:127], v[72:75], a[148:151], v[124:127]
 ds_read_b128 v[60:63], v4 offset:31744
 v_mfma_f32_16x16x32_bf16 v[124:127], v[76:79], a[156:159], v[124:127]
 s_waitcnt lgkmcnt(4)
 v_mfma_f32_16x16x32_bf16 v[92:95], v[32:35], a[128:131], v[92:95]
 ds_read_b128 v[64:67], v5 offset:0
 v_mfma_f32_16x16x32_bf16 v[92:95], v[36:39], a[136:139], v[92:95]
 buffer_load_dwordx4 v2, s[48:51], s86 offen offset:2048 sc1 lds
 v_mfma_f32_16x16x32_bf16 v[92:95], v[40:43], a[144:147], v[92:95]
 ds_read_b128 v[68:71], v5 offset:9216
 v_mfma_f32_16x16x32_bf16 v[92:95], v[44:47], a[152:155], v[92:95]
 v_mfma_f32_16x16x32_bf16 v[128:131], v[32:35], a[132:135], v[128:131]
 ds_read_b128 v[72:75], v5 offset:18432
 v_mfma_f32_16x16x32_bf16 v[128:131], v[36:39], a[140:143], v[128:131]
 buffer_load_dwordx4 v2, s[48:51], s86 offen offset:3072 sc1 lds
 v_mfma_f32_16x16x32_bf16 v[128:131], v[40:43], a[148:151], v[128:131]
 ds_read_b128 v[76:79], v5 offset:27648
 v_mfma_f32_16x16x32_bf16 v[128:131], v[44:47], a[156:159], v[128:131]
 s_waitcnt lgkmcnt(4)
 v_mfma_f32_16x16x32_bf16 v[96:99], v[48:51], a[128:131], v[96:99]
 s_add_u32 m0, s91, 81920
 ds_read_b128 v[32:35], v5 offset:1024
 v_mfma_f32_16x16x32_bf16 v[96:99], v[52:55], a[136:139], v[96:99]
 s_add_u32 s86, s90, 155648
 buffer_load_dwordx4 v2, s[48:51], s86 offen offset:0 sc1 lds
 v_mfma_f32_16x16x32_bf16 v[96:99], v[56:59], a[144:147], v[96:99]
 ds_read_b128 v[36:39], v5 offset:10240
 v_mfma_f32_16x16x32_bf16 v[96:99], v[60:63], a[152:155], v[96:99]
 v_mfma_f32_16x16x32_bf16 v[132:135], v[48:51], a[132:135], v[132:135]
 ds_read_b128 v[40:43], v5 offset:19456
 v_mfma_f32_16x16x32_bf16 v[132:135], v[52:55], a[140:143], v[132:135]
 s_add_u32 s83, s88, 524288
 buffer_load_dwordx4 a[236:239], v6, s[16:19], s83 offen sc1
 v_mfma_f32_16x16x32_bf16 v[132:135], v[56:59], a[148:151], v[132:135]
 ds_read_b128 v[44:47], v5 offset:28672
 v_mfma_f32_16x16x32_bf16 v[132:135], v[60:63], a[156:159], v[132:135]
 s_waitcnt lgkmcnt(4)
 v_mfma_f32_16x16x32_bf16 v[100:103], v[64:67], a[128:131], v[100:103]
 ds_read_b128 v[48:51], v5 offset:2048
 v_mfma_f32_16x16x32_bf16 v[100:103], v[68:71], a[136:139], v[100:103]
 buffer_load_dwordx4 a[240:243], v7, s[16:19], s83 offen sc1
 v_mfma_f32_16x16x32_bf16 v[100:103], v[72:75], a[144:147], v[100:103]
 ds_read_b128 v[52:55], v5 offset:11264
 v_mfma_f32_16x16x32_bf16 v[100:103], v[76:79], a[152:155], v[100:103]
 v_mfma_f32_16x16x32_bf16 v[136:139], v[64:67], a[132:135], v[136:139]
 ds_read_b128 v[56:59], v5 offset:20480
 v_mfma_f32_16x16x32_bf16 v[136:139], v[68:71], a[140:143], v[136:139]
 s_add_u32 s83, s88, 655360
 buffer_load_dwordx4 a[244:247], v6, s[16:19], s83 offen sc1
 v_mfma_f32_16x16x32_bf16 v[136:139], v[72:75], a[148:151], v[136:139]
 ds_read_b128 v[60:63], v5 offset:29696
 v_mfma_f32_16x16x32_bf16 v[136:139], v[76:79], a[156:159], v[136:139]
 s_waitcnt lgkmcnt(4)
 v_mfma_f32_16x16x32_bf16 v[104:107], v[32:35], a[128:131], v[104:107]
 ds_read_b128 v[64:67], v5 offset:3072
 v_mfma_f32_16x16x32_bf16 v[104:107], v[36:39], a[136:139], v[104:107]
 buffer_load_dwordx4 a[248:251], v7, s[16:19], s83 offen sc1
 v_mfma_f32_16x16x32_bf16 v[104:107], v[40:43], a[144:147], v[104:107]
 ds_read_b128 v[68:71], v5 offset:12288
 v_mfma_f32_16x16x32_bf16 v[104:107], v[44:47], a[152:155], v[104:107]
 v_mfma_f32_16x16x32_bf16 v[140:143], v[32:35], a[132:135], v[140:143]
 ds_read_b128 v[72:75], v5 offset:21504
 v_mfma_f32_16x16x32_bf16 v[140:143], v[36:39], a[140:143], v[140:143]
 s_add_u32 s83, s88, 786432
 buffer_load_dwordx4 a[176:179], v6, s[16:19], s83 offen sc1
 v_mfma_f32_16x16x32_bf16 v[140:143], v[40:43], a[148:151], v[140:143]
 ds_read_b128 v[76:79], v5 offset:30720
 v_mfma_f32_16x16x32_bf16 v[140:143], v[44:47], a[156:159], v[140:143]
 s_waitcnt vmcnt(22) lgkmcnt(4)
 s_barrier
 v_add_u32 v3, 0x9000, v3
 v_mfma_f32_16x16x32_bf16 v[108:111], v[48:51], a[128:131], v[108:111]
 ds_read_b128 v[32:35], v3 offset:0
 v_add_u32 v4, 0x9000, v4
 v_mfma_f32_16x16x32_bf16 v[108:111], v[52:55], a[136:139], v[108:111]
 buffer_load_dwordx4 a[180:183], v7, s[16:19], s83 offen sc1
 v_mfma_f32_16x16x32_bf16 v[108:111], v[56:59], a[144:147], v[108:111]
 ds_read_b128 v[36:39], v3 offset:9216
 v_add_u32 v5, 0x9000, v5
 v_mfma_f32_16x16x32_bf16 v[108:111], v[60:63], a[152:155], v[108:111]
 v_mfma_f32_16x16x32_bf16 v[144:147], v[48:51], a[132:135], v[144:147]
 ds_read_b128 v[40:43], v3 offset:18432
 v_mfma_f32_16x16x32_bf16 v[144:147], v[52:55], a[140:143], v[144:147]
 s_add_u32 s83, s88, 917504
 buffer_load_dwordx4 a[184:187], v6, s[16:19], s83 offen sc1
 v_mfma_f32_16x16x32_bf16 v[144:147], v[56:59], a[148:151], v[144:147]
 ds_read_b128 v[44:47], v3 offset:27648
 v_mfma_f32_16x16x32_bf16 v[144:147], v[60:63], a[156:159], v[144:147]
 s_waitcnt lgkmcnt(4)
 v_mfma_f32_16x16x32_bf16 v[112:115], v[64:67], a[128:131], v[112:115]
 ds_read_b128 v[48:51], v3 offset:1024
 v_mfma_f32_16x16x32_bf16 v[112:115], v[68:71], a[136:139], v[112:115]
 buffer_load_dwordx4 a[188:191], v7, s[16:19], s83 offen sc1
 v_mfma_f32_16x16x32_bf16 v[112:115], v[72:75], a[144:147], v[112:115]
 ds_read_b128 v[52:55], v3 offset:10240
 v_mfma_f32_16x16x32_bf16 v[112:115], v[76:79], a[152:155], v[112:115]
 v_mfma_f32_16x16x32_bf16 v[148:151], v[64:67], a[132:135], v[148:151]
 ds_read_b128 v[56:59], v3 offset:19456
 v_mfma_f32_16x16x32_bf16 v[148:151], v[68:71], a[140:143], v[148:151]
 v_mfma_f32_16x16x32_bf16 v[148:151], v[72:75], a[148:151], v[148:151]
 ds_read_b128 v[60:63], v3 offset:28672
 v_mfma_f32_16x16x32_bf16 v[148:151], v[76:79], a[156:159], v[148:151]
 s_waitcnt vmcnt(17) lgkmcnt(4)
 v_mfma_f32_16x16x32_bf16 v[152:155], v[32:35], a[204:207], 0
 s_add_u32 m0, s91, 110592
 ds_read_b128 v[64:67], v3 offset:2048
 v_mfma_f32_16x16x32_bf16 v[152:155], v[36:39], a[212:215], v[152:155]
 s_add_u32 s86, s90, 294912
 buffer_load_dwordx4 v2, s[48:51], s86 offen offset:0 sc1 lds
 v_mfma_f32_16x16x32_bf16 v[152:155], v[40:43], a[220:223], v[152:155]
 ds_read_b128 v[68:71], v3 offset:11264
 v_mfma_f32_16x16x32_bf16 v[152:155], v[44:47], a[228:231], v[152:155]
 v_mfma_f32_16x16x32_bf16 v[188:191], v[32:35], a[208:211], 0
 ds_read_b128 v[72:75], v3 offset:20480
 v_mfma_f32_16x16x32_bf16 v[188:191], v[36:39], a[216:219], v[188:191]
 buffer_load_dwordx4 v2, s[48:51], s86 offen offset:1024 sc1 lds
 v_mfma_f32_16x16x32_bf16 v[188:191], v[40:43], a[224:227], v[188:191]
 ds_read_b128 v[76:79], v3 offset:29696
 v_mfma_f32_16x16x32_bf16 v[188:191], v[44:47], a[232:235], v[188:191]
 s_waitcnt lgkmcnt(4)
 v_mfma_f32_16x16x32_bf16 v[156:159], v[48:51], a[204:207], 0
 ds_read_b128 v[32:35], v3 offset:3072
 v_mfma_f32_16x16x32_bf16 v[156:159], v[52:55], a[212:215], v[156:159]
 buffer_load_dwordx4 v2, s[48:51], s86 offen offset:2048 sc1 lds
 v_mfma_f32_16x16x32_bf16 v[156:159], v[56:59], a[220:223], v[156:159]
 ds_read_b128 v[36:39], v3 offset:12288
 v_mfma_f32_16x16x32_bf16 v[156:159], v[60:63], a[228:231], v[156:159]
 v_mfma_f32_16x16x32_bf16 v[192:195], v[48:51], a[208:211], 0
 ds_read_b128 v[40:43], v3 offset:21504
 v_mfma_f32_16x16x32_bf16 v[192:195], v[52:55], a[216:219], v[192:195]
 buffer_load_dwordx4 v2, s[48:51], s86 offen offset:3072 sc1 lds
 v_mfma_f32_16x16x32_bf16 v[192:195], v[56:59], a[224:227], v[192:195]
 ds_read_b128 v[44:47], v3 offset:30720
 v_mfma_f32_16x16x32_bf16 v[192:195], v[60:63], a[232:235], v[192:195]
 s_waitcnt lgkmcnt(4)
 v_mfma_f32_16x16x32_bf16 v[160:163], v[64:67], a[204:207], 0
 s_add_u32 m0, s91, 114688
 ds_read_b128 v[48:51], v4 offset:4096
 v_mfma_f32_16x16x32_bf16 v[160:163], v[68:71], a[212:215], v[160:163]
 s_add_u32 s86, s90, 299008
 buffer_load_dwordx4 v2, s[48:51], s86 offen offset:0 sc1 lds
 v_mfma_f32_16x16x32_bf16 v[160:163], v[72:75], a[220:223], v[160:163]
 ds_read_b128 v[52:55], v4 offset:13312
 v_mfma_f32_16x16x32_bf16 v[160:163], v[76:79], a[228:231], v[160:163]
 v_mfma_f32_16x16x32_bf16 v[196:199], v[64:67], a[208:211], 0
 ds_read_b128 v[56:59], v4 offset:22528
 v_mfma_f32_16x16x32_bf16 v[196:199], v[68:71], a[216:219], v[196:199]
 buffer_load_dwordx4 v2, s[48:51], s86 offen offset:1024 sc1 lds
 v_mfma_f32_16x16x32_bf16 v[196:199], v[72:75], a[224:227], v[196:199]
 ds_read_b128 v[60:63], v4 offset:31744
 v_mfma_f32_16x16x32_bf16 v[196:199], v[76:79], a[232:235], v[196:199]
 s_waitcnt lgkmcnt(4)
 v_mfma_f32_16x16x32_bf16 v[164:167], v[32:35], a[204:207], 0
 ds_read_b128 v[64:67], v5 offset:0
 v_mfma_f32_16x16x32_bf16 v[164:167], v[36:39], a[212:215], v[164:167]
 buffer_load_dwordx4 v2, s[48:51], s86 offen offset:2048 sc1 lds
 v_mfma_f32_16x16x32_bf16 v[164:167], v[40:43], a[220:223], v[164:167]
 ds_read_b128 v[68:71], v5 offset:9216
 v_mfma_f32_16x16x32_bf16 v[164:167], v[44:47], a[228:231], v[164:167]
 v_mfma_f32_16x16x32_bf16 v[200:203], v[32:35], a[208:211], 0
 ds_read_b128 v[72:75], v5 offset:18432
 v_mfma_f32_16x16x32_bf16 v[200:203], v[36:39], a[216:219], v[200:203]
 buffer_load_dwordx4 v2, s[48:51], s86 offen offset:3072 sc1 lds
 v_mfma_f32_16x16x32_bf16 v[200:203], v[40:43], a[224:227], v[200:203]
 s_add_u32 s93, s95, 0
 ds_read_b128 v[76:79], v5 offset:27648
 v_cvt_pk_bf16_f32 v116, v116, v117
 v_mfma_f32_16x16x32_bf16 v[200:203], v[44:47], a[232:235], v[200:203]
 s_waitcnt lgkmcnt(4)
 v_cvt_pk_bf16_f32 v117, v118, v119
 v_cvt_pk_bf16_f32 v118, v120, v121
 v_mfma_f32_16x16x32_bf16 v[168:171], v[48:51], a[204:207], 0
 s_add_u32 m0, s91, 118784
 ds_read_b128 v[32:35], v5 offset:1024
 v_cvt_pk_bf16_f32 v119, v122, v123
 v_mfma_f32_16x16x32_bf16 v[168:171], v[52:55], a[212:215], v[168:171]
 s_add_u32 s86, s90, 303104
 buffer_load_dwordx4 v2, s[48:51], s86 offen offset:0 sc1 lds
 v_mfma_f32_16x16x32_bf16 v[168:171], v[56:59], a[220:223], v[168:171]
 s_add_u32 s94, s95, 4096
 ds_read_b128 v[36:39], v5 offset:10240
 v_cvt_pk_bf16_f32 v124, v124, v125
 v_mfma_f32_16x16x32_bf16 v[168:171], v[60:63], a[228:231], v[168:171]
 buffer_store_dwordx4 v[116:119], v2, s[40:43], s93 offen offset:2048 sc1
 v_mfma_f32_16x16x32_bf16 v[204:207], v[48:51], a[208:211], 0
 ds_read_b128 v[40:43], v5 offset:19456
 v_cvt_pk_bf16_f32 v125, v126, v127
 v_mfma_f32_16x16x32_bf16 v[204:207], v[52:55], a[216:219], v[204:207]
 s_add_u32 s83, s88, 1048576
 buffer_load_dwordx4 a[128:131], v6, s[16:19], s83 offen sc1
 v_mfma_f32_16x16x32_bf16 v[204:207], v[56:59], a[224:227], v[204:207]
 ds_read_b128 v[44:47], v5 offset:28672
 v_cvt_pk_bf16_f32 v126, v128, v129
 v_mfma_f32_16x16x32_bf16 v[204:207], v[60:63], a[232:235], v[204:207]
 s_waitcnt lgkmcnt(4)
 v_cvt_pk_bf16_f32 v127, v130, v131
 v_cvt_pk_bf16_f32 v136, v136, v137
 v_mfma_f32_16x16x32_bf16 v[172:175], v[64:67], a[204:207], 0
 ds_read_b128 v[48:51], v5 offset:2048
 v_cvt_pk_bf16_f32 v137, v138, v139
 v_mfma_f32_16x16x32_bf16 v[172:175], v[68:71], a[212:215], v[172:175]
 buffer_load_dwordx4 a[132:135], v7, s[16:19], s83 offen sc1
 v_mfma_f32_16x16x32_bf16 v[172:175], v[72:75], a[220:223], v[172:175]
 ds_read_b128 v[52:55], v5 offset:11264
 v_cvt_pk_bf16_f32 v138, v140, v141
 v_mfma_f32_16x16x32_bf16 v[172:175], v[76:79], a[228:231], v[172:175]
 buffer_store_dwordx4 v[124:127], v2, s[40:43], s93 offen offset:3072 sc1
 v_mfma_f32_16x16x32_bf16 v[208:211], v[64:67], a[208:211], 0
 ds_read_b128 v[56:59], v5 offset:20480
 v_cvt_pk_bf16_f32 v139, v142, v143
 v_mfma_f32_16x16x32_bf16 v[208:211], v[68:71], a[216:219], v[208:211]
 s_add_u32 s83, s88, 1179648
 buffer_load_dwordx4 a[136:139], v6, s[16:19], s83 offen sc1
 v_mfma_f32_16x16x32_bf16 v[208:211], v[72:75], a[224:227], v[208:211]
 ds_read_b128 v[60:63], v5 offset:29696
 v_cvt_pk_bf16_f32 v144, v144, v145
 v_mfma_f32_16x16x32_bf16 v[208:211], v[76:79], a[232:235], v[208:211]
 s_waitcnt lgkmcnt(4)
 buffer_store_dwordx4 v[136:139], v2, s[40:43], s94 offen offset:0 sc1
 v_mfma_f32_16x16x32_bf16 v[176:179], v[32:35], a[204:207], 0
 ds_read_b128 v[64:67], v5 offset:3072
 v_cvt_pk_bf16_f32 v145, v146, v147
 v_mfma_f32_16x16x32_bf16 v[176:179], v[36:39], a[212:215], v[176:179]
 buffer_load_dwordx4 a[140:143], v7, s[16:19], s83 offen sc1
 v_mfma_f32_16x16x32_bf16 v[176:179], v[40:43], a[220:223], v[176:179]
 ds_read_b128 v[68:71], v5 offset:12288
 v_cvt_pk_bf16_f32 v146, v148, v149
 v_mfma_f32_16x16x32_bf16 v[176:179], v[44:47], a[228:231], v[176:179]
 v_cvt_pk_bf16_f32 v147, v150, v151
 v_cvt_pk_bf16_f32 v132, v132, v133
 v_mfma_f32_16x16x32_bf16 v[212:215], v[32:35], a[208:211], 0
 ds_read_b128 v[72:75], v5 offset:21504
 v_cvt_pk_bf16_f32 v133, v134, v135
 v_mfma_f32_16x16x32_bf16 v[212:215], v[36:39], a[216:219], v[212:215]
 s_add_u32 s83, s88, 1310720
 buffer_load_dwordx4 a[144:147], v6, s[16:19], s83 offen sc1
 v_mfma_f32_16x16x32_bf16 v[212:215], v[40:43], a[224:227], v[212:215]
 ds_read_b128 v[76:79], v5 offset:30720
 v_cvt_pk_bf16_f32 v100, v100, v101
 v_mfma_f32_16x16x32_bf16 v[212:215], v[44:47], a[232:235], v[212:215]
 s_waitcnt vmcnt(25) lgkmcnt(4)
 s_barrier
 v_add_u32 v3, 0x9000, v3
 v_mfma_f32_16x16x32_bf16 v[180:183], v[48:51], a[204:207], 0
 ds_read_b128 v[32:35], v3 offset:0
 v_add_u32 v4, 0x9000, v4
 v_mfma_f32_16x16x32_bf16 v[180:183], v[52:55], a[212:215], v[180:183]
 buffer_load_dwordx4 a[148:151], v7, s[16:19], s83 offen sc1
 v_mfma_f32_16x16x32_bf16 v[180:183], v[56:59], a[220:223], v[180:183]
 ds_read_b128 v[36:39], v3 offset:9216
 v_add_u32 v5, 0x9000, v5
 v_mfma_f32_16x16x32_bf16 v[180:183], v[60:63], a[228:231], v[180:183]
 buffer_store_dwordx4 v[144:147], v2, s[40:43], s94 offen offset:1024 sc1
 v_mfma_f32_16x16x32_bf16 v[216:219], v[48:51], a[208:211], 0
 ds_read_b128 v[40:43], v3 offset:18432
 v_cvt_pk_bf16_f32 v101, v102, v103
 v_mfma_f32_16x16x32_bf16 v[216:219], v[52:55], a[216:219], v[216:219]
 s_add_u32 s83, s88, 1441792
 buffer_load_dwordx4 a[152:155], v6, s[16:19], s83 offen sc1
 v_mfma_f32_16x16x32_bf16 v[216:219], v[56:59], a[224:227], v[216:219]
 ds_read_b128 v[44:47], v3 offset:27648
 v_cvt_pk_bf16_f32 v102, v104, v105
 v_mfma_f32_16x16x32_bf16 v[216:219], v[60:63], a[232:235], v[216:219]
 s_waitcnt lgkmcnt(4)
 buffer_store_dwordx2 v[132:133], v9, s[40:43], s94 offen offset:2560 sc1
 v_mfma_f32_16x16x32_bf16 v[184:187], v[64:67], a[204:207], 0
 ds_read_b128 v[48:51], v3 offset:1024
 v_cvt_pk_bf16_f32 v103, v106, v107
 v_mfma_f32_16x16x32_bf16 v[184:187], v[68:71], a[212:215], v[184:187]
 buffer_load_dwordx4 a[156:159], v7, s[16:19], s83 offen sc1
 v_mfma_f32_16x16x32_bf16 v[184:187], v[72:75], a[220:223], v[184:187]
 ds_read_b128 v[52:55], v3 offset:10240
 v_cvt_pk_bf16_f32 v108, v108, v109
 v_mfma_f32_16x16x32_bf16 v[184:187], v[76:79], a[228:231], v[184:187]
 buffer_store_dwordx4 v[100:103], v2, s[40:43], s93 offen offset:0 sc1
 v_mfma_f32_16x16x32_bf16 v[220:223], v[64:67], a[208:211], 0
 ds_read_b128 v[56:59], v3 offset:19456
 v_cvt_pk_bf16_f32 v109, v110, v111
 v_mfma_f32_16x16x32_bf16 v[220:223], v[68:71], a[216:219], v[220:223]
 v_cvt_pk_bf16_f32 v110, v112, v113
 v_cvt_pk_bf16_f32 v111, v114, v115
 v_mfma_f32_16x16x32_bf16 v[220:223], v[72:75], a[224:227], v[220:223]
 ds_read_b128 v[60:63], v3 offset:28672
 v_cvt_pk_bf16_f32 v224, v96, v97
 v_mfma_f32_16x16x32_bf16 v[220:223], v[76:79], a[232:235], v[220:223]
 s_waitcnt vmcnt(23) lgkmcnt(4)
 buffer_store_dwordx4 v[108:111], v2, s[40:43], s93 offen offset:1024 sc1
 v_mfma_f32_16x16x32_bf16 v[152:155], v[32:35], a[236:239], v[152:155]
 s_add_u32 m0, s91, 0
 ds_read_b128 v[64:67], v3 offset:2048
 v_cvt_pk_bf16_f32 v225, v98, v99
 v_mfma_f32_16x16x32_bf16 v[152:155], v[36:39], a[244:247], v[152:155]
 s_add_u32 s86, s90, 442368
 buffer_load_dwordx4 v2, s[48:51], s86 offen offset:0 sc1 lds
 v_mfma_f32_16x16x32_bf16 v[152:155], v[40:43], a[176:179], v[152:155]
 ds_read_b128 v[68:71], v3 offset:11264
 v_mfma_f32_16x16x32_bf16 v[152:155], v[44:47], a[184:187], v[152:155]
 buffer_store_dwordx2 v[224:225], v9, s[40:43], s94 offen offset:2048 sc1
 v_mfma_f32_16x16x32_bf16 v[188:191], v[32:35], a[240:243], v[188:191]
 ds_read_b128 v[72:75], v3 offset:20480
 v_mfma_f32_16x16x32_bf16 v[188:191], v[36:39], a[248:251], v[188:191]
 buffer_load_dwordx4 v2, s[48:51], s86 offen offset:1024 sc1 lds
 v_mfma_f32_16x16x32_bf16 v[188:191], v[40:43], a[180:183], v[188:191]
 ds_read_b128 v[76:79], v3 offset:29696
 v_mfma_f32_16x16x32_bf16 v[188:191], v[44:47], a[188:191], v[188:191]
 s_waitcnt lgkmcnt(4)
 v_mfma_f32_16x16x32_bf16 v[156:159], v[48:51], a[236:239], v[156:159]
 ds_read_b128 v[32:35], v3 offset:3072
 v_mfma_f32_16x16x32_bf16 v[156:159], v[52:55], a[244:247], v[156:159]
 buffer_load_dwordx4 v2, s[48:51], s86 offen offset:2048 sc1 lds
 v_mfma_f32_16x16x32_bf16 v[156:159], v[56:59], a[176:179], v[156:159]
 ds_read_b128 v[36:39], v3 offset:12288
 v_mfma_f32_16x16x32_bf16 v[156:159], v[60:63], a[184:187], v[156:159]
 v_mfma_f32_16x16x32_bf16 v[192:195], v[48:51], a[240:243], v[192:195]
 ds_read_b128 v[40:43], v3 offset:21504
 v_mfma_f32_16x16x32_bf16 v[192:195], v[52:55], a[248:251], v[192:195]
 buffer_load_dwordx4 v2, s[48:51], s86 offen offset:3072 sc1 lds
 v_mfma_f32_16x16x32_bf16 v[192:195], v[56:59], a[180:183], v[192:195]
 ds_read_b128 v[44:47], v3 offset:30720
 v_mfma_f32_16x16x32_bf16 v[192:195], v[60:63], a[188:191], v[192:195]
 s_waitcnt lgkmcnt(4)
 v_mfma_f32_16x16x32_bf16 v[160:163], v[64:67], a[236:239], v[160:163]
 s_add_u32 m0, s91, 4096
 ds_read_b128 v[48:51], v4 offset:4096
 v_mfma_f32_16x16x32_bf16 v[160:163], v[68:71], a[244:247], v[160:163]
 s_add_u32 s86, s90, 446464
 buffer_load_dwordx4 v2, s[48:51], s86 offen offset:0 sc1 lds
 v_mfma_f32_16x16x32_bf16 v[160:163], v[72:75], a[176:179], v[160:163]
 ds_read_b128 v[52:55], v4 offset:13312
 v_mfma_f32_16x16x32_bf16 v[160:163], v[76:79], a[184:187], v[160:163]
 v_mfma_f32_16x16x32_bf16 v[196:199], v[64:67], a[240:243], v[196:199]
 ds_read_b128 v[56:59], v4 offset:22528
 v_mfma_f32_16x16x32_bf16 v[196:199], v[68:71], a[248:251], v[196:199]
 buffer_load_dwordx4 v2, s[48:51], s86 offen offset:1024 sc1 lds
 v_mfma_f32_16x16x32_bf16 v[196:199], v[72:75], a[180:183], v[196:199]
 ds_read_b128 v[60:63], v4 offset:31744
 v_mfma_f32_16x16x32_bf16 v[196:199], v[76:79], a[188:191], v[196:199]
 s_waitcnt lgkmcnt(4)
 v_mfma_f32_16x16x32_bf16 v[164:167], v[32:35], a[236:239], v[164:167]
 ds_read_b128 v[64:67], v5 offset:0
 v_mfma_f32_16x16x32_bf16 v[164:167], v[36:39], a[244:247], v[164:167]
 buffer_load_dwordx4 v2, s[48:51], s86 offen offset:2048 sc1 lds
 v_mfma_f32_16x16x32_bf16 v[164:167], v[40:43], a[176:179], v[164:167]
 ds_read_b128 v[68:71], v5 offset:9216
 v_mfma_f32_16x16x32_bf16 v[164:167], v[44:47], a[184:187], v[164:167]
 v_mfma_f32_16x16x32_bf16 v[200:203], v[32:35], a[240:243], v[200:203]
 ds_read_b128 v[72:75], v5 offset:18432
 v_mfma_f32_16x16x32_bf16 v[200:203], v[36:39], a[248:251], v[200:203]
 buffer_load_dwordx4 v2, s[48:51], s86 offen offset:3072 sc1 lds
 v_mfma_f32_16x16x32_bf16 v[200:203], v[40:43], a[180:183], v[200:203]
 ds_read_b128 v[76:79], v5 offset:27648
 v_mfma_f32_16x16x32_bf16 v[200:203], v[44:47], a[188:191], v[200:203]
 s_waitcnt lgkmcnt(4)
 v_mfma_f32_16x16x32_bf16 v[168:171], v[48:51], a[236:239], v[168:171]
 s_add_u32 m0, s91, 8192
 ds_read_b128 v[32:35], v5 offset:1024
 v_mfma_f32_16x16x32_bf16 v[168:171], v[52:55], a[244:247], v[168:171]
 s_add_u32 s86, s90, 450560
 buffer_load_dwordx4 v2, s[48:51], s86 offen offset:0 sc1 lds
 v_mfma_f32_16x16x32_bf16 v[168:171], v[56:59], a[176:179], v[168:171]
 ds_read_b128 v[36:39], v5 offset:10240
 v_mfma_f32_16x16x32_bf16 v[168:171], v[60:63], a[184:187], v[168:171]
 v_mfma_f32_16x16x32_bf16 v[204:207], v[48:51], a[240:243], v[204:207]
 ds_read_b128 v[40:43], v5 offset:19456
 v_mfma_f32_16x16x32_bf16 v[204:207], v[52:55], a[248:251], v[204:207]
 s_add_u32 s83, s88, 1572864
 buffer_load_dwordx4 a[204:207], v6, s[16:19], s83 offen sc1
 v_mfma_f32_16x16x32_bf16 v[204:207], v[56:59], a[180:183], v[204:207]
 ds_read_b128 v[44:47], v5 offset:28672
 v_mfma_f32_16x16x32_bf16 v[204:207], v[60:63], a[188:191], v[204:207]
 s_waitcnt lgkmcnt(4)
 v_mfma_f32_16x16x32_bf16 v[172:175], v[64:67], a[236:239], v[172:175]
 ds_read_b128 v[48:51], v5 offset:2048
 v_mfma_f32_16x16x32_bf16 v[172:175], v[68:71], a[244:247], v[172:175]
 buffer_load_dwordx4 a[208:211], v7, s[16:19], s83 offen sc1
 v_mfma_f32_16x16x32_bf16 v[172:175], v[72:75], a[176:179], v[172:175]
 ds_read_b128 v[52:55], v5 offset:11264
 v_mfma_f32_16x16x32_bf16 v[172:175], v[76:79], a[184:187], v[172:175]
 v_mfma_f32_16x16x32_bf16 v[208:211], v[64:67], a[240:243], v[208:211]
 ds_read_b128 v[56:59], v5 offset:20480
 v_mfma_f32_16x16x32_bf16 v[208:211], v[68:71], a[248:251], v[208:211]
 s_add_u32 s83, s88, 1703936
 buffer_load_dwordx4 a[212:215], v6, s[16:19], s83 offen sc1
 v_mfma_f32_16x16x32_bf16 v[208:211], v[72:75], a[180:183], v[208:211]
 ds_read_b128 v[60:63], v5 offset:29696
 v_mfma_f32_16x16x32_bf16 v[208:211], v[76:79], a[188:191], v[208:211]
 s_waitcnt lgkmcnt(4)
 v_mfma_f32_16x16x32_bf16 v[176:179], v[32:35], a[236:239], v[176:179]
 ds_read_b128 v[64:67], v5 offset:3072
 v_mfma_f32_16x16x32_bf16 v[176:179], v[36:39], a[244:247], v[176:179]
 buffer_load_dwordx4 a[216:219], v7, s[16:19], s83 offen sc1
 v_mfma_f32_16x16x32_bf16 v[176:179], v[40:43], a[176:179], v[176:179]
 ds_read_b128 v[68:71], v5 offset:12288
 v_mfma_f32_16x16x32_bf16 v[176:179], v[44:47], a[184:187], v[176:179]
 v_mfma_f32_16x16x32_bf16 v[212:215], v[32:35], a[240:243], v[212:215]
 ds_read_b128 v[72:75], v5 offset:21504
 v_mfma_f32_16x16x32_bf16 v[212:215], v[36:39], a[248:251], v[212:215]
 s_add_u32 s83, s88, 1835008
 buffer_load_dwordx4 a[220:223], v6, s[16:19], s83 offen sc1
 v_mfma_f32_16x16x32_bf16 v[212:215], v[40:43], a[180:183], v[212:215]
 ds_read_b128 v[76:79], v5 offset:30720
 v_mfma_f32_16x16x32_bf16 v[212:215], v[44:47], a[188:191], v[212:215]
 s_waitcnt vmcnt(30) lgkmcnt(4)
 s_barrier
 v_add_u32 v3, 0x9000, v3
 v_mfma_f32_16x16x32_bf16 v[180:183], v[48:51], a[236:239], v[180:183]
 ds_read_b128 v[32:35], v3 offset:0
 v_add_u32 v4, 0x9000, v4
 v_mfma_f32_16x16x32_bf16 v[180:183], v[52:55], a[244:247], v[180:183]
 buffer_load_dwordx4 a[224:227], v7, s[16:19], s83 offen sc1
 v_mfma_f32_16x16x32_bf16 v[180:183], v[56:59], a[176:179], v[180:183]
 ds_read_b128 v[36:39], v3 offset:9216
 v_add_u32 v5, 0x9000, v5
 v_mfma_f32_16x16x32_bf16 v[180:183], v[60:63], a[184:187], v[180:183]
 v_mfma_f32_16x16x32_bf16 v[216:219], v[48:51], a[240:243], v[216:219]
 ds_read_b128 v[40:43], v3 offset:18432
 v_mfma_f32_16x16x32_bf16 v[216:219], v[52:55], a[248:251], v[216:219]
 s_add_u32 s83, s88, 1966080
 buffer_load_dwordx4 a[228:231], v6, s[16:19], s83 offen sc1
 v_mfma_f32_16x16x32_bf16 v[216:219], v[56:59], a[180:183], v[216:219]
 ds_read_b128 v[44:47], v3 offset:27648
 v_mfma_f32_16x16x32_bf16 v[216:219], v[60:63], a[188:191], v[216:219]
 s_waitcnt lgkmcnt(4)
 v_mfma_f32_16x16x32_bf16 v[184:187], v[64:67], a[236:239], v[184:187]
 ds_read_b128 v[48:51], v3 offset:1024
 v_mfma_f32_16x16x32_bf16 v[184:187], v[68:71], a[244:247], v[184:187]
 buffer_load_dwordx4 a[232:235], v7, s[16:19], s83 offen sc1
 v_mfma_f32_16x16x32_bf16 v[184:187], v[72:75], a[176:179], v[184:187]
 ds_read_b128 v[52:55], v3 offset:10240
 v_mfma_f32_16x16x32_bf16 v[184:187], v[76:79], a[184:187], v[184:187]
 v_mfma_f32_16x16x32_bf16 v[220:223], v[64:67], a[240:243], v[220:223]
 ds_read_b128 v[56:59], v3 offset:19456
 v_mfma_f32_16x16x32_bf16 v[220:223], v[68:71], a[248:251], v[220:223]
 v_mfma_f32_16x16x32_bf16 v[220:223], v[72:75], a[180:183], v[220:223]
 ds_read_b128 v[60:63], v3 offset:28672
 v_mfma_f32_16x16x32_bf16 v[220:223], v[76:79], a[188:191], v[220:223]
 s_waitcnt vmcnt(20) lgkmcnt(4)
 v_mfma_f32_16x16x32_bf16 v[152:155], v[32:35], a[128:131], v[152:155]
 s_add_u32 m0, s91, 36864
 ds_read_b128 v[64:67], v3 offset:2048
 v_mfma_f32_16x16x32_bf16 v[152:155], v[36:39], a[136:139], v[152:155]
 s_add_u32 s86, s90, 589824
 buffer_load_dwordx4 v2, s[48:51], s86 offen offset:0 sc1 lds
 v_mfma_f32_16x16x32_bf16 v[152:155], v[40:43], a[144:147], v[152:155]
 ds_read_b128 v[68:71], v3 offset:11264
 v_mfma_f32_16x16x32_bf16 v[152:155], v[44:47], a[152:155], v[152:155]
 v_mfma_f32_16x16x32_bf16 v[188:191], v[32:35], a[132:135], v[188:191]
 ds_read_b128 v[72:75], v3 offset:20480
 v_mfma_f32_16x16x32_bf16 v[188:191], v[36:39], a[140:143], v[188:191]
 buffer_load_dwordx4 v2, s[48:51], s86 offen offset:1024 sc1 lds
 v_mfma_f32_16x16x32_bf16 v[188:191], v[40:43], a[148:151], v[188:191]
 ds_read_b128 v[76:79], v3 offset:29696
 v_mfma_f32_16x16x32_bf16 v[188:191], v[44:47], a[156:159], v[188:191]
 s_waitcnt lgkmcnt(4)
 v_mfma_f32_16x16x32_bf16 v[156:159], v[48:51], a[128:131], v[156:159]
 ds_read_b128 v[32:35], v3 offset:3072
 v_mfma_f32_16x16x32_bf16 v[156:159], v[52:55], a[136:139], v[156:159]
 buffer_load_dwordx4 v2, s[48:51], s86 offen offset:2048 sc1 lds
 v_mfma_f32_16x16x32_bf16 v[156:159], v[56:59], a[144:147], v[156:159]
 ds_read_b128 v[36:39], v3 offset:12288
 v_mfma_f32_16x16x32_bf16 v[156:159], v[60:63], a[152:155], v[156:159]
 v_mfma_f32_16x16x32_bf16 v[192:195], v[48:51], a[132:135], v[192:195]
 ds_read_b128 v[40:43], v3 offset:21504
 v_mfma_f32_16x16x32_bf16 v[192:195], v[52:55], a[140:143], v[192:195]
 buffer_load_dwordx4 v2, s[48:51], s86 offen offset:3072 sc1 lds
 v_mfma_f32_16x16x32_bf16 v[192:195], v[56:59], a[148:151], v[192:195]
 ds_read_b128 v[44:47], v3 offset:30720
 v_mfma_f32_16x16x32_bf16 v[192:195], v[60:63], a[156:159], v[192:195]
 s_waitcnt lgkmcnt(4)
 v_mfma_f32_16x16x32_bf16 v[160:163], v[64:67], a[128:131], v[160:163]
 s_add_u32 m0, s91, 40960
 ds_read_b128 v[48:51], v4 offset:4096
 v_mfma_f32_16x16x32_bf16 v[160:163], v[68:71], a[136:139], v[160:163]
 s_add_u32 s86, s90, 593920
 buffer_load_dwordx4 v2, s[48:51], s86 offen offset:0 sc1 lds
 v_mfma_f32_16x16x32_bf16 v[160:163], v[72:75], a[144:147], v[160:163]
 ds_read_b128 v[52:55], v4 offset:13312
 v_mfma_f32_16x16x32_bf16 v[160:163], v[76:79], a[152:155], v[160:163]
 v_mfma_f32_16x16x32_bf16 v[196:199], v[64:67], a[132:135], v[196:199]
 ds_read_b128 v[56:59], v4 offset:22528
 v_mfma_f32_16x16x32_bf16 v[196:199], v[68:71], a[140:143], v[196:199]
 buffer_load_dwordx4 v2, s[48:51], s86 offen offset:1024 sc1 lds
 v_mfma_f32_16x16x32_bf16 v[196:199], v[72:75], a[148:151], v[196:199]
 ds_read_b128 v[60:63], v4 offset:31744
 v_mfma_f32_16x16x32_bf16 v[196:199], v[76:79], a[156:159], v[196:199]
 s_waitcnt lgkmcnt(4)
 v_mfma_f32_16x16x32_bf16 v[164:167], v[32:35], a[128:131], v[164:167]
 ds_read_b128 v[64:67], v5 offset:0
 v_mfma_f32_16x16x32_bf16 v[164:167], v[36:39], a[136:139], v[164:167]
 buffer_load_dwordx4 v2, s[48:51], s86 offen offset:2048 sc1 lds
 v_mfma_f32_16x16x32_bf16 v[164:167], v[40:43], a[144:147], v[164:167]
 ds_read_b128 v[68:71], v5 offset:9216
 v_mfma_f32_16x16x32_bf16 v[164:167], v[44:47], a[152:155], v[164:167]
 v_mfma_f32_16x16x32_bf16 v[200:203], v[32:35], a[132:135], v[200:203]
 ds_read_b128 v[72:75], v5 offset:18432
 v_mfma_f32_16x16x32_bf16 v[200:203], v[36:39], a[140:143], v[200:203]
 buffer_load_dwordx4 v2, s[48:51], s86 offen offset:3072 sc1 lds
 v_mfma_f32_16x16x32_bf16 v[200:203], v[40:43], a[148:151], v[200:203]
 ds_read_b128 v[76:79], v5 offset:27648
 v_mfma_f32_16x16x32_bf16 v[200:203], v[44:47], a[156:159], v[200:203]
 s_waitcnt lgkmcnt(4)
 v_mfma_f32_16x16x32_bf16 v[168:171], v[48:51], a[128:131], v[168:171]
 s_add_u32 m0, s91, 45056
 ds_read_b128 v[32:35], v5 offset:1024
 v_mfma_f32_16x16x32_bf16 v[168:171], v[52:55], a[136:139], v[168:171]
 s_add_u32 s86, s90, 598016
 buffer_load_dwordx4 v2, s[48:51], s86 offen offset:0 sc1 lds
 v_mfma_f32_16x16x32_bf16 v[168:171], v[56:59], a[144:147], v[168:171]
 ds_read_b128 v[36:39], v5 offset:10240
 v_mfma_f32_16x16x32_bf16 v[168:171], v[60:63], a[152:155], v[168:171]
 v_mfma_f32_16x16x32_bf16 v[204:207], v[48:51], a[132:135], v[204:207]
 ds_read_b128 v[40:43], v5 offset:19456
 v_mfma_f32_16x16x32_bf16 v[204:207], v[52:55], a[140:143], v[204:207]
 s_add_u32 s83, s88, 2097152
 buffer_load_dwordx4 a[236:239], v6, s[16:19], s83 offen sc1
 v_mfma_f32_16x16x32_bf16 v[204:207], v[56:59], a[148:151], v[204:207]
 ds_read_b128 v[44:47], v5 offset:28672
 v_mfma_f32_16x16x32_bf16 v[204:207], v[60:63], a[156:159], v[204:207]
 s_waitcnt lgkmcnt(4)
 v_mfma_f32_16x16x32_bf16 v[172:175], v[64:67], a[128:131], v[172:175]
 ds_read_b128 v[48:51], v5 offset:2048
 v_mfma_f32_16x16x32_bf16 v[172:175], v[68:71], a[136:139], v[172:175]
 buffer_load_dwordx4 a[240:243], v7, s[16:19], s83 offen sc1
 v_mfma_f32_16x16x32_bf16 v[172:175], v[72:75], a[144:147], v[172:175]
 ds_read_b128 v[52:55], v5 offset:11264
 v_mfma_f32_16x16x32_bf16 v[172:175], v[76:79], a[152:155], v[172:175]
 v_mfma_f32_16x16x32_bf16 v[208:211], v[64:67], a[132:135], v[208:211]
 ds_read_b128 v[56:59], v5 offset:20480
 v_mfma_f32_16x16x32_bf16 v[208:211], v[68:71], a[140:143], v[208:211]
 s_add_u32 s83, s88, 2228224
 buffer_load_dwordx4 a[244:247], v6, s[16:19], s83 offen sc1
 v_mfma_f32_16x16x32_bf16 v[208:211], v[72:75], a[148:151], v[208:211]
 ds_read_b128 v[60:63], v5 offset:29696
 v_mfma_f32_16x16x32_bf16 v[208:211], v[76:79], a[156:159], v[208:211]
 s_waitcnt lgkmcnt(4)
 v_mfma_f32_16x16x32_bf16 v[176:179], v[32:35], a[128:131], v[176:179]
 ds_read_b128 v[64:67], v5 offset:3072
 v_mfma_f32_16x16x32_bf16 v[176:179], v[36:39], a[136:139], v[176:179]
 buffer_load_dwordx4 a[248:251], v7, s[16:19], s83 offen sc1
 v_mfma_f32_16x16x32_bf16 v[176:179], v[40:43], a[144:147], v[176:179]
 ds_read_b128 v[68:71], v5 offset:12288
 v_mfma_f32_16x16x32_bf16 v[176:179], v[44:47], a[152:155], v[176:179]
 v_mfma_f32_16x16x32_bf16 v[212:215], v[32:35], a[132:135], v[212:215]
 ds_read_b128 v[72:75], v5 offset:21504
 v_mfma_f32_16x16x32_bf16 v[212:215], v[36:39], a[140:143], v[212:215]
 s_add_u32 s83, s88, 2359296
 buffer_load_dwordx4 a[176:179], v6, s[16:19], s83 offen sc1
 v_mfma_f32_16x16x32_bf16 v[212:215], v[40:43], a[148:151], v[212:215]
 ds_read_b128 v[76:79], v5 offset:30720
 v_mfma_f32_16x16x32_bf16 v[212:215], v[44:47], a[156:159], v[212:215]
 s_waitcnt vmcnt(22) lgkmcnt(4)
 s_barrier
 v_add_u32 v3, 0xfffe5000, v3
 v_mfma_f32_16x16x32_bf16 v[180:183], v[48:51], a[128:131], v[180:183]
 ds_read_b128 v[32:35], v3 offset:0
 v_add_u32 v4, 0xfffe5000, v4
 v_mfma_f32_16x16x32_bf16 v[180:183], v[52:55], a[136:139], v[180:183]
 buffer_load_dwordx4 a[180:183], v7, s[16:19], s83 offen sc1
 s_cmp_eq_u32 s52, 0
 s_cbranch_scc1 L_flag_f
L_flag_f_b:
 v_mfma_f32_16x16x32_bf16 v[180:183], v[56:59], a[144:147], v[180:183]
 ds_read_b128 v[36:39], v3 offset:9216
 v_add_u32 v5, 0xfffe5000, v5
 v_mfma_f32_16x16x32_bf16 v[180:183], v[60:63], a[152:155], v[180:183]
 v_mfma_f32_16x16x32_bf16 v[216:219], v[48:51], a[132:135], v[216:219]
 ds_read_b128 v[40:43], v3 offset:18432
 v_mfma_f32_16x16x32_bf16 v[216:219], v[52:55], a[140:143], v[216:219]
 s_add_u32 s83, s88, 2490368
 buffer_load_dwordx4 a[184:187], v6, s[16:19], s83 offen sc1
 v_mfma_f32_16x16x32_bf16 v[216:219], v[56:59], a[148:151], v[216:219]
 ds_read_b128 v[44:47], v3 offset:27648
 v_mfma_f32_16x16x32_bf16 v[216:219], v[60:63], a[156:159], v[216:219]
 s_waitcnt lgkmcnt(4)
 v_mfma_f32_16x16x32_bf16 v[184:187], v[64:67], a[128:131], v[184:187]
 ds_read_b128 v[48:51], v3 offset:1024
 v_mfma_f32_16x16x32_bf16 v[184:187], v[68:71], a[136:139], v[184:187]
 buffer_load_dwordx4 a[188:191], v7, s[16:19], s83 offen sc1
 v_mfma_f32_16x16x32_bf16 v[184:187], v[72:75], a[144:147], v[184:187]
 ds_read_b128 v[52:55], v3 offset:10240
 v_mfma_f32_16x16x32_bf16 v[184:187], v[76:79], a[152:155], v[184:187]
 v_mfma_f32_16x16x32_bf16 v[220:223], v[64:67], a[132:135], v[220:223]
 ds_read_b128 v[56:59], v3 offset:19456
 v_mfma_f32_16x16x32_bf16 v[220:223], v[68:71], a[140:143], v[220:223]
 v_mfma_f32_16x16x32_bf16 v[220:223], v[72:75], a[148:151], v[220:223]
 ds_read_b128 v[60:63], v3 offset:28672
 v_mfma_f32_16x16x32_bf16 v[220:223], v[76:79], a[156:159], v[220:223]
 s_waitcnt vmcnt(17) lgkmcnt(4)
 v_mfma_f32_16x16x32_bf16 v[152:155], v[32:35], a[204:207], v[152:155]
 s_add_u32 m0, s91, 73728
 ds_read_b128 v[64:67], v3 offset:2048
 v_mfma_f32_16x16x32_bf16 v[152:155], v[36:39], a[212:215], v[152:155]
 s_add_u32 s86, s90, 737280
 buffer_load_dwordx4 v2, s[48:51], s86 offen offset:0 sc1 lds
 v_mfma_f32_16x16x32_bf16 v[152:155], v[40:43], a[220:223], v[152:155]
 ds_read_b128 v[68:71], v3 offset:11264
 v_mfma_f32_16x16x32_bf16 v[152:155], v[44:47], a[228:231], v[152:155]
 v_mfma_f32_16x16x32_bf16 v[188:191], v[32:35], a[208:211], v[188:191]
 ds_read_b128 v[72:75], v3 offset:20480
 v_mfma_f32_16x16x32_bf16 v[188:191], v[36:39], a[216:219], v[188:191]
 buffer_load_dwordx4 v2, s[48:51], s86 offen offset:1024 sc1 lds
 v_mfma_f32_16x16x32_bf16 v[188:191], v[40:43], a[224:227], v[188:191]
 ds_read_b128 v[76:79], v3 offset:29696
 v_mfma_f32_16x16x32_bf16 v[188:191], v[44:47], a[232:235], v[188:191]
 s_waitcnt lgkmcnt(4)
 v_mfma_f32_16x16x32_bf16 v[156:159], v[48:51], a[204:207], v[156:159]
 ds_read_b128 v[32:35], v3 offset:3072
 v_mfma_f32_16x16x32_bf16 v[156:159], v[52:55], a[212:215], v[156:159]
 buffer_load_dwordx4 v2, s[48:51], s86 offen offset:2048 sc1 lds
 v_mfma_f32_16x16x32_bf16 v[156:159], v[56:59], a[220:223], v[156:159]
 ds_read_b128 v[36:39], v3 offset:12288
 v_mfma_f32_16x16x32_bf16 v[156:159], v[60:63], a[228:231], v[156:159]
 v_mfma_f32_16x16x32_bf16 v[192:195], v[48:51], a[208:211], v[192:195]
 ds_read_b128 v[40:43], v3 offset:21504
 v_mfma_f32_16x16x32_bf16 v[192:195], v[52:55], a[216:219], v[192:195]
 buffer_load_dwordx4 v2, s[48:51], s86 offen offset:3072 sc1 lds
 v_mfma_f32_16x16x32_bf16 v[192:195], v[56:59], a[224:227], v[192:195]
 ds_read_b128 v[44:47], v3 offset:30720
 v_mfma_f32_16x16x32_bf16 v[192:195], v[60:63], a[232:235], v[192:195]
 s_waitcnt lgkmcnt(4)
 v_mfma_f32_16x16x32_bf16 v[160:163], v[64:67], a[204:207], v[160:163]
 s_add_u32 m0, s91, 77824
 ds_read_b128 v[48:51], v4 offset:4096
 v_mfma_f32_16x16x32_bf16 v[160:163], v[68:71], a[212:215], v[160:163]
 s_add_u32 s86, s90, 741376
 buffer_load_dwordx4 v2, s[48:51], s86 offen offset:0 sc1 lds
 v_mfma_f32_16x16x32_bf16 v[160:163], v[72:75], a[220:223], v[160:163]
 ds_read_b128 v[52:55], v4 offset:13312
 v_mfma_f32_16x16x32_bf16 v[160:163], v[76:79], a[228:231], v[160:163]
 v_mfma_f32_16x16x32_bf16 v[196:199], v[64:67], a[208:211], v[196:199]
 ds_read_b128 v[56:59], v4 offset:22528
 v_mfma_f32_16x16x32_bf16 v[196:199], v[68:71], a[216:219], v[196:199]
 buffer_load_dwordx4 v2, s[48:51], s86 offen offset:1024 sc1 lds
 v_mfma_f32_16x16x32_bf16 v[196:199], v[72:75], a[224:227], v[196:199]
 ds_read_b128 v[60:63], v4 offset:31744
 v_mfma_f32_16x16x32_bf16 v[196:199], v[76:79], a[232:235], v[196:199]
 s_waitcnt lgkmcnt(4)
 v_mfma_f32_16x16x32_bf16 v[164:167], v[32:35], a[204:207], v[164:167]
 ds_read_b128 v[64:67], v5 offset:0
 v_mfma_f32_16x16x32_bf16 v[164:167], v[36:39], a[212:215], v[164:167]
 buffer_load_dwordx4 v2, s[48:51], s86 offen offset:2048 sc1 lds
 v_mfma_f32_16x16x32_bf16 v[164:167], v[40:43], a[220:223], v[164:167]
 ds_read_b128 v[68:71], v5 offset:9216
 v_mfma_f32_16x16x32_bf16 v[164:167], v[44:47], a[228:231], v[164:167]
 v_mfma_f32_16x16x32_bf16 v[200:203], v[32:35], a[208:211], v[200:203]
 ds_read_b128 v[72:75], v5 offset:18432
 v_mfma_f32_16x16x32_bf16 v[200:203], v[36:39], a[216:219], v[200:203]
 buffer_load_dwordx4 v2, s[48:51], s86 offen offset:3072 sc1 lds
 v_mfma_f32_16x16x32_bf16 v[200:203], v[40:43], a[224:227], v[200:203]
 ds_read_b128 v[76:79], v5 offset:27648
 v_mfma_f32_16x16x32_bf16 v[200:203], v[44:47], a[232:235], v[200:203]
 s_waitcnt lgkmcnt(4)
 v_mfma_f32_16x16x32_bf16 v[168:171], v[48:51], a[204:207], v[168:171]
 s_add_u32 m0, s91, 81920
 ds_read_b128 v[32:35], v5 offset:1024
 v_mfma_f32_16x16x32_bf16 v[168:171], v[52:55], a[212:215], v[168:171]
 s_add_u32 s86, s90, 745472
 buffer_load_dwordx4 v2, s[48:51], s86 offen offset:0 sc1 lds
 v_mfma_f32_16x16x32_bf16 v[168:171], v[56:59], a[220:223], v[168:171]
 ds_read_b128 v[36:39], v5 offset:10240
 v_mfma_f32_16x16x32_bf16 v[168:171], v[60:63], a[228:231], v[168:171]
 v_mfma_f32_16x16x32_bf16 v[204:207], v[48:51], a[208:211], v[204:207]
 ds_read_b128 v[40:43], v5 offset:19456
 v_mfma_f32_16x16x32_bf16 v[204:207], v[52:55], a[216:219], v[204:207]
 s_add_u32 s83, s88, 2621440
 buffer_load_dwordx4 a[128:131], v6, s[16:19], s83 offen sc1
 v_mfma_f32_16x16x32_bf16 v[204:207], v[56:59], a[224:227], v[204:207]
 ds_read_b128 v[44:47], v5 offset:28672
 v_mfma_f32_16x16x32_bf16 v[204:207], v[60:63], a[232:235], v[204:207]
 s_waitcnt lgkmcnt(4)
 v_mfma_f32_16x16x32_bf16 v[172:175], v[64:67], a[204:207], v[172:175]
 ds_read_b128 v[48:51], v5 offset:2048
 v_mfma_f32_16x16x32_bf16 v[172:175], v[68:71], a[212:215], v[172:175]
 buffer_load_dwordx4 a[132:135], v7, s[16:19], s83 offen sc1
 v_mfma_f32_16x16x32_bf16 v[172:175], v[72:75], a[220:223], v[172:175]
 ds_read_b128 v[52:55], v5 offset:11264
 v_mfma_f32_16x16x32_bf16 v[172:175], v[76:79], a[228:231], v[172:175]
 v_mfma_f32_16x16x32_bf16 v[208:211], v[64:67], a[208:211], v[208:211]
 ds_read_b128 v[56:59], v5 offset:20480
 v_mfma_f32_16x16x32_bf16 v[208:211], v[68:71], a[216:219], v[208:211]
 s_add_u32 s83, s88, 2752512
 buffer_load_dwordx4 a[136:139], v6, s[16:19], s83 offen sc1
 v_mfma_f32_16x16x32_bf16 v[208:211], v[72:75], a[224:227], v[208:211]
 ds_read_b128 v[60:63], v5 offset:29696
 v_mfma_f32_16x16x32_bf16 v[208:211], v[76:79], a[232:235], v[208:211]
 s_waitcnt lgkmcnt(4)
 v_mfma_f32_16x16x32_bf16 v[176:179], v[32:35], a[204:207], v[176:179]
 ds_read_b128 v[64:67], v5 offset:3072
 v_mfma_f32_16x16x32_bf16 v[176:179], v[36:39], a[212:215], v[176:179]
 buffer_load_dwordx4 a[140:143], v7, s[16:19], s83 offen sc1
 v_mfma_f32_16x16x32_bf16 v[176:179], v[40:43], a[220:223], v[176:179]
 ds_read_b128 v[68:71], v5 offset:12288
 v_mfma_f32_16x16x32_bf16 v[176:179], v[44:47], a[228:231], v[176:179]
 v_mfma_f32_16x16x32_bf16 v[212:215], v[32:35], a[208:211], v[212:215]
 ds_read_b128 v[72:75], v5 offset:21504
 v_mfma_f32_16x16x32_bf16 v[212:215], v[36:39], a[216:219], v[212:215]
 s_add_u32 s83, s88, 2883584
 buffer_load_dwordx4 a[144:147], v6, s[16:19], s83 offen sc1
 v_mfma_f32_16x16x32_bf16 v[212:215], v[40:43], a[224:227], v[212:215]
 ds_read_b128 v[76:79], v5 offset:30720
 v_mfma_f32_16x16x32_bf16 v[212:215], v[44:47], a[232:235], v[212:215]
 s_waitcnt vmcnt(22) lgkmcnt(4)
 s_barrier
 v_add_u32 v3, 0x9000, v3
 v_mfma_f32_16x16x32_bf16 v[180:183], v[48:51], a[204:207], v[180:183]
 ds_read_b128 v[32:35], v3 offset:0
 v_add_u32 v4, 0x9000, v4
 v_mfma_f32_16x16x32_bf16 v[180:183], v[52:55], a[212:215], v[180:183]
 buffer_load_dwordx4 a[148:151], v7, s[16:19], s83 offen sc1
 v_mfma_f32_16x16x32_bf16 v[180:183], v[56:59], a[220:223], v[180:183]
 ds_read_b128 v[36:39], v3 offset:9216
 v_add_u32 v5, 0x9000, v5
 v_mfma_f32_16x16x32_bf16 v[180:183], v[60:63], a[228:231], v[180:183]
 v_mfma_f32_16x16x32_bf16 v[216:219], v[48:51], a[208:211], v[216:219]
 ds_read_b128 v[40:43], v3 offset:18432
 v_mfma_f32_16x16x32_bf16 v[216:219], v[52:55], a[216:219], v[216:219]
 s_add_u32 s83, s88, 3014656
 buffer_load_dwordx4 a[152:155], v6, s[16:19], s83 offen sc1
 v_mfma_f32_16x16x32_bf16 v[216:219], v[56:59], a[224:227], v[216:219]
 ds_read_b128 v[44:47], v3 offset:27648
 v_mfma_f32_16x16x32_bf16 v[216:219], v[60:63], a[232:235], v[216:219]
 s_waitcnt lgkmcnt(4)
 v_mfma_f32_16x16x32_bf16 v[184:187], v[64:67], a[204:207], v[184:187]
 ds_read_b128 v[48:51], v3 offset:1024
 v_mfma_f32_16x16x32_bf16 v[184:187], v[68:71], a[212:215], v[184:187]
 buffer_load_dwordx4 a[156:159], v7, s[16:19], s83 offen sc1
 v_mfma_f32_16x16x32_bf16 v[184:187], v[72:75], a[220:223], v[184:187]
 ds_read_b128 v[52:55], v3 offset:10240
 v_mfma_f32_16x16x32_bf16 v[184:187], v[76:79], a[228:231], v[184:187]
 v_mfma_f32_16x16x32_bf16 v[220:223], v[64:67], a[208:211], v[220:223]
 ds_read_b128 v[56:59], v3 offset:19456
 v_mfma_f32_16x16x32_bf16 v[220:223], v[68:71], a[216:219], v[220:223]
 v_mfma_f32_16x16x32_bf16 v[220:223], v[72:75], a[224:227], v[220:223]
 ds_read_b128 v[60:63], v3 offset:28672
 v_mfma_f32_16x16x32_bf16 v[220:223], v[76:79], a[232:235], v[220:223]
 s_waitcnt vmcnt(17) lgkmcnt(4)
 v_mfma_f32_16x16x32_bf16 v[152:155], v[32:35], a[236:239], v[152:155]
 s_add_u32 m0, s91, 110592
 ds_read_b128 v[64:67], v3 offset:2048
 v_mfma_f32_16x16x32_bf16 v[152:155], v[36:39], a[244:247], v[152:155]
 s_add_u32 s86, s90, 884736
 buffer_load_dwordx4 v2, s[48:51], s86 offen offset:0 sc1 lds
 v_mfma_f32_16x16x32_bf16 v[152:155], v[40:43], a[176:179], v[152:155]
 ds_read_b128 v[68:71], v3 offset:11264
 v_mfma_f32_16x16x32_bf16 v[152:155], v[44:47], a[184:187], v[152:155]
 v_mfma_f32_16x16x32_bf16 v[188:191], v[32:35], a[240:243], v[188:191]
 ds_read_b128 v[72:75], v3 offset:20480
 v_mfma_f32_16x16x32_bf16 v[188:191], v[36:39], a[248:251], v[188:191]
 buffer_load_dwordx4 v2, s[48:51], s86 offen offset:1024 sc1 lds
 v_mfma_f32_16x16x32_bf16 v[188:191], v[40:43], a[180:183], v[188:191]
 ds_read_b128 v[76:79], v3 offset:29696
 v_mfma_f32_16x16x32_bf16 v[188:191], v[44:47], a[188:191], v[188:191]
 s_waitcnt lgkmcnt(4)
 v_mfma_f32_16x16x32_bf16 v[156:159], v[48:51], a[236:239], v[156:159]
 ds_read_b128 v[32:35], v3 offset:3072
 v_mfma_f32_16x16x32_bf16 v[156:159], v[52:55], a[244:247], v[156:159]
 buffer_load_dwordx4 v2, s[48:51], s86 offen offset:2048 sc1 lds
 v_mfma_f32_16x16x32_bf16 v[156:159], v[56:59], a[176:179], v[156:159]
 ds_read_b128 v[36:39], v3 offset:12288
 v_mfma_f32_16x16x32_bf16 v[156:159], v[60:63], a[184:187], v[156:159]
 v_mfma_f32_16x16x32_bf16 v[192:195], v[48:51], a[240:243], v[192:195]
 ds_read_b128 v[40:43], v3 offset:21504
 v_mfma_f32_16x16x32_bf16 v[192:195], v[52:55], a[248:251], v[192:195]
 buffer_load_dwordx4 v2, s[48:51], s86 offen offset:3072 sc1 lds
 v_mfma_f32_16x16x32_bf16 v[192:195], v[56:59], a[180:183], v[192:195]
 ds_read_b128 v[44:47], v3 offset:30720
 v_mfma_f32_16x16x32_bf16 v[192:195], v[60:63], a[188:191], v[192:195]
 s_waitcnt lgkmcnt(4)
 v_mfma_f32_16x16x32_bf16 v[160:163], v[64:67], a[236:239], v[160:163]
 s_add_u32 m0, s91, 114688
 ds_read_b128 v[48:51], v4 offset:4096
 v_mfma_f32_16x16x32_bf16 v[160:163], v[68:71], a[244:247], v[160:163]
 s_add_u32 s86, s90, 888832
 buffer_load_dwordx4 v2, s[48:51], s86 offen offset:0 sc1 lds
 v_mfma_f32_16x16x32_bf16 v[160:163], v[72:75], a[176:179], v[160:163]
 ds_read_b128 v[52:55], v4 offset:13312
 v_mfma_f32_16x16x32_bf16 v[160:163], v[76:79], a[184:187], v[160:163]
 v_mfma_f32_16x16x32_bf16 v[196:199], v[64:67], a[240:243], v[196:199]
 ds_read_b128 v[56:59], v4 offset:22528
 v_mfma_f32_16x16x32_bf16 v[196:199], v[68:71], a[248:251], v[196:199]
 buffer_load_dwordx4 v2, s[48:51], s86 offen offset:1024 sc1 lds
 v_mfma_f32_16x16x32_bf16 v[196:199], v[72:75], a[180:183], v[196:199]
 ds_read_b128 v[60:63], v4 offset:31744
 v_mfma_f32_16x16x32_bf16 v[196:199], v[76:79], a[188:191], v[196:199]
 s_waitcnt lgkmcnt(4)
 v_mfma_f32_16x16x32_bf16 v[164:167], v[32:35], a[236:239], v[164:167]
 ds_read_b128 v[64:67], v5 offset:0
 v_mfma_f32_16x16x32_bf16 v[164:167], v[36:39], a[244:247], v[164:167]
 buffer_load_dwordx4 v2, s[48:51], s86 offen offset:2048 sc1 lds
 v_mfma_f32_16x16x32_bf16 v[164:167], v[40:43], a[176:179], v[164:167]
 ds_read_b128 v[68:71], v5 offset:9216
 v_mfma_f32_16x16x32_bf16 v[164:167], v[44:47], a[184:187], v[164:167]
 v_mfma_f32_16x16x32_bf16 v[200:203], v[32:35], a[240:243], v[200:203]
 ds_read_b128 v[72:75], v5 offset:18432
 v_mfma_f32_16x16x32_bf16 v[200:203], v[36:39], a[248:251], v[200:203]
 buffer_load_dwordx4 v2, s[48:51], s86 offen offset:3072 sc1 lds
 v_mfma_f32_16x16x32_bf16 v[200:203], v[40:43], a[180:183], v[200:203]
 ds_read_b128 v[76:79], v5 offset:27648
 v_mfma_f32_16x16x32_bf16 v[200:203], v[44:47], a[188:191], v[200:203]
 s_waitcnt lgkmcnt(4)
 v_mfma_f32_16x16x32_bf16 v[168:171], v[48:51], a[236:239], v[168:171]
 s_add_u32 m0, s91, 118784
 ds_read_b128 v[32:35], v5 offset:1024
 v_mfma_f32_16x16x32_bf16 v[168:171], v[52:55], a[244:247], v[168:171]
 s_add_u32 s86, s90, 892928
 buffer_load_dwordx4 v2, s[48:51], s86 offen offset:0 sc1 lds
 v_mfma_f32_16x16x32_bf16 v[168:171], v[56:59], a[176:179], v[168:171]
 ds_read_b128 v[36:39], v5 offset:10240
 v_mfma_f32_16x16x32_bf16 v[168:171], v[60:63], a[184:187], v[168:171]
 v_mfma_f32_16x16x32_bf16 v[204:207], v[48:51], a[240:243], v[204:207]
 ds_read_b128 v[40:43], v5 offset:19456
 v_mfma_f32_16x16x32_bf16 v[204:207], v[52:55], a[248:251], v[204:207]
 s_add_u32 s83, s88, 3145728
 buffer_load_dwordx4 a[204:207], v6, s[16:19], s83 offen sc1
 v_mfma_f32_16x16x32_bf16 v[204:207], v[56:59], a[180:183], v[204:207]
 ds_read_b128 v[44:47], v5 offset:28672
 v_mfma_f32_16x16x32_bf16 v[204:207], v[60:63], a[188:191], v[204:207]
 s_waitcnt lgkmcnt(4)
 v_mfma_f32_16x16x32_bf16 v[172:175], v[64:67], a[236:239], v[172:175]
 ds_read_b128 v[48:51], v5 offset:2048
 v_mfma_f32_16x16x32_bf16 v[172:175], v[68:71], a[244:247], v[172:175]
 buffer_load_dwordx4 a[208:211], v7, s[16:19], s83 offen sc1
 v_mfma_f32_16x16x32_bf16 v[172:175], v[72:75], a[176:179], v[172:175]
 ds_read_b128 v[52:55], v5 offset:11264
 v_mfma_f32_16x16x32_bf16 v[172:175], v[76:79], a[184:187], v[172:175]
 v_mfma_f32_16x16x32_bf16 v[208:211], v[64:67], a[240:243], v[208:211]
 ds_read_b128 v[56:59], v5 offset:20480
 v_mfma_f32_16x16x32_bf16 v[208:211], v[68:71], a[248:251], v[208:211]
 s_add_u32 s83, s88, 3276800
 buffer_load_dwordx4 a[212:215], v6, s[16:19], s83 offen sc1
 v_mfma_f32_16x16x32_bf16 v[208:211], v[72:75], a[180:183], v[208:211]
 ds_read_b128 v[60:63], v5 offset:29696
 v_mfma_f32_16x16x32_bf16 v[208:211], v[76:79], a[188:191], v[208:211]
 s_waitcnt lgkmcnt(4)
 v_mfma_f32_16x16x32_bf16 v[176:179], v[32:35], a[236:239], v[176:179]
 ds_read_b128 v[64:67], v5 offset:3072
 v_mfma_f32_16x16x32_bf16 v[176:179], v[36:39], a[244:247], v[176:179]
 buffer_load_dwordx4 a[216:219], v7, s[16:19], s83 offen sc1
 v_mfma_f32_16x16x32_bf16 v[176:179], v[40:43], a[176:179], v[176:179]
 ds_read_b128 v[68:71], v5 offset:12288
 v_mfma_f32_16x16x32_bf16 v[176:179], v[44:47], a[184:187], v[176:179]
 v_mfma_f32_16x16x32_bf16 v[212:215], v[32:35], a[240:243], v[212:215]
 ds_read_b128 v[72:75], v5 offset:21504
 v_mfma_f32_16x16x32_bf16 v[212:215], v[36:39], a[248:251], v[212:215]
 s_add_u32 s83, s88, 3407872
 buffer_load_dwordx4 a[220:223], v6, s[16:19], s83 offen sc1
 v_mfma_f32_16x16x32_bf16 v[212:215], v[40:43], a[180:183], v[212:215]
 ds_read_b128 v[76:79], v5 offset:30720
 v_mfma_f32_16x16x32_bf16 v[212:215], v[44:47], a[188:191], v[212:215]
 s_waitcnt vmcnt(22) lgkmcnt(4)
 s_barrier
 v_add_u32 v3, 0x9000, v3
 v_mfma_f32_16x16x32_bf16 v[180:183], v[48:51], a[236:239], v[180:183]
 ds_read_b128 v[32:35], v3 offset:0
 v_add_u32 v4, 0x9000, v4
 v_mfma_f32_16x16x32_bf16 v[180:183], v[52:55], a[244:247], v[180:183]
 buffer_load_dwordx4 a[224:227], v7, s[16:19], s83 offen sc1
 v_mfma_f32_16x16x32_bf16 v[180:183], v[56:59], a[176:179], v[180:183]
 ds_read_b128 v[36:39], v3 offset:9216
 v_add_u32 v5, 0x9000, v5
 v_mfma_f32_16x16x32_bf16 v[180:183], v[60:63], a[184:187], v[180:183]
 v_mfma_f32_16x16x32_bf16 v[216:219], v[48:51], a[240:243], v[216:219]
 ds_read_b128 v[40:43], v3 offset:18432
 v_mfma_f32_16x16x32_bf16 v[216:219], v[52:55], a[248:251], v[216:219]
 s_add_u32 s83, s88, 3538944
 buffer_load_dwordx4 a[228:231], v6, s[16:19], s83 offen sc1
 v_mfma_f32_16x16x32_bf16 v[216:219], v[56:59], a[180:183], v[216:219]
 ds_read_b128 v[44:47], v3 offset:27648
 v_mfma_f32_16x16x32_bf16 v[216:219], v[60:63], a[188:191], v[216:219]
 s_waitcnt lgkmcnt(4)
 v_mfma_f32_16x16x32_bf16 v[184:187], v[64:67], a[236:239], v[184:187]
 ds_read_b128 v[48:51], v3 offset:1024
 v_mfma_f32_16x16x32_bf16 v[184:187], v[68:71], a[244:247], v[184:187]
 buffer_load_dwordx4 a[232:235], v7, s[16:19], s83 offen sc1
 v_mfma_f32_16x16x32_bf16 v[184:187], v[72:75], a[176:179], v[184:187]
 ds_read_b128 v[52:55], v3 offset:10240
 v_mfma_f32_16x16x32_bf16 v[184:187], v[76:79], a[184:187], v[184:187]
 v_mfma_f32_16x16x32_bf16 v[220:223], v[64:67], a[240:243], v[220:223]
 ds_read_b128 v[56:59], v3 offset:19456
 v_mfma_f32_16x16x32_bf16 v[220:223], v[68:71], a[248:251], v[220:223]
 v_mfma_f32_16x16x32_bf16 v[220:223], v[72:75], a[180:183], v[220:223]
 ds_read_b128 v[60:63], v3 offset:28672
 v_mfma_f32_16x16x32_bf16 v[220:223], v[76:79], a[188:191], v[220:223]
 s_waitcnt vmcnt(17) lgkmcnt(4)
 v_mfma_f32_16x16x32_bf16 v[152:155], v[32:35], a[128:131], v[152:155]
 s_add_u32 m0, s91, 0
 ds_read_b128 v[64:67], v3 offset:2048
 v_mfma_f32_16x16x32_bf16 v[152:155], v[36:39], a[136:139], v[152:155]
 s_add_u32 s86, s90, 1032192
 buffer_load_dwordx4 v2, s[48:51], s86 offen offset:0 sc1 lds
 v_mfma_f32_16x16x32_bf16 v[152:155], v[40:43], a[144:147], v[152:155]
 ds_read_b128 v[68:71], v3 offset:11264
 v_mfma_f32_16x16x32_bf16 v[152:155], v[44:47], a[152:155], v[152:155]
 v_mfma_f32_16x16x32_bf16 v[188:191], v[32:35], a[132:135], v[188:191]
 ds_read_b128 v[72:75], v3 offset:20480
 v_mfma_f32_16x16x32_bf16 v[188:191], v[36:39], a[140:143], v[188:191]
 buffer_load_dwordx4 v2, s[48:51], s86 offen offset:1024 sc1 lds
 v_mfma_f32_16x16x32_bf16 v[188:191], v[40:43], a[148:151], v[188:191]
 ds_read_b128 v[76:79], v3 offset:29696
 v_mfma_f32_16x16x32_bf16 v[188:191], v[44:47], a[156:159], v[188:191]
 s_waitcnt lgkmcnt(4)
 v_mfma_f32_16x16x32_bf16 v[156:159], v[48:51], a[128:131], v[156:159]
 ds_read_b128 v[32:35], v3 offset:3072
 v_mfma_f32_16x16x32_bf16 v[156:159], v[52:55], a[136:139], v[156:159]
 buffer_load_dwordx4 v2, s[48:51], s86 offen offset:2048 sc1 lds
 v_mfma_f32_16x16x32_bf16 v[156:159], v[56:59], a[144:147], v[156:159]
 ds_read_b128 v[36:39], v3 offset:12288
 v_mfma_f32_16x16x32_bf16 v[156:159], v[60:63], a[152:155], v[156:159]
 v_mfma_f32_16x16x32_bf16 v[192:195], v[48:51], a[132:135], v[192:195]
 ds_read_b128 v[40:43], v3 offset:21504
 v_mfma_f32_16x16x32_bf16 v[192:195], v[52:55], a[140:143], v[192:195]
 buffer_load_dwordx4 v2, s[48:51], s86 offen offset:3072 sc1 lds
 v_mfma_f32_16x16x32_bf16 v[192:195], v[56:59], a[148:151], v[192:195]
 ds_read_b128 v[44:47], v3 offset:30720
 v_mfma_f32_16x16x32_bf16 v[192:195], v[60:63], a[156:159], v[192:195]
 s_waitcnt lgkmcnt(4)
 v_mfma_f32_16x16x32_bf16 v[160:163], v[64:67], a[128:131], v[160:163]
 s_add_u32 m0, s91, 4096
 ds_read_b128 v[48:51], v4 offset:4096
 v_mfma_f32_16x16x32_bf16 v[160:163], v[68:71], a[136:139], v[160:163]
 s_add_u32 s86, s90, 1036288
 buffer_load_dwordx4 v2, s[48:51], s86 offen offset:0 sc1 lds
 v_mfma_f32_16x16x32_bf16 v[160:163], v[72:75], a[144:147], v[160:163]
 ds_read_b128 v[52:55], v4 offset:13312
 v_mfma_f32_16x16x32_bf16 v[160:163], v[76:79], a[152:155], v[160:163]
 v_mfma_f32_16x16x32_bf16 v[196:199], v[64:67], a[132:135], v[196:199]
 ds_read_b128 v[56:59], v4 offset:22528
 v_mfma_f32_16x16x32_bf16 v[196:199], v[68:71], a[140:143], v[196:199]
 buffer_load_dwordx4 v2, s[48:51], s86 offen offset:1024 sc1 lds
 v_mfma_f32_16x16x32_bf16 v[196:199], v[72:75], a[148:151], v[196:199]
 ds_read_b128 v[60:63], v4 offset:31744
 v_mfma_f32_16x16x32_bf16 v[196:199], v[76:79], a[156:159], v[196:199]
 s_waitcnt lgkmcnt(4)
 v_mfma_f32_16x16x32_bf16 v[164:167], v[32:35], a[128:131], v[164:167]
 ds_read_b128 v[64:67], v5 offset:0
 v_mfma_f32_16x16x32_bf16 v[164:167], v[36:39], a[136:139], v[164:167]
 buffer_load_dwordx4 v2, s[48:51], s86 offen offset:2048 sc1 lds
 v_mfma_f32_16x16x32_bf16 v[164:167], v[40:43], a[144:147], v[164:167]
 ds_read_b128 v[68:71], v5 offset:9216
 v_mfma_f32_16x16x32_bf16 v[164:167], v[44:47], a[152:155], v[164:167]
 v_mfma_f32_16x16x32_bf16 v[200:203], v[32:35], a[132:135], v[200:203]
 ds_read_b128 v[72:75], v5 offset:18432
 v_mfma_f32_16x16x32_bf16 v[200:203], v[36:39], a[140:143], v[200:203]
 buffer_load_dwordx4 v2, s[48:51], s86 offen offset:3072 sc1 lds
 v_mfma_f32_16x16x32_bf16 v[200:203], v[40:43], a[148:151], v[200:203]
 ds_read_b128 v[76:79], v5 offset:27648
 v_mfma_f32_16x16x32_bf16 v[200:203], v[44:47], a[156:159], v[200:203]
 s_waitcnt lgkmcnt(4)
 v_mfma_f32_16x16x32_bf16 v[168:171], v[48:51], a[128:131], v[168:171]
 s_add_u32 m0, s91, 8192
 ds_read_b128 v[32:35], v5 offset:1024
 v_mfma_f32_16x16x32_bf16 v[168:171], v[52:55], a[136:139], v[168:171]
 s_add_u32 s86, s90, 1040384
 buffer_load_dwordx4 v2, s[48:51], s86 offen offset:0 sc1 lds
 v_mfma_f32_16x16x32_bf16 v[168:171], v[56:59], a[144:147], v[168:171]
 ds_read_b128 v[36:39], v5 offset:10240
 v_mfma_f32_16x16x32_bf16 v[168:171], v[60:63], a[152:155], v[168:171]
 v_mfma_f32_16x16x32_bf16 v[204:207], v[48:51], a[132:135], v[204:207]
 ds_read_b128 v[40:43], v5 offset:19456
 v_mfma_f32_16x16x32_bf16 v[204:207], v[52:55], a[140:143], v[204:207]
 s_add_u32 s83, s88, 3670016
 buffer_load_dwordx4 a[236:239], v6, s[16:19], s83 offen sc1
 v_mfma_f32_16x16x32_bf16 v[204:207], v[56:59], a[148:151], v[204:207]
 ds_read_b128 v[44:47], v5 offset:28672
 v_mfma_f32_16x16x32_bf16 v[204:207], v[60:63], a[156:159], v[204:207]
 s_waitcnt lgkmcnt(4)
 buffer_load_dword v28, v29, s[20:23], s99 offen sc1
 v_mfma_f32_16x16x32_bf16 v[172:175], v[64:67], a[128:131], v[172:175]
 ds_read_b128 v[48:51], v5 offset:2048
 v_mfma_f32_16x16x32_bf16 v[172:175], v[68:71], a[136:139], v[172:175]
 buffer_load_dwordx4 a[240:243], v7, s[16:19], s83 offen sc1
 v_mfma_f32_16x16x32_bf16 v[172:175], v[72:75], a[144:147], v[172:175]
 ds_read_b128 v[52:55], v5 offset:11264
 v_mfma_f32_16x16x32_bf16 v[172:175], v[76:79], a[152:155], v[172:175]
 v_mfma_f32_16x16x32_bf16 v[208:211], v[64:67], a[132:135], v[208:211]
 ds_read_b128 v[56:59], v5 offset:20480
 v_mfma_f32_16x16x32_bf16 v[208:211], v[68:71], a[140:143], v[208:211]
 s_add_u32 s83, s88, 3801088
 buffer_load_dwordx4 a[244:247], v6, s[16:19], s83 offen sc1
 v_mfma_f32_16x16x32_bf16 v[208:211], v[72:75], a[148:151], v[208:211]
 ds_read_b128 v[60:63], v5 offset:29696
 v_mfma_f32_16x16x32_bf16 v[208:211], v[76:79], a[156:159], v[208:211]
 s_waitcnt lgkmcnt(4)
 v_mfma_f32_16x16x32_bf16 v[176:179], v[32:35], a[128:131], v[176:179]
 ds_read_b128 v[64:67], v5 offset:3072
 v_mfma_f32_16x16x32_bf16 v[176:179], v[36:39], a[136:139], v[176:179]
 buffer_load_dwordx4 a[248:251], v7, s[16:19], s83 offen sc1
 v_mfma_f32_16x16x32_bf16 v[176:179], v[40:43], a[144:147], v[176:179]
 ds_read_b128 v[68:71], v5 offset:12288
 v_mfma_f32_16x16x32_bf16 v[176:179], v[44:47], a[152:155], v[176:179]
 v_mfma_f32_16x16x32_bf16 v[212:215], v[32:35], a[132:135], v[212:215]
 ds_read_b128 v[72:75], v5 offset:21504
 v_mfma_f32_16x16x32_bf16 v[212:215], v[36:39], a[140:143], v[212:215]
 s_add_u32 s83, s88, 3932160
 buffer_load_dwordx4 a[176:179], v6, s[16:19], s83 offen sc1
 v_mfma_f32_16x16x32_bf16 v[212:215], v[40:43], a[148:151], v[212:215]
 ds_read_b128 v[76:79], v5 offset:30720
 v_mfma_f32_16x16x32_bf16 v[212:215], v[44:47], a[156:159], v[212:215]
 s_waitcnt vmcnt(23) lgkmcnt(4)
 s_barrier
 v_add_u32 v5, 0x9000, v5
 v_mfma_f32_16x16x32_bf16 v[180:183], v[48:51], a[128:131], v[180:183]
 ds_read_b128 v[32:35], v5 offset:0
 v_add_u32 v3, 0x9000, v3
 v_mfma_f32_16x16x32_bf16 v[180:183], v[52:55], a[136:139], v[180:183]
 buffer_load_dwordx4 a[180:183], v7, s[16:19], s83 offen sc1
 v_mfma_f32_16x16x32_bf16 v[180:183], v[56:59], a[144:147], v[180:183]
 ds_read_b128 v[36:39], v5 offset:9216
 v_add_u32 v4, 0x9000, v4
 v_mfma_f32_16x16x32_bf16 v[180:183], v[60:63], a[152:155], v[180:183]
 v_mfma_f32_16x16x32_bf16 v[216:219], v[48:51], a[132:135], v[216:219]
 ds_read_b128 v[40:43], v5 offset:18432
 v_add_u32 v20, 0xfffe5000, v3
 v_mfma_f32_16x16x32_bf16 v[216:219], v[52:55], a[140:143], v[216:219]
 s_add_u32 s83, s88, 4063232
 buffer_load_dwordx4 a[184:187], v6, s[16:19], s83 offen sc1
 v_mfma_f32_16x16x32_bf16 v[216:219], v[56:59], a[148:151], v[216:219]
 ds_read_b128 v[44:47], v5 offset:27648
 v_add_u32 v21, 0xfffe5000, v4
 v_mfma_f32_16x16x32_bf16 v[216:219], v[60:63], a[156:159], v[216:219]
 s_waitcnt lgkmcnt(4)
 v_mfma_f32_16x16x32_bf16 v[184:187], v[64:67], a[128:131], v[184:187]
 ds_read_b128 v[48:51], v5 offset:1024
 v_add_u32 v22, 0xfffe5000, v5
 v_mfma_f32_16x16x32_bf16 v[184:187], v[68:71], a[136:139], v[184:187]
 buffer_load_dwordx4 a[188:191], v7, s[16:19], s83 offen sc1
 v_mfma_f32_16x16x32_bf16 v[184:187], v[72:75], a[144:147], v[184:187]
 ds_read_b128 v[52:55], v5 offset:10240
 v_mfma_f32_16x16x32_bf16 v[184:187], v[76:79], a[152:155], v[184:187]
 v_mfma_f32_16x16x32_bf16 v[220:223], v[64:67], a[132:135], v[220:223]
 ds_read_b128 v[56:59], v5 offset:19456
 v_mfma_f32_16x16x32_bf16 v[220:223], v[68:71], a[140:143], v[220:223]
 v_mfma_f32_16x16x32_bf16 v[220:223], v[72:75], a[148:151], v[220:223]
 ds_read_b128 v[60:63], v5 offset:28672
 v_mfma_f32_16x16x32_bf16 v[220:223], v[76:79], a[156:159], v[220:223]
 s_waitcnt vmcnt(18) lgkmcnt(4)
 v_mfma_f32_16x16x32_bf16 v[172:175], v[32:35], a[204:207], v[172:175]
 ds_read_b128 v[64:67], v5 offset:2048
 v_mfma_f32_16x16x32_bf16 v[172:175], v[36:39], a[212:215], v[172:175]
 v_mfma_f32_16x16x32_bf16 v[172:175], v[40:43], a[220:223], v[172:175]
 ds_read_b128 v[68:71], v5 offset:11264
 v_mfma_f32_16x16x32_bf16 v[172:175], v[44:47], a[228:231], v[172:175]
 v_mfma_f32_16x16x32_bf16 v[208:211], v[32:35], a[208:211], v[208:211]
 ds_read_b128 v[72:75], v5 offset:20480
 v_mfma_f32_16x16x32_bf16 v[208:211], v[36:39], a[216:219], v[208:211]
 v_mfma_f32_16x16x32_bf16 v[208:211], v[40:43], a[224:227], v[208:211]
 ds_read_b128 v[76:79], v5 offset:29696
 v_mfma_f32_16x16x32_bf16 v[208:211], v[44:47], a[232:235], v[208:211]
 s_waitcnt lgkmcnt(4)
 v_mfma_f32_16x16x32_bf16 v[176:179], v[48:51], a[204:207], v[176:179]
 s_xor_b32 s60, s80, 1
 ds_read_b128 v[32:35], v5 offset:3072
 v_mfma_f32_16x16x32_bf16 v[176:179], v[52:55], a[212:215], v[176:179]
 s_sub_u32 s60, s60, s80
 s_waitcnt vmcnt(7)
 v_cmp_eq_u32 vcc, 0, v28
 s_cbranch_vccnz L_spin_f
L_spin_f_b:
 v_mfma_f32_16x16x32_bf16 v[176:179], v[56:59], a[220:223], v[176:179]
 s_mul_i32 s60, s60, 65536
 ds_read_b128 v[36:39], v5 offset:12288
 v_mfma_f32_16x16x32_bf16 v[176:179], v[60:63], a[228:231], v[176:179]
 s_add_u32 s60, s60, s95
 v_mfma_f32_16x16x32_bf16 v[212:215], v[48:51], a[208:211], v[212:215]
 s_add_u32 s61, s60, 6144
 ds_read_b128 v[40:43], v5 offset:21504
 v_mfma_f32_16x16x32_bf16 v[212:215], v[52:55], a[216:219], v[212:215]
 s_add_u32 s60, s60, 0
 buffer_load_dwordx4 v[116:119], v2, s[40:43], s60 offen sc1
 v_mfma_f32_16x16x32_bf16 v[212:215], v[56:59], a[224:227], v[212:215]
 ds_read_b128 v[44:47], v5 offset:30720
 v_mfma_f32_16x16x32_bf16 v[212:215], v[60:63], a[232:235], v[212:215]
 s_waitcnt lgkmcnt(4)
 s_barrier
 buffer_load_dwordx4 v[120:123], v2, s[40:43], s60 offen offset:1024 sc1
 v_mfma_f32_16x16x32_bf16 v[180:183], v[64:67], a[204:207], v[180:183]
 ds_read_b128 v[48:51], v22 offset:0
 v_mfma_f32_16x16x32_bf16 v[180:183], v[68:71], a[212:215], v[180:183]
 buffer_load_dwordx2 v[124:125], v9, s[40:43], s61 offen sc1
 v_mfma_f32_16x16x32_bf16 v[180:183], v[72:75], a[220:223], v[180:183]
 s_xor_b32 s62, s80, 2
 ds_read_b128 v[52:55], v22 offset:9216
 v_mfma_f32_16x16x32_bf16 v[180:183], v[76:79], a[228:231], v[180:183]
 s_sub_u32 s62, s62, s80
 v_mfma_f32_16x16x32_bf16 v[216:219], v[64:67], a[208:211], v[216:219]
 s_mul_i32 s62, s62, 65536
 ds_read_b128 v[56:59], v22 offset:18432
 v_mfma_f32_16x16x32_bf16 v[216:219], v[68:71], a[216:219], v[216:219]
 s_add_u32 s62, s62, s95
 s_add_u32 s63, s62, 6656
 s_add_u32 s62, s62, 2048
 buffer_load_dwordx4 v[126:129], v2, s[40:43], s62 offen sc1
 v_mfma_f32_16x16x32_bf16 v[216:219], v[72:75], a[224:227], v[216:219]
 ds_read_b128 v[60:63], v22 offset:27648
 v_mfma_f32_16x16x32_bf16 v[216:219], v[76:79], a[232:235], v[216:219]
 s_waitcnt lgkmcnt(4)
 buffer_load_dwordx4 v[130:133], v2, s[40:43], s62 offen offset:1024 sc1
 v_mfma_f32_16x16x32_bf16 v[184:187], v[32:35], a[204:207], v[184:187]
 ds_read_b128 v[64:67], v22 offset:1024
 v_mfma_f32_16x16x32_bf16 v[184:187], v[36:39], a[212:215], v[184:187]
 buffer_load_dwordx2 v[134:135], v9, s[40:43], s63 offen sc1
 v_mfma_f32_16x16x32_bf16 v[184:187], v[40:43], a[220:223], v[184:187]
 s_xor_b32 s64, s80, 3
 ds_read_b128 v[68:71], v22 offset:10240
 v_mfma_f32_16x16x32_bf16 v[184:187], v[44:47], a[228:231], v[184:187]
 s_sub_u32 s64, s64, s80
 v_mfma_f32_16x16x32_bf16 v[220:223], v[32:35], a[208:211], v[220:223]
 s_mul_i32 s64, s64, 65536
 ds_read_b128 v[72:75], v22 offset:19456
 v_mfma_f32_16x16x32_bf16 v[220:223], v[36:39], a[216:219], v[220:223]
 s_add_u32 s64, s64, s95
 s_add_u32 s65, s64, 6656
 s_add_u32 s64, s64, 4096
 buffer_load_dwordx4 v[136:139], v2, s[40:43], s64 offen sc1
 v_mfma_f32_16x16x32_bf16 v[220:223], v[40:43], a[224:227], v[220:223]
 ds_read_b128 v[76:79], v22 offset:28672
 v_mfma_f32_16x16x32_bf16 v[220:223], v[44:47], a[232:235], v[220:223]
 s_waitcnt vmcnt(7) lgkmcnt(4)
 buffer_load_dwordx4 v[140:143], v2, s[40:43], s64 offen offset:1024 sc1
 v_mfma_f32_16x16x32_bf16 v[172:175], v[48:51], a[236:239], v[172:175]
 ds_read_b128 v[32:35], v22 offset:2048
 v_mfma_f32_16x16x32_bf16 v[172:175], v[52:55], a[244:247], v[172:175]
 buffer_load_dwordx2 v[144:145], v9, s[40:43], s65 offen sc1
 v_mfma_f32_16x16x32_bf16 v[172:175], v[56:59], a[176:179], v[172:175]
 ds_read_b128 v[36:39], v22 offset:11264
 v_mfma_f32_16x16x32_bf16 v[172:175], v[60:63], a[184:187], v[172:175]
 buffer_load_dwordx2 v[10:11], v8, s[24:27], 0 offen offset:0
 v_mfma_f32_16x16x32_bf16 v[208:211], v[48:51], a[240:243], v[208:211]
 ds_read_b128 v[40:43], v22 offset:20480
 v_mfma_f32_16x16x32_bf16 v[208:211], v[52:55], a[248:251], v[208:211]
 buffer_load_dwordx2 v[12:13], v8, s[24:27], 0 offen offset:32
 v_mfma_f32_16x16x32_bf16 v[208:211], v[56:59], a[180:183], v[208:211]
 ds_read_b128 v[44:47], v22 offset:29696
 v_mfma_f32_16x16x32_bf16 v[208:211], v[60:63], a[188:191], v[208:211]
 s_waitcnt lgkmcnt(4)
 buffer_load_dwordx2 v[14:15], v8, s[24:27], 0 offen offset:64
 v_mfma_f32_16x16x32_bf16 v[176:179], v[64:67], a[236:239], v[176:179]
 s_add_u32 s93, s95, 8192
 ds_read_b128 v[48:51], v22 offset:3072
 v_mfma_f32_16x16x32_bf16 v[176:179], v[68:71], a[244:247], v[176:179]
 s_add_u32 s94, s95, 12288
 buffer_load_dwordx2 v[16:17], v8, s[24:27], 0 offen offset:96
 v_mfma_f32_16x16x32_bf16 v[176:179], v[72:75], a[176:179], v[176:179]
 ds_read_b128 v[52:55], v22 offset:12288
 v_cvt_pk_bf16_f32 v172, v172, v173
 v_mfma_f32_16x16x32_bf16 v[176:179], v[76:79], a[184:187], v[176:179]
 buffer_load_dwordx2 v[18:19], v8, s[24:27], 0 offen offset:128
 v_mfma_f32_16x16x32_bf16 v[212:215], v[64:67], a[240:243], v[212:215]
 ds_read_b128 v[56:59], v22 offset:21504
 v_cvt_pk_bf16_f32 v173, v174, v175
 v_mfma_f32_16x16x32_bf16 v[212:215], v[68:71], a[248:251], v[212:215]
 v_cvt_pk_bf16_f32 v208, v208, v209
 v_cvt_pk_bf16_f32 v209, v210, v211
 v_mfma_f32_16x16x32_bf16 v[212:215], v[72:75], a[180:183], v[212:215]
 ds_read_b128 v[60:63], v22 offset:30720
 v_mfma_f32_16x16x32_bf16 v[212:215], v[76:79], a[188:191], v[212:215]
 s_waitcnt lgkmcnt(4)
 v_mfma_f32_16x16x32_bf16 v[180:183], v[32:35], a[236:239], v[180:183]
 ds_read_b128 v[64:67], v4 offset:4096
 v_mfma_f32_16x16x32_bf16 v[180:183], v[36:39], a[244:247], v[180:183]
 v_cvt_pk_bf16_f32 v174, v176, v177
 v_cvt_pk_bf16_f32 v175, v178, v179
 v_mfma_f32_16x16x32_bf16 v[180:183], v[40:43], a[176:179], v[180:183]
 ds_read_b128 v[68:71], v4 offset:13312
 v_mfma_f32_16x16x32_bf16 v[180:183], v[44:47], a[184:187], v[180:183]
 buffer_store_dwordx4 v[172:175], v2, s[40:43], s93 offen offset:0 sc1
 v_mfma_f32_16x16x32_bf16 v[216:219], v[32:35], a[240:243], v[216:219]
 ds_read_b128 v[72:75], v4 offset:22528
 v_mfma_f32_16x16x32_bf16 v[216:219], v[36:39], a[248:251], v[216:219]
 v_cvt_pk_bf16_f32 v210, v212, v213
 v_cvt_pk_bf16_f32 v211, v214, v215
 v_mfma_f32_16x16x32_bf16 v[216:219], v[40:43], a[180:183], v[216:219]
 ds_read_b128 v[76:79], v4 offset:31744
 v_mfma_f32_16x16x32_bf16 v[216:219], v[44:47], a[188:191], v[216:219]
 s_waitcnt lgkmcnt(4)
 buffer_store_dwordx4 v[208:211], v2, s[40:43], s94 offen offset:0 sc1
 v_mfma_f32_16x16x32_bf16 v[184:187], v[48:51], a[236:239], v[184:187]
 ds_read_b128 v[32:35], v21 offset:4096
 v_mfma_f32_16x16x32_bf16 v[184:187], v[52:55], a[244:247], v[184:187]
 v_cvt_pk_bf16_f32 v180, v180, v181
 v_cvt_pk_bf16_f32 v181, v182, v183
 v_mfma_f32_16x16x32_bf16 v[184:187], v[56:59], a[176:179], v[184:187]
 ds_read_b128 v[36:39], v21 offset:13312
 v_mfma_f32_16x16x32_bf16 v[184:187], v[60:63], a[184:187], v[184:187]
 v_mfma_f32_16x16x32_bf16 v[220:223], v[48:51], a[240:243], v[220:223]
 ds_read_b128 v[40:43], v21 offset:22528
 v_mfma_f32_16x16x32_bf16 v[220:223], v[52:55], a[248:251], v[220:223]
 v_cvt_pk_bf16_f32 v216, v216, v217
 v_cvt_pk_bf16_f32 v217, v218, v219
 v_mfma_f32_16x16x32_bf16 v[220:223], v[56:59], a[180:183], v[220:223]
 ds_read_b128 v[44:47], v21 offset:31744
 v_mfma_f32_16x16x32_bf16 v[220:223], v[60:63], a[188:191], v[220:223]
 s_waitcnt lgkmcnt(4)
 v_mfma_f32_16x16x32_bf16 v[168:171], v[64:67], a[204:207], v[168:171]
 ds_read_b128 v[48:51], v3 offset:2048
 v_mfma_f32_16x16x32_bf16 v[168:171], v[68:71], a[212:215], v[168:171]
 v_cvt_pk_bf16_f32 v182, v184, v185
 v_cvt_pk_bf16_f32 v183, v186, v187
 v_mfma_f32_16x16x32_bf16 v[168:171], v[72:75], a[220:223], v[168:171]
 ds_read_b128 v[52:55], v3 offset:11264
 v_mfma_f32_16x16x32_bf16 v[168:171], v[76:79], a[228:231], v[168:171]
 buffer_store_dwordx4 v[180:183], v2, s[40:43], s93 offen offset:1024 sc1
 v_mfma_f32_16x16x32_bf16 v[204:207], v[64:67], a[208:211], v[204:207]
 ds_read_b128 v[56:59], v3 offset:20480
 v_mfma_f32_16x16x32_bf16 v[204:207], v[68:71], a[216:219], v[204:207]
 v_cvt_pk_bf16_f32 v218, v220, v221
 v_cvt_pk_bf16_f32 v219, v222, v223
 v_mfma_f32_16x16x32_bf16 v[204:207], v[72:75], a[224:227], v[204:207]
 s_waitcnt vmcnt(8)
 ds_read_b128 v[60:63], v3 offset:29696
 v_mfma_f32_16x16x32_bf16 v[204:207], v[76:79], a[232:235], v[204:207]
 s_waitcnt lgkmcnt(4)
 buffer_store_dwordx4 v[216:219], v2, s[40:43], s94 offen offset:1024 sc1
 v_mfma_f32_16x16x32_bf16 v[168:171], v[32:35], a[236:239], v[168:171]
 ds_read_b128 v[64:67], v20 offset:2048
 v_lshlrev_b32 v228, 16, v116
 v_mfma_f32_16x16x32_bf16 v[168:171], v[36:39], a[244:247], v[168:171]
 v_and_b32 v229, s73, v116
 v_add_f32 v80, v80, v228
 v_lshlrev_b32 v230, 16, v117
 v_mfma_f32_16x16x32_bf16 v[168:171], v[40:43], a[176:179], v[168:171]
 ds_read_b128 v[68:71], v20 offset:11264
 v_add_f32 v81, v81, v229
 v_mfma_f32_16x16x32_bf16 v[168:171], v[44:47], a[184:187], v[168:171]
 v_and_b32 v231, s73, v117
 v_add_f32 v82, v82, v230
 v_mfma_f32_16x16x32_bf16 v[204:207], v[32:35], a[240:243], v[204:207]
 ds_read_b128 v[72:75], v20 offset:20480
 v_add_f32 v83, v83, v231
 v_mfma_f32_16x16x32_bf16 v[204:207], v[36:39], a[248:251], v[204:207]
 v_lshlrev_b32 v232, 16, v118
 v_and_b32 v233, s73, v118
 v_lshlrev_b32 v234, 16, v119
 v_mfma_f32_16x16x32_bf16 v[204:207], v[40:43], a[180:183], v[204:207]
 ds_read_b128 v[76:79], v20 offset:29696
 v_add_f32 v84, v84, v232
 v_mfma_f32_16x16x32_bf16 v[204:207], v[44:47], a[188:191], v[204:207]
 s_waitcnt lgkmcnt(4)
 v_add_f32 v85, v85, v233
 v_and_b32 v235, s73, v119
 v_mfma_f32_16x16x32_bf16 v[160:163], v[48:51], a[204:207], v[160:163]
 ds_read_b128 v[32:35], v3 offset:3072
 v_add_f32 v86, v86, v234
 v_add_f32 v87, v87, v235
 v_mfma_f32_16x16x32_bf16 v[160:163], v[52:55], a[212:215], v[160:163]
 v_cvt_pk_bf16_f32 v224, v168, v169
 v_cvt_pk_bf16_f32 v225, v170, v171
 v_mfma_f32_16x16x32_bf16 v[160:163], v[56:59], a[220:223], v[160:163]
 ds_read_b128 v[36:39], v3 offset:12288
 v_lshlrev_b32 v228, 16, v120
 v_mfma_f32_16x16x32_bf16 v[160:163], v[60:63], a[228:231], v[160:163]
 buffer_store_dwordx2 v[224:225], v9, s[40:43], s94 offen offset:2048 sc1
 v_mfma_f32_16x16x32_bf16 v[196:199], v[48:51], a[208:211], v[196:199]
 ds_read_b128 v[40:43], v3 offset:21504
 v_and_b32 v229, s73, v120
 v_add_f32 v88, v88, v228
 v_mfma_f32_16x16x32_bf16 v[196:199], v[52:55], a[216:219], v[196:199]
 v_cvt_pk_bf16_f32 v204, v204, v205
 v_cvt_pk_bf16_f32 v205, v206, v207
 v_mfma_f32_16x16x32_bf16 v[196:199], v[56:59], a[224:227], v[196:199]
 ds_read_b128 v[44:47], v3 offset:30720
 v_add_f32 v89, v89, v229
 v_mfma_f32_16x16x32_bf16 v[196:199], v[60:63], a[232:235], v[196:199]
 s_waitcnt lgkmcnt(4)
 buffer_store_dwordx2 v[204:205], v9, s[40:43], s94 offen offset:2560 sc1
 v_mfma_f32_16x16x32_bf16 v[160:163], v[64:67], a[236:239], v[160:163]
 ds_read_b128 v[48:51], v20 offset:3072
 v_lshlrev_b32 v230, 16, v121
 v_and_b32 v231, s73, v121
 v_mfma_f32_16x16x32_bf16 v[160:163], v[68:71], a[244:247], v[160:163]
 v_add_f32 v90, v90, v230
 v_add_f32 v91, v91, v231
 v_mfma_f32_16x16x32_bf16 v[160:163], v[72:75], a[176:179], v[160:163]
 ds_read_b128 v[52:55], v20 offset:12288
 v_lshlrev_b32 v232, 16, v122
 v_mfma_f32_16x16x32_bf16 v[160:163], v[76:79], a[184:187], v[160:163]
 v_and_b32 v233, s73, v122
 v_add_f32 v92, v92, v232
 v_lshlrev_b32 v234, 16, v123
 v_mfma_f32_16x16x32_bf16 v[196:199], v[64:67], a[240:243], v[196:199]
 ds_read_b128 v[56:59], v20 offset:21504
 v_add_f32 v93, v93, v233
 v_mfma_f32_16x16x32_bf16 v[196:199], v[68:71], a[248:251], v[196:199]
 v_and_b32 v235, s73, v123
 v_add_f32 v94, v94, v234
 v_mfma_f32_16x16x32_bf16 v[196:199], v[72:75], a[180:183], v[196:199]
 ds_read_b128 v[60:63], v20 offset:30720
 v_add_f32 v95, v95, v235
 v_mfma_f32_16x16x32_bf16 v[196:199], v[76:79], a[188:191], v[196:199]
 s_waitcnt lgkmcnt(4)
 v_lshlrev_b32 v228, 16, v124
 v_and_b32 v229, s73, v124
 v_lshlrev_b32 v230, 16, v125
 v_mfma_f32_16x16x32_bf16 v[164:167], v[32:35], a[204:207], v[164:167]
 ds_read_b128 v[64:67], v3 offset:0
 v_add_f32 v96, v96, v228
 v_mfma_f32_16x16x32_bf16 v[164:167], v[36:39], a[212:215], v[164:167]
 v_add_f32 v97, v97, v229
 v_and_b32 v231, s73, v125
 v_mfma_f32_16x16x32_bf16 v[164:167], v[40:43], a[220:223], v[164:167]
 ds_read_b128 v[68:71], v3 offset:9216
 v_add_f32 v98, v98, v230
 v_add_f32 v99, v99, v231
 v_mfma_f32_16x16x32_bf16 v[164:167], v[44:47], a[228:231], v[164:167]
 v_lshlrev_b32 v228, 16, v126
 v_and_b32 v229, s73, v126
 v_mfma_f32_16x16x32_bf16 v[200:203], v[32:35], a[208:211], v[200:203]
 ds_read_b128 v[72:75], v3 offset:18432
 v_add_f32 v80, v80, v228
 v_mfma_f32_16x16x32_bf16 v[200:203], v[36:39], a[216:219], v[200:203]
 v_cvt_pk_bf16_f32 v196, v196, v197
 v_cvt_pk_bf16_f32 v197, v198, v199
 v_mfma_f32_16x16x32_bf16 v[200:203], v[40:43], a[224:227], v[200:203]
 ds_read_b128 v[76:79], v3 offset:27648
 v_add_f32 v81, v81, v229
 v_lshlrev_b32 v230, 16, v127
 v_mfma_f32_16x16x32_bf16 v[200:203], v[44:47], a[232:235], v[200:203]
 s_waitcnt lgkmcnt(4)
 v_and_b32 v231, s73, v127
 v_add_f32 v82, v82, v230
 v_mfma_f32_16x16x32_bf16 v[164:167], v[48:51], a[236:239], v[164:167]
 ds_read_b128 v[32:35], v20 offset:0
 v_add_f32 v83, v83, v231
 v_mfma_f32_16x16x32_bf16 v[164:167], v[52:55], a[244:247], v[164:167]
 v_lshlrev_b32 v232, 16, v128
 v_and_b32 v233, s73, v128
 v_mfma_f32_16x16x32_bf16 v[164:167], v[56:59], a[176:179], v[164:167]
 ds_read_b128 v[36:39], v20 offset:9216
 v_add_f32 v84, v84, v232
 v_add_f32 v85, v85, v233
 v_mfma_f32_16x16x32_bf16 v[164:167], v[60:63], a[184:187], v[164:167]
 v_lshlrev_b32 v234, 16, v129
 v_and_b32 v235, s73, v129
 v_mfma_f32_16x16x32_bf16 v[200:203], v[48:51], a[240:243], v[200:203]
 ds_read_b128 v[40:43], v20 offset:18432
 v_add_f32 v86, v86, v234
 v_mfma_f32_16x16x32_bf16 v[200:203], v[52:55], a[248:251], v[200:203]
 v_add_f32 v87, v87, v235
 v_lshlrev_b32 v228, 16, v130
 v_and_b32 v229, s73, v130
 v_mfma_f32_16x16x32_bf16 v[200:203], v[56:59], a[180:183], v[200:203]
 ds_read_b128 v[44:47], v20 offset:27648
 v_add_f32 v88, v88, v228
 v_mfma_f32_16x16x32_bf16 v[200:203], v[60:63], a[188:191], v[200:203]
 s_waitcnt lgkmcnt(4)
 v_add_f32 v89, v89, v229
 v_lshlrev_b32 v230, 16, v131
 v_mfma_f32_16x16x32_bf16 v[152:155], v[64:67], a[204:207], v[152:155]
 ds_read_b128 v[48:51], v3 offset:1024
 v_and_b32 v231, s73, v131
 v_mfma_f32_16x16x32_bf16 v[152:155], v[68:71], a[212:215], v[152:155]
 v_add_f32 v90, v90, v230
 v_add_f32 v91, v91, v231
 v_lshlrev_b32 v232, 16, v132
 v_mfma_f32_16x16x32_bf16 v[152:155], v[72:75], a[220:223], v[152:155]
 ds_read_b128 v[52:55], v3 offset:10240
 v_and_b32 v233, s73, v132
 v_mfma_f32_16x16x32_bf16 v[152:155], v[76:79], a[228:231], v[152:155]
 v_add_f32 v92, v92, v232
 v_add_f32 v93, v93, v233
 v_mfma_f32_16x16x32_bf16 v[188:191], v[64:67], a[208:211], v[188:191]
 ds_read_b128 v[56:59], v3 offset:19456
 v_lshlrev_b32 v234, 16, v133
 v_and_b32 v235, s73, v133
 v_mfma_f32_16x16x32_bf16 v[188:191], v[68:71], a[216:219], v[188:191]
 v_cvt_pk_bf16_f32 v198, v200, v201
 v_cvt_pk_bf16_f32 v199, v202, v203
 v_mfma_f32_16x16x32_bf16 v[188:191], v[72:75], a[224:227], v[188:191]
 ds_read_b128 v[60:63], v3 offset:28672
 v_add_f32 v94, v94, v234
 v_mfma_f32_16x16x32_bf16 v[188:191], v[76:79], a[232:235], v[188:191]
 s_waitcnt lgkmcnt(4)
 buffer_store_dwordx4 v[196:199], v2, s[40:43], s93 offen offset:3072 sc1
 v_mfma_f32_16x16x32_bf16 v[152:155], v[32:35], a[236:239], v[152:155]
 ds_read_b128 v[64:67], v20 offset:1024
 v_add_f32 v95, v95, v235
 v_lshlrev_b32 v228, 16, v134
 v_mfma_f32_16x16x32_bf16 v[152:155], v[36:39], a[244:247], v[152:155]
 v_and_b32 v229, s73, v134
 v_add_f32 v96, v96, v228
 v_mfma_f32_16x16x32_bf16 v[152:155], v[40:43], a[176:179], v[152:155]
 ds_read_b128 v[68:71], v20 offset:10240
 v_add_f32 v97, v97, v229
 v_mfma_f32_16x16x32_bf16 v[152:155], v[44:47], a[184:187], v[152:155]
 v_lshlrev_b32 v230, 16, v135
 v_and_b32 v231, s73, v135
 v_mfma_f32_16x16x32_bf16 v[188:191], v[32:35], a[240:243], v[188:191]
 ds_read_b128 v[72:75], v20 offset:19456
 v_add_f32 v98, v98, v230
 v_add_f32 v99, v99, v231
 v_mfma_f32_16x16x32_bf16 v[188:191], v[36:39], a[248:251], v[188:191]
 v_lshlrev_b32 v228, 16, v136
 v_and_b32 v229, s73, v136
 v_mfma_f32_16x16x32_bf16 v[188:191], v[40:43], a[180:183], v[188:191]
 ds_read_b128 v[76:79], v20 offset:28672
 v_add_f32 v80, v80, v228
 v_mfma_f32_16x16x32_bf16 v[188:191], v[44:47], a[188:191], v[188:191]
 s_waitcnt lgkmcnt(4)
 v_add_f32 v81, v81, v229
 v_lshlrev_b32 v230, 16, v137
 v_and_b32 v231, s73, v137
 v_mfma_f32_16x16x32_bf16 v[156:159], v[48:51], a[204:207], v[156:159]
 v_add_f32 v82, v82, v230
 v_add_f32 v83, v83, v231
 v_mfma_f32_16x16x32_bf16 v[156:159], v[52:55], a[212:215], v[156:159]
 v_lshlrev_b32 v232, 16, v138
 v_and_b32 v233, s73, v138
 v_mfma_f32_16x16x32_bf16 v[156:159], v[56:59], a[220:223], v[156:159]
 v_add_f32 v84, v84, v232
 v_add_f32 v85, v85, v233
 v_mfma_f32_16x16x32_bf16 v[156:159], v[60:63], a[228:231], v[156:159]
 v_lshlrev_b32 v234, 16, v139
 v_and_b32 v235, s73, v139
 v_lshlrev_b32 v228, 16, v140
 v_mfma_f32_16x16x32_bf16 v[192:195], v[48:51], a[208:211], v[192:195]
 v_add_f32 v86, v86, v234
 v_add_f32 v87, v87, v235
 v_mfma_f32_16x16x32_bf16 v[192:195], v[52:55], a[216:219], v[192:195]
 v_cvt_pk_bf16_f32 v188, v188, v189
 v_cvt_pk_bf16_f32 v189, v190, v191
 v_mfma_f32_16x16x32_bf16 v[192:195], v[56:59], a[224:227], v[192:195]
 v_and_b32 v229, s73, v140
 v_add_f32 v88, v88, v228
 v_lshlrev_b32 v230, 16, v141
 v_mfma_f32_16x16x32_bf16 v[192:195], v[60:63], a[232:235], v[192:195]
 s_waitcnt lgkmcnt(0)
 v_add_f32 v89, v89, v229
 v_and_b32 v231, s73, v141
 v_mfma_f32_16x16x32_bf16 v[156:159], v[64:67], a[236:239], v[156:159]
 v_add_f32 v90, v90, v230
 v_add_f32 v91, v91, v231
 v_mfma_f32_16x16x32_bf16 v[156:159], v[68:71], a[244:247], v[156:159]
 v_lshlrev_b32 v232, 16, v142
 v_and_b32 v233, s73, v142
 v_mfma_f32_16x16x32_bf16 v[156:159], v[72:75], a[176:179], v[156:159]
 v_add_f32 v92, v92, v232
 v_add_f32 v93, v93, v233
 v_lshlrev_b32 v234, 16, v143
 v_mfma_f32_16x16x32_bf16 v[156:159], v[76:79], a[184:187], v[156:159]
 v_and_b32 v235, s73, v143
 v_add_f32 v94, v94, v234
 v_mfma_f32_16x16x32_bf16 v[192:195], v[64:67], a[240:243], v[192:195]
 v_add_f32 v95, v95, v235
 v_lshlrev_b32 v228, 16, v144
 v_mfma_f32_16x16x32_bf16 v[192:195], v[68:71], a[248:251], v[192:195]
 v_and_b32 v229, s73, v144
 v_add_f32 v96, v96, v228
 v_mfma_f32_16x16x32_bf16 v[192:195], v[72:75], a[180:183], v[192:195]
 v_add_f32 v97, v97, v229
 v_lshlrev_b32 v230, 16, v145
 v_and_b32 v231, s73, v145
 v_mfma_f32_16x16x32_bf16 v[192:195], v[76:79], a[188:191], v[192:195]
 v_add_f32 v98, v98, v230
 v_add_f32 v99, v99, v231
 s_nop 5
 v_cvt_pk_bf16_f32 v190, v192, v193
 v_cvt_pk_bf16_f32 v191, v194, v195
 buffer_store_dwordx4 v[188:191], v2, s[40:43], s93 offen offset:2048 sc1
 s_xor_b32 s66, s80, 1
 s_sub_u32 s66, s66, s80
 s_mul_i32 s66, s66, 65536
 s_add_u32 s66, s66, s95
 s_add_u32 s67, s66, 14336
 s_add_u32 s66, s66, 8192
 buffer_load_dwordx4 v[116:119], v2, s[40:43], s66 offen sc1
 buffer_load_dwordx4 v[120:123], v2, s[40:43], s66 offen offset:1024 sc1
 buffer_load_dwordx2 v[124:125], v9, s[40:43], s67 offen sc1
 s_xor_b32 s68, s80, 2
 s_sub_u32 s68, s68, s80
 s_mul_i32 s68, s68, 65536
 s_add_u32 s68, s68, s95
 s_add_u32 s69, s68, 14848
 s_add_u32 s68, s68, 10240
 buffer_load_dwordx4 v[126:129], v2, s[40:43], s68 offen sc1
 buffer_load_dwordx4 v[130:133], v2, s[40:43], s68 offen offset:1024 sc1
 buffer_load_dwordx2 v[134:135], v9, s[40:43], s69 offen sc1
 s_xor_b32 s70, s80, 3
 s_sub_u32 s70, s70, s80
 s_mul_i32 s70, s70, 65536
 s_add_u32 s70, s70, s95
 s_add_u32 s71, s70, 14848
 s_add_u32 s70, s70, 12288
 buffer_load_dwordx4 v[136:139], v2, s[40:43], s70 offen sc1
 buffer_load_dwordx4 v[140:143], v2, s[40:43], s70 offen offset:1024 sc1
 buffer_load_dwordx2 v[144:145], v9, s[40:43], s71 offen sc1
 s_mov_b32 s83, 0x3f80
 s_mov_b32 s86, 0x3f800000
 v_mul_f32 v228, s74, v80
 v_mul_f32 v229, s74, v81
 v_mul_f32 v230, s74, v82
 v_mul_f32 v231, s74, v83
 v_exp_f32 v228, v228
 v_exp_f32 v229, v229
 v_exp_f32 v230, v230
 v_exp_f32 v231, v231
 v_add_f32 v228, 1.0, v228
 v_add_f32 v229, 1.0, v229
 v_add_f32 v230, 1.0, v230
 v_add_f32 v231, 1.0, v231
 v_rcp_f32 v228, v228
 v_rcp_f32 v229, v229
 v_rcp_f32 v230, v230
 v_rcp_f32 v231, v231
 v_mul_f32 v80, v80, v228
 v_mul_f32 v81, v81, v229
 v_mul_f32 v82, v82, v230
 v_mul_f32 v83, v83, v231
 v_mul_f32 v232, s74, v84
 v_mul_f32 v233, s74, v85
 v_mul_f32 v234, s74, v86
 v_mul_f32 v235, s74, v87
 v_exp_f32 v232, v232
 v_exp_f32 v233, v233
 v_exp_f32 v234, v234
 v_exp_f32 v235, v235
 v_add_f32 v232, 1.0, v232
 v_add_f32 v233, 1.0, v233
 v_add_f32 v234, 1.0, v234
 v_add_f32 v235, 1.0, v235
 v_rcp_f32 v232, v232
 v_rcp_f32 v233, v233
 v_rcp_f32 v234, v234
 v_rcp_f32 v235, v235
 v_mul_f32 v84, v84, v232
 v_mul_f32 v85, v85, v233
 v_mul_f32 v86, v86, v234
 v_mul_f32 v87, v87, v235
 v_mul_f32 v228, s74, v88
 v_mul_f32 v229, s74, v89
 v_mul_f32 v230, s74, v90
 v_mul_f32 v231, s74, v91
 v_exp_f32 v228, v228
 v_exp_f32 v229, v229
 v_exp_f32 v230, v230
 v_exp_f32 v231, v231
 v_add_f32 v228, 1.0, v228
 v_add_f32 v229, 1.0, v229
 v_add_f32 v230, 1.0, v230
 v_add_f32 v231, 1.0, v231
 v_rcp_f32 v228, v228
 v_rcp_f32 v229, v229
 v_rcp_f32 v230, v230
 v_rcp_f32 v231, v231
 v_mul_f32 v88, v88, v228
 v_mul_f32 v89, v89, v229
 v_mul_f32 v90, v90, v230
 v_mul_f32 v91, v91, v231
 v_mul_f32 v232, s74, v92
 v_mul_f32 v233, s74, v93
 v_mul_f32 v234, s74, v94
 v_mul_f32 v235, s74, v95
 v_exp_f32 v232, v232
 v_exp_f32 v233, v233
 v_exp_f32 v234, v234
 v_exp_f32 v235, v235
 v_add_f32 v232, 1.0, v232
 v_add_f32 v233, 1.0, v233
 v_add_f32 v234, 1.0, v234
 v_add_f32 v235, 1.0, v235
 v_rcp_f32 v232, v232
 v_rcp_f32 v233, v233
 v_rcp_f32 v234, v234
 v_rcp_f32 v235, v235
 v_mul_f32 v92, v92, v232
 v_mul_f32 v93, v93, v233
 v_mul_f32 v94, v94, v234
 v_mul_f32 v95, v95, v235
 v_mul_f32 v228, s74, v96
 v_mul_f32 v229, s74, v97
 v_mul_f32 v230, s74, v98
 v_mul_f32 v231, s74, v99
 v_exp_f32 v228, v228
 v_exp_f32 v229, v229
 v_exp_f32 v230, v230
 v_exp_f32 v231, v231
 v_add_f32 v228, 1.0, v228
 v_add_f32 v229, 1.0, v229
 v_add_f32 v230, 1.0, v230
 v_add_f32 v231, 1.0, v231
 v_rcp_f32 v228, v228
 v_rcp_f32 v229, v229
 v_rcp_f32 v230, v230
 v_rcp_f32 v231, v231
 v_mul_f32 v96, v96, v228
 v_mul_f32 v97, v97, v229
 v_mul_f32 v98, v98, v230
 v_mul_f32 v99, v99, v231
 s_waitcnt vmcnt(21)
 v_lshlrev_b32 v32, 16, v10
 v_and_b32 v33, s73, v10
 v_lshlrev_b32 v34, 16, v11
 v_and_b32 v35, s73, v11
 s_waitcnt vmcnt(20)
 v_lshlrev_b32 v36, 16, v12
 v_and_b32 v37, s73, v12
 v_lshlrev_b32 v38, 16, v13
 v_and_b32 v39, s73, v13
 s_waitcnt vmcnt(19)
 v_lshlrev_b32 v40, 16, v14
 v_and_b32 v41, s73, v14
 v_lshlrev_b32 v42, 16, v15
 v_and_b32 v43, s73, v15
 s_waitcnt vmcnt(18)
 v_lshlrev_b32 v44, 16, v16
 v_and_b32 v45, s73, v16
 v_lshlrev_b32 v46, 16, v17
 v_and_b32 v47, s73, v17
 s_waitcnt vmcnt(17)
 v_lshlrev_b32 v48, 16, v18
 v_and_b32 v49, s73, v18
 v_lshlrev_b32 v50, 16, v19
 v_and_b32 v51, s73, v19
 s_waitcnt vmcnt(8)
 v_max3_u32 v236, v116, v117, v118
 s_waitcnt vmcnt(7)
 v_max3_u32 v237, v119, v120, v121
 s_waitcnt vmcnt(6)
 v_max3_u32 v238, v122, v123, v124
 v_max3_u32 v236, v236, v237, v125
 v_max_u32 v236, v236, v238
 v_cmp_eq_u32 vcc, -1, v236
 s_cbranch_vccnz L_sent_10
L_sent_10_b:
 v_dot2_f32_bf16 v152, v116, s83, v152
 v_dot2_f32_bf16 v153, v116, s86, v153
 v_dot2_f32_bf16 v154, v117, s83, v154
 v_dot2_f32_bf16 v155, v117, s86, v155
 v_dot2_f32_bf16 v156, v118, s83, v156
 v_dot2_f32_bf16 v157, v118, s86, v157
 v_dot2_f32_bf16 v158, v119, s83, v158
 v_dot2_f32_bf16 v159, v119, s86, v159
 v_dot2_f32_bf16 v160, v120, s83, v160
 v_dot2_f32_bf16 v161, v120, s86, v161
 v_dot2_f32_bf16 v162, v121, s83, v162
 v_dot2_f32_bf16 v163, v121, s86, v163
 v_dot2_f32_bf16 v164, v122, s83, v164
 v_dot2_f32_bf16 v165, v122, s86, v165
 v_dot2_f32_bf16 v166, v123, s83, v166
 v_dot2_f32_bf16 v167, v123, s86, v167
 v_dot2_f32_bf16 v168, v124, s83, v168
 v_dot2_f32_bf16 v169, v124, s86, v169
 v_dot2_f32_bf16 v170, v125, s83, v170
 v_dot2_f32_bf16 v171, v125, s86, v171
 s_waitcnt vmcnt(5)
 v_max3_u32 v236, v126, v127, v128
 s_waitcnt vmcnt(4)
 v_max3_u32 v237, v129, v130, v131
 s_waitcnt vmcnt(3)
 v_max3_u32 v238, v132, v133, v134
 v_max3_u32 v236, v236, v237, v135
 v_max_u32 v236, v236, v238
 v_cmp_eq_u32 vcc, -1, v236
 s_cbranch_vccnz L_sent_11
L_sent_11_b:
 v_dot2_f32_bf16 v152, v126, s83, v152
 v_dot2_f32_bf16 v153, v126, s86, v153
 v_dot2_f32_bf16 v154, v127, s83, v154
 v_dot2_f32_bf16 v155, v127, s86, v155
 v_dot2_f32_bf16 v156, v128, s83, v156
 v_dot2_f32_bf16 v157, v128, s86, v157
 v_dot2_f32_bf16 v158, v129, s83, v158
 v_dot2_f32_bf16 v159, v129, s86, v159
 v_dot2_f32_bf16 v160, v130, s83, v160
 v_dot2_f32_bf16 v161, v130, s86, v161
 v_dot2_f32_bf16 v162, v131, s83, v162
 v_dot2_f32_bf16 v163, v131, s86, v163
 v_dot2_f32_bf16 v164, v132, s83, v164
 v_dot2_f32_bf16 v165, v132, s86, v165
 v_dot2_f32_bf16 v166, v133, s83, v166
 v_dot2_f32_bf16 v167, v133, s86, v167
 v_dot2_f32_bf16 v168, v134, s83, v168
 v_dot2_f32_bf16 v169, v134, s86, v169
 v_dot2_f32_bf16 v170, v135, s83, v170
 v_dot2_f32_bf16 v171, v135, s86, v171
 s_waitcnt vmcnt(2)
 v_max3_u32 v236, v136, v137, v138
 s_waitcnt vmcnt(1)
 v_max3_u32 v237, v139, v140, v141
 s_waitcnt vmcnt(0)
 v_max3_u32 v238, v142, v143, v144
 v_max3_u32 v236, v236, v237, v145
 v_max_u32 v236, v236, v238
 v_cmp_eq_u32 vcc, -1, v236
 s_cbranch_vccnz L_sent_12
L_sent_12_b:
 v_dot2_f32_bf16 v152, v136, s83, v152
 v_dot2_f32_bf16 v153, v136, s86, v153
 v_dot2_f32_bf16 v154, v137, s83, v154
 v_dot2_f32_bf16 v155, v137, s86, v155
 v_dot2_f32_bf16 v156, v138, s83, v156
 v_dot2_f32_bf16 v157, v138, s86, v157
 v_dot2_f32_bf16 v158, v139, s83, v158
 v_dot2_f32_bf16 v159, v139, s86, v159
 v_dot2_f32_bf16 v160, v140, s83, v160
 v_dot2_f32_bf16 v161, v140, s86, v161
 v_dot2_f32_bf16 v162, v141, s83, v162
 v_dot2_f32_bf16 v163, v141, s86, v163
 v_dot2_f32_bf16 v164, v142, s83, v164
 v_dot2_f32_bf16 v165, v142, s86, v165
 v_dot2_f32_bf16 v166, v143, s83, v166
 v_dot2_f32_bf16 v167, v143, s86, v167
 v_dot2_f32_bf16 v168, v144, s83, v168
 v_dot2_f32_bf16 v169, v144, s86, v169
 v_dot2_f32_bf16 v170, v145, s83, v170
 v_dot2_f32_bf16 v171, v145, s86, v171
 s_nop 2
 s_mul_i32 s84, s92, 0x7f000000
 v_fmac_f32 v32, v152, v80
 v_fmac_f32 v33, v153, v81
 v_fmac_f32 v34, v154, v82
 v_fmac_f32 v35, v155, v83
 v_cvt_pk_bf16_f32 v224, v32, v33
 v_cvt_pk_bf16_f32 v225, v34, v35
 buffer_store_dwordx2 v[224:225], v8, s[28:31], 0 offen offset:0
 v_fmac_f32 v36, v156, v84
 v_fmac_f32 v37, v157, v85
 v_fmac_f32 v38, v158, v86
 v_fmac_f32 v39, v159, v87
 v_cvt_pk_bf16_f32 v226, v36, v37
 v_cvt_pk_bf16_f32 v227, v38, v39
 buffer_store_dwordx2 v[226:227], v8, s[28:31], 0 offen offset:32
 v_fmac_f32 v40, v160, v88
 v_fmac_f32 v41, v161, v89
 v_fmac_f32 v42, v162, v90
 v_fmac_f32 v43, v163, v91
 v_cvt_pk_bf16_f32 v224, v40, v41
 v_cvt_pk_bf16_f32 v225, v42, v43
 buffer_store_dwordx2 v[224:225], v8, s[28:31], 0 offen offset:64
 v_fmac_f32 v44, v164, v92
 v_fmac_f32 v45, v165, v93
 v_fmac_f32 v46, v166, v94
 v_fmac_f32 v47, v167, v95
 v_cvt_pk_bf16_f32 v226, v44, v45
 v_cvt_pk_bf16_f32 v227, v46, v47
 buffer_store_dwordx2 v[226:227], v8, s[28:31], 0 offen offset:96
 v_fmac_f32 v48, v168, v96
 v_fmac_f32 v49, v169, v97
 v_fmac_f32 v50, v170, v98
 v_fmac_f32 v51, v171, v99
 v_cvt_pk_bf16_f32 v224, v48, v49
 v_cvt_pk_bf16_f32 v225, v50, v51
 buffer_store_dwordx2 v[224:225], v8, s[28:31], s84 offen offset:128
L_main_end:
 s_endpgm
L_flag_f:
 s_lshl2_add_u32 s84, s80, s99
 v_mov_b32 v24, 1
 s_mov_b64 exec, 1
 buffer_store_dword v24, off, s[20:23], s84 offset:0 sc1
 s_mov_b64 exec, -1
 s_branch L_flag_f_b
L_spin_f:
 s_mov_b32 s97, 0
L_spin_f_l:
 buffer_load_dword v28, v29, s[20:23], s99 offen sc1
 s_add_u32 s97, s97, 1
 s_waitcnt vmcnt(0)
 v_cmp_eq_u32 vcc, 0, v28
 s_cmp_ge_u32 s97, 0x40000
 s_cbranch_scc1 L_spin_f_b
 s_cbranch_vccz L_spin_f_b
 s_sleep 1
 s_branch L_spin_f_l
L_sent_10:
 s_mov_b32 s97, 0
L_sent_10_l:
 s_sleep 2
 buffer_load_dwordx4 v[116:119], v2, s[40:43], s66 offen sc1
 buffer_load_dwordx4 v[120:123], v2, s[40:43], s66 offen offset:1024 sc1
 buffer_load_dwordx2 v[124:125], v9, s[40:43], s67 offen sc1
 s_add_u32 s97, s97, 1
 s_waitcnt vmcnt(0)
 v_max3_u32 v236, v116, v117, v118
 v_max3_u32 v237, v119, v120, v121
 v_max3_u32 v238, v122, v123, v124
 v_max3_u32 v236, v236, v237, v125
 v_max_u32 v236, v236, v238
 v_cmp_eq_u32 vcc, -1, v236
 s_cmp_ge_u32 s97, 0x40000
 s_cbranch_scc1 L_sent_10_b
 s_cbranch_vccnz L_sent_10_l
 s_branch L_sent_10_b
L_sent_11:
 s_mov_b32 s97, 0
L_sent_11_l:
 s_sleep 2
 buffer_load_dwordx4 v[126:129], v2, s[40:43], s68 offen sc1
 buffer_load_dwordx4 v[130:133], v2, s[40:43], s68 offen offset:1024 sc1
 buffer_load_dwordx2 v[134:135], v9, s[40:43], s69 offen sc1
 s_add_u32 s97, s97, 1
 s_waitcnt vmcnt(0)
 v_max3_u32 v236, v126, v127, v128
 v_max3_u32 v237, v129, v130, v131
 v_max3_u32 v238, v132, v133, v134
 v_max3_u32 v236, v236, v237, v135
 v_max_u32 v236, v236, v238
 v_cmp_eq_u32 vcc, -1, v236
 s_cmp_ge_u32 s97, 0x40000
 s_cbranch_scc1 L_sent_11_b
 s_cbranch_vccnz L_sent_11_l
 s_branch L_sent_11_b
L_sent_12:
 s_mov_b32 s97, 0
L_sent_12_l:
 s_sleep 2
 buffer_load_dwordx4 v[136:139], v2, s[40:43], s70 offen sc1
 buffer_load_dwordx4 v[140:143], v2, s[40:43], s70 offen offset:1024 sc1
 buffer_load_dwordx2 v[144:145], v9, s[40:43], s71 offen sc1
 s_add_u32 s97, s97, 1
 s_waitcnt vmcnt(0)
 v_max3_u32 v236, v136, v137, v138
 v_max3_u32 v237, v139, v140, v141
 v_max3_u32 v238, v142, v143, v144
 v_max3_u32 v236, v236, v237, v145
 v_max_u32 v236, v236, v238
 v_cmp_eq_u32 vcc, -1, v236
 s_cmp_ge_u32 s97, 0x40000
 s_cbranch_scc1 L_sent_12_b
 s_cbranch_vccnz L_sent_12_l
 s_branch L_sent_12_b
L_flag_o:
 s_lshl_b32 s84, s54, 7
 s_lshl2_add_u32 s84, s53, s84
 s_add_u32 s84, s84, 8192
 v_mov_b32 v24, 1
 s_mov_b64 exec, 1
 buffer_store_dword v24, off, s[20:23], s84 offset:0 sc1
 s_mov_b64 exec, -1
 s_branch L_flag_o_b
L_spin_o:
 s_mov_b32 s97, 0
L_spin_o_l:
 buffer_load_dword v28, v30, s[20:23], s98 offen sc1
 s_add_u32 s97, s97, 1
 s_waitcnt vmcnt(0)
 v_cmp_eq_u32 vcc, 0, v28
 s_cmp_ge_u32 s97, 0x40000
 s_cbranch_scc1 L_spin_o_b
 s_cbranch_vccz L_spin_o_b
 s_sleep 1
 s_branch L_spin_o_l
L_spin_a:
 s_mov_b32 s97, 0
L_spin_a_l:
 buffer_load_dword v28, v31, s[44:47], 0 offen sc1
 s_add_u32 s97, s97, 1
 s_waitcnt vmcnt(0)
 v_cmp_gt_u32 vcc, 32, v28
 s_cmp_ge_u32 s97, 0x40000
 s_cbranch_scc1 L_spin_a_b
 s_cbranch_vccz L_spin_a_b
 s_sleep 1
 s_branch L_spin_a_l
L_job0:
 s_add_u32 s60, s60, 4096
 s_cmp_lg_u32 s52, 0
 s_cbranch_scc1 L_job_b
 s_mov_b32 s44, s14
 s_mov_b32 s45, s15
 s_mov_b32 s46, 256
 s_mov_b32 s47, 0x20000
 s_and_b32 s55, s2, 7
 s_lshl_b32 s55, s55, 5
 v_mov_b32 v10, 1
 s_mov_b64 exec, 1
 buffer_atomic_add v10, off, s[44:47], s55 sc1
 s_mov_b64 exec, -1
 s_branch L_job_b
L_slow:
 s_waitcnt vmcnt(0) lgkmcnt(0)
 s_nop 7
 v_accvgpr_write_b32 a0, 0
 v_accvgpr_write_b32 a1, 0
 v_accvgpr_write_b32 a2, 0
 v_accvgpr_write_b32 a3, 0
 v_accvgpr_write_b32 a4, 0
 v_accvgpr_write_b32 a5, 0
 v_accvgpr_write_b32 a6, 0
 v_accvgpr_write_b32 a7, 0
 v_accvgpr_write_b32 a8, 0
 v_accvgpr_write_b32 a9, 0
 v_accvgpr_write_b32 a10, 0
 v_accvgpr_write_b32 a11, 0
 v_accvgpr_write_b32 a12, 0
 v_accvgpr_write_b32 a13, 0
 v_accvgpr_write_b32 a14, 0
 v_accvgpr_write_b32 a15, 0
 v_accvgpr_write_b32 a16, 0
 v_accvgpr_write_b32 a17, 0
 v_accvgpr_write_b32 a18, 0
 v_accvgpr_write_b32 a19, 0
 v_accvgpr_write_b32 a20, 0
 v_accvgpr_write_b32 a21, 0
 v_accvgpr_write_b32 a22, 0
 v_accvgpr_write_b32 a23, 0
 v_accvgpr_write_b32 a24, 0
 v_accvgpr_write_b32 a25, 0
 v_accvgpr_write_b32 a26, 0
 v_accvgpr_write_b32 a27, 0
 v_accvgpr_write_b32 a28, 0
 v_accvgpr_write_b32 a29, 0
 v_accvgpr_write_b32 a30, 0
 v_accvgpr_write_b32 a31, 0
 v_accvgpr_write_b32 a32, 0
 v_accvgpr_write_b32 a33, 0
 v_accvgpr_write_b32 a34, 0
 v_accvgpr_write_b32 a35, 0
 v_accvgpr_write_b32 a36, 0
 v_accvgpr_write_b32 a37, 0
 v_accvgpr_write_b32 a38, 0
 v_accvgpr_write_b32 a39, 0
 v_accvgpr_write_b32 a40, 0
 v_accvgpr_write_b32 a41, 0
 v_accvgpr_write_b32 a42, 0
 v_accvgpr_write_b32 a43, 0
 v_accvgpr_write_b32 a44, 0
 v_accvgpr_write_b32 a45, 0
 v_accvgpr_write_b32 a46, 0
 v_accvgpr_write_b32 a47, 0
 v_accvgpr_write_b32 a48, 0
 v_accvgpr_write_b32 a49, 0
 v_accvgpr_write_b32 a50, 0
 v_accvgpr_write_b32 a51, 0
 v_accvgpr_write_b32 a52, 0
 v_accvgpr_write_b32 a53, 0
 v_accvgpr_write_b32 a54, 0
 v_accvgpr_write_b32 a55, 0
 v_accvgpr_write_b32 a56, 0
 v_accvgpr_write_b32 a57, 0
 v_accvgpr_write_b32 a58, 0
 v_accvgpr_write_b32 a59, 0
 v_accvgpr_write_b32 a60, 0
 v_accvgpr_write_b32 a61, 0
 v_accvgpr_write_b32 a62, 0
 v_accvgpr_write_b32 a63, 0
 v_accvgpr_write_b32 a64, 0
 v_accvgpr_write_b32 a65, 0
 v_accvgpr_write_b32 a66, 0
 v_accvgpr_write_b32 a67, 0
 v_accvgpr_write_b32 a68, 0
 v_accvgpr_write_b32 a69, 0
 v_accvgpr_write_b32 a70, 0
 v_accvgpr_write_b32 a71, 0
 v_accvgpr_write_b32 a72, 0
 v_accvgpr_write_b32 a73, 0
 v_accvgpr_write_b32 a74, 0
 v_accvgpr_write_b32 a75, 0
 v_accvgpr_write_b32 a76, 0
 v_accvgpr_write_b32 a77, 0
 v_accvgpr_write_b32 a78, 0
 v_accvgpr_write_b32 a79, 0
 v_accvgpr_write_b32 a80, 0
 v_accvgpr_write_b32 a81, 0
 v_accvgpr_write_b32 a82, 0
 v_accvgpr_write_b32 a83, 0
 v_accvgpr_write_b32 a84, 0
 v_accvgpr_write_b32 a85, 0
 v_accvgpr_write_b32 a86, 0
 v_accvgpr_write_b32 a87, 0
 v_accvgpr_write_b32 a88, 0
 v_accvgpr_write_b32 a89, 0
 v_accvgpr_write_b32 a90, 0
 v_accvgpr_write_b32 a91, 0
 v_accvgpr_write_b32 a92, 0
 v_accvgpr_write_b32 a93, 0
 v_accvgpr_write_b32 a94, 0
 v_accvgpr_write_b32 a95, 0
 v_accvgpr_write_b32 a96, 0
 v_accvgpr_write_b32 a97, 0
 v_accvgpr_write_b32 a98, 0
 v_accvgpr_write_b32 a99, 0
 v_accvgpr_write_b32 a100, 0
 v_accvgpr_write_b32 a101, 0
 v_accvgpr_write_b32 a102, 0
 v_accvgpr_write_b32 a103, 0
 v_accvgpr_write_b32 a104, 0
 v_accvgpr_write_b32 a105, 0
 v_accvgpr_write_b32 a106, 0
 v_accvgpr_write_b32 a107, 0
 v_accvgpr_write_b32 a108, 0
 v_accvgpr_write_b32 a109, 0
 v_accvgpr_write_b32 a110, 0
 v_accvgpr_write_b32 a111, 0
 v_accvgpr_write_b32 a112, 0
 v_accvgpr_write_b32 a113, 0
 v_accvgpr_write_b32 a114, 0
 v_accvgpr_write_b32 a115, 0
 v_accvgpr_write_b32 a116, 0
 v_accvgpr_write_b32 a117, 0
 v_accvgpr_write_b32 a118, 0
 v_accvgpr_write_b32 a119, 0
 v_accvgpr_write_b32 a120, 0
 v_accvgpr_write_b32 a121, 0
 v_accvgpr_write_b32 a122, 0
 v_accvgpr_write_b32 a123, 0
 v_accvgpr_write_b32 a124, 0
 v_accvgpr_write_b32 a125, 0
 v_accvgpr_write_b32 a126, 0
 v_accvgpr_write_b32 a127, 0
 v_mov_b32 v160, 0xff800000
 v_mov_b32 v124, 0
 v_mov_b32 v161, 0xff800000
 v_mov_b32 v125, 0
 v_mov_b32 v162, 0xff800000
 v_mov_b32 v126, 0
 v_mov_b32 v163, 0xff800000
 v_mov_b32 v127, 0
 v_and_b32 v10, 15, v1
 v_lshrrev_b32 v11, 4, v1
 v_lshlrev_b32 v12, 8, v10
 v_lshl_add_u32 v12, v11, 4, v12
 v_subrev_u32 v13, s72, v244
 v_subrev_u32 v14, s72, v245
 s_lshl_b32 s55, s52, 13
 s_add_u32 s55, s55, 131072
 s_sub_u32 s56, s55, 65536
 v_add_u32 v16, s56, v16
 v_add_u32 v17, s56, v17
 v_add_u32 v18, s56, v18
 v_add_u32 v19, s56, v19
 v_add_u32 v20, s56, v20
 v_add_u32 v21, s56, v21
 v_add_u32 v22, s56, v22
 v_add_u32 v23, s56, v23
 s_mov_b32 s76, 0
L_slow_loop:
 s_add_u32 s58, s76, 0
 buffer_load_dwordx4 a[128:131], v12, s[24:27], s58 offen offset:0
 buffer_load_dwordx4 a[132:135], v12, s[24:27], s58 offen offset:64
 buffer_load_dwordx4 a[136:139], v12, s[24:27], s58 offen offset:128
 buffer_load_dwordx4 a[140:143], v12, s[24:27], s58 offen offset:192
 s_add_u32 s58, s76, 4096
 buffer_load_dwordx4 a[144:147], v12, s[24:27], s58 offen offset:0
 buffer_load_dwordx4 a[148:151], v12, s[24:27], s58 offen offset:64
 buffer_load_dwordx4 a[152:155], v12, s[24:27], s58 offen offset:128
 buffer_load_dwordx4 a[156:159], v12, s[24:27], s58 offen offset:192
 s_add_u32 m0, s55, 0
 s_add_u32 s58, s76, 16384
 buffer_load_dwordx4 v13, s[28:31], s58 offen offset:0 lds
 buffer_load_dwordx4 v14, s[28:31], s58 offen offset:1024 lds
 buffer_load_dwordx4 v13, s[28:31], s58 offen offset:2048 lds
 buffer_load_dwordx4 v14, s[28:31], s58 offen offset:3072 lds
 s_add_u32 m0, s55, 4096
 s_add_u32 s58, s76, 20480
 buffer_load_dwordx4 v13, s[28:31], s58 offen offset:0 lds
 buffer_load_dwordx4 v14, s[28:31], s58 offen offset:1024 lds
 buffer_load_dwordx4 v13, s[28:31], s58 offen offset:2048 lds
 buffer_load_dwordx4 v14, s[28:31], s58 offen offset:3072 lds
 s_waitcnt vmcnt(0)
 ds_read_b64_tr_b16 v[208:209], v16 offset:0
 ds_read_b64_tr_b16 v[210:211], v16 offset:4096
 ds_read_b64_tr_b16 v[212:213], v17 offset:0
 ds_read_b64_tr_b16 v[214:215], v17 offset:4096
 ds_read_b64_tr_b16 v[216:217], v18 offset:0
 ds_read_b64_tr_b16 v[218:219], v18 offset:4096
 ds_read_b64_tr_b16 v[220:221], v19 offset:0
 ds_read_b64_tr_b16 v[222:223], v19 offset:4096
 ds_read_b64_tr_b16 v[224:225], v20 offset:0
 ds_read_b64_tr_b16 v[226:227], v20 offset:4096
 ds_read_b64_tr_b16 v[228:229], v21 offset:0
 ds_read_b64_tr_b16 v[230:231], v21 offset:4096
 ds_read_b64_tr_b16 v[232:233], v22 offset:0
 ds_read_b64_tr_b16 v[234:235], v22 offset:4096
 ds_read_b64_tr_b16 v[236:237], v23 offset:0
 ds_read_b64_tr_b16 v[238:239], v23 offset:4096
 v_mfma_f32_16x16x32_bf16 v[128:131], a[128:131], v[80:83], 0
 v_mfma_f32_16x16x32_bf16 v[128:131], a[132:135], v[96:99], v[128:131]
 v_mfma_f32_16x16x32_bf16 v[128:131], a[136:139], v[48:51], v[128:131]
 v_mfma_f32_16x16x32_bf16 v[128:131], a[140:143], v[64:67], v[128:131]
 v_mfma_f32_16x16x32_bf16 v[132:135], a[128:131], v[84:87], 0
 v_mfma_f32_16x16x32_bf16 v[132:135], a[132:135], v[100:103], v[132:135]
 v_mfma_f32_16x16x32_bf16 v[132:135], a[136:139], v[52:55], v[132:135]
 v_mfma_f32_16x16x32_bf16 v[132:135], a[140:143], v[68:71], v[132:135]
 v_mfma_f32_16x16x32_bf16 v[136:139], a[128:131], v[88:91], 0
 v_mfma_f32_16x16x32_bf16 v[136:139], a[132:135], v[104:107], v[136:139]
 v_mfma_f32_16x16x32_bf16 v[136:139], a[136:139], v[56:59], v[136:139]
 v_mfma_f32_16x16x32_bf16 v[136:139], a[140:143], v[72:75], v[136:139]
 v_mfma_f32_16x16x32_bf16 v[140:143], a[128:131], v[92:95], 0
 v_mfma_f32_16x16x32_bf16 v[140:143], a[132:135], v[108:111], v[140:143]
 v_mfma_f32_16x16x32_bf16 v[140:143], a[136:139], v[60:63], v[140:143]
 v_mfma_f32_16x16x32_bf16 v[140:143], a[140:143], v[76:79], v[140:143]
 v_mfma_f32_16x16x32_bf16 v[144:147], a[144:147], v[80:83], 0
 v_mfma_f32_16x16x32_bf16 v[144:147], a[148:151], v[96:99], v[144:147]
 v_mfma_f32_16x16x32_bf16 v[144:147], a[152:155], v[48:51], v[144:147]
 v_mfma_f32_16x16x32_bf16 v[144:147], a[156:159], v[64:67], v[144:147]
 v_mfma_f32_16x16x32_bf16 v[148:151], a[144:147], v[84:87], 0
 v_mfma_f32_16x16x32_bf16 v[148:151], a[148:151], v[100:103], v[148:151]
 v_mfma_f32_16x16x32_bf16 v[148:151], a[152:155], v[52:55], v[148:151]
 v_mfma_f32_16x16x32_bf16 v[148:151], a[156:159], v[68:71], v[148:151]
 v_mfma_f32_16x16x32_bf16 v[152:155], a[144:147], v[88:91], 0
 v_mfma_f32_16x16x32_bf16 v[152:155], a[148:151], v[104:107], v[152:155]
 v_mfma_f32_16x16x32_bf16 v[152:155], a[152:155], v[56:59], v[152:155]
 v_mfma_f32_16x16x32_bf16 v[152:155], a[156:159], v[72:75], v[152:155]
 v_mfma_f32_16x16x32_bf16 v[156:159], a[144:147], v[92:95], 0
 v_mfma_f32_16x16x32_bf16 v[156:159], a[148:151], v[108:111], v[156:159]
 v_mfma_f32_16x16x32_bf16 v[156:159], a[152:155], v[60:63], v[156:159]
 v_mfma_f32_16x16x32_bf16 v[156:159], a[156:159], v[76:79], v[156:159]
 s_nop 7
 v_max3_f32 v10, v128, v129, v130
 v_max3_f32 v10, v10, v131, v144
 v_max3_f32 v10, v10, v145, v146
 v_max3_f32 v10, v10, v147, v160
 v_mov_b32 v11, v10
 s_nop 1
 v_permlane16_swap_b32 v11, v10
 v_max_f32 v10, v10, v11
 v_mov_b32 v11, v10
 s_nop 1
 v_permlane32_swap_b32 v11, v10
 v_max_f32 v10, v10, v11
 v_sub_f32 v164, v160, v10
 v_exp_f32 v164, v164
 v_mov_b32 v160, v10
 v_mul_f32 v124, v124, v164
 v_sub_f32 v128, v128, v10
 v_exp_f32 v128, v128
 s_nop 0
 v_add_f32 v124, v124, v128
 v_sub_f32 v129, v129, v10
 v_exp_f32 v129, v129
 s_nop 0
 v_add_f32 v124, v124, v129
 v_sub_f32 v130, v130, v10
 v_exp_f32 v130, v130
 s_nop 0
 v_add_f32 v124, v124, v130
 v_sub_f32 v131, v131, v10
 v_exp_f32 v131, v131
 s_nop 0
 v_add_f32 v124, v124, v131
 v_cvt_pk_bf16_f32 v176, v128, v129
 v_cvt_pk_bf16_f32 v177, v130, v131
 v_sub_f32 v144, v144, v10
 v_exp_f32 v144, v144
 s_nop 0
 v_add_f32 v124, v124, v144
 v_sub_f32 v145, v145, v10
 v_exp_f32 v145, v145
 s_nop 0
 v_add_f32 v124, v124, v145
 v_sub_f32 v146, v146, v10
 v_exp_f32 v146, v146
 s_nop 0
 v_add_f32 v124, v124, v146
 v_sub_f32 v147, v147, v10
 v_exp_f32 v147, v147
 s_nop 0
 v_add_f32 v124, v124, v147
 v_cvt_pk_bf16_f32 v178, v144, v145
 v_cvt_pk_bf16_f32 v179, v146, v147
 v_accvgpr_read_b32 v11, a0
 v_mul_f32 v11, v11, v164
 v_accvgpr_write_b32 a0, v11
 v_accvgpr_read_b32 v11, a1
 v_mul_f32 v11, v11, v164
 v_accvgpr_write_b32 a1, v11
 v_accvgpr_read_b32 v11, a2
 v_mul_f32 v11, v11, v164
 v_accvgpr_write_b32 a2, v11
 v_accvgpr_read_b32 v11, a3
 v_mul_f32 v11, v11, v164
 v_accvgpr_write_b32 a3, v11
 v_accvgpr_read_b32 v11, a16
 v_mul_f32 v11, v11, v164
 v_accvgpr_write_b32 a16, v11
 v_accvgpr_read_b32 v11, a17
 v_mul_f32 v11, v11, v164
 v_accvgpr_write_b32 a17, v11
 v_accvgpr_read_b32 v11, a18
 v_mul_f32 v11, v11, v164
 v_accvgpr_write_b32 a18, v11
 v_accvgpr_read_b32 v11, a19
 v_mul_f32 v11, v11, v164
 v_accvgpr_write_b32 a19, v11
 v_accvgpr_read_b32 v11, a32
 v_mul_f32 v11, v11, v164
 v_accvgpr_write_b32 a32, v11
 v_accvgpr_read_b32 v11, a33
 v_mul_f32 v11, v11, v164
 v_accvgpr_write_b32 a33, v11
 v_accvgpr_read_b32 v11, a34
 v_mul_f32 v11, v11, v164
 v_accvgpr_write_b32 a34, v11
 v_accvgpr_read_b32 v11, a35
 v_mul_f32 v11, v11, v164
 v_accvgpr_write_b32 a35, v11
 v_accvgpr_read_b32 v11, a48
 v_mul_f32 v11, v11, v164
 v_accvgpr_write_b32 a48, v11
 v_accvgpr_read_b32 v11, a49
 v_mul_f32 v11, v11, v164
 v_accvgpr_write_b32 a49, v11
 v_accvgpr_read_b32 v11, a50
 v_mul_f32 v11, v11, v164
 v_accvgpr_write_b32 a50, v11
 v_accvgpr_read_b32 v11, a51
 v_mul_f32 v11, v11, v164
 v_accvgpr_write_b32 a51, v11
 v_accvgpr_read_b32 v11, a64
 v_mul_f32 v11, v11, v164
 v_accvgpr_write_b32 a64, v11
 v_accvgpr_read_b32 v11, a65
 v_mul_f32 v11, v11, v164
 v_accvgpr_write_b32 a65, v11
 v_accvgpr_read_b32 v11, a66
 v_mul_f32 v11, v11, v164
 v_accvgpr_write_b32 a66, v11
 v_accvgpr_read_b32 v11, a67
 v_mul_f32 v11, v11, v164
 v_accvgpr_write_b32 a67, v11
 v_accvgpr_read_b32 v11, a80
 v_mul_f32 v11, v11, v164
 v_accvgpr_write_b32 a80, v11
 v_accvgpr_read_b32 v11, a81
 v_mul_f32 v11, v11, v164
 v_accvgpr_write_b32 a81, v11
 v_accvgpr_read_b32 v11, a82
 v_mul_f32 v11, v11, v164
 v_accvgpr_write_b32 a82, v11
 v_accvgpr_read_b32 v11, a83
 v_mul_f32 v11, v11, v164
 v_accvgpr_write_b32 a83, v11
 v_accvgpr_read_b32 v11, a96
 v_mul_f32 v11, v11, v164
 v_accvgpr_write_b32 a96, v11
 v_accvgpr_read_b32 v11, a97
 v_mul_f32 v11, v11, v164
 v_accvgpr_write_b32 a97, v11
 v_accvgpr_read_b32 v11, a98
 v_mul_f32 v11, v11, v164
 v_accvgpr_write_b32 a98, v11
 v_accvgpr_read_b32 v11, a99
 v_mul_f32 v11, v11, v164
 v_accvgpr_write_b32 a99, v11
 v_accvgpr_read_b32 v11, a112
 v_mul_f32 v11, v11, v164
 v_accvgpr_write_b32 a112, v11
 v_accvgpr_read_b32 v11, a113
 v_mul_f32 v11, v11, v164
 v_accvgpr_write_b32 a113, v11
 v_accvgpr_read_b32 v11, a114
 v_mul_f32 v11, v11, v164
 v_accvgpr_write_b32 a114, v11
 v_accvgpr_read_b32 v11, a115
 v_mul_f32 v11, v11, v164
 v_accvgpr_write_b32 a115, v11
 v_max3_f32 v10, v132, v133, v134
 v_max3_f32 v10, v10, v135, v148
 v_max3_f32 v10, v10, v149, v150
 v_max3_f32 v10, v10, v151, v161
 v_mov_b32 v11, v10
 s_nop 1
 v_permlane16_swap_b32 v11, v10
 v_max_f32 v10, v10, v11
 v_mov_b32 v11, v10
 s_nop 1
 v_permlane32_swap_b32 v11, v10
 v_max_f32 v10, v10, v11
 v_sub_f32 v165, v161, v10
 v_exp_f32 v165, v165
 v_mov_b32 v161, v10
 v_mul_f32 v125, v125, v165
 v_sub_f32 v132, v132, v10
 v_exp_f32 v132, v132
 s_nop 0
 v_add_f32 v125, v125, v132
 v_sub_f32 v133, v133, v10
 v_exp_f32 v133, v133
 s_nop 0
 v_add_f32 v125, v125, v133
 v_sub_f32 v134, v134, v10
 v_exp_f32 v134, v134
 s_nop 0
 v_add_f32 v125, v125, v134
 v_sub_f32 v135, v135, v10
 v_exp_f32 v135, v135
 s_nop 0
 v_add_f32 v125, v125, v135
 v_cvt_pk_bf16_f32 v180, v132, v133
 v_cvt_pk_bf16_f32 v181, v134, v135
 v_sub_f32 v148, v148, v10
 v_exp_f32 v148, v148
 s_nop 0
 v_add_f32 v125, v125, v148
 v_sub_f32 v149, v149, v10
 v_exp_f32 v149, v149
 s_nop 0
 v_add_f32 v125, v125, v149
 v_sub_f32 v150, v150, v10
 v_exp_f32 v150, v150
 s_nop 0
 v_add_f32 v125, v125, v150
 v_sub_f32 v151, v151, v10
 v_exp_f32 v151, v151
 s_nop 0
 v_add_f32 v125, v125, v151
 v_cvt_pk_bf16_f32 v182, v148, v149
 v_cvt_pk_bf16_f32 v183, v150, v151
 v_accvgpr_read_b32 v11, a4
 v_mul_f32 v11, v11, v165
 v_accvgpr_write_b32 a4, v11
 v_accvgpr_read_b32 v11, a5
 v_mul_f32 v11, v11, v165
 v_accvgpr_write_b32 a5, v11
 v_accvgpr_read_b32 v11, a6
 v_mul_f32 v11, v11, v165
 v_accvgpr_write_b32 a6, v11
 v_accvgpr_read_b32 v11, a7
 v_mul_f32 v11, v11, v165
 v_accvgpr_write_b32 a7, v11
 v_accvgpr_read_b32 v11, a20
 v_mul_f32 v11, v11, v165
 v_accvgpr_write_b32 a20, v11
 v_accvgpr_read_b32 v11, a21
 v_mul_f32 v11, v11, v165
 v_accvgpr_write_b32 a21, v11
 v_accvgpr_read_b32 v11, a22
 v_mul_f32 v11, v11, v165
 v_accvgpr_write_b32 a22, v11
 v_accvgpr_read_b32 v11, a23
 v_mul_f32 v11, v11, v165
 v_accvgpr_write_b32 a23, v11
 v_accvgpr_read_b32 v11, a36
 v_mul_f32 v11, v11, v165
 v_accvgpr_write_b32 a36, v11
 v_accvgpr_read_b32 v11, a37
 v_mul_f32 v11, v11, v165
 v_accvgpr_write_b32 a37, v11
 v_accvgpr_read_b32 v11, a38
 v_mul_f32 v11, v11, v165
 v_accvgpr_write_b32 a38, v11
 v_accvgpr_read_b32 v11, a39
 v_mul_f32 v11, v11, v165
 v_accvgpr_write_b32 a39, v11
 v_accvgpr_read_b32 v11, a52
 v_mul_f32 v11, v11, v165
 v_accvgpr_write_b32 a52, v11
 v_accvgpr_read_b32 v11, a53
 v_mul_f32 v11, v11, v165
 v_accvgpr_write_b32 a53, v11
 v_accvgpr_read_b32 v11, a54
 v_mul_f32 v11, v11, v165
 v_accvgpr_write_b32 a54, v11
 v_accvgpr_read_b32 v11, a55
 v_mul_f32 v11, v11, v165
 v_accvgpr_write_b32 a55, v11
 v_accvgpr_read_b32 v11, a68
 v_mul_f32 v11, v11, v165
 v_accvgpr_write_b32 a68, v11
 v_accvgpr_read_b32 v11, a69
 v_mul_f32 v11, v11, v165
 v_accvgpr_write_b32 a69, v11
 v_accvgpr_read_b32 v11, a70
 v_mul_f32 v11, v11, v165
 v_accvgpr_write_b32 a70, v11
 v_accvgpr_read_b32 v11, a71
 v_mul_f32 v11, v11, v165
 v_accvgpr_write_b32 a71, v11
 v_accvgpr_read_b32 v11, a84
 v_mul_f32 v11, v11, v165
 v_accvgpr_write_b32 a84, v11
 v_accvgpr_read_b32 v11, a85
 v_mul_f32 v11, v11, v165
 v_accvgpr_write_b32 a85, v11
 v_accvgpr_read_b32 v11, a86
 v_mul_f32 v11, v11, v165
 v_accvgpr_write_b32 a86, v11
 v_accvgpr_read_b32 v11, a87
 v_mul_f32 v11, v11, v165
 v_accvgpr_write_b32 a87, v11
 v_accvgpr_read_b32 v11, a100
 v_mul_f32 v11, v11, v165
 v_accvgpr_write_b32 a100, v11
 v_accvgpr_read_b32 v11, a101
 v_mul_f32 v11, v11, v165
 v_accvgpr_write_b32 a101, v11
 v_accvgpr_read_b32 v11, a102
 v_mul_f32 v11, v11, v165
 v_accvgpr_write_b32 a102, v11
 v_accvgpr_read_b32 v11, a103
 v_mul_f32 v11, v11, v165
 v_accvgpr_write_b32 a103, v11
 v_accvgpr_read_b32 v11, a116
 v_mul_f32 v11, v11, v165
 v_accvgpr_write_b32 a116, v11
 v_accvgpr_read_b32 v11, a117
 v_mul_f32 v11, v11, v165
 v_accvgpr_write_b32 a117, v11
 v_accvgpr_read_b32 v11, a118
 v_mul_f32 v11, v11, v165
 v_accvgpr_write_b32 a118, v11
 v_accvgpr_read_b32 v11, a119
 v_mul_f32 v11, v11, v165
 v_accvgpr_write_b32 a119, v11
 v_max3_f32 v10, v136, v137, v138
 v_max3_f32 v10, v10, v139, v152
 v_max3_f32 v10, v10, v153, v154
 v_max3_f32 v10, v10, v155, v162
 v_mov_b32 v11, v10
 s_nop 1
 v_permlane16_swap_b32 v11, v10
 v_max_f32 v10, v10, v11
 v_mov_b32 v11, v10
 s_nop 1
 v_permlane32_swap_b32 v11, v10
 v_max_f32 v10, v10, v11
 v_sub_f32 v166, v162, v10
 v_exp_f32 v166, v166
 v_mov_b32 v162, v10
 v_mul_f32 v126, v126, v166
 v_sub_f32 v136, v136, v10
 v_exp_f32 v136, v136
 s_nop 0
 v_add_f32 v126, v126, v136
 v_sub_f32 v137, v137, v10
 v_exp_f32 v137, v137
 s_nop 0
 v_add_f32 v126, v126, v137
 v_sub_f32 v138, v138, v10
 v_exp_f32 v138, v138
 s_nop 0
 v_add_f32 v126, v126, v138
 v_sub_f32 v139, v139, v10
 v_exp_f32 v139, v139
 s_nop 0
 v_add_f32 v126, v126, v139
 v_cvt_pk_bf16_f32 v184, v136, v137
 v_cvt_pk_bf16_f32 v185, v138, v139
 v_sub_f32 v152, v152, v10
 v_exp_f32 v152, v152
 s_nop 0
 v_add_f32 v126, v126, v152
 v_sub_f32 v153, v153, v10
 v_exp_f32 v153, v153
 s_nop 0
 v_add_f32 v126, v126, v153
 v_sub_f32 v154, v154, v10
 v_exp_f32 v154, v154
 s_nop 0
 v_add_f32 v126, v126, v154
 v_sub_f32 v155, v155, v10
 v_exp_f32 v155, v155
 s_nop 0
 v_add_f32 v126, v126, v155
 v_cvt_pk_bf16_f32 v186, v152, v153
 v_cvt_pk_bf16_f32 v187, v154, v155
 v_accvgpr_read_b32 v11, a8
 v_mul_f32 v11, v11, v166
 v_accvgpr_write_b32 a8, v11
 v_accvgpr_read_b32 v11, a9
 v_mul_f32 v11, v11, v166
 v_accvgpr_write_b32 a9, v11
 v_accvgpr_read_b32 v11, a10
 v_mul_f32 v11, v11, v166
 v_accvgpr_write_b32 a10, v11
 v_accvgpr_read_b32 v11, a11
 v_mul_f32 v11, v11, v166
 v_accvgpr_write_b32 a11, v11
 v_accvgpr_read_b32 v11, a24
 v_mul_f32 v11, v11, v166
 v_accvgpr_write_b32 a24, v11
 v_accvgpr_read_b32 v11, a25
 v_mul_f32 v11, v11, v166
 v_accvgpr_write_b32 a25, v11
 v_accvgpr_read_b32 v11, a26
 v_mul_f32 v11, v11, v166
 v_accvgpr_write_b32 a26, v11
 v_accvgpr_read_b32 v11, a27
 v_mul_f32 v11, v11, v166
 v_accvgpr_write_b32 a27, v11
 v_accvgpr_read_b32 v11, a40
 v_mul_f32 v11, v11, v166
 v_accvgpr_write_b32 a40, v11
 v_accvgpr_read_b32 v11, a41
 v_mul_f32 v11, v11, v166
 v_accvgpr_write_b32 a41, v11
 v_accvgpr_read_b32 v11, a42
 v_mul_f32 v11, v11, v166
 v_accvgpr_write_b32 a42, v11
 v_accvgpr_read_b32 v11, a43
 v_mul_f32 v11, v11, v166
 v_accvgpr_write_b32 a43, v11
 v_accvgpr_read_b32 v11, a56
 v_mul_f32 v11, v11, v166
 v_accvgpr_write_b32 a56, v11
 v_accvgpr_read_b32 v11, a57
 v_mul_f32 v11, v11, v166
 v_accvgpr_write_b32 a57, v11
 v_accvgpr_read_b32 v11, a58
 v_mul_f32 v11, v11, v166
 v_accvgpr_write_b32 a58, v11
 v_accvgpr_read_b32 v11, a59
 v_mul_f32 v11, v11, v166
 v_accvgpr_write_b32 a59, v11
 v_accvgpr_read_b32 v11, a72
 v_mul_f32 v11, v11, v166
 v_accvgpr_write_b32 a72, v11
 v_accvgpr_read_b32 v11, a73
 v_mul_f32 v11, v11, v166
 v_accvgpr_write_b32 a73, v11
 v_accvgpr_read_b32 v11, a74
 v_mul_f32 v11, v11, v166
 v_accvgpr_write_b32 a74, v11
 v_accvgpr_read_b32 v11, a75
 v_mul_f32 v11, v11, v166
 v_accvgpr_write_b32 a75, v11
 v_accvgpr_read_b32 v11, a88
 v_mul_f32 v11, v11, v166
 v_accvgpr_write_b32 a88, v11
 v_accvgpr_read_b32 v11, a89
 v_mul_f32 v11, v11, v166
 v_accvgpr_write_b32 a89, v11
 v_accvgpr_read_b32 v11, a90
 v_mul_f32 v11, v11, v166
 v_accvgpr_write_b32 a90, v11
 v_accvgpr_read_b32 v11, a91
 v_mul_f32 v11, v11, v166
 v_accvgpr_write_b32 a91, v11
 v_accvgpr_read_b32 v11, a104
 v_mul_f32 v11, v11, v166
 v_accvgpr_write_b32 a104, v11
 v_accvgpr_read_b32 v11, a105
 v_mul_f32 v11, v11, v166
 v_accvgpr_write_b32 a105, v11
 v_accvgpr_read_b32 v11, a106
 v_mul_f32 v11, v11, v166
 v_accvgpr_write_b32 a106, v11
 v_accvgpr_read_b32 v11, a107
 v_mul_f32 v11, v11, v166
 v_accvgpr_write_b32 a107, v11
 v_accvgpr_read_b32 v11, a120
 v_mul_f32 v11, v11, v166
 v_accvgpr_write_b32 a120, v11
 v_accvgpr_read_b32 v11, a121
 v_mul_f32 v11, v11, v166
 v_accvgpr_write_b32 a121, v11
 v_accvgpr_read_b32 v11, a122
 v_mul_f32 v11, v11, v166
 v_accvgpr_write_b32 a122, v11
 v_accvgpr_read_b32 v11, a123
 v_mul_f32 v11, v11, v166
 v_accvgpr_write_b32 a123, v11
 v_max3_f32 v10, v140, v141, v142
 v_max3_f32 v10, v10, v143, v156
 v_max3_f32 v10, v10, v157, v158
 v_max3_f32 v10, v10, v159, v163
 v_mov_b32 v11, v10
 s_nop 1
 v_permlane16_swap_b32 v11, v10
 v_max_f32 v10, v10, v11
 v_mov_b32 v11, v10
 s_nop 1
 v_permlane32_swap_b32 v11, v10
 v_max_f32 v10, v10, v11
 v_sub_f32 v167, v163, v10
 v_exp_f32 v167, v167
 v_mov_b32 v163, v10
 v_mul_f32 v127, v127, v167
 v_sub_f32 v140, v140, v10
 v_exp_f32 v140, v140
 s_nop 0
 v_add_f32 v127, v127, v140
 v_sub_f32 v141, v141, v10
 v_exp_f32 v141, v141
 s_nop 0
 v_add_f32 v127, v127, v141
 v_sub_f32 v142, v142, v10
 v_exp_f32 v142, v142
 s_nop 0
 v_add_f32 v127, v127, v142
 v_sub_f32 v143, v143, v10
 v_exp_f32 v143, v143
 s_nop 0
 v_add_f32 v127, v127, v143
 v_cvt_pk_bf16_f32 v188, v140, v141
 v_cvt_pk_bf16_f32 v189, v142, v143
 v_sub_f32 v156, v156, v10
 v_exp_f32 v156, v156
 s_nop 0
 v_add_f32 v127, v127, v156
 v_sub_f32 v157, v157, v10
 v_exp_f32 v157, v157
 s_nop 0
 v_add_f32 v127, v127, v157
 v_sub_f32 v158, v158, v10
 v_exp_f32 v158, v158
 s_nop 0
 v_add_f32 v127, v127, v158
 v_sub_f32 v159, v159, v10
 v_exp_f32 v159, v159
 s_nop 0
 v_add_f32 v127, v127, v159
 v_cvt_pk_bf16_f32 v190, v156, v157
 v_cvt_pk_bf16_f32 v191, v158, v159
 v_accvgpr_read_b32 v11, a12
 v_mul_f32 v11, v11, v167
 v_accvgpr_write_b32 a12, v11
 v_accvgpr_read_b32 v11, a13
 v_mul_f32 v11, v11, v167
 v_accvgpr_write_b32 a13, v11
 v_accvgpr_read_b32 v11, a14
 v_mul_f32 v11, v11, v167
 v_accvgpr_write_b32 a14, v11
 v_accvgpr_read_b32 v11, a15
 v_mul_f32 v11, v11, v167
 v_accvgpr_write_b32 a15, v11
 v_accvgpr_read_b32 v11, a28
 v_mul_f32 v11, v11, v167
 v_accvgpr_write_b32 a28, v11
 v_accvgpr_read_b32 v11, a29
 v_mul_f32 v11, v11, v167
 v_accvgpr_write_b32 a29, v11
 v_accvgpr_read_b32 v11, a30
 v_mul_f32 v11, v11, v167
 v_accvgpr_write_b32 a30, v11
 v_accvgpr_read_b32 v11, a31
 v_mul_f32 v11, v11, v167
 v_accvgpr_write_b32 a31, v11
 v_accvgpr_read_b32 v11, a44
 v_mul_f32 v11, v11, v167
 v_accvgpr_write_b32 a44, v11
 v_accvgpr_read_b32 v11, a45
 v_mul_f32 v11, v11, v167
 v_accvgpr_write_b32 a45, v11
 v_accvgpr_read_b32 v11, a46
 v_mul_f32 v11, v11, v167
 v_accvgpr_write_b32 a46, v11
 v_accvgpr_read_b32 v11, a47
 v_mul_f32 v11, v11, v167
 v_accvgpr_write_b32 a47, v11
 v_accvgpr_read_b32 v11, a60
 v_mul_f32 v11, v11, v167
 v_accvgpr_write_b32 a60, v11
 v_accvgpr_read_b32 v11, a61
 v_mul_f32 v11, v11, v167
 v_accvgpr_write_b32 a61, v11
 v_accvgpr_read_b32 v11, a62
 v_mul_f32 v11, v11, v167
 v_accvgpr_write_b32 a62, v11
 v_accvgpr_read_b32 v11, a63
 v_mul_f32 v11, v11, v167
 v_accvgpr_write_b32 a63, v11
 v_accvgpr_read_b32 v11, a76
 v_mul_f32 v11, v11, v167
 v_accvgpr_write_b32 a76, v11
 v_accvgpr_read_b32 v11, a77
 v_mul_f32 v11, v11, v167
 v_accvgpr_write_b32 a77, v11
 v_accvgpr_read_b32 v11, a78
 v_mul_f32 v11, v11, v167
 v_accvgpr_write_b32 a78, v11
 v_accvgpr_read_b32 v11, a79
 v_mul_f32 v11, v11, v167
 v_accvgpr_write_b32 a79, v11
 v_accvgpr_read_b32 v11, a92
 v_mul_f32 v11, v11, v167
 v_accvgpr_write_b32 a92, v11
 v_accvgpr_read_b32 v11, a93
 v_mul_f32 v11, v11, v167
 v_accvgpr_write_b32 a93, v11
 v_accvgpr_read_b32 v11, a94
 v_mul_f32 v11, v11, v167
 v_accvgpr_write_b32 a94, v11
 v_accvgpr_read_b32 v11, a95
 v_mul_f32 v11, v11, v167
 v_accvgpr_write_b32 a95, v11
 v_accvgpr_read_b32 v11, a108
 v_mul_f32 v11, v11, v167
 v_accvgpr_write_b32 a108, v11
 v_accvgpr_read_b32 v11, a109
 v_mul_f32 v11, v11, v167
 v_accvgpr_write_b32 a109, v11
 v_accvgpr_read_b32 v11, a110
 v_mul_f32 v11, v11, v167
 v_accvgpr_write_b32 a110, v11
 v_accvgpr_read_b32 v11, a111
 v_mul_f32 v11, v11, v167
 v_accvgpr_write_b32 a111, v11
 v_accvgpr_read_b32 v11, a124
 v_mul_f32 v11, v11, v167
 v_accvgpr_write_b32 a124, v11
 v_accvgpr_read_b32 v11, a125
 v_mul_f32 v11, v11, v167
 v_accvgpr_write_b32 a125, v11
 v_accvgpr_read_b32 v11, a126
 v_mul_f32 v11, v11, v167
 v_accvgpr_write_b32 a126, v11
 v_accvgpr_read_b32 v11, a127
 v_mul_f32 v11, v11, v167
 v_accvgpr_write_b32 a127, v11
 s_nop 1
 s_waitcnt lgkmcnt(14)
 v_mfma_f32_16x16x32_bf16 a[0:3], v[208:211], v[176:179], a[0:3]
 v_mfma_f32_16x16x32_bf16 a[4:7], v[208:211], v[180:183], a[4:7]
 v_mfma_f32_16x16x32_bf16 a[8:11], v[208:211], v[184:187], a[8:11]
 v_mfma_f32_16x16x32_bf16 a[12:15], v[208:211], v[188:191], a[12:15]
 s_waitcnt lgkmcnt(12)
 v_mfma_f32_16x16x32_bf16 a[16:19], v[212:215], v[176:179], a[16:19]
 v_mfma_f32_16x16x32_bf16 a[20:23], v[212:215], v[180:183], a[20:23]
 v_mfma_f32_16x16x32_bf16 a[24:27], v[212:215], v[184:187], a[24:27]
 v_mfma_f32_16x16x32_bf16 a[28:31], v[212:215], v[188:191], a[28:31]
 s_waitcnt lgkmcnt(10)
 v_mfma_f32_16x16x32_bf16 a[32:35], v[216:219], v[176:179], a[32:35]
 v_mfma_f32_16x16x32_bf16 a[36:39], v[216:219], v[180:183], a[36:39]
 v_mfma_f32_16x16x32_bf16 a[40:43], v[216:219], v[184:187], a[40:43]
 v_mfma_f32_16x16x32_bf16 a[44:47], v[216:219], v[188:191], a[44:47]
 s_waitcnt lgkmcnt(8)
 v_mfma_f32_16x16x32_bf16 a[48:51], v[220:223], v[176:179], a[48:51]
 v_mfma_f32_16x16x32_bf16 a[52:55], v[220:223], v[180:183], a[52:55]
 v_mfma_f32_16x16x32_bf16 a[56:59], v[220:223], v[184:187], a[56:59]
 v_mfma_f32_16x16x32_bf16 a[60:63], v[220:223], v[188:191], a[60:63]
 s_waitcnt lgkmcnt(6)
 v_mfma_f32_16x16x32_bf16 a[64:67], v[224:227], v[176:179], a[64:67]
 v_mfma_f32_16x16x32_bf16 a[68:71], v[224:227], v[180:183], a[68:71]
 v_mfma_f32_16x16x32_bf16 a[72:75], v[224:227], v[184:187], a[72:75]
 v_mfma_f32_16x16x32_bf16 a[76:79], v[224:227], v[188:191], a[76:79]
 s_waitcnt lgkmcnt(4)
 v_mfma_f32_16x16x32_bf16 a[80:83], v[228:231], v[176:179], a[80:83]
 v_mfma_f32_16x16x32_bf16 a[84:87], v[228:231], v[180:183], a[84:87]
 v_mfma_f32_16x16x32_bf16 a[88:91], v[228:231], v[184:187], a[88:91]
 v_mfma_f32_16x16x32_bf16 a[92:95], v[228:231], v[188:191], a[92:95]
 s_waitcnt lgkmcnt(2)
 v_mfma_f32_16x16x32_bf16 a[96:99], v[232:235], v[176:179], a[96:99]
 v_mfma_f32_16x16x32_bf16 a[100:103], v[232:235], v[180:183], a[100:103]
 v_mfma_f32_16x16x32_bf16 a[104:107], v[232:235], v[184:187], a[104:107]
 v_mfma_f32_16x16x32_bf16 a[108:111], v[232:235], v[188:191], a[108:111]
 s_waitcnt lgkmcnt(0)
 v_mfma_f32_16x16x32_bf16 a[112:115], v[236:239], v[176:179], a[112:115]
 v_mfma_f32_16x16x32_bf16 a[116:119], v[236:239], v[180:183], a[116:119]
 v_mfma_f32_16x16x32_bf16 a[120:123], v[236:239], v[184:187], a[120:123]
 v_mfma_f32_16x16x32_bf16 a[124:127], v[236:239], v[188:191], a[124:127]
 s_nop 7
 s_add_u32 s76, s76, 8192
 s_cmp_lt_u32 s76, 524288
 s_cbranch_scc1 L_slow_loop
 v_mov_b32 v10, v124
 s_nop 1
 v_permlane16_swap_b32 v10, v124
 v_add_f32 v124, v124, v10
 v_mov_b32 v10, v124
 s_nop 1
 v_permlane32_swap_b32 v10, v124
 v_add_f32 v124, v124, v10
 v_rcp_f32 v240, v124
 v_mov_b32 v10, v125
 s_nop 1
 v_permlane16_swap_b32 v10, v125
 v_add_f32 v125, v125, v10
 v_mov_b32 v10, v125
 s_nop 1
 v_permlane32_swap_b32 v10, v125
 v_add_f32 v125, v125, v10
 v_rcp_f32 v241, v125
 v_mov_b32 v10, v126
 s_nop 1
 v_permlane16_swap_b32 v10, v126
 v_add_f32 v126, v126, v10
 v_mov_b32 v10, v126
 s_nop 1
 v_permlane32_swap_b32 v10, v126
 v_add_f32 v126, v126, v10
 v_rcp_f32 v242, v126
 v_mov_b32 v10, v127
 s_nop 1
 v_permlane16_swap_b32 v10, v127
 v_add_f32 v127, v127, v10
 v_mov_b32 v10, v127
 s_nop 1
 v_permlane32_swap_b32 v10, v127
 v_add_f32 v127, v127, v10
 v_rcp_f32 v243, v127
 s_nop 0
 s_and_b32 s92, s80, 1
 s_lshl2_add_u32 s83, s81, s82
 s_lshl_b32 s99, s83, 7
 s_lshl2_add_u32 s83, s83, s80
 s_lshl2_add_u32 s83, s83, s52
 s_mul_i32 s95, s83, 16384
 s_lshr_b32 s83, s81, 1
 s_lshl_b32 s83, s83, 7
 s_lshl_b32 s84, s80, 5
 s_add_u32 s98, s83, s84
 s_add_u32 s98, s98, 8192
 s_lshl_b32 s83, s81, 7
 s_lshl_b32 s84, s52, 5
 s_add_u32 s83, s83, s84
 s_lshr_b32 s84, s80, 1
 s_lshl4_add_u32 s83, s84, s83
 v_and_b32 v24, 15, v1
 v_add_u32 v24, s83, v24
 v_mul_u32_u24 v24, 1152, v24
 v_lshrrev_b32 v25, 4, v1
 v_lshl_add_u32 v24, v25, 3, v24
 s_mul_i32 s83, s82, 288
 s_mul_i32 s84, s92, 160
 s_add_u32 s83, s83, s84
 v_add_u32 v8, s83, v24
 v_lshlrev_b32 v9, 3, v1
 v_and_b32 v29, 3, v1
 v_lshlrev_b32 v29, 2, v29
 s_mul_i32 s84, s92, 5120
 v_add_u32 v3, s84, v2
 v_mov_b32 v4, v2
 s_sub_u32 s84, 5120, s84
 v_add_u32 v5, s84, v2
 s_waitcnt vmcnt(0)
 s_barrier
 ds_read_b128 v[32:35], v3 offset:0
 ds_read_b128 v[36:39], v3 offset:9216
 ds_read_b128 v[40:43], v3 offset:18432
 ds_read_b128 v[44:47], v3 offset:27648
 ds_read_b128 v[48:51], v3 offset:1024
 ds_read_b128 v[52:55], v3 offset:10240
 ds_read_b128 v[56:59], v3 offset:19456
 ds_read_b128 v[60:63], v3 offset:28672
 s_waitcnt lgkmcnt(0)
 s_branch L_fin_join
 s_endpgm
.section .rodata,"a"
.p2align 6
.amdhsa_kernel recurrent_scan__mha_block_cached__swiglu_ffn__prompt_kernel
  .amdhsa_next_free_vgpr 512
  .amdhsa_next_free_sgpr 102
  .amdhsa_accum_offset 256
  .amdhsa_group_segment_fixed_size 0
  .amdhsa_kernarg_size 96
  .amdhsa_user_sgpr_count 2
  .amdhsa_user_sgpr_kernarg_segment_ptr 1
  .amdhsa_system_sgpr_workgroup_id_x 1
  .amdhsa_float_denorm_mode_32 3
.end_amdhsa_kernel
```
